```python
import torch

def _softmax(x, axis=-1):
    return torch.softmax(x, dim=axis)

def _gelu(x):
    return torch.nn.functional.gelu(x, approximate='tanh')

def _silu(x):
    return torch.nn.functional.silu(x)

def _sigmoid(x):
    return torch.sigmoid(x)

def _layernorm(x, axis=-1, eps=1e-05):
    m = x.mean(dim=axis, keepdim=True)
    v = x.var(dim=axis, keepdim=True, unbiased=False)
    return (x - m) / torch.sqrt(v + eps)

def _scatter_add(tgt, idx, src, axis=0):
    return tgt.clone().index_add_(axis, idx, src)

def _segment_sum(src, seg, n):
    out = torch.zeros((n,) + src.shape[1:], dtype=src.dtype)
    return out.index_add_(0, seg, src)

def _pad(x, pw):
    flat = tuple((v for pair in reversed(pw) for v in pair))
    return torch.nn.functional.pad(x, flat)
kernel_name = 'parallel_sum__memory_aug_recurrent_mem_tr__dense_activation_silu__prompt'

def setup_inputs():

    _w = lambda a: (lambda t: t.to(torch.bfloat16) if t.is_floating_point() else t)(torch.as_tensor(a))

    def _A_setup():
        B, S, Dm = (1, 2048, 1024)
        H, Dh = (32, 128)
        M, seg = (8, 32)
        seg = min(seg, S)
        S = S // seg * seg
        return {'x': _w((lambda *s: torch.randn(*s, dtype=torch.bfloat16) * 0.05)(B, S, Dm)), 'mem0': _w((lambda *s: torch.randn(*s, dtype=torch.bfloat16) * 0.2)(B, M, Dm)), 'Wq': _w((lambda *s: torch.randn(*s, dtype=torch.bfloat16) * 1.6)(Dm, H, Dh) * Dm ** (-0.5)), 'Wk': _w((lambda *s: torch.randn(*s, dtype=torch.bfloat16) * 1.6)(Dm, H, Dh) * Dm ** (-0.5)), 'Wv': _w((lambda *s: torch.randn(*s, dtype=torch.bfloat16) * 0.2)(Dm, H, Dh) * Dm ** (-0.5)), 'Wo': _w((lambda *s: torch.randn(*s, dtype=torch.bfloat16) * 0.2)(H, Dh, Dm) * (H * Dh) ** (-0.5)), 'seg_len': seg}
    _A_in = _A_setup()

    def _B_setup():
        B, S, D, F = (1, 2048, 1024, 3584)
        return {'x': _w((lambda *s: torch.randn(*s, dtype=torch.bfloat16) * 0.05)(B, S, D)), 'w1': _w((lambda *s: torch.randn(*s, dtype=torch.bfloat16) * 0.8)(D, F) * D ** (-0.5)), 'w2': _w((lambda *s: torch.randn(*s, dtype=torch.bfloat16) * 0.1)(F, D) * F ** (-0.5))}
    _B_in = _B_setup()
    return {'A_x': _A_in['x'], 'A_mem0': _A_in['mem0'], 'A_Wq': _A_in['Wq'], 'A_Wk': _A_in['Wk'], 'A_Wv': _A_in['Wv'], 'A_Wo': _A_in['Wo'], 'A_seg_len': _A_in['seg_len'], 'B_x': _B_in['x'], 'B_w1': _B_in['w1'], 'B_w2': _B_in['w2']}

def reference(A_x, A_mem0, A_Wq, A_Wk, A_Wv, A_Wo, A_seg_len, B_x, B_w1, B_w2):

    def _A_ref(x, mem0, Wq, Wk, Wv, Wo, seg_len):
        B, S, Dm = x.shape
        H, Dh = (Wq.shape[1], Wq.shape[2])
        M = mem0.shape[1]
        scale = Dh ** (-0.5)
        n_seg = S // seg_len
        L = M + seg_len
        idx = torch.arange(L)
        mask = (idx[:, None] < M) | (idx[:, None] >= idx[None, :])
        mem = mem0
        outs = []
        for s in range(n_seg):
            xs = x[:, s * seg_len:(s + 1) * seg_len, :].clone()
            h = torch.concatenate([mem, xs], axis=1)
            q = torch.einsum('btd,dhe->bhte', h, Wq)
            k = torch.einsum('btd,dhe->bhte', h, Wk)
            v = torch.einsum('btd,dhe->bhte', h, Wv)
            scores = torch.einsum('bhqe,bhke->bhqk', q, k) * scale
            scores = torch.where(mask[None, None], scores, -1000000000.0)
            p = _softmax(scores, axis=-1)
            o = torch.einsum('bhqk,bhke->bhqe', p, v)
            o = torch.einsum('bhte,hed->btd', o, Wo)
            mem = o[:, :M, :].clone()
            outs.append(o[:, M:, :])
        return torch.concatenate(outs, axis=1)

    def _B_ref(x, w1, w2):
        h = torch.einsum('bsd,df->bsf', x, w1)
        h = _silu(h)
        out = torch.einsum('bsf,fd->bsd', h, w2)
        return out
    x = A_x
    xn = _layernorm(x, axis=-1)
    return x + _A_ref(xn, A_mem0, A_Wq, A_Wk, A_Wv, A_Wo, A_seg_len) + _B_ref(xn, B_w1, B_w2)
```

```asm
; @launch grid=(256,1,1) block=(256,1,1) lds=163840
.amdgcn_target "amdgcn-amd-amdhsa--gfx950"
.text
.globl parallel_sum__memory_aug_recurrent_mem_tr__dense_activation_silu__prompt_kernel
.p2align 8
.type parallel_sum__memory_aug_recurrent_mem_tr__dense_activation_silu__prompt_kernel,@function
parallel_sum__memory_aug_recurrent_mem_tr__dense_activation_silu__prompt_kernel:
    s_cmp_ge_u32 s2, 256
    s_cbranch_scc1 EXIT
    s_load_dwordx16 s[16:31], s[0:1], 0
    s_load_dwordx8 s[32:39], s[0:1], 64
    s_load_dwordx2 s[40:41], s[0:1], 96
    s_getreg_b32 s42, hwreg(HW_REG_XCC_ID, 0, 4)
    v_lshrrev_b32 v1, 6, v0
    s_nop 0
    v_readfirstlane_b32 s44, v1
    s_waitcnt lgkmcnt(0)
    s_mov_b32 s4, s40
    s_and_b32 s5, s41, 0xffff
    s_mov_b32 s6, 0x10000000
    s_mov_b32 s7, 0x20000
    s_mov_b32 s8, s38
    s_and_b32 s9, s39, 0xffff
    s_mov_b32 s10, 0x100
    s_mov_b32 s11, 0x20000
    s_lshr_b32 s43, s2, 3
    v_mov_b32 v126, 0
    s_cmp_lg_u32 s44, 0
    s_cbranch_scc1 CALIB
    s_add_u32 s57, s42, 0
    s_min_u32 s57, s57, 8
    s_lshl_b32 s57, s57, 2
    s_lshl_b32 s58, 1, s43
    s_mov_b64 exec, 1
    v_mov_b32 v126, s58
    buffer_atomic_or v126, off, s[8:11], s57 sc0 sc1
    s_mov_b64 exec, -1
    s_branch RESTART
CALIB:
    s_cmp_lg_u32 s42, 0
    s_cbranch_scc1 RESTART
    s_lshl_b32 s56, s44, 14
    s_add_u32 s56, s56, 0x7000000
    buffer_load_dword v12, off, s[4:7], s56 offset:1024
RESTART:
    s_mov_b32 s12, s16
    s_and_b32 s13, s17, 0xffff
    s_mov_b32 s14, 0x400000
    s_mov_b32 s15, 0x20000
    s_sub_u32 s2, s42, 2
    s_and_b32 s2, s2, 7
    s_xor_b32 s56, s2, 2
    s_cmp_lt_u32 s2, 4
    s_cselect_b32 s2, s56, s2
    s_lshl_b32 s2, s2, 5
    s_add_u32 s2, s2, s43
    s_or_b32 s56, s42, s43
    s_cbranch_scc1 nocal_1
    s_waitcnt vmcnt(0)
    s_lshl_b32 s56, s44, 2
    v_mov_b32 v2, s56
    s_mov_b64 exec, 1
    ds_write_b32 v2, v126
    s_mov_b64 exec, -1
    v_mov_b32 v2, 0
    s_waitcnt lgkmcnt(0)
    s_barrier
    ds_read_b32 v2, v2
    s_waitcnt lgkmcnt(0)
    v_readfirstlane_b32 s56, v2
    s_bitcmp1_b32 s56, 0
    s_cbranch_scc1 nocal_1
    s_lshl_b32 s56, s44, 14
    s_add_u32 s56, s56, 0x7000000
    s_lshr_b32 s58, s44, 1
    s_lshl_b32 s58, s58, 13
    s_xor_b32 s56, s56, s58
    s_xor_b32 s57, s56, 0x2000
    s_mov_b64 exec, 1
    s_waitcnt vmcnt(0)
    s_memtime s[64:65]
    s_waitcnt lgkmcnt(0)
    buffer_store_dword v1, off, s[4:7], s56 sc1
    s_waitcnt vmcnt(0)
    s_memtime s[66:67]
    s_waitcnt lgkmcnt(0)
    buffer_store_dword v1, off, s[4:7], s57 sc1
    s_waitcnt vmcnt(0)
    s_memtime s[68:69]
    s_waitcnt lgkmcnt(0)
    s_sub_u32 s64, s66, s64
    s_sub_u32 s66, s68, s66
    s_cmp_eq_u32 s58, 0
    s_cselect_b32 s65, s64, s66
    s_cselect_b32 s66, s66, s64
    v_mov_b32 v2, s65
    v_mov_b32 v3, s66
    s_lshl_b32 s56, s44, 3
    v_mov_b32 v4, s56
    ds_write_b64 v4, v[2:3] offset:16
    s_waitcnt lgkmcnt(0)
    s_barrier
    v_mov_b32 v2, 0
    ds_read_b128 v[4:7], v2 offset:16
    ds_read_b128 v[8:11], v2 offset:32
    s_waitcnt lgkmcnt(0)
    v_min3_u32 v4, v4, v6, v8
    v_min3_u32 v5, v5, v7, v9
    v_min_u32 v4, v4, v10
    v_min_u32 v5, v5, v11
    v_cmp_lt_u32 vcc, v5, v4
    s_nop 1
    v_cndmask_b32 v2, 1, 2, vcc
    v_mov_b32 v3, v5
    s_cmp_lg_u32 s44, 0
    s_cbranch_scc1 nocal_1_x
    buffer_store_dwordx3 v[2:4], off, s[8:11], 0 offset:40 sc1
nocal_1_x:
    s_mov_b64 exec, -1
nocal_1:
    v_and_b32 v61, 63, v0
    v_and_b32 v60, 7, v61
    v_lshlrev_b32 v60, 11, v60
    v_lshrrev_b32 v62, 4, v61
    v_lshl_add_u32 v60, v62, 5, v60
    v_and_b32 v62, 8, v61
    v_add_u32 v60, v60, v62
    s_lshl_b32 s56, s2, 14
    s_lshl_b32 s57, s44, 9
    s_add_u32 s56, s56, s57
    buffer_load_dwordx2 v[64:65], v60, s[12:15], s56 offen offset:0
    buffer_load_dwordx2 v[66:67], v60, s[12:15], s56 offen offset:16
    buffer_load_dwordx2 v[68:69], v60, s[12:15], s56 offen offset:128
    buffer_load_dwordx2 v[70:71], v60, s[12:15], s56 offen offset:144
    buffer_load_dwordx2 v[72:73], v60, s[12:15], s56 offen offset:256
    buffer_load_dwordx2 v[74:75], v60, s[12:15], s56 offen offset:272
    buffer_load_dwordx2 v[76:77], v60, s[12:15], s56 offen offset:384
    buffer_load_dwordx2 v[78:79], v60, s[12:15], s56 offen offset:400
    s_cmp_ge_u32 s42, 2
    s_cbranch_scc1 WORKER
    v_and_b32 v112, 63, v0
    v_lshrrev_b32 v113, 5, v112
    s_and_b32 s58, s44, 1
    s_lshl_b32 s58, s58, 1
    v_add_u32 v113, s58, v113
    v_lshlrev_b32 v113, 1, v113
    v_and_b32 v114, 7, v112
    v_xor_b32 v113, v113, v114
    v_lshlrev_b32 v113, 4, v113
    v_lshrrev_b32 v114, 3, v112
    v_lshl_add_u32 v119, v114, 13, v113
    s_lshl_b32 s58, s44, 16
    s_lshl_b32 s59, s42, 12
    s_add_u32 s58, s58, s59
    s_lshl_b32 s59, s43, 7
    s_add_u32 s58, s58, s59
    v_add_u32 v119, s58, v119
    s_lshl_b32 s64, s44, 10
    s_add_u32 s64, s64, 32768
    v_bfe_u32 v113, v112, 2, 2
    v_and_b32 v114, 1, v112
    v_lshl_add_u32 v113, v113, 1, v114
    v_lshlrev_b32 v113, 11, v113
    v_lshrrev_b32 v114, 4, v112
    v_lshl_add_u32 v113, v114, 5, v113
    v_bfe_u32 v114, v112, 1, 1
    v_lshl_add_u32 v113, v114, 4, v113
    s_lshl_b32 s59, s44, 9
    v_add_u32 v113, s59, v113
    s_mov_b32 s80, s18
    s_and_b32 s81, s19, 0xffff
    s_mov_b32 s82, 0x4000
    s_mov_b32 s83, 0x20000
    buffer_load_dwordx4 v[36:39], v113, s[80:83], 0 offen offset:0
    buffer_load_dwordx4 v[40:43], v113, s[80:83], 0 offen offset:128
    buffer_load_dwordx4 v[44:47], v113, s[80:83], 0 offen offset:256
    buffer_load_dwordx4 v[120:123], v113, s[80:83], 0 offen offset:384
    s_mov_b32 s12, s20
    s_and_b32 s13, s21, 0xffff
    s_mov_b32 s14, 0x800000
    s_mov_b32 s15, 0x20000
    s_add_u32 m0, s64, 0
    s_mov_b32 s65, 0x0
    buffer_load_dwordx4 v119, s[12:15], s65 offen lds
    s_add_u32 m0, s64, 4096
    s_mov_b32 s65, 0x40000
    buffer_load_dwordx4 v119, s[12:15], s65 offen lds
    s_add_u32 m0, s64, 65536
    s_mov_b32 s65, 0x400000
    buffer_load_dwordx4 v119, s[12:15], s65 offen lds
    s_add_u32 m0, s64, 69632
    s_mov_b32 s65, 0x440000
    buffer_load_dwordx4 v119, s[12:15], s65 offen lds
    s_add_u32 m0, s64, 8192
    s_mov_b32 s65, 0x80000
    buffer_load_dwordx4 v119, s[12:15], s65 offen lds
    s_add_u32 m0, s64, 12288
    s_mov_b32 s65, 0xc0000
    buffer_load_dwordx4 v119, s[12:15], s65 offen lds
    s_add_u32 m0, s64, 73728
    s_mov_b32 s65, 0x480000
    buffer_load_dwordx4 v119, s[12:15], s65 offen lds
    s_add_u32 m0, s64, 77824
    s_mov_b32 s65, 0x4c0000
    buffer_load_dwordx4 v119, s[12:15], s65 offen lds
    s_add_u32 m0, s64, 16384
    s_mov_b32 s65, 0x100000
    buffer_load_dwordx4 v119, s[12:15], s65 offen lds
    s_add_u32 m0, s64, 20480
    s_mov_b32 s65, 0x140000
    buffer_load_dwordx4 v119, s[12:15], s65 offen lds
    s_add_u32 m0, s64, 81920
    s_mov_b32 s65, 0x500000
    buffer_load_dwordx4 v119, s[12:15], s65 offen lds
    s_add_u32 m0, s64, 86016
    s_mov_b32 s65, 0x540000
    buffer_load_dwordx4 v119, s[12:15], s65 offen lds
    s_add_u32 m0, s64, 24576
    s_mov_b32 s65, 0x180000
    buffer_load_dwordx4 v119, s[12:15], s65 offen lds
    s_add_u32 m0, s64, 28672
    s_mov_b32 s65, 0x1c0000
    buffer_load_dwordx4 v119, s[12:15], s65 offen lds
    s_add_u32 m0, s64, 90112
    s_mov_b32 s65, 0x580000
    buffer_load_dwordx4 v119, s[12:15], s65 offen lds
    s_add_u32 m0, s64, 94208
    s_mov_b32 s65, 0x5c0000
    buffer_load_dwordx4 v119, s[12:15], s65 offen lds
    v_and_b32 v58, 7, v61
    v_lshlrev_b32 v58, 4, v58
    s_lshl_b32 s57, s44, 2
    v_add_u32 v59, s57, v58
    s_waitcnt vmcnt(20)
    s_cmp_lg_u32 s44, 0
    s_cbranch_scc1 clm_2_x
    s_mov_b32 s59, s43
clm_2:
    v_readfirstlane_b32 s56, v126
    s_bitcmp1_b32 s56, s59
    s_cbranch_scc0 clm_2_ok
    s_mov_b32 s59, 32
    s_cmp_eq_u32 s56, -1
    s_cbranch_scc1 clm_2_ok
    s_ff0_i32_b32 s59, s56
    s_add_u32 s57, s42, 0
    s_min_u32 s57, s57, 8
    s_lshl_b32 s57, s57, 2
    s_lshl_b32 s58, 1, s59
    s_mov_b64 exec, 1
    v_mov_b32 v126, s58
    buffer_atomic_or v126, off, s[8:11], s57 sc0 sc1
    s_mov_b64 exec, -1
    s_waitcnt vmcnt(0)
    s_branch clm_2
clm_2_ok:
    v_mov_b32 v52, s59
    v_mov_b32 v53, 0
    ds_write_b32 v53, v52 offset:48
clm_2_x:
    s_add_u32 m0, s64, 32768
    s_mov_b32 s65, 0x200000
    buffer_load_dwordx4 v119, s[12:15], s65 offen lds
    v_lshlrev_b32 v80, 16, v64
    v_and_b32 v81, 0xffff0000, v64
    v_lshlrev_b32 v82, 16, v65
    v_and_b32 v83, 0xffff0000, v65
    v_lshlrev_b32 v84, 16, v66
    v_and_b32 v85, 0xffff0000, v66
    v_lshlrev_b32 v86, 16, v67
    v_and_b32 v87, 0xffff0000, v67
    v_lshlrev_b32 v88, 16, v68
    v_and_b32 v89, 0xffff0000, v68
    v_lshlrev_b32 v90, 16, v69
    v_and_b32 v91, 0xffff0000, v69
    v_lshlrev_b32 v92, 16, v70
    v_and_b32 v93, 0xffff0000, v70
    v_lshlrev_b32 v94, 16, v71
    v_and_b32 v95, 0xffff0000, v71
    v_lshlrev_b32 v96, 16, v72
    v_and_b32 v97, 0xffff0000, v72
    v_lshlrev_b32 v98, 16, v73
    v_and_b32 v99, 0xffff0000, v73
    v_lshlrev_b32 v100, 16, v74
    v_and_b32 v101, 0xffff0000, v74
    v_lshlrev_b32 v102, 16, v75
    v_and_b32 v103, 0xffff0000, v75
    v_lshlrev_b32 v104, 16, v76
    v_and_b32 v105, 0xffff0000, v76
    v_lshlrev_b32 v106, 16, v77
    v_and_b32 v107, 0xffff0000, v77
    v_lshlrev_b32 v108, 16, v78
    v_and_b32 v109, 0xffff0000, v78
    s_add_u32 m0, s64, 36864
    s_mov_b32 s65, 0x240000
    buffer_load_dwordx4 v119, s[12:15], s65 offen lds
    v_lshlrev_b32 v110, 16, v79
    v_and_b32 v111, 0xffff0000, v79
    v_add_f32 v52, v80, v84
    v_add_f32 v53, v81, v85
    v_add_f32 v54, v82, v86
    v_add_f32 v55, v83, v87
    v_add_f32 v52, v52, v88
    v_add_f32 v53, v53, v89
    v_add_f32 v54, v54, v90
    v_add_f32 v55, v55, v91
    v_add_f32 v52, v52, v92
    v_add_f32 v53, v53, v93
    v_add_f32 v54, v54, v94
    v_add_f32 v55, v55, v95
    v_add_f32 v52, v52, v96
    v_add_f32 v53, v53, v97
    v_add_f32 v54, v54, v98
    v_add_f32 v55, v55, v99
    v_add_f32 v52, v52, v100
    v_add_f32 v53, v53, v101
    v_add_f32 v54, v54, v102
    v_add_f32 v55, v55, v103
    v_add_f32 v52, v52, v104
    v_add_f32 v53, v53, v105
    v_add_f32 v54, v54, v106
    v_add_f32 v55, v55, v107
    v_add_f32 v52, v52, v108
    v_add_f32 v53, v53, v109
    v_add_f32 v54, v54, v110
    v_add_f32 v55, v55, v111
    s_add_u32 m0, s64, 98304
    s_mov_b32 s65, 0x600000
    buffer_load_dwordx4 v119, s[12:15], s65 offen lds
    v_add_f32 v52, v52, v53
    v_add_f32 v54, v54, v55
    v_add_f32 v56, v52, v54
    s_nop 1
    v_add_f32_dpp v56, v56, v56 row_ror:8 row_mask:0xf bank_mask:0xf
    v_mov_b32 v57, v56
    s_nop 1
    v_permlane16_swap_b32 v56, v57
    v_add_f32 v56, v56, v57
    v_mov_b32 v57, v56
    s_nop 1
    v_permlane32_swap_b32 v56, v57
    v_add_f32 v56, v56, v57
    ds_write_b32 v59, v56 offset:64
    s_waitcnt lgkmcnt(0)
    s_barrier
    ds_read_b128 v[52:55], v58 offset:64
    v_mov_b32 v57, 0
    ds_read_b32 v57, v57 offset:48
    s_waitcnt lgkmcnt(0)
    v_readfirstlane_b32 s59, v57
    s_cmp_eq_u32 s59, s43
    s_cbranch_scc1 keep_3
    s_waitcnt vmcnt(0)
    s_barrier
    s_cmp_ge_u32 s59, 32
    s_cbranch_scc1 EXIT
    s_mov_b32 s43, s59
    s_add_u32 s42, s42, 0
    v_mov_b32 v126, 0
    s_branch RESTART
keep_3:
    v_add_f32 v52, v52, v53
    v_add_f32 v54, v54, v55
    v_add_f32 v56, v52, v54
    v_mul_f32 v56, 0x3a800000, v56
    v_cvt_pk_bf16_f32 v50, v56, v56
    v_and_b32 v50, 0xffff0000, v50
    v_sub_f32 v64, v80, v56
    v_mul_f32 v52, v64, v64
    v_sub_f32 v65, v81, v56
    v_mul_f32 v53, v65, v65
    v_sub_f32 v66, v82, v56
    v_mul_f32 v54, v66, v66
    v_sub_f32 v67, v83, v56
    v_mul_f32 v55, v67, v67
    v_sub_f32 v68, v84, v56
    v_fmac_f32 v52, v68, v68
    v_sub_f32 v69, v85, v56
    v_fmac_f32 v53, v69, v69
    v_sub_f32 v70, v86, v56
    s_add_u32 m0, s64, 102400
    s_mov_b32 s65, 0x640000
    buffer_load_dwordx4 v119, s[12:15], s65 offen lds
    v_fmac_f32 v54, v70, v70
    v_sub_f32 v71, v87, v56
    v_fmac_f32 v55, v71, v71
    v_sub_f32 v64, v88, v56
    v_fmac_f32 v52, v64, v64
    v_sub_f32 v65, v89, v56
    v_fmac_f32 v53, v65, v65
    v_sub_f32 v66, v90, v56
    v_fmac_f32 v54, v66, v66
    v_sub_f32 v67, v91, v56
    v_fmac_f32 v55, v67, v67
    v_sub_f32 v68, v92, v56
    v_fmac_f32 v52, v68, v68
    v_sub_f32 v69, v93, v56
    v_fmac_f32 v53, v69, v69
    v_sub_f32 v70, v94, v56
    v_fmac_f32 v54, v70, v70
    v_sub_f32 v71, v95, v56
    v_fmac_f32 v55, v71, v71
    v_sub_f32 v64, v96, v56
    v_fmac_f32 v52, v64, v64
    v_sub_f32 v65, v97, v56
    v_fmac_f32 v53, v65, v65
    v_sub_f32 v66, v98, v56
    v_fmac_f32 v54, v66, v66
    v_sub_f32 v67, v99, v56
    v_fmac_f32 v55, v67, v67
    v_sub_f32 v68, v100, v56
    v_fmac_f32 v52, v68, v68
    v_sub_f32 v69, v101, v56
    s_add_u32 m0, s64, 40960
    s_mov_b32 s65, 0x280000
    buffer_load_dwordx4 v119, s[12:15], s65 offen lds
    v_fmac_f32 v53, v69, v69
    v_sub_f32 v70, v102, v56
    v_fmac_f32 v54, v70, v70
    v_sub_f32 v71, v103, v56
    v_fmac_f32 v55, v71, v71
    v_sub_f32 v64, v104, v56
    v_fmac_f32 v52, v64, v64
    v_sub_f32 v65, v105, v56
    v_fmac_f32 v53, v65, v65
    v_sub_f32 v66, v106, v56
    v_fmac_f32 v54, v66, v66
    v_sub_f32 v67, v107, v56
    v_fmac_f32 v55, v67, v67
    v_sub_f32 v68, v108, v56
    v_fmac_f32 v52, v68, v68
    v_sub_f32 v69, v109, v56
    v_fmac_f32 v53, v69, v69
    v_sub_f32 v70, v110, v56
    v_fmac_f32 v54, v70, v70
    v_sub_f32 v71, v111, v56
    v_fmac_f32 v55, v71, v71
    v_add_f32 v52, v52, v53
    v_add_f32 v54, v54, v55
    v_add_f32 v56, v52, v54
    v_sub_f32 v80, v80, v50
    v_sub_f32 v81, v81, v50
    v_sub_f32 v82, v82, v50
    v_sub_f32 v83, v83, v50
    v_sub_f32 v84, v84, v50
    v_sub_f32 v85, v85, v50
    v_sub_f32 v86, v86, v50
    s_add_u32 m0, s64, 45056
    s_mov_b32 s65, 0x2c0000
    buffer_load_dwordx4 v119, s[12:15], s65 offen lds
    v_sub_f32 v87, v87, v50
    v_sub_f32 v88, v88, v50
    v_sub_f32 v89, v89, v50
    v_sub_f32 v90, v90, v50
    v_sub_f32 v91, v91, v50
    v_sub_f32 v92, v92, v50
    v_sub_f32 v93, v93, v50
    v_sub_f32 v94, v94, v50
    v_sub_f32 v95, v95, v50
    v_sub_f32 v96, v96, v50
    v_sub_f32 v97, v97, v50
    v_sub_f32 v98, v98, v50
    v_sub_f32 v99, v99, v50
    v_sub_f32 v100, v100, v50
    v_sub_f32 v101, v101, v50
    v_sub_f32 v102, v102, v50
    v_sub_f32 v103, v103, v50
    v_sub_f32 v104, v104, v50
    v_sub_f32 v105, v105, v50
    v_sub_f32 v106, v106, v50
    v_sub_f32 v107, v107, v50
    v_sub_f32 v108, v108, v50
    v_sub_f32 v109, v109, v50
    v_sub_f32 v110, v110, v50
    v_sub_f32 v111, v111, v50
    v_cvt_pk_bf16_f32 v64, v80, v81
    v_cvt_pk_bf16_f32 v65, v82, v83
    v_cvt_pk_bf16_f32 v66, v84, v85
    v_cvt_pk_bf16_f32 v67, v86, v87
    v_cvt_pk_bf16_f32 v68, v88, v89
    s_add_u32 m0, s64, 106496
    s_mov_b32 s65, 0x680000
    buffer_load_dwordx4 v119, s[12:15], s65 offen lds
    v_cvt_pk_bf16_f32 v69, v90, v91
    v_cvt_pk_bf16_f32 v70, v92, v93
    v_cvt_pk_bf16_f32 v71, v94, v95
    v_cvt_pk_bf16_f32 v72, v96, v97
    v_cvt_pk_bf16_f32 v73, v98, v99
    v_cvt_pk_bf16_f32 v74, v100, v101
    v_cvt_pk_bf16_f32 v75, v102, v103
    v_cvt_pk_bf16_f32 v76, v104, v105
    v_cvt_pk_bf16_f32 v77, v106, v107
    v_cvt_pk_bf16_f32 v78, v108, v109
    v_cvt_pk_bf16_f32 v79, v110, v111
    v_add_f32_dpp v56, v56, v56 row_ror:8 row_mask:0xf bank_mask:0xf
    v_mov_b32 v57, v56
    s_nop 1
    v_permlane16_swap_b32 v56, v57
    v_add_f32 v56, v56, v57
    v_mov_b32 v57, v56
    s_nop 1
    v_permlane32_swap_b32 v56, v57
    v_add_f32 v56, v56, v57
    ds_write_b32 v59, v56 offset:192
    s_waitcnt lgkmcnt(0)
    s_barrier
    ds_read_b128 v[52:55], v58 offset:192
    s_waitcnt lgkmcnt(0)
    v_add_f32 v52, v52, v53
    v_add_f32 v54, v54, v55
    v_add_f32 v56, v52, v54
    v_mul_f32 v56, 0x3a800000, v56
    v_cvt_pk_bf16_f32 v56, v56, v56
    v_and_b32 v56, 0xffff0000, v56
    v_add_f32 v56, 0x3727c5ac, v56
    v_cvt_pk_bf16_f32 v56, v56, v56
    v_and_b32 v56, 0xffff0000, v56
    v_sqrt_f32 v56, v56
    s_nop 0
    v_cvt_pk_bf16_f32 v56, v56, v56
    v_and_b32 v56, 0xffff0000, v56
    v_rcp_f32 v56, v56
    s_add_u32 m0, s64, 110592
    s_mov_b32 s65, 0x6c0000
    buffer_load_dwordx4 v119, s[12:15], s65 offen lds
    v_lshlrev_b32 v80, 16, v64
    v_and_b32 v81, 0xffff0000, v64
    v_lshlrev_b32 v82, 16, v65
    v_and_b32 v83, 0xffff0000, v65
    v_lshlrev_b32 v84, 16, v66
    v_and_b32 v85, 0xffff0000, v66
    v_lshlrev_b32 v86, 16, v67
    v_and_b32 v87, 0xffff0000, v67
    v_lshlrev_b32 v88, 16, v68
    v_and_b32 v89, 0xffff0000, v68
    v_lshlrev_b32 v90, 16, v69
    v_and_b32 v91, 0xffff0000, v69
    v_lshlrev_b32 v92, 16, v70
    v_and_b32 v93, 0xffff0000, v70
    v_lshlrev_b32 v94, 16, v71
    v_and_b32 v95, 0xffff0000, v71
    v_lshlrev_b32 v96, 16, v72
    v_and_b32 v97, 0xffff0000, v72
    v_lshlrev_b32 v98, 16, v73
    v_and_b32 v99, 0xffff0000, v73
    v_lshlrev_b32 v100, 16, v74
    v_and_b32 v101, 0xffff0000, v74
    v_lshlrev_b32 v102, 16, v75
    v_and_b32 v103, 0xffff0000, v75
    v_lshlrev_b32 v104, 16, v76
    v_and_b32 v105, 0xffff0000, v76
    v_lshlrev_b32 v106, 16, v77
    v_and_b32 v107, 0xffff0000, v77
    v_lshlrev_b32 v108, 16, v78
    v_and_b32 v109, 0xffff0000, v78
    s_add_u32 m0, s64, 49152
    s_mov_b32 s65, 0x300000
    buffer_load_dwordx4 v119, s[12:15], s65 offen lds
    v_lshlrev_b32 v110, 16, v79
    v_and_b32 v111, 0xffff0000, v79
    v_mul_f32 v80, v80, v56
    v_mul_f32 v81, v81, v56
    v_mul_f32 v82, v82, v56
    v_mul_f32 v83, v83, v56
    v_mul_f32 v84, v84, v56
    v_mul_f32 v85, v85, v56
    v_mul_f32 v86, v86, v56
    v_mul_f32 v87, v87, v56
    v_mul_f32 v88, v88, v56
    v_mul_f32 v89, v89, v56
    v_mul_f32 v90, v90, v56
    v_mul_f32 v91, v91, v56
    v_mul_f32 v92, v92, v56
    v_mul_f32 v93, v93, v56
    v_mul_f32 v94, v94, v56
    v_mul_f32 v95, v95, v56
    v_mul_f32 v96, v96, v56
    v_mul_f32 v97, v97, v56
    v_mul_f32 v98, v98, v56
    v_mul_f32 v99, v99, v56
    v_mul_f32 v100, v100, v56
    v_mul_f32 v101, v101, v56
    v_mul_f32 v102, v102, v56
    v_mul_f32 v103, v103, v56
    v_mul_f32 v104, v104, v56
    v_mul_f32 v105, v105, v56
    v_mul_f32 v106, v106, v56
    v_mul_f32 v107, v107, v56
    v_mul_f32 v108, v108, v56
    s_add_u32 m0, s64, 53248
    s_mov_b32 s65, 0x340000
    buffer_load_dwordx4 v119, s[12:15], s65 offen lds
    v_mul_f32 v109, v109, v56
    v_mul_f32 v110, v110, v56
    v_mul_f32 v111, v111, v56
    v_lshrrev_b32 v60, 3, v61
    v_lshlrev_b32 v60, 9, v60
    v_add_u32 v60, v60, v58
    s_lshr_b32 s56, s2, 2
    s_lshl_b32 s56, s56, 16
    s_and_b32 s57, s2, 3
    s_lshl_b32 s57, s57, 7
    s_add_u32 s56, s56, s57
    s_lshl_b32 s57, s44, 14
    s_add_u32 s56, s56, s57
    v_cvt_pk_bf16_f32 v64, v80, v81
    v_cvt_pk_bf16_f32 v65, v82, v83
    v_cvt_pk_bf16_f32 v66, v84, v85
    v_cvt_pk_bf16_f32 v67, v86, v87
    buffer_store_dwordx4 v[64:67], v60, s[4:7], s56 offen sc1
    s_add_u32 s56, s56, 4096
    v_cvt_pk_bf16_f32 v68, v88, v89
    v_cvt_pk_bf16_f32 v69, v90, v91
    v_cvt_pk_bf16_f32 v70, v92, v93
    v_cvt_pk_bf16_f32 v71, v94, v95
    buffer_store_dwordx4 v[68:71], v60, s[4:7], s56 offen sc1
    s_add_u32 s56, s56, 4096
    v_cvt_pk_bf16_f32 v72, v96, v97
    v_cvt_pk_bf16_f32 v73, v98, v99
    v_cvt_pk_bf16_f32 v74, v100, v101
    v_cvt_pk_bf16_f32 v75, v102, v103
    buffer_store_dwordx4 v[72:75], v60, s[4:7], s56 offen sc1
    s_add_u32 s56, s56, 4096
    v_cvt_pk_bf16_f32 v76, v104, v105
    v_cvt_pk_bf16_f32 v77, v106, v107
    v_cvt_pk_bf16_f32 v78, v108, v109
    v_cvt_pk_bf16_f32 v79, v110, v111
    buffer_store_dwordx4 v[76:79], v60, s[4:7], s56 offen sc1
    v_lshlrev_b32 v60, 2, v61
    v_mov_b32 v57, 0
    s_lshl_b32 s56, s2, 6
    s_add_u32 s56, s56, 0x5200000
    s_mov_b64 exec, 0xffff
    buffer_store_dword v57, v60, s[4:7], s56 offen sc1
    s_mov_b64 exec, -1
    s_lshr_b32 s56, s2, 5
    s_sub_u32 s56, s56, 1
    s_and_b32 s56, s56, 7
    s_lshl_b32 s56, s56, 2
    s_add_u32 s56, s56, 100
    v_and_b32 v52, 63, v0
    v_lshrrev_b32 v53, 4, v52
    v_and_b32 v54, 15, v52
    s_mov_b32 s76, s56
    s_lshr_b32 s56, s43, 1
    s_lshl_b32 s59, s42, 4
    s_add_u32 s56, s56, s59
    s_and_b32 s57, s43, 1
    s_mul_i32 s66, s42, 0x400000
    s_add_u32 s66, s66, 0x6000000
    v_lshlrev_b32 v55, 4, v52
    s_lshl_b32 s58, s44, 12
    s_and_b32 s78, s58, 0xffffe000
    s_add_u32 s58, s58, s78
    s_add_u32 s59, s58, s66
    v_add_u32 v1, s59, v55
    s_xor_b32 s59, s59, 0x400000
    s_add_u32 s59, s59, 0x8000
    v_add_u32 v2, s59, v55
    s_lshl_b32 s59, s44, 14
    s_add_u32 s59, s59, s66
    s_add_u32 s59, s59, 0x10000
    s_add_u32 m0, s64, 114688
    s_mov_b32 s65, 0x700000
    buffer_load_dwordx4 v119, s[12:15], s65 offen lds
    v_add_u32 v3, s59, v55
    v_mov_b32 v13, v55
    v_add_u32 v16, 16384, v55
    s_lshr_b32 s59, s44, 1
    s_lshl_b32 s59, s59, 16
    s_and_b32 s58, s44, 1
    s_lshl_b32 s58, s58, 12
    s_add_u32 s59, s59, s58
    s_add_u32 s59, s59, 32768
    v_add_u32 v19, s59, v55
    v_lshrrev_b32 v56, 2, v54
    v_and_b32 v57, 1, v54
    v_lshl_add_u32 v67, v56, 1, v57
    v_bfe_u32 v68, v54, 1, 1
    v_cmp_eq_u32 s[70:71], 0, v68
    v_cmp_gt_u32 s[72:73], 32, v52
    v_mov_b32 v58, 0x80000000
    v_lshrrev_b32 v56, 1, v53
    v_lshl_add_u32 v56, v56, 1, v54
    v_and_b32 v57, 1, v53
    v_lshlrev_b32 v57, 3, v57
    v_lshl_add_u32 v56, v56, 4, v57
    s_lshl_b32 s58, s43, 10
    s_and_b32 s78, s58, 0xffffe000
    s_add_u32 s58, s58, s78
    s_lshl_b32 s59, s44, 8
    s_add_u32 s58, s58, s59
    s_add_u32 s58, s58, s66
    s_add_u32 s58, s58, 0x10000
    v_add_u32 v56, s58, v56
    v_cndmask_b32 v4, v58, v56, s[70:71]
    v_lshlrev_b32 v56, 4, v52
    s_lshl_b32 s58, s43, 11
    s_and_b32 s78, s58, 0xffffe000
    s_add_u32 s58, s58, s78
    s_add_u32 s58, s58, s66
    s_add_u32 s58, s58, 0x20000
    s_xor_b32 s59, s58, 2048
    v_add_u32 v6, s59, v56
    s_and_b32 s59, s44, 1
    s_lshl_b32 s59, s59, 10
    s_add_u32 s58, s58, s59
    v_add_u32 v56, s58, v56
    s_lshr_b32 s59, s44, 1
    v_cmp_eq_u32 vcc, s59, v68
    s_nop 1
    v_cndmask_b32 v5, v58, v56, vcc
    s_lshl_b32 s58, s43, 9
    s_and_b32 s78, s58, 0xffffe000
    s_add_u32 s58, s58, s78
    s_lshr_b32 s59, s44, 1
    s_lshl_b32 s68, s59, 8
    s_add_u32 s58, s58, s68
    s_xor_b32 s59, s59, s44
    s_and_b32 s59, s59, 1
    s_mul_i32 s59, s59, 0x8000
    s_add_u32 s58, s58, s59
    s_add_u32 s58, s58, s66
    v_lshlrev_b32 v56, 2, v52
    v_add_u32 v7, s58, v56
    v_and_b32 v0, 124, v56
    s_lshl_b32 s58, s42, 12
    s_add_u32 s58, s58, 0x6800000
    s_mul_i32 s59, s44, 0x180
    s_add_u32 s90, s58, s59
    s_lshl_b32 s59, s43, 7
    s_add_u32 s89, s58, s59
    s_add_u32 s89, s89, 0x4000
    s_xor_b32 s91, s89, 0x1000
    s_lshr_b32 s59, s43, 3
    s_mul_i32 s59, s59, 0x180
    s_add_u32 s58, s58, s59
    s_and_b32 s59, s43, 7
    s_lshl_b32 s59, s59, 2
    s_add_u32 s59, s59, s44
    s_lshl_b32 s59, s59, 2
    s_add_u32 s88, s58, s59
    v_lshlrev_b32 v56, 7, v53
    v_lshl_add_u32 v56, v67, 4, v56
    s_lshl_b32 s58, s56, 11
    s_lshl_b32 s59, s57, 10
    s_add_u32 s58, s58, s59
    s_mov_b32 s67, s58
    s_and_b32 s59, s44, 1
    s_lshl_b32 s59, s59, 9
    s_add_u32 s58, s58, s59
    s_add_u32 s58, s58, 0x2400000
    v_add_u32 v56, s58, v56
    v_cndmask_b32 v8, v58, v56, s[70:71]
    v_lshlrev_b32 v56, 2, v53
    s_add_u32 m0, s64, 118784
    s_mov_b32 s65, 0x740000
    buffer_load_dwordx4 v119, s[12:15], s65 offen lds
    v_lshl_add_u32 v56, v54, 4, v56
    s_lshl_b32 s59, s44, 8
    s_add_u32 s58, s67, s59
    s_add_u32 s58, s58, 0x2800000
    v_add_u32 v9, s58, v56
    v_lshlrev_b32 v56, 9, v53
    v_lshl_add_u32 v56, v54, 4, v56
    s_lshl_b32 s67, s56, 13
    s_lshl_b32 s59, s57, 12
    s_add_u32 s67, s67, s59
    s_lshr_b32 s59, s44, 1
    s_lshl_b32 s59, s59, 11
    s_add_u32 s58, s67, s59
    s_and_b32 s59, s44, 1
    s_lshl_b32 s59, s59, 8
    s_add_u32 s58, s58, s59
    s_add_u32 s58, s58, 0x1400000
    v_add_u32 v10, s58, v56
    v_lshrrev_b32 v56, 3, v54
    v_lshlrev_b32 v56, 4, v56
    v_and_b32 v57, 7, v54
    v_add_u32 v56, v56, v57
    v_lshlrev_b32 v57, 9, v53
    v_lshl_add_u32 v56, v56, 4, v57
    s_and_b32 s59, s44, 1
    s_lshl_b32 s59, s59, 11
    s_add_u32 s58, s67, s59
    s_lshr_b32 s59, s44, 1
    s_lshl_b32 s59, s59, 7
    s_add_u32 s58, s58, s59
    s_add_u32 s58, s58, 0x400000
    v_add_u32 v11, s58, v56
    v_bfe_u32 v56, v54, 2, 1
    v_lshlrev_b32 v56, 1, v56
    v_xor_b32 v56, v56, v53
    v_lshlrev_b32 v56, 3, v56
    v_lshl_add_u32 v56, v54, 5, v56
    s_lshl_b32 s58, s44, 10
    s_add_u32 s58, s58, 24576
    v_add_u32 v14, s58, v56
    v_lshrrev_b32 v56, 1, v53
    v_lshlrev_b32 v56, 4, v56
    v_and_b32 v57, 1, v53
    v_lshl_add_u32 v59, v57, 2, v56
    v_lshlrev_b32 v56, 1, v57
    v_xor_b32 v56, v56, v54
    v_and_b32 v56, 3, v56
    v_lshlrev_b32 v56, 3, v56
    v_lshl_add_u32 v56, v57, 7, v56
    v_lshrrev_b32 v57, 2, v54
    v_lshl_add_u32 v56, v57, 5, v56
    v_lshrrev_b32 v57, 1, v53
    s_add_u32 m0, s64, 57344
    s_mov_b32 s65, 0x380000
    buffer_load_dwordx4 v119, s[12:15], s65 offen lds
    v_lshl_add_u32 v56, v57, 10, v56
    v_add_u32 v15, 24576, v56
    v_lshrrev_b32 v56, 3, v54
    v_lshl_add_u32 v56, v53, 1, v56
    v_add_u32 v56, s44, v56
    v_and_b32 v56, 3, v56
    v_lshlrev_b32 v56, 3, v56
    v_lshl_add_u32 v56, v53, 9, v56
    v_lshrrev_b32 v57, 1, v54
    v_lshl_add_u32 v56, v57, 5, v56
    v_and_b32 v57, 1, v54
    v_lshl_add_u32 v56, v57, 2, v56
    v_add_u32 v17, 28672, v56
    v_bfe_u32 v56, v52, 2, 1
    v_lshl_add_u32 v56, v53, 1, v56
    v_lshlrev_b32 v56, 8, v56
    v_bfe_u32 v57, v52, 3, 1
    v_lshl_add_u32 v56, v57, 7, v56
    v_and_b32 v57, 3, v52
    v_lshl_add_u32 v56, v57, 5, v56
    s_lshr_b32 s58, s44, 1
    s_lshl_b32 s58, s58, 11
    s_add_u32 s58, s58, 28672
    v_add_u32 v18, s58, v56
    v_mov_b32 v56, 0x4444
    v_mov_b32 v57, 0xeeee
    v_cndmask_b32 v20, v57, v56, s[70:71]
    v_mov_b32 v26, 0x3f803f80
    v_mov_b32 v32, -1
    v_mov_b32 v27, 0x3f803f80
    v_mov_b32 v33, -1
    v_mov_b32 v28, 0x3f803f80
    v_mov_b32 v34, -1
    v_mov_b32 v29, 0x3f803f80
    s_add_u32 m0, s64, 61440
    s_mov_b32 s65, 0x3c0000
    buffer_load_dwordx4 v119, s[12:15], s65 offen lds
    v_mov_b32 v35, -1
    v_mov_b32 v30, 0
    v_mov_b32 v31, 0
    v_mov_b32 v56, 0x3f80
    v_mov_b32 v57, 0x3f800000
    v_and_b32 v55, 1, v52
    v_cmp_eq_u32 vcc, 1, v55
    s_nop 1
    v_cndmask_b32 v56, v56, v57, vcc
    v_and_b32 v55, 2, v52
    v_cmp_eq_u32 vcc, 0, v55
    s_nop 1
    v_cndmask_b32 v24, 0, v56, vcc
    v_cndmask_b32 v25, v56, 0, vcc
    v_lshlrev_b32 v55, 4, v52
    buffer_load_dword v60, off, s[8:11], 0 offset:40 sc1
    s_lshl_b32 s67, s43, 11
    s_and_b32 s78, s67, 0xffffe000
    s_add_u32 s67, s67, s78
    s_add_u32 s67, s67, 0x20000
    s_lshl_b32 s68, s43, 10
    s_and_b32 s78, s68, 0xffffe000
    s_add_u32 s68, s68, s78
    s_add_u32 s68, s68, 0x10000
    s_cmp_eq_u32 s44, 1
    s_cselect_b32 s67, s68, s67
    s_lshl_b32 s68, s43, 9
    s_and_b32 s78, s68, 0xffffe000
    s_add_u32 s68, s68, s78
    s_cmp_eq_u32 s44, 2
    s_cselect_b32 s67, s68, s67
    s_add_u32 s68, s68, 0x8000
    s_cmp_eq_u32 s44, 3
    s_cselect_b32 s67, s68, s67
    s_add_u32 s67, s67, s66
    s_cmp_ge_u32 s44, 2
    s_cselect_b64 s[74:75], s[72:73], -1
    v_add_u32 v56, s67, v55
    v_cndmask_b32 v12, v58, v56, s[74:75]
    v_lshrrev_b32 v55, 3, v54
    v_lshl_add_u32 v56, v55, 3, v59
    v_bfe_u32 v57, v54, 2, 1
    v_add_u32 v56, v56, v57
    v_and_b32 v57, 1, v53
    v_lshl_add_u32 v57, v55, 1, v57
    v_lshlrev_b32 v57, 1, v57
    v_bfe_u32 v55, v54, 1, 1
    s_lshl_b32 s58, s44, 1
    v_add_u32 v55, s58, v55
    v_xor_b32 v55, v55, v57
    v_lshlrev_b32 v55, 4, v55
    v_lshl_add_u32 v56, v56, 7, v55
    v_and_b32 v55, 1, v54
    v_lshl_add_u32 v56, v55, 3, v56
    v_add_u32 v62, 32768, v56
    s_add_u32 m0, s64, 122880
    s_mov_b32 s65, 0x780000
    buffer_load_dwordx4 v119, s[12:15], s65 offen lds
    v_add_u32 v63, 98304, v56
    v_lshrrev_b32 v55, 2, v52
    v_and_b32 v56, 9, v55
    v_bfe_u32 v57, v55, 1, 1
    v_lshl_add_u32 v56, v57, 2, v56
    v_bfe_u32 v57, v55, 2, 1
    v_lshl_add_u32 v56, v57, 1, v56
    v_lshrrev_b32 v55, 5, v52
    v_lshlrev_b32 v55, 1, v55
    v_and_b32 v57, 3, v52
    v_xor_b32 v55, v55, v57
    v_lshlrev_b32 v55, 4, v55
    v_lshl_add_u32 v56, v56, 11, v55
    s_lshl_b32 s58, s42, 22
    s_lshl_b32 s59, s44, 15
    s_add_u32 s58, s58, s59
    s_lshl_b32 s59, s43, 6
    s_add_u32 s58, s58, s59
    v_add_u32 v61, s58, v56
    v_lshrrev_b32 v55, 3, v54
    v_and_b32 v56, 1, v53
    v_lshlrev_b32 v56, 1, v56
    v_lshl_add_u32 v56, v55, 3, v56
    v_bfe_u32 v57, v54, 2, 1
    v_add_u32 v56, v56, v57
    v_lshlrev_b32 v56, 6, v56
    v_lshl_add_u32 v56, v55, 5, v56
    v_and_b32 v57, 3, v54
    v_lshl_add_u32 v56, v57, 3, v56
    v_lshrrev_b32 v55, 1, v53
    v_lshl_add_u32 v56, v55, 10, v56
    s_lshl_b32 s59, s44, 14
    s_and_b32 s58, s59, 0x8000
    s_add_u32 s59, s59, s58
    s_add_u32 s59, s59, 32768
    v_add_u32 v64, s59, v56
    v_xor_b32 v65, 32, v64
    v_lshlrev_b32 v55, 11, v67
    v_lshl_add_u32 v55, v53, 5, v55
    v_lshl_add_u32 v55, v68, 4, v55
    s_lshl_b32 s59, s44, 9
    s_add_u32 m0, s64, 126976
    s_mov_b32 s65, 0x7c0000
    buffer_load_dwordx4 v119, s[12:15], s65 offen lds
    v_add_u32 v66, s59, v55
    s_waitcnt vmcnt(22)
    s_barrier
    ds_read_b64_tr_b16 a[0:1], v62 offset:0
    ds_read_b64_tr_b16 a[2:3], v62 offset:256
    ds_read_b64_tr_b16 a[4:5], v62 offset:4096
    ds_read_b64_tr_b16 a[6:7], v62 offset:4352
    ds_read_b64_tr_b16 a[64:65], v63 offset:0
    ds_read_b64_tr_b16 a[66:67], v63 offset:256
    ds_read_b64_tr_b16 a[68:69], v63 offset:4096
    ds_read_b64_tr_b16 a[70:71], v63 offset:4352
    ds_read_b64_tr_b16 a[8:9], v62 offset:8192
    ds_read_b64_tr_b16 a[10:11], v62 offset:8448
    ds_read_b64_tr_b16 a[12:13], v62 offset:12288
    ds_read_b64_tr_b16 a[14:15], v62 offset:12544
    ds_read_b64_tr_b16 a[72:73], v63 offset:8192
    ds_read_b64_tr_b16 a[74:75], v63 offset:8448
    ds_read_b64_tr_b16 a[76:77], v63 offset:12288
    ds_read_b64_tr_b16 a[78:79], v63 offset:12544
    ds_read_b64_tr_b16 a[16:17], v62 offset:16384
    ds_read_b64_tr_b16 a[18:19], v62 offset:16640
    ds_read_b64_tr_b16 a[20:21], v62 offset:20480
    ds_read_b64_tr_b16 a[22:23], v62 offset:20736
    ds_read_b64_tr_b16 a[80:81], v63 offset:16384
    ds_read_b64_tr_b16 a[82:83], v63 offset:16640
    ds_read_b64_tr_b16 a[84:85], v63 offset:20480
    ds_read_b64_tr_b16 a[86:87], v63 offset:20736
    ds_read_b64_tr_b16 a[24:25], v62 offset:24576
    ds_read_b64_tr_b16 a[26:27], v62 offset:24832
    ds_read_b64_tr_b16 a[28:29], v62 offset:28672
    ds_read_b64_tr_b16 a[30:31], v62 offset:28928
    ds_read_b64_tr_b16 a[88:89], v63 offset:24576
    ds_read_b64_tr_b16 a[90:91], v63 offset:24832
    ds_read_b64_tr_b16 a[92:93], v63 offset:28672
    ds_read_b64_tr_b16 a[94:95], v63 offset:28928
    s_waitcnt lgkmcnt(0)
    s_barrier
    s_mov_b32 s12, s26
    s_and_b32 s13, s27, 0xffff
    s_mov_b32 s14, 0x800000
    s_mov_b32 s15, 0x20000
    s_add_u32 m0, s64, 0
    s_mov_b32 s65, 0x0
    buffer_load_dwordx4 v61, s[12:15], s65 offen lds
    s_add_u32 m0, s64, 4096
    s_mov_b32 s65, 0x20000
    buffer_load_dwordx4 v61, s[12:15], s65 offen lds
    s_add_u32 m0, s64, 8192
    s_mov_b32 s65, 0x40000
    buffer_load_dwordx4 v61, s[12:15], s65 offen lds
    s_add_u32 m0, s64, 12288
    s_mov_b32 s65, 0x60000
    buffer_load_dwordx4 v61, s[12:15], s65 offen lds
    s_add_u32 m0, s64, 16384
    s_mov_b32 s65, 0x100000
    buffer_load_dwordx4 v61, s[12:15], s65 offen lds
    s_add_u32 m0, s64, 20480
    s_mov_b32 s65, 0x120000
    buffer_load_dwordx4 v61, s[12:15], s65 offen lds
    s_add_u32 m0, s64, 24576
    s_mov_b32 s65, 0x140000
    buffer_load_dwordx4 v61, s[12:15], s65 offen lds
    s_add_u32 m0, s64, 28672
    s_mov_b32 s65, 0x160000
    buffer_load_dwordx4 v61, s[12:15], s65 offen lds
    s_add_u32 m0, s64, 65536
    s_mov_b32 s65, 0x200000
    buffer_load_dwordx4 v61, s[12:15], s65 offen lds
    s_add_u32 m0, s64, 69632
    s_mov_b32 s65, 0x220000
    buffer_load_dwordx4 v61, s[12:15], s65 offen lds
    s_add_u32 m0, s64, 73728
    s_mov_b32 s65, 0x240000
    buffer_load_dwordx4 v61, s[12:15], s65 offen lds
    s_add_u32 m0, s64, 77824
    s_mov_b32 s65, 0x260000
    buffer_load_dwordx4 v61, s[12:15], s65 offen lds
    s_add_u32 m0, s64, 81920
    s_mov_b32 s65, 0x300000
    buffer_load_dwordx4 v61, s[12:15], s65 offen lds
    s_add_u32 m0, s64, 86016
    s_mov_b32 s65, 0x320000
    buffer_load_dwordx4 v61, s[12:15], s65 offen lds
    s_add_u32 m0, s64, 90112
    s_mov_b32 s65, 0x340000
    buffer_load_dwordx4 v61, s[12:15], s65 offen lds
    s_add_u32 m0, s64, 94208
    s_mov_b32 s65, 0x360000
    buffer_load_dwordx4 v61, s[12:15], s65 offen lds
    s_waitcnt vmcnt(16)
    s_barrier
    s_cmp_lg_u32 s44, 0
    s_cbranch_scc1 nobar_4
    s_mov_b64 exec, 1
    v_mov_b32 v56, 1
    buffer_atomic_add v56, off, s[8:11], s76 sc1
    s_mov_b64 exec, -1
nobar_4:
    s_mov_b32 s55, 0x40000
cal_5:
    v_readfirstlane_b32 s77, v60
    s_cmp_lg_u32 s77, 0
    s_cbranch_scc1 cal_5_ok
    buffer_load_dword v60, off, s[8:11], 0 offset:40 sc1
    s_waitcnt vmcnt(0)
    s_sub_u32 s55, s55, 1
    s_cmp_lg_u32 s55, 0
    s_cbranch_scc1 cal_5
cal_5_ok:
    s_and_b32 s77, s77, 2
    s_lshl_b32 s77, s77, 12
    s_add_u32 s88, s88, s77
    s_add_u32 s90, s90, s77
    v_lshlrev_b32 v55, 4, v52
    s_mul_i32 s58, s44, 0x80000
    s_add_u32 s58, s58, s66
    s_add_u32 s58, s58, s77
    s_lshl_b32 s59, s43, 11
    s_and_b32 s78, s59, 0xffffe000
    s_add_u32 s59, s59, s78
    s_add_u32 s67, s58, s59
    s_add_u32 s67, s67, 0x20000
    buffer_store_dwordx4 v[32:35], v55, s[4:7], s67 offen
    buffer_store_dwordx4 v[32:35], v55, s[4:7], s67 offen offset:1024
    s_lshl_b32 s59, s43, 10
    s_and_b32 s78, s59, 0xffffe000
    s_add_u32 s59, s59, s78
    s_add_u32 s68, s58, s59
    s_add_u32 s68, s68, 0x10000
    buffer_store_dwordx4 v[32:35], v55, s[4:7], s68 offen
    v_cndmask_b32 v56, v58, v55, s[72:73]
    s_lshl_b32 s59, s43, 9
    s_and_b32 s78, s59, 0xffffe000
    s_add_u32 s59, s59, s78
    s_add_u32 s69, s58, s59
    buffer_store_dwordx4 v[32:35], v56, s[4:7], s69 offen
    s_add_u32 s67, s69, 0x8000
    buffer_store_dwordx4 v[32:35], v56, s[4:7], s67 offen sc1
    v_mov_b32 v56, 0
    s_mov_b64 exec, 1
    buffer_store_dword v56, off, s[4:7], s88
    s_mov_b64 exec, -1
    ds_read_b64_tr_b16 a[32:33], v62 offset:32768
    ds_read_b64_tr_b16 a[34:35], v62 offset:33024
    ds_read_b64_tr_b16 a[36:37], v62 offset:36864
    ds_read_b64_tr_b16 a[38:39], v62 offset:37120
    ds_read_b64_tr_b16 a[96:97], v63 offset:32768
    ds_read_b64_tr_b16 a[98:99], v63 offset:33024
    ds_read_b64_tr_b16 a[100:101], v63 offset:36864
    ds_read_b64_tr_b16 a[102:103], v63 offset:37120
    ds_read_b64_tr_b16 a[40:41], v62 offset:40960
    ds_read_b64_tr_b16 a[42:43], v62 offset:41216
    ds_read_b64_tr_b16 a[44:45], v62 offset:45056
    ds_read_b64_tr_b16 a[46:47], v62 offset:45312
    ds_read_b64_tr_b16 a[104:105], v63 offset:40960
    ds_read_b64_tr_b16 a[106:107], v63 offset:41216
    ds_read_b64_tr_b16 a[108:109], v63 offset:45056
    ds_read_b64_tr_b16 a[110:111], v63 offset:45312
    ds_read_b64_tr_b16 a[48:49], v62 offset:49152
    ds_read_b64_tr_b16 a[50:51], v62 offset:49408
    ds_read_b64_tr_b16 a[52:53], v62 offset:53248
    ds_read_b64_tr_b16 a[54:55], v62 offset:53504
    ds_read_b64_tr_b16 a[112:113], v63 offset:49152
    ds_read_b64_tr_b16 a[114:115], v63 offset:49408
    ds_read_b64_tr_b16 a[116:117], v63 offset:53248
    ds_read_b64_tr_b16 a[118:119], v63 offset:53504
    ds_read_b64_tr_b16 a[56:57], v62 offset:57344
    ds_read_b64_tr_b16 a[58:59], v62 offset:57600
    ds_read_b64_tr_b16 a[60:61], v62 offset:61440
    ds_read_b64_tr_b16 a[62:63], v62 offset:61696
    ds_read_b64_tr_b16 a[120:121], v63 offset:57344
    ds_read_b64_tr_b16 a[122:123], v63 offset:57600
    ds_read_b64_tr_b16 a[124:125], v63 offset:61440
    ds_read_b64_tr_b16 a[126:127], v63 offset:61696
    s_waitcnt lgkmcnt(0)
    s_barrier
    s_add_u32 m0, s64, 32768
    s_mov_b32 s65, 0x80000
    buffer_load_dwordx4 v61, s[12:15], s65 offen lds
    s_add_u32 m0, s64, 36864
    s_mov_b32 s65, 0xa0000
    buffer_load_dwordx4 v61, s[12:15], s65 offen lds
    s_add_u32 m0, s64, 40960
    s_mov_b32 s65, 0xc0000
    buffer_load_dwordx4 v61, s[12:15], s65 offen lds
    s_add_u32 m0, s64, 45056
    s_mov_b32 s65, 0xe0000
    buffer_load_dwordx4 v61, s[12:15], s65 offen lds
    s_add_u32 m0, s64, 49152
    s_mov_b32 s65, 0x180000
    buffer_load_dwordx4 v61, s[12:15], s65 offen lds
    s_add_u32 m0, s64, 53248
    s_mov_b32 s65, 0x1a0000
    buffer_load_dwordx4 v61, s[12:15], s65 offen lds
    s_add_u32 m0, s64, 57344
    s_mov_b32 s65, 0x1c0000
    buffer_load_dwordx4 v61, s[12:15], s65 offen lds
    s_add_u32 m0, s64, 61440
    s_mov_b32 s65, 0x1e0000
    buffer_load_dwordx4 v61, s[12:15], s65 offen lds
    s_add_u32 m0, s64, 98304
    s_mov_b32 s65, 0x280000
    buffer_load_dwordx4 v61, s[12:15], s65 offen lds
    s_add_u32 m0, s64, 102400
    s_mov_b32 s65, 0x2a0000
    buffer_load_dwordx4 v61, s[12:15], s65 offen lds
    s_add_u32 m0, s64, 106496
    s_mov_b32 s65, 0x2c0000
    buffer_load_dwordx4 v61, s[12:15], s65 offen lds
    s_add_u32 m0, s64, 110592
    s_mov_b32 s65, 0x2e0000
    buffer_load_dwordx4 v61, s[12:15], s65 offen lds
    s_add_u32 m0, s64, 114688
    s_mov_b32 s65, 0x380000
    buffer_load_dwordx4 v61, s[12:15], s65 offen lds
    s_add_u32 m0, s64, 118784
    s_mov_b32 s65, 0x3a0000
    buffer_load_dwordx4 v61, s[12:15], s65 offen lds
    s_add_u32 m0, s64, 122880
    s_mov_b32 s65, 0x3c0000
    buffer_load_dwordx4 v61, s[12:15], s65 offen lds
    s_add_u32 m0, s64, 126976
    s_mov_b32 s65, 0x3e0000
    buffer_load_dwordx4 v61, s[12:15], s65 offen lds
    s_waitcnt vmcnt(16)
    s_barrier
    s_cmp_lg_u32 s44, 0
    s_cbranch_scc1 nobar_6
    s_mov_b64 exec, 1
    v_mov_b32 v56, 1
    buffer_atomic_add v56, off, s[8:11], 0 offset:36 sc1
    s_mov_b64 exec, -1
nobar_6:
    ds_read_b64_tr_b16 v[128:129], v64 offset:0
    ds_read_b64_tr_b16 v[130:131], v64 offset:256
    ds_read_b64_tr_b16 v[132:133], v64 offset:2048
    ds_read_b64_tr_b16 v[134:135], v64 offset:2304
    ds_read_b64_tr_b16 v[136:137], v65 offset:0
    ds_read_b64_tr_b16 v[138:139], v65 offset:256
    ds_read_b64_tr_b16 v[140:141], v65 offset:2048
    ds_read_b64_tr_b16 v[142:143], v65 offset:2304
    ds_read_b64_tr_b16 v[144:145], v64 offset:4096
    ds_read_b64_tr_b16 v[146:147], v64 offset:4352
    ds_read_b64_tr_b16 v[148:149], v64 offset:6144
    ds_read_b64_tr_b16 v[150:151], v64 offset:6400
    ds_read_b64_tr_b16 v[152:153], v65 offset:4096
    ds_read_b64_tr_b16 v[154:155], v65 offset:4352
    ds_read_b64_tr_b16 v[156:157], v65 offset:6144
    ds_read_b64_tr_b16 v[158:159], v65 offset:6400
    ds_read_b64_tr_b16 v[160:161], v64 offset:8192
    ds_read_b64_tr_b16 v[162:163], v64 offset:8448
    ds_read_b64_tr_b16 v[164:165], v64 offset:10240
    ds_read_b64_tr_b16 v[166:167], v64 offset:10496
    ds_read_b64_tr_b16 v[168:169], v65 offset:8192
    ds_read_b64_tr_b16 v[170:171], v65 offset:8448
    ds_read_b64_tr_b16 v[172:173], v65 offset:10240
    ds_read_b64_tr_b16 v[174:175], v65 offset:10496
    ds_read_b64_tr_b16 v[176:177], v64 offset:12288
    ds_read_b64_tr_b16 v[178:179], v64 offset:12544
    ds_read_b64_tr_b16 v[180:181], v64 offset:14336
    ds_read_b64_tr_b16 v[182:183], v64 offset:14592
    ds_read_b64_tr_b16 v[184:185], v65 offset:12288
    ds_read_b64_tr_b16 v[186:187], v65 offset:12544
    ds_read_b64_tr_b16 v[188:189], v65 offset:14336
    ds_read_b64_tr_b16 v[190:191], v65 offset:14592
    v_add_u32 v64, 0x8000, v64
    v_add_u32 v65, 0x8000, v65
    s_waitcnt lgkmcnt(0)
    s_barrier
    s_mov_b32 s12, s22
    s_and_b32 s13, s23, 0xffff
    s_mov_b32 s14, 0x800000
    s_mov_b32 s15, 0x20000
    s_add_u32 m0, s64, 0
    s_mov_b32 s65, 0x0
    buffer_load_dwordx4 v119, s[12:15], s65 offen lds
    s_add_u32 m0, s64, 4096
    s_mov_b32 s65, 0x40000
    buffer_load_dwordx4 v119, s[12:15], s65 offen lds
    s_add_u32 m0, s64, 65536
    s_mov_b32 s65, 0x400000
    buffer_load_dwordx4 v119, s[12:15], s65 offen lds
    s_add_u32 m0, s64, 69632
    s_mov_b32 s65, 0x440000
    buffer_load_dwordx4 v119, s[12:15], s65 offen lds
    s_add_u32 m0, s64, 8192
    s_mov_b32 s65, 0x80000
    buffer_load_dwordx4 v119, s[12:15], s65 offen lds
    s_add_u32 m0, s64, 12288
    s_mov_b32 s65, 0xc0000
    buffer_load_dwordx4 v119, s[12:15], s65 offen lds
    s_add_u32 m0, s64, 73728
    s_mov_b32 s65, 0x480000
    buffer_load_dwordx4 v119, s[12:15], s65 offen lds
    s_add_u32 m0, s64, 77824
    s_mov_b32 s65, 0x4c0000
    buffer_load_dwordx4 v119, s[12:15], s65 offen lds
    s_add_u32 m0, s64, 16384
    s_mov_b32 s65, 0x100000
    buffer_load_dwordx4 v119, s[12:15], s65 offen lds
    s_add_u32 m0, s64, 20480
    s_mov_b32 s65, 0x140000
    buffer_load_dwordx4 v119, s[12:15], s65 offen lds
    s_add_u32 m0, s64, 81920
    s_mov_b32 s65, 0x500000
    buffer_load_dwordx4 v119, s[12:15], s65 offen lds
    s_add_u32 m0, s64, 86016
    s_mov_b32 s65, 0x540000
    buffer_load_dwordx4 v119, s[12:15], s65 offen lds
    s_add_u32 m0, s64, 24576
    s_mov_b32 s65, 0x180000
    buffer_load_dwordx4 v119, s[12:15], s65 offen lds
    s_add_u32 m0, s64, 28672
    s_mov_b32 s65, 0x1c0000
    buffer_load_dwordx4 v119, s[12:15], s65 offen lds
    s_add_u32 m0, s64, 90112
    s_mov_b32 s65, 0x580000
    buffer_load_dwordx4 v119, s[12:15], s65 offen lds
    s_add_u32 m0, s64, 94208
    s_mov_b32 s65, 0x5c0000
    buffer_load_dwordx4 v119, s[12:15], s65 offen lds
    s_waitcnt vmcnt(16)
    s_barrier
    ds_read_b64_tr_b16 v[192:193], v64 offset:0
    ds_read_b64_tr_b16 v[194:195], v64 offset:256
    ds_read_b64_tr_b16 v[196:197], v64 offset:2048
    ds_read_b64_tr_b16 v[198:199], v64 offset:2304
    ds_read_b64_tr_b16 v[200:201], v65 offset:0
    ds_read_b64_tr_b16 v[202:203], v65 offset:256
    ds_read_b64_tr_b16 v[204:205], v65 offset:2048
    ds_read_b64_tr_b16 v[206:207], v65 offset:2304
    ds_read_b64_tr_b16 v[208:209], v64 offset:4096
    ds_read_b64_tr_b16 v[210:211], v64 offset:4352
    ds_read_b64_tr_b16 v[212:213], v64 offset:6144
    ds_read_b64_tr_b16 v[214:215], v64 offset:6400
    ds_read_b64_tr_b16 v[216:217], v65 offset:4096
    ds_read_b64_tr_b16 v[218:219], v65 offset:4352
    ds_read_b64_tr_b16 v[220:221], v65 offset:6144
    ds_read_b64_tr_b16 v[222:223], v65 offset:6400
    ds_read_b64_tr_b16 v[224:225], v64 offset:8192
    ds_read_b64_tr_b16 v[226:227], v64 offset:8448
    ds_read_b64_tr_b16 v[228:229], v64 offset:10240
    ds_read_b64_tr_b16 v[230:231], v64 offset:10496
    ds_read_b64_tr_b16 v[232:233], v65 offset:8192
    ds_read_b64_tr_b16 v[234:235], v65 offset:8448
    ds_read_b64_tr_b16 v[236:237], v65 offset:10240
    ds_read_b64_tr_b16 v[238:239], v65 offset:10496
    ds_read_b64_tr_b16 v[240:241], v64 offset:12288
    ds_read_b64_tr_b16 v[242:243], v64 offset:12544
    ds_read_b64_tr_b16 v[244:245], v64 offset:14336
    ds_read_b64_tr_b16 v[246:247], v64 offset:14592
    ds_read_b64_tr_b16 v[248:249], v65 offset:12288
    ds_read_b64_tr_b16 v[250:251], v65 offset:12544
    ds_read_b64_tr_b16 v[252:253], v65 offset:14336
    ds_read_b64_tr_b16 v[254:255], v65 offset:14592
    v_add_u32 v64, 0x8000, v64
    v_add_u32 v65, 0x8000, v65
    s_waitcnt lgkmcnt(0)
    s_barrier
    s_add_u32 m0, s64, 32768
    s_mov_b32 s65, 0x200000
    buffer_load_dwordx4 v119, s[12:15], s65 offen lds
    s_add_u32 m0, s64, 36864
    s_mov_b32 s65, 0x240000
    buffer_load_dwordx4 v119, s[12:15], s65 offen lds
    s_add_u32 m0, s64, 98304
    s_mov_b32 s65, 0x600000
    buffer_load_dwordx4 v119, s[12:15], s65 offen lds
    s_add_u32 m0, s64, 102400
    s_mov_b32 s65, 0x640000
    buffer_load_dwordx4 v119, s[12:15], s65 offen lds
    s_add_u32 m0, s64, 40960
    s_mov_b32 s65, 0x280000
    buffer_load_dwordx4 v119, s[12:15], s65 offen lds
    s_add_u32 m0, s64, 45056
    s_mov_b32 s65, 0x2c0000
    buffer_load_dwordx4 v119, s[12:15], s65 offen lds
    s_add_u32 m0, s64, 106496
    s_mov_b32 s65, 0x680000
    buffer_load_dwordx4 v119, s[12:15], s65 offen lds
    s_add_u32 m0, s64, 110592
    s_mov_b32 s65, 0x6c0000
    buffer_load_dwordx4 v119, s[12:15], s65 offen lds
    s_add_u32 m0, s64, 49152
    s_mov_b32 s65, 0x300000
    buffer_load_dwordx4 v119, s[12:15], s65 offen lds
    s_add_u32 m0, s64, 53248
    s_mov_b32 s65, 0x340000
    buffer_load_dwordx4 v119, s[12:15], s65 offen lds
    s_add_u32 m0, s64, 114688
    s_mov_b32 s65, 0x700000
    buffer_load_dwordx4 v119, s[12:15], s65 offen lds
    s_add_u32 m0, s64, 118784
    s_mov_b32 s65, 0x740000
    buffer_load_dwordx4 v119, s[12:15], s65 offen lds
    s_add_u32 m0, s64, 57344
    s_mov_b32 s65, 0x380000
    buffer_load_dwordx4 v119, s[12:15], s65 offen lds
    s_add_u32 m0, s64, 61440
    s_mov_b32 s65, 0x3c0000
    buffer_load_dwordx4 v119, s[12:15], s65 offen lds
    s_add_u32 m0, s64, 122880
    s_mov_b32 s65, 0x780000
    buffer_load_dwordx4 v119, s[12:15], s65 offen lds
    s_add_u32 m0, s64, 126976
    s_mov_b32 s65, 0x7c0000
    buffer_load_dwordx4 v119, s[12:15], s65 offen lds
    s_waitcnt vmcnt(16)
    s_barrier
    ds_read_b64_tr_b16 a[128:129], v62 offset:0
    ds_read_b64_tr_b16 a[130:131], v62 offset:256
    ds_read_b64_tr_b16 a[132:133], v62 offset:4096
    ds_read_b64_tr_b16 a[134:135], v62 offset:4352
    ds_read_b64_tr_b16 a[192:193], v63 offset:0
    ds_read_b64_tr_b16 a[194:195], v63 offset:256
    ds_read_b64_tr_b16 a[196:197], v63 offset:4096
    ds_read_b64_tr_b16 a[198:199], v63 offset:4352
    ds_read_b64_tr_b16 a[136:137], v62 offset:8192
    ds_read_b64_tr_b16 a[138:139], v62 offset:8448
    ds_read_b64_tr_b16 a[140:141], v62 offset:12288
    ds_read_b64_tr_b16 a[142:143], v62 offset:12544
    ds_read_b64_tr_b16 a[200:201], v63 offset:8192
    ds_read_b64_tr_b16 a[202:203], v63 offset:8448
    ds_read_b64_tr_b16 a[204:205], v63 offset:12288
    ds_read_b64_tr_b16 a[206:207], v63 offset:12544
    ds_read_b64_tr_b16 a[144:145], v62 offset:16384
    ds_read_b64_tr_b16 a[146:147], v62 offset:16640
    ds_read_b64_tr_b16 a[148:149], v62 offset:20480
    ds_read_b64_tr_b16 a[150:151], v62 offset:20736
    ds_read_b64_tr_b16 a[208:209], v63 offset:16384
    ds_read_b64_tr_b16 a[210:211], v63 offset:16640
    ds_read_b64_tr_b16 a[212:213], v63 offset:20480
    ds_read_b64_tr_b16 a[214:215], v63 offset:20736
    ds_read_b64_tr_b16 a[152:153], v62 offset:24576
    ds_read_b64_tr_b16 a[154:155], v62 offset:24832
    ds_read_b64_tr_b16 a[156:157], v62 offset:28672
    ds_read_b64_tr_b16 a[158:159], v62 offset:28928
    ds_read_b64_tr_b16 a[216:217], v63 offset:24576
    ds_read_b64_tr_b16 a[218:219], v63 offset:24832
    ds_read_b64_tr_b16 a[220:221], v63 offset:28672
    ds_read_b64_tr_b16 a[222:223], v63 offset:28928
    s_waitcnt lgkmcnt(0)
    s_barrier
    s_mov_b32 s12, s24
    s_and_b32 s13, s25, 0xffff
    s_mov_b32 s14, 0x800000
    s_mov_b32 s15, 0x20000
    s_add_u32 m0, s64, 0
    s_mov_b32 s65, 0x0
    buffer_load_dwordx4 v119, s[12:15], s65 offen lds
    s_add_u32 m0, s64, 4096
    s_mov_b32 s65, 0x40000
    buffer_load_dwordx4 v119, s[12:15], s65 offen lds
    s_add_u32 m0, s64, 65536
    s_mov_b32 s65, 0x400000
    buffer_load_dwordx4 v119, s[12:15], s65 offen lds
    s_add_u32 m0, s64, 69632
    s_mov_b32 s65, 0x440000
    buffer_load_dwordx4 v119, s[12:15], s65 offen lds
    s_add_u32 m0, s64, 8192
    s_mov_b32 s65, 0x80000
    buffer_load_dwordx4 v119, s[12:15], s65 offen lds
    s_add_u32 m0, s64, 12288
    s_mov_b32 s65, 0xc0000
    buffer_load_dwordx4 v119, s[12:15], s65 offen lds
    s_add_u32 m0, s64, 73728
    s_mov_b32 s65, 0x480000
    buffer_load_dwordx4 v119, s[12:15], s65 offen lds
    s_add_u32 m0, s64, 77824
    s_mov_b32 s65, 0x4c0000
    buffer_load_dwordx4 v119, s[12:15], s65 offen lds
    s_add_u32 m0, s64, 16384
    s_mov_b32 s65, 0x100000
    buffer_load_dwordx4 v119, s[12:15], s65 offen lds
    s_add_u32 m0, s64, 20480
    s_mov_b32 s65, 0x140000
    buffer_load_dwordx4 v119, s[12:15], s65 offen lds
    s_add_u32 m0, s64, 81920
    s_mov_b32 s65, 0x500000
    buffer_load_dwordx4 v119, s[12:15], s65 offen lds
    s_add_u32 m0, s64, 86016
    s_mov_b32 s65, 0x540000
    buffer_load_dwordx4 v119, s[12:15], s65 offen lds
    s_add_u32 m0, s64, 24576
    s_mov_b32 s65, 0x180000
    buffer_load_dwordx4 v119, s[12:15], s65 offen lds
    s_add_u32 m0, s64, 28672
    s_mov_b32 s65, 0x1c0000
    buffer_load_dwordx4 v119, s[12:15], s65 offen lds
    s_add_u32 m0, s64, 90112
    s_mov_b32 s65, 0x580000
    buffer_load_dwordx4 v119, s[12:15], s65 offen lds
    s_add_u32 m0, s64, 94208
    s_mov_b32 s65, 0x5c0000
    buffer_load_dwordx4 v119, s[12:15], s65 offen lds
    s_waitcnt vmcnt(16)
    s_barrier
    ds_read_b64_tr_b16 a[160:161], v62 offset:32768
    ds_read_b64_tr_b16 a[162:163], v62 offset:33024
    ds_read_b64_tr_b16 a[164:165], v62 offset:36864
    ds_read_b64_tr_b16 a[166:167], v62 offset:37120
    ds_read_b64_tr_b16 a[224:225], v63 offset:32768
    ds_read_b64_tr_b16 a[226:227], v63 offset:33024
    ds_read_b64_tr_b16 a[228:229], v63 offset:36864
    ds_read_b64_tr_b16 a[230:231], v63 offset:37120
    ds_read_b64_tr_b16 a[168:169], v62 offset:40960
    ds_read_b64_tr_b16 a[170:171], v62 offset:41216
    ds_read_b64_tr_b16 a[172:173], v62 offset:45056
    ds_read_b64_tr_b16 a[174:175], v62 offset:45312
    ds_read_b64_tr_b16 a[232:233], v63 offset:40960
    ds_read_b64_tr_b16 a[234:235], v63 offset:41216
    ds_read_b64_tr_b16 a[236:237], v63 offset:45056
    ds_read_b64_tr_b16 a[238:239], v63 offset:45312
    ds_read_b64_tr_b16 a[176:177], v62 offset:49152
    ds_read_b64_tr_b16 a[178:179], v62 offset:49408
    ds_read_b64_tr_b16 a[180:181], v62 offset:53248
    ds_read_b64_tr_b16 a[182:183], v62 offset:53504
    ds_read_b64_tr_b16 a[240:241], v63 offset:49152
    ds_read_b64_tr_b16 a[242:243], v63 offset:49408
    ds_read_b64_tr_b16 a[244:245], v63 offset:53248
    ds_read_b64_tr_b16 a[246:247], v63 offset:53504
    ds_read_b64_tr_b16 a[184:185], v62 offset:57344
    ds_read_b64_tr_b16 a[186:187], v62 offset:57600
    ds_read_b64_tr_b16 a[188:189], v62 offset:61440
    ds_read_b64_tr_b16 a[190:191], v62 offset:61696
    ds_read_b64_tr_b16 a[248:249], v63 offset:57344
    ds_read_b64_tr_b16 a[250:251], v63 offset:57600
    ds_read_b64_tr_b16 a[252:253], v63 offset:61440
    ds_read_b64_tr_b16 a[254:255], v63 offset:61696
    s_waitcnt lgkmcnt(0)
    s_barrier
    buffer_load_dword v124, off, s[8:11], 0 offset:36 sc1
    v_and_b32 v126, 28, v0
    buffer_load_dword v125, v126, s[8:11], 0 offen offset:100 sc1
EARLY_A:
    s_add_u32 m0, s64, 32768
    s_mov_b32 s65, 0x200000
    buffer_load_dwordx4 v119, s[12:15], s65 offen lds
    s_add_u32 m0, s64, 36864
    s_mov_b32 s65, 0x240000
    buffer_load_dwordx4 v119, s[12:15], s65 offen lds
    s_add_u32 m0, s64, 98304
    s_mov_b32 s65, 0x600000
    buffer_load_dwordx4 v119, s[12:15], s65 offen lds
    s_add_u32 m0, s64, 102400
    s_mov_b32 s65, 0x640000
    buffer_load_dwordx4 v119, s[12:15], s65 offen lds
    s_add_u32 m0, s64, 40960
    s_mov_b32 s65, 0x280000
    buffer_load_dwordx4 v119, s[12:15], s65 offen lds
    s_add_u32 m0, s64, 45056
    s_mov_b32 s65, 0x2c0000
    buffer_load_dwordx4 v119, s[12:15], s65 offen lds
    s_add_u32 m0, s64, 106496
    s_mov_b32 s65, 0x680000
    buffer_load_dwordx4 v119, s[12:15], s65 offen lds
    s_add_u32 m0, s64, 110592
    s_mov_b32 s65, 0x6c0000
    buffer_load_dwordx4 v119, s[12:15], s65 offen lds
    s_add_u32 m0, s64, 49152
    s_mov_b32 s65, 0x300000
    buffer_load_dwordx4 v119, s[12:15], s65 offen lds
    s_add_u32 m0, s64, 53248
    s_mov_b32 s65, 0x340000
    buffer_load_dwordx4 v119, s[12:15], s65 offen lds
    s_add_u32 m0, s64, 114688
    s_mov_b32 s65, 0x700000
    buffer_load_dwordx4 v119, s[12:15], s65 offen lds
    s_add_u32 m0, s64, 118784
    s_mov_b32 s65, 0x740000
    buffer_load_dwordx4 v119, s[12:15], s65 offen lds
    s_add_u32 m0, s64, 57344
    s_mov_b32 s65, 0x380000
    buffer_load_dwordx4 v119, s[12:15], s65 offen lds
    s_add_u32 m0, s64, 61440
    s_mov_b32 s65, 0x3c0000
    buffer_load_dwordx4 v119, s[12:15], s65 offen lds
    s_add_u32 m0, s64, 122880
    s_mov_b32 s65, 0x780000
    buffer_load_dwordx4 v119, s[12:15], s65 offen lds
    s_add_u32 m0, s64, 126976
    s_mov_b32 s65, 0x7c0000
    buffer_load_dwordx4 v119, s[12:15], s65 offen lds
    s_lshr_b32 s24, s43, 1
    s_lshl_b32 s59, s42, 4
    s_add_u32 s24, s24, s59
    s_lshl_b32 s24, s24, 6
    s_add_u32 s24, s24, 0x5200028
    s_and_b32 s59, s43, 1
    s_add_u32 s24, s24, s59
    s_mov_b32 s47, s24
    s_waitcnt vmcnt(16)
    s_mov_b32 s55, 0x40000
    s_branch cbar_7_t
cbar_7:
    buffer_load_dword v124, off, s[8:11], 0 offset:36 sc1
    s_waitcnt vmcnt(0)
cbar_7_t:
    v_cmp_gt_u32 vcc, 64, v124
    s_cbranch_vccz cbar_7_ok
    s_sub_u32 s55, s55, 1
    s_cmp_lg_u32 s55, 0
    s_cbranch_scc1 cbar_7
cbar_7_ok:
    s_mov_b32 s55, 0x40000
    s_branch xn0_8_t
xn0_8:
    buffer_load_dword v125, v126, s[8:11], 0 offen offset:100 sc1
    s_waitcnt vmcnt(0)
xn0_8_t:
    v_cmp_gt_u32 vcc, 32, v125
    s_cbranch_vccz xn0_8_ok
    s_sub_u32 s55, s55, 1
    s_cmp_lg_u32 s55, 0
    s_cbranch_scc1 xn0_8
xn0_8_ok:
    v_and_b32 v126, 4, v0
    buffer_load_ubyte v124, v126, s[4:7], s47 offen sc1
    s_barrier
    ds_read_b64_tr_b16 v[72:73], v62 offset:0
    ds_read_b64_tr_b16 v[74:75], v62 offset:256
    ds_read_b64_tr_b16 v[76:77], v62 offset:4096
    ds_read_b64_tr_b16 v[78:79], v62 offset:4352
    ds_read_b64_tr_b16 v[80:81], v63 offset:0
    ds_read_b64_tr_b16 v[82:83], v63 offset:256
    ds_read_b64_tr_b16 v[84:85], v63 offset:4096
    ds_read_b64_tr_b16 v[86:87], v63 offset:4352
    ds_read_b64_tr_b16 v[88:89], v62 offset:8192
    ds_read_b64_tr_b16 v[90:91], v62 offset:8448
    ds_read_b64_tr_b16 v[92:93], v62 offset:12288
    ds_read_b64_tr_b16 v[94:95], v62 offset:12544
    ds_read_b64_tr_b16 v[96:97], v63 offset:8192
    ds_read_b64_tr_b16 v[98:99], v63 offset:8448
    ds_read_b64_tr_b16 v[100:101], v63 offset:12288
    ds_read_b64_tr_b16 v[102:103], v63 offset:12544
    s_waitcnt lgkmcnt(0)
    s_barrier
    ds_write_b128 v19, v[72:75] offset:0
    ds_write_b128 v19, v[76:79] offset:1024
    ds_write_b128 v19, v[80:83] offset:2048
    ds_write_b128 v19, v[84:87] offset:3072
    ds_write_b128 v19, v[88:91] offset:8192
    ds_write_b128 v19, v[92:95] offset:9216
    ds_write_b128 v19, v[96:99] offset:10240
    ds_write_b128 v19, v[100:103] offset:11264
    ds_read_b64_tr_b16 v[72:73], v62 offset:16384
    ds_read_b64_tr_b16 v[74:75], v62 offset:16640
    ds_read_b64_tr_b16 v[76:77], v62 offset:20480
    ds_read_b64_tr_b16 v[78:79], v62 offset:20736
    ds_read_b64_tr_b16 v[80:81], v63 offset:16384
    ds_read_b64_tr_b16 v[82:83], v63 offset:16640
    ds_read_b64_tr_b16 v[84:85], v63 offset:20480
    ds_read_b64_tr_b16 v[86:87], v63 offset:20736
    ds_read_b64_tr_b16 v[88:89], v62 offset:24576
    ds_read_b64_tr_b16 v[90:91], v62 offset:24832
    ds_read_b64_tr_b16 v[92:93], v62 offset:28672
    ds_read_b64_tr_b16 v[94:95], v62 offset:28928
    ds_read_b64_tr_b16 v[96:97], v63 offset:24576
    ds_read_b64_tr_b16 v[98:99], v63 offset:24832
    ds_read_b64_tr_b16 v[100:101], v63 offset:28672
    ds_read_b64_tr_b16 v[102:103], v63 offset:28928
    s_waitcnt lgkmcnt(0)
    s_barrier
    ds_write_b128 v19, v[72:75] offset:16384
    ds_write_b128 v19, v[76:79] offset:17408
    ds_write_b128 v19, v[80:83] offset:18432
    ds_write_b128 v19, v[84:87] offset:19456
    ds_write_b128 v19, v[88:91] offset:24576
    ds_write_b128 v19, v[92:95] offset:25600
    ds_write_b128 v19, v[96:99] offset:26624
    ds_write_b128 v19, v[100:103] offset:27648
    s_waitcnt vmcnt(9)
    s_barrier
    ds_read_b64_tr_b16 v[72:73], v62 offset:32768
    ds_read_b64_tr_b16 v[74:75], v62 offset:33024
    ds_read_b64_tr_b16 v[76:77], v62 offset:36864
    ds_read_b64_tr_b16 v[78:79], v62 offset:37120
    ds_read_b64_tr_b16 v[80:81], v63 offset:32768
    ds_read_b64_tr_b16 v[82:83], v63 offset:33024
    ds_read_b64_tr_b16 v[84:85], v63 offset:36864
    ds_read_b64_tr_b16 v[86:87], v63 offset:37120
    ds_read_b64_tr_b16 v[88:89], v62 offset:40960
    ds_read_b64_tr_b16 v[90:91], v62 offset:41216
    ds_read_b64_tr_b16 v[92:93], v62 offset:45056
    ds_read_b64_tr_b16 v[94:95], v62 offset:45312
    ds_read_b64_tr_b16 v[96:97], v63 offset:40960
    ds_read_b64_tr_b16 v[98:99], v63 offset:41216
    ds_read_b64_tr_b16 v[100:101], v63 offset:45056
    ds_read_b64_tr_b16 v[102:103], v63 offset:45312
    s_waitcnt lgkmcnt(0)
    s_barrier
    ds_write_b128 v19, v[72:75] offset:32768
    ds_write_b128 v19, v[76:79] offset:33792
    ds_write_b128 v19, v[80:83] offset:34816
    ds_write_b128 v19, v[84:87] offset:35840
    ds_write_b128 v19, v[88:91] offset:40960
    ds_write_b128 v19, v[92:95] offset:41984
    ds_write_b128 v19, v[96:99] offset:43008
    ds_write_b128 v19, v[100:103] offset:44032
    s_waitcnt vmcnt(5)
    s_barrier
    ds_read_b64_tr_b16 v[72:73], v62 offset:49152
    ds_read_b64_tr_b16 v[74:75], v62 offset:49408
    ds_read_b64_tr_b16 v[76:77], v62 offset:53248
    ds_read_b64_tr_b16 v[78:79], v62 offset:53504
    ds_read_b64_tr_b16 v[80:81], v63 offset:49152
    ds_read_b64_tr_b16 v[82:83], v63 offset:49408
    ds_read_b64_tr_b16 v[84:85], v63 offset:53248
    ds_read_b64_tr_b16 v[86:87], v63 offset:53504
    s_waitcnt lgkmcnt(0)
    s_barrier
    ds_write_b128 v19, v[72:75] offset:49152
    ds_write_b128 v19, v[76:79] offset:50176
    ds_write_b128 v19, v[80:83] offset:51200
    ds_write_b128 v19, v[84:87] offset:52224
    s_waitcnt vmcnt(0)
    s_mov_b32 s55, 0x40000
    s_branch kv0_9_t
kv0_9:
    buffer_load_ubyte v124, v126, s[4:7], s47 offen sc1
    s_waitcnt vmcnt(0)
kv0_9_t:
    v_cmp_gt_u32 vcc, 1, v124
    s_cbranch_vccz kv0_9_ok
    s_sub_u32 s55, s55, 1
    s_cmp_lg_u32 s55, 0
    s_cbranch_scc1 kv0_9
kv0_9_ok:
EARLY_B:
    s_lshl_b32 s54, s44, 10
    s_add_u32 s54, s54, 16384
    s_mov_b32 m0, s54
    s_xor_b32 s54, s54, 4096
    buffer_load_dwordx4 v11, s[4:7], 0 offen sc1 lds
    s_barrier
    ds_read_b64_tr_b16 v[72:73], v62 offset:57344
    ds_read_b64_tr_b16 v[74:75], v62 offset:57600
    ds_read_b64_tr_b16 v[76:77], v62 offset:61440
    ds_read_b64_tr_b16 v[78:79], v62 offset:61696
    ds_read_b64_tr_b16 v[80:81], v63 offset:57344
    ds_read_b64_tr_b16 v[82:83], v63 offset:57600
    ds_read_b64_tr_b16 v[84:85], v63 offset:61440
    ds_read_b64_tr_b16 v[86:87], v63 offset:61696
    s_waitcnt lgkmcnt(0)
    s_barrier
    ds_write_b128 v19, v[72:75] offset:57344
    ds_write_b128 v19, v[76:79] offset:58368
    ds_write_b128 v19, v[80:83] offset:59392
    ds_write_b128 v19, v[84:87] offset:60416
    v_mov_b32 v52, v36
    v_mov_b32 v53, v37
    v_mov_b32 v54, v38
    v_mov_b32 v55, v39
    v_mov_b32 v56, v40
    v_mov_b32 v57, v41
    v_mov_b32 v58, v42
    v_mov_b32 v59, v43
    v_mov_b32 v60, v44
    v_mov_b32 v61, v45
    v_mov_b32 v62, v46
    v_mov_b32 v63, v47
    v_mov_b32 v64, v120
    v_mov_b32 v65, v121
    v_mov_b32 v66, v122
    v_mov_b32 v67, v123
    s_mov_b32 s55, 0x40000
    s_mov_b32 s45, 0
    s_mov_b32 s92, 1
    s_mov_b32 s46, s77
    s_add_u32 s49, s77, 4096
    s_add_u32 s50, s77, 0x80000
    s_mov_b32 s93, 0
    s_lshl_b32 s27, s43, 9
    s_and_b32 s78, s27, 0xffffe000
    s_add_u32 s27, s27, s78
    s_lshl_b32 s59, s44, 7
    s_add_u32 s27, s27, s59
    s_xor_b32 s59, s42, 1
    s_mul_i32 s59, s59, 0x400000
    s_add_u32 s27, s27, s59
    s_add_u32 s27, s27, 0x6008000
    s_mov_b32 s25, s77
    s_mov_b32 s32, 0xcccccccc
    s_mov_b32 s33, 0xcccccccc
    s_add_u32 s48, s77, 0x180000
    s_mov_b32 s51, 0
    s_mov_b32 s52, 0x40000
    s_mov_b32 s53, 0
    s_mov_b32 s3, 0x8000000
    s_mov_b32 s60, 0
    s_mov_b32 s61, 0
    s_mov_b32 s62, 0
    s_mov_b32 s63, 0
    v_mov_b32 v40, 0
    v_mov_b32 v41, 0
    v_mov_b32 v42, 0
    v_mov_b32 v43, 0
    v_mov_b32 v44, 0
    v_mov_b32 v45, 0
    v_mov_b32 v46, 0
    v_mov_b32 v47, 0
    v_mov_b32 v48, 0
    v_mov_b32 v49, 0
    v_mov_b32 v50, 0
    v_mov_b32 v51, 0
    s_waitcnt vmcnt(0)
    s_cmp_eq_u32 s44, 0
    s_cbranch_scc1 c0_entry
    s_cmp_eq_u32 s44, 1
    s_cbranch_scc1 c1_entry
    s_cmp_eq_u32 s44, 2
    s_cbranch_scc1 c2_entry
    s_branch c3_entry
c0_entry:
    ds_write_b128 v13, v[52:55] offset:0
    ds_write_b128 v13, v[56:59] offset:1024
    ds_write_b128 v13, v[60:63] offset:2048
    ds_write_b128 v13, v[64:67] offset:3072
    s_branch c0_apost
.p2align 6
    s_nop 0
    s_nop 0
    s_nop 0
    s_nop 0
    s_nop 0
    s_nop 0
    s_nop 0
c0_top:
    ds_read_b64_tr_b16 v[116:117], v15 offset:512
    ds_read_b64_tr_b16 v[118:119], v15 offset:768
    v_mov_b32 v40, 0
    v_mov_b32 v41, 0
    v_mov_b32 v42, 0
    v_mov_b32 v43, 0
    v_mov_b32 v44, 0
    v_mov_b32 v45, 0
    v_mov_b32 v46, 0
    v_mov_b32 v47, 0
    v_mov_b32 v48, 0
    v_mov_b32 v49, 0
    v_mov_b32 v50, 0
    v_mov_b32 v51, 0
    s_nop 15
    s_nop 15
    s_nop 15
    s_nop 14
    s_nop 14
    s_nop 14
    s_nop 14
    buffer_load_dwordx4 v[52:55], v2, s[4:7], s46 offen offset:0 sc1
    buffer_load_dwordx4 v[56:59], v2, s[4:7], s46 offen offset:1024 sc1
    buffer_load_dwordx4 v[60:63], v2, s[4:7], s46 offen offset:2048 sc1
    buffer_load_dwordx4 v[64:67], v2, s[4:7], s46 offen offset:3072 sc1
    s_barrier
    buffer_load_dwordx4 v[68:71], v1, s[4:7], s46 offen offset:0 sc1
    buffer_load_dwordx4 v[72:75], v1, s[4:7], s46 offen offset:1024 sc1
    buffer_load_dwordx4 v[76:79], v1, s[4:7], s46 offen offset:2048 sc1
    buffer_load_dwordx4 v[80:83], v1, s[4:7], s46 offen offset:3072 sc1
    s_waitcnt vmcnt(4)
c0_mo_chk:
    v_max3_u32 v22, v52, v56, v60
    v_max_u32 v22, v22, v64
    v_cmp_eq_u32 vcc, -1, v22
    s_cbranch_vccnz c0_mo_retry
c0_mo_ok:
    v_mfma_f32_4x4x4_16b_bf16 v[84:87], v[24:25], v[52:53], 0
    v_mfma_f32_4x4x4_16b_bf16 v[88:91], v[24:25], v[54:55], 0
    v_mfma_f32_4x4x4_16b_bf16 v[92:95], v[24:25], v[56:57], 0
    v_mfma_f32_4x4x4_16b_bf16 v[96:99], v[24:25], v[58:59], 0
    v_mfma_f32_4x4x4_16b_bf16 v[100:103], v[24:25], v[60:61], 0
    v_mfma_f32_4x4x4_16b_bf16 v[104:107], v[24:25], v[62:63], 0
    v_mfma_f32_4x4x4_16b_bf16 v[108:111], v[24:25], v[64:65], 0
    v_mfma_f32_4x4x4_16b_bf16 v[112:115], v[24:25], v[66:67], 0
c0_mx_run:
    s_waitcnt vmcnt(3) lgkmcnt(0)
    v_mfma_f32_4x4x4_16b_bf16 v[84:87], v[24:25], v[68:69], v[84:87]
    v_mfma_f32_4x4x4_16b_bf16 v[88:91], v[24:25], v[70:71], v[88:91]
    s_waitcnt vmcnt(2)
    v_mfma_f32_4x4x4_16b_bf16 v[92:95], v[24:25], v[72:73], v[92:95]
    v_mfma_f32_4x4x4_16b_bf16 v[96:99], v[24:25], v[74:75], v[96:99]
    v_max_u32 v22, v68, v72
    v_cvt_pk_bf16_f32 v52, v84, v85
    v_cvt_pk_bf16_f32 v53, v86, v87
    v_cvt_pk_bf16_f32 v54, v88, v89
    v_cvt_pk_bf16_f32 v55, v90, v91
    ds_write_b128 v13, v[52:55] offset:0
    s_waitcnt vmcnt(1)
    v_mfma_f32_4x4x4_16b_bf16 v[100:103], v[24:25], v[76:77], v[100:103]
    v_mfma_f32_4x4x4_16b_bf16 v[104:107], v[24:25], v[78:79], v[104:107]
    v_cvt_pk_bf16_f32 v56, v92, v93
    v_cvt_pk_bf16_f32 v57, v94, v95
    v_cvt_pk_bf16_f32 v58, v96, v97
    v_cvt_pk_bf16_f32 v59, v98, v99
    ds_write_b128 v13, v[56:59] offset:1024
    s_waitcnt vmcnt(0)
    v_mfma_f32_4x4x4_16b_bf16 v[108:111], v[24:25], v[80:81], v[108:111]
    v_mfma_f32_4x4x4_16b_bf16 v[112:115], v[24:25], v[82:83], v[112:115]
    v_max3_u32 v22, v22, v76, v80
    v_cvt_pk_bf16_f32 v60, v100, v101
    v_cvt_pk_bf16_f32 v61, v102, v103
    v_cmp_eq_u32 vcc, -1, v22
    v_cvt_pk_bf16_f32 v62, v104, v105
    v_cvt_pk_bf16_f32 v63, v106, v107
    ds_write_b128 v13, v[60:63] offset:2048
    v_cvt_pk_bf16_f32 v64, v108, v109
    v_cvt_pk_bf16_f32 v65, v110, v111
    v_cvt_pk_bf16_f32 v66, v112, v113
    v_cvt_pk_bf16_f32 v67, v114, v115
    ds_write_b128 v13, v[64:67] offset:3072
    s_cbranch_vccnz c0_mx_retry
c0_mx_ok:
c0_apost:
    v_smfmac_f32_16x16x64_bf16 v[40:43], v[52:55], a[0:7], v20
    v_smfmac_f32_16x16x64_bf16 v[44:47], v[52:55], a[128:135], v20
    v_smfmac_f32_16x16x64_bf16 v[40:43], v[56:59], a[8:15], v20
    v_smfmac_f32_16x16x64_bf16 v[44:47], v[56:59], a[136:143], v20
    s_mov_b32 m0, s54
    s_xor_b32 s54, s54, 4096
    buffer_load_dwordx4 v11, s[4:7], s52 offen sc1 lds
    buffer_load_dwordx4 v[36:39], v10, s[4:7], s51 offen sc1
    s_waitcnt lgkmcnt(0)
    s_barrier
    ds_read_b128 v[68:71], v13 offset:4096
    ds_read_b128 v[72:75], v13 offset:5120
    ds_read_b128 v[76:79], v13 offset:6144
    ds_read_b128 v[80:83], v13 offset:7168
    v_smfmac_f32_16x16x64_bf16 v[40:43], v[60:63], a[16:23], v20
    ds_read_b128 v[84:87], v13 offset:8192
    ds_read_b128 v[88:91], v13 offset:9216
    ds_read_b128 v[92:95], v13 offset:10240
    v_smfmac_f32_16x16x64_bf16 v[44:47], v[60:63], a[144:151], v20
    ds_read_b128 v[96:99], v13 offset:11264
    ds_read_b128 v[100:103], v13 offset:12288
    ds_read_b128 v[104:107], v13 offset:13312
    v_smfmac_f32_16x16x64_bf16 v[40:43], v[64:67], a[24:31], v20
    ds_read_b128 v[108:111], v13 offset:14336
    ds_read_b128 v[112:115], v13 offset:15360
    v_smfmac_f32_16x16x64_bf16 v[44:47], v[64:67], a[152:159], v20
    s_waitcnt lgkmcnt(11)
    v_smfmac_f32_16x16x64_bf16 v[40:43], v[68:71], a[32:39], v20
    buffer_store_dwordx4 v[116:119], v8, s[4:7], s3 offen sc1
    v_smfmac_f32_16x16x64_bf16 v[44:47], v[68:71], a[160:167], v20
    s_waitcnt lgkmcnt(10)
    v_smfmac_f32_16x16x64_bf16 v[40:43], v[72:75], a[40:47], v20
    buffer_store_dword v30, v9, s[4:7], s3 offen sc1
    v_smfmac_f32_16x16x64_bf16 v[44:47], v[72:75], a[168:175], v20
    s_waitcnt lgkmcnt(9)
    v_smfmac_f32_16x16x64_bf16 v[40:43], v[76:79], a[48:55], v20
    buffer_store_dwordx4 v[32:35], v12, s[4:7], s48 offen
    v_smfmac_f32_16x16x64_bf16 v[44:47], v[76:79], a[176:183], v20
    s_waitcnt lgkmcnt(8)
    v_smfmac_f32_16x16x64_bf16 v[40:43], v[80:83], a[56:63], v20
    buffer_store_dwordx4 v[32:35], v12, s[4:7], s48 offen offset:1024
    v_smfmac_f32_16x16x64_bf16 v[44:47], v[80:83], a[184:191], v20
    s_waitcnt lgkmcnt(7)
    v_smfmac_f32_16x16x64_bf16 v[40:43], v[84:87], a[64:71], v20
    ds_read_b128 v[68:71], v19 offset:49152
    v_smfmac_f32_16x16x64_bf16 v[44:47], v[84:87], a[192:199], v20
    s_waitcnt lgkmcnt(7)
    v_smfmac_f32_16x16x64_bf16 v[40:43], v[88:91], a[72:79], v20
    ds_read_b128 v[72:75], v19 offset:50176
    v_smfmac_f32_16x16x64_bf16 v[44:47], v[88:91], a[200:207], v20
    s_waitcnt lgkmcnt(7)
    v_smfmac_f32_16x16x64_bf16 v[40:43], v[92:95], a[80:87], v20
    ds_read_b128 v[116:119], v19 offset:57344
    v_smfmac_f32_16x16x64_bf16 v[44:47], v[92:95], a[208:215], v20
    s_waitcnt lgkmcnt(7)
    v_smfmac_f32_16x16x64_bf16 v[40:43], v[96:99], a[88:95], v20
    ds_read_b128 v[120:123], v19 offset:58368
    v_smfmac_f32_16x16x64_bf16 v[44:47], v[96:99], a[216:223], v20
    s_waitcnt lgkmcnt(7)
    v_smfmac_f32_16x16x64_bf16 v[40:43], v[100:103], a[96:103], v20
    ds_read_b128 v[52:55], v16 offset:0
    v_smfmac_f32_16x16x64_bf16 v[44:47], v[100:103], a[224:231], v20
    s_waitcnt lgkmcnt(7)
    v_smfmac_f32_16x16x64_bf16 v[40:43], v[104:107], a[104:111], v20
    ds_read_b128 v[56:59], v16 offset:1024
    v_smfmac_f32_16x16x64_bf16 v[44:47], v[104:107], a[232:239], v20
    s_waitcnt lgkmcnt(7)
    v_smfmac_f32_16x16x64_bf16 v[40:43], v[108:111], a[112:119], v20
    ds_read_b128 v[60:63], v16 offset:2048
    v_smfmac_f32_16x16x64_bf16 v[44:47], v[108:111], a[240:247], v20
    s_waitcnt lgkmcnt(7)
    v_smfmac_f32_16x16x64_bf16 v[40:43], v[112:115], a[120:127], v20
    ds_read_b128 v[64:67], v16 offset:3072
    s_cmp_eq_u32 s45, 63
    v_smfmac_f32_16x16x64_bf16 v[44:47], v[112:115], a[248:255], v20
    s_cbranch_scc1 c0_last
    s_waitcnt lgkmcnt(6)
    v_smfmac_f32_16x16x64_bf16 v[48:51], v[76:79], v[68:75], v20
    v_pk_add_f32 v[40:41], v[40:41], v[42:43]
    v_cvt_pk_bf16_f32 v40, v40, v41
    ds_write2_b32 v14, v40, v40 offset0:0 offset1:1
    s_nop 0
    v_pk_add_f32 v[44:45], v[44:45], v[46:47]
    v_cvt_pk_bf16_f32 v44, v44, v45
    ds_write2_b32 v14, v44, v44 offset0:128 offset1:129
    s_waitcnt lgkmcnt(6)
    v_smfmac_f32_16x16x64_bf16 v[48:51], v[80:83], v[116:123], v20
    v_xor_b32 v16, 4096, v16
    s_waitcnt lgkmcnt(0)
    s_barrier
    ds_read_b64_tr_b16 v[116:117], v15 offset:0
    ds_read_b64_tr_b16 v[118:119], v15 offset:256
    ds_read_b64_tr_b16 v[120:121], v15 offset:2048
    ds_read_b64_tr_b16 v[122:123], v15 offset:2304
    ds_read_b64_tr_b16 v[68:69], v15 offset:512
    ds_read_b64_tr_b16 v[70:71], v15 offset:768
    ds_read_b64_tr_b16 v[72:73], v15 offset:2560
    ds_read_b64_tr_b16 v[74:75], v15 offset:2816
    ds_read_b128 v[76:79], v19 offset:2048
    ds_read_b128 v[80:83], v19 offset:3072
    s_waitcnt lgkmcnt(6)
    v_mfma_f32_16x16x32_bf16 v[40:43], v[52:55], v[116:119], 0
    v_mfma_f32_16x16x32_bf16 v[40:43], v[56:59], v[120:123], v[40:43]
    v_mfma_f32_16x16x32_bf16 v[44:47], v[60:63], v[116:119], 0
    v_mfma_f32_16x16x32_bf16 v[44:47], v[64:67], v[120:123], v[44:47]
    buffer_store_dwordx4 v[40:43], v5, s[4:7], s46 offen
    s_waitcnt lgkmcnt(2)
    v_mfma_f32_16x16x32_bf16 v[124:127], v[68:71], v[116:119], 0
    v_mfma_f32_16x16x32_bf16 v[124:127], v[72:75], v[120:123], v[124:127]
    ds_read_b128 v[52:55], v19 offset:10240
    ds_read_b128 v[56:59], v19 offset:11264
    ds_read_b128 v[60:63], v19 offset:18432
    ds_read_b128 v[64:67], v19 offset:19456
    ds_read_b128 v[68:71], v19 offset:26624
    ds_read_b128 v[72:75], v19 offset:27648
    ds_read_b128 v[116:119], v19 offset:34816
    ds_read_b128 v[120:123], v19 offset:35840
    v_cndmask_b32 v40, v40, v44, s[32:33]
    v_cndmask_b32 v41, v41, v45, s[32:33]
    v_cndmask_b32 v42, v42, v46, s[32:33]
    v_cndmask_b32 v43, v43, v47, s[32:33]
    v_cndmask_b32 v124, v124, v125, s[32:33]
    v_mov_b32 v127, 0
    s_waitcnt lgkmcnt(8)
    v_smfmac_f32_16x16x64_bf16 v[48:51], v[84:87], v[76:83], v20
    ds_read_b128 v[76:79], v19 offset:43008
    ds_read_b128 v[80:83], v19 offset:44032
    s_waitcnt lgkmcnt(8)
    v_smfmac_f32_16x16x64_bf16 v[48:51], v[88:91], v[52:59], v20
    ds_read_b128 v[52:55], v19 offset:51200
    ds_read_b128 v[56:59], v19 offset:52224
    ds_read_b128 v[84:87], v13 offset:0
    ds_read_b128 v[88:91], v13 offset:1024
    s_waitcnt lgkmcnt(10)
    v_smfmac_f32_16x16x64_bf16 v[48:51], v[92:95], v[60:67], v20
    ds_read_b128 v[60:63], v19 offset:59392
    ds_read_b128 v[64:67], v19 offset:60416
    s_waitcnt lgkmcnt(10)
    v_smfmac_f32_16x16x64_bf16 v[48:51], v[96:99], v[68:75], v20
    ds_read_b128 v[68:71], v19 offset:0
    ds_read_b128 v[72:75], v19 offset:1024
    ds_read_b128 v[92:95], v13 offset:2048
    ds_read_b128 v[96:99], v13 offset:3072
    s_waitcnt lgkmcnt(12)
    v_smfmac_f32_16x16x64_bf16 v[48:51], v[100:103], v[116:123], v20
    ds_read_b128 v[116:119], v19 offset:8192
    ds_read_b128 v[120:123], v19 offset:9216
    s_waitcnt vmcnt(0)
    buffer_load_dwordx4 v[44:47], v6, s[4:7], s46 offen sc1
    buffer_load_dword v125, v6, s[4:7], s46 offen offset:1024 sc1
    s_waitcnt lgkmcnt(12)
    v_smfmac_f32_16x16x64_bf16 v[48:51], v[104:107], v[76:83], v20
    ds_read_b128 v[76:79], v19 offset:16384
    ds_read_b128 v[80:83], v19 offset:17408
    ds_read_b128 v[100:103], v13 offset:4096
    ds_read_b128 v[104:107], v13 offset:5120
    s_waitcnt lgkmcnt(14)
    v_smfmac_f32_16x16x64_bf16 v[48:51], v[108:111], v[52:59], v20
    ds_read_b128 v[52:55], v19 offset:24576
    ds_read_b128 v[56:59], v19 offset:25600
    s_waitcnt lgkmcnt(12)
    v_smfmac_f32_16x16x64_bf16 v[48:51], v[112:115], v[60:67], v20
    ds_read_b128 v[60:63], v19 offset:32768
    ds_read_b128 v[64:67], v19 offset:33792
    s_waitcnt lgkmcnt(12)
    v_smfmac_f32_16x16x64_bf16 v[48:51], v[84:87], v[68:75], v20
    ds_read_b128 v[68:71], v19 offset:40960
    ds_read_b128 v[72:75], v19 offset:41984
    s_waitcnt lgkmcnt(10)
    v_smfmac_f32_16x16x64_bf16 v[48:51], v[88:91], v[116:123], v20
    s_waitcnt lgkmcnt(8)
    v_smfmac_f32_16x16x64_bf16 v[48:51], v[92:95], v[76:83], v20
    s_waitcnt lgkmcnt(4)
    v_smfmac_f32_16x16x64_bf16 v[48:51], v[96:99], v[52:59], v20
    s_waitcnt lgkmcnt(2)
    v_smfmac_f32_16x16x64_bf16 v[48:51], v[100:103], v[60:67], v20
    s_waitcnt lgkmcnt(0)
    v_smfmac_f32_16x16x64_bf16 v[48:51], v[104:107], v[68:75], v20
    s_mov_b32 s56, 0x3e0293ee
    s_nop 6
    v_pk_add_f32 v[48:49], v[48:49], v[50:51]
    v_cvt_pk_bf16_f32 v30, v48, v49
    s_waitcnt vmcnt(0)
c0_s_chk:
    v_pk_add_f32 v[44:45], v[44:45], v[40:41]
    v_pk_add_f32 v[46:47], v[46:47], v[42:43]
    v_add_f32 v125, v125, v124
    v_maximum3_f32 v22, v44, v45, v46
    v_maximum3_f32 v22, v22, v47, v125
    v_cmp_u_f32 vcc, v22, v22
    s_cbranch_vccnz c0_s_retry
c0_s_ok:
    v_max_f32_dpp v23, v22, v22 quad_perm:[2,3,0,1] row_mask:0xf bank_mask:0xf
    v_max_f32_dpp v21, v22, v22 quad_perm:[2,3,0,1] row_mask:0xf bank_mask:0xf
    v_mov_b32 v40, 0
    v_mov_b32 v41, 0
    v_permlane32_swap_b32 v23, v21
    v_max_f32 v22, v23, v21
    v_max_f32 v23, v23, v21
    v_mov_b32 v42, 0
    v_mov_b32 v43, 0
    v_permlane16_swap_b32 v22, v23
    v_max_f32 v22, v22, v23
    v_mul_f32 v22, 0xbe0293ee, v22
    v_fma_f32 v125, v125, s56, v22
    v_pk_fma_f32 v[44:45], v[44:45], s[56:57], v[22:23] op_sel_hi:[1,0,0]
    v_exp_f32 v125, v125
    v_pk_fma_f32 v[46:47], v[46:47], s[56:57], v[22:23] op_sel_hi:[1,0,0]
    v_exp_f32 v44, v44
    v_mov_b32_dpp v23, v125 quad_perm:[2,3,2,3] row_mask:0xf bank_mask:0xf
    v_exp_f32 v45, v45
    v_cvt_pk_bf16_f32 v126, v125, v23
    v_exp_f32 v46, v46
    v_cvt_pk_bf16_f32 v52, v44, v45
    v_exp_f32 v47, v47
    v_mfma_f32_16x16x16_bf16 v[56:59], v[26:27], v[126:127], 0
    v_cvt_pk_bf16_f32 v53, v46, v47
    v_mov_b32_dpp v54, v52 quad_perm:[2,3,2,3] row_mask:0xf bank_mask:0xf
    v_mfma_f32_16x16x16_bf16 v[60:63], v[30:31], v[126:127], 0
    v_mov_b32_dpp v55, v53 quad_perm:[2,3,2,3] row_mask:0xf bank_mask:0xf
    v_mov_b32 v44, 0
    v_mov_b32 v45, 0
    v_mfma_f32_16x16x32_bf16 v[56:59], v[26:29], v[52:55], v[56:59]
    v_mfma_f32_16x16x32_bf16 v[60:63], v[36:39], v[52:55], v[60:63]
    v_mov_b32 v46, 0
    v_mov_b32 v47, 0
    s_nop 1
    v_rcp_f32 v22, v56
    s_nop 2
    v_pk_mul_f32 v[60:61], v[60:61], v[22:23] op_sel_hi:[1,0]
    v_pk_mul_f32 v[62:63], v[62:63], v[22:23] op_sel_hi:[1,0]
    v_cvt_pk_bf16_f32 v48, v60, v61
    v_cvt_pk_bf16_f32 v49, v62, v63
    buffer_store_dwordx2 v[48:49], v4, s[4:7], s46 offen
    s_mov_b32 s16, 0
    s_barrier
    s_nop 9
    s_nop 9
    s_nop 9
    s_nop 8
    s_nop 8
    buffer_load_dwordx4 v[76:79], v3, s[4:7], s46 offen offset:0 sc1
    s_nop 5
    buffer_load_dwordx4 v[80:83], v3, s[4:7], s46 offen offset:1024 sc1
    s_nop 5
    buffer_load_dwordx4 v[84:87], v3, s[4:7], s46 offen offset:2048 sc1
    s_nop 5
    buffer_load_dwordx4 v[88:91], v3, s[4:7], s46 offen offset:3072 sc1
    s_nop 5
    buffer_load_dwordx4 v[92:95], v3, s[4:7], s49 offen offset:0 sc1
    s_nop 5
    buffer_load_dwordx4 v[96:99], v3, s[4:7], s49 offen offset:1024 sc1
    s_nop 5
    buffer_load_dwordx4 v[100:103], v3, s[4:7], s49 offen offset:2048 sc1
    s_nop 5
    buffer_load_dwordx4 v[104:107], v3, s[4:7], s49 offen offset:3072 sc1
    s_waitcnt vmcnt(7)
    v_max_u32 v22, v76, v78
    v_cmp_eq_u32 vcc, -1, v22
    s_cbranch_vccnz c0_om0
    v_smfmac_f32_16x16x64_bf16 v[40:43], v[76:79], v[128:135], v20
    v_smfmac_f32_16x16x64_bf16 v[44:47], v[76:79], v[136:143], v20
c0_ob0:
    s_waitcnt vmcnt(6)
    v_max_u32 v22, v80, v82
    v_cmp_eq_u32 vcc, -1, v22
    s_cbranch_vccnz c0_om1
    v_smfmac_f32_16x16x64_bf16 v[40:43], v[80:83], v[144:151], v20
    v_smfmac_f32_16x16x64_bf16 v[44:47], v[80:83], v[152:159], v20
c0_ob1:
    s_waitcnt vmcnt(5)
    v_max_u32 v22, v84, v86
    v_cmp_eq_u32 vcc, -1, v22
    s_cbranch_vccnz c0_om2
    v_smfmac_f32_16x16x64_bf16 v[40:43], v[84:87], v[160:167], v20
    v_smfmac_f32_16x16x64_bf16 v[44:47], v[84:87], v[168:175], v20
c0_ob2:
    s_waitcnt vmcnt(4)
    v_max_u32 v22, v88, v90
    v_cmp_eq_u32 vcc, -1, v22
    s_cbranch_vccnz c0_om3
    v_smfmac_f32_16x16x64_bf16 v[40:43], v[88:91], v[176:183], v20
    v_smfmac_f32_16x16x64_bf16 v[44:47], v[88:91], v[184:191], v20
c0_ob3:
    s_waitcnt vmcnt(3)
    v_max_u32 v22, v92, v94
    v_cmp_eq_u32 vcc, -1, v22
    s_cbranch_vccnz c0_om4
    v_smfmac_f32_16x16x64_bf16 v[40:43], v[92:95], v[192:199], v20
    v_smfmac_f32_16x16x64_bf16 v[44:47], v[92:95], v[200:207], v20
c0_ob4:
    s_waitcnt vmcnt(2)
    v_max_u32 v22, v96, v98
    v_cmp_eq_u32 vcc, -1, v22
    s_cbranch_vccnz c0_om5
    v_smfmac_f32_16x16x64_bf16 v[40:43], v[96:99], v[208:215], v20
    v_smfmac_f32_16x16x64_bf16 v[44:47], v[96:99], v[216:223], v20
c0_ob5:
    s_waitcnt vmcnt(1)
    v_max_u32 v22, v100, v102
    v_cmp_eq_u32 vcc, -1, v22
    s_cbranch_vccnz c0_om6
    v_smfmac_f32_16x16x64_bf16 v[40:43], v[100:103], v[224:231], v20
    v_smfmac_f32_16x16x64_bf16 v[44:47], v[100:103], v[232:239], v20
c0_ob6:
    s_waitcnt vmcnt(0)
    v_max_u32 v22, v104, v106
    v_cmp_eq_u32 vcc, -1, v22
    s_cbranch_vccnz c0_om7
    v_smfmac_f32_16x16x64_bf16 v[40:43], v[104:107], v[240:247], v20
    v_smfmac_f32_16x16x64_bf16 v[44:47], v[104:107], v[248:255], v20
c0_ob7:
    s_cmp_lg_u32 s16, 0
    s_cbranch_scc1 c0_ofix
c0_o_end:
    s_mov_b32 s48, s46
    s_mov_b32 s46, s50
    s_nop 0
    v_pk_add_f32 v[40:41], v[40:41], v[42:43]
    ds_write2st64_b32 v17, v40, v41 offset0:0 offset1:1
    s_add_u32 s49, s46, 4096
    s_nop 0
    v_pk_add_f32 v[44:45], v[44:45], v[46:47]
    ds_write2st64_b32 v17, v44, v45 offset0:8 offset1:9
    s_mov_b32 s45, s92
    s_add_u32 s92, s92, 1
    s_add_u32 s50, s50, 0x80000
    s_and_b32 s50, s50, 0x1c2000
    s_mov_b32 s51, s52
    s_add_u32 s52, s52, 0x40000
    s_mov_b32 s3, s53
    s_add_u32 s53, s53, 0x10000
    s_waitcnt lgkmcnt(0)
    s_barrier
    ds_read_b128 v[52:55], v18 offset:0
    ds_read_b128 v[56:59], v18 offset:16
    s_waitcnt lgkmcnt(1)
    v_pk_add_f32 v[52:53], v[52:53], v[54:55]
    s_waitcnt lgkmcnt(0)
    v_pk_add_f32 v[56:57], v[56:57], v[58:59]
    v_pk_add_f32 v[52:53], v[52:53], v[56:57]
    v_cvt_pk_bf16_f32 v23, v52, v53
    buffer_store_dword v23, v7, s[4:7], s46 offen
    s_branch c0_top
c0_last:
    s_waitcnt lgkmcnt(0)
    v_smfmac_f32_16x16x64_bf16 v[48:51], v[76:79], v[68:75], v20
    v_smfmac_f32_16x16x64_bf16 v[48:51], v[80:83], v[116:123], v20
    v_pk_add_f32 v[44:45], v[44:45], v[46:47]
    v_cvt_pk_bf16_f32 v44, v44, v45
    ds_write2_b32 v14, v44, v44 offset0:128 offset1:129
    ds_read_b128 v[76:79], v19 offset:2048
    ds_read_b128 v[80:83], v19 offset:3072
    ds_read_b128 v[52:55], v19 offset:10240
    ds_read_b128 v[56:59], v19 offset:11264
    ds_read_b128 v[60:63], v19 offset:18432
    ds_read_b128 v[64:67], v19 offset:19456
    ds_read_b128 v[68:71], v19 offset:26624
    ds_read_b128 v[72:75], v19 offset:27648
    s_waitcnt lgkmcnt(8)
    s_barrier
    ds_read_b64_tr_b16 v[124:125], v15 offset:512
    ds_read_b64_tr_b16 v[126:127], v15 offset:768
    ds_read_b128 v[116:119], v19 offset:34816
    ds_read_b128 v[120:123], v19 offset:35840
    s_waitcnt lgkmcnt(2)
    buffer_store_dwordx4 v[124:127], v8, s[4:7], s53 offen sc1
    v_smfmac_f32_16x16x64_bf16 v[48:51], v[84:87], v[76:83], v20
    ds_read_b128 v[76:79], v19 offset:43008
    ds_read_b128 v[80:83], v19 offset:44032
    v_smfmac_f32_16x16x64_bf16 v[48:51], v[88:91], v[52:59], v20
    ds_read_b128 v[52:55], v19 offset:51200
    ds_read_b128 v[56:59], v19 offset:52224
    ds_read_b128 v[84:87], v13 offset:0
    ds_read_b128 v[88:91], v13 offset:1024
    v_smfmac_f32_16x16x64_bf16 v[48:51], v[92:95], v[60:67], v20
    ds_read_b128 v[60:63], v19 offset:59392
    ds_read_b128 v[64:67], v19 offset:60416
    v_smfmac_f32_16x16x64_bf16 v[48:51], v[96:99], v[68:75], v20
    ds_read_b128 v[68:71], v19 offset:0
    ds_read_b128 v[72:75], v19 offset:1024
    ds_read_b128 v[92:95], v13 offset:2048
    ds_read_b128 v[96:99], v13 offset:3072
    s_waitcnt lgkmcnt(12)
    v_smfmac_f32_16x16x64_bf16 v[48:51], v[100:103], v[116:123], v20
    ds_read_b128 v[116:119], v19 offset:8192
    ds_read_b128 v[120:123], v19 offset:9216
    s_waitcnt lgkmcnt(12)
    v_smfmac_f32_16x16x64_bf16 v[48:51], v[104:107], v[76:83], v20
    ds_read_b128 v[76:79], v19 offset:16384
    ds_read_b128 v[80:83], v19 offset:17408
    ds_read_b128 v[100:103], v13 offset:4096
    ds_read_b128 v[104:107], v13 offset:5120
    s_waitcnt lgkmcnt(14)
    v_smfmac_f32_16x16x64_bf16 v[48:51], v[108:111], v[52:59], v20
    ds_read_b128 v[52:55], v19 offset:24576
    ds_read_b128 v[56:59], v19 offset:25600
    s_waitcnt lgkmcnt(12)
    v_smfmac_f32_16x16x64_bf16 v[48:51], v[112:115], v[60:67], v20
    ds_read_b128 v[60:63], v19 offset:32768
    ds_read_b128 v[64:67], v19 offset:33792
    s_waitcnt lgkmcnt(12)
    v_smfmac_f32_16x16x64_bf16 v[48:51], v[84:87], v[68:75], v20
    ds_read_b128 v[68:71], v19 offset:40960
    ds_read_b128 v[72:75], v19 offset:41984
    s_waitcnt lgkmcnt(10)
    v_smfmac_f32_16x16x64_bf16 v[48:51], v[88:91], v[116:123], v20
    s_waitcnt lgkmcnt(8)
    v_smfmac_f32_16x16x64_bf16 v[48:51], v[92:95], v[76:83], v20
    s_waitcnt lgkmcnt(4)
    v_smfmac_f32_16x16x64_bf16 v[48:51], v[96:99], v[52:59], v20
    s_waitcnt lgkmcnt(2)
    v_smfmac_f32_16x16x64_bf16 v[48:51], v[100:103], v[60:67], v20
    s_waitcnt lgkmcnt(0)
    v_smfmac_f32_16x16x64_bf16 v[48:51], v[104:107], v[68:75], v20
    s_nop 7
    v_pk_add_f32 v[48:49], v[48:49], v[50:51]
    v_cvt_pk_bf16_f32 v30, v48, v49
    buffer_store_dword v30, v9, s[4:7], s53 offen sc1
    s_branch CDONE
c0_mo_retry:
    s_add_u32 s60, s60, 1
    s_cmp_eq_u32 s55, 0
    s_cbranch_scc1 c0_mo_ok
    s_sub_u32 s55, s55, 1
    v_cmp_eq_u32 s[16:17], -1, v52
    v_cmp_eq_u32 s[18:19], -1, v56
    v_cmp_eq_u32 s[20:21], -1, v60
    v_cmp_eq_u32 s[22:23], -1, v64
    s_mov_b64 exec, s[16:17]
    buffer_load_dwordx4 v[52:55], v2, s[4:7], s46 offen offset:0 sc1
    s_mov_b64 exec, s[18:19]
    buffer_load_dwordx4 v[56:59], v2, s[4:7], s46 offen offset:1024 sc1
    s_mov_b64 exec, s[20:21]
    buffer_load_dwordx4 v[60:63], v2, s[4:7], s46 offen offset:2048 sc1
    s_mov_b64 exec, s[22:23]
    buffer_load_dwordx4 v[64:67], v2, s[4:7], s46 offen offset:3072 sc1
    s_mov_b64 exec, -1
    s_waitcnt vmcnt(0)
    s_branch c0_mo_chk
c0_mx_retry:
    s_add_u32 s61, s61, 1
    s_cmp_eq_u32 s55, 0
    s_cbranch_scc1 c0_mx_ok
    s_sub_u32 s55, s55, 1
    v_cmp_eq_u32 s[16:17], -1, v68
    v_cmp_eq_u32 s[18:19], -1, v72
    v_cmp_eq_u32 s[20:21], -1, v76
    v_cmp_eq_u32 s[22:23], -1, v80
    s_mov_b64 exec, s[16:17]
    buffer_load_dwordx4 v[68:71], v1, s[4:7], s46 offen offset:0 sc1
    s_mov_b64 exec, s[18:19]
    buffer_load_dwordx4 v[72:75], v1, s[4:7], s46 offen offset:1024 sc1
    s_mov_b64 exec, s[20:21]
    buffer_load_dwordx4 v[76:79], v1, s[4:7], s46 offen offset:2048 sc1
    s_mov_b64 exec, s[22:23]
    buffer_load_dwordx4 v[80:83], v1, s[4:7], s46 offen offset:3072 sc1
    s_mov_b64 exec, -1
    s_waitcnt lgkmcnt(0)
    buffer_load_dwordx4 v[52:55], v2, s[4:7], s46 offen offset:0 sc1
    buffer_load_dwordx4 v[56:59], v2, s[4:7], s46 offen offset:1024 sc1
    buffer_load_dwordx4 v[60:63], v2, s[4:7], s46 offen offset:2048 sc1
    buffer_load_dwordx4 v[64:67], v2, s[4:7], s46 offen offset:3072 sc1
    s_waitcnt vmcnt(0)
    v_mfma_f32_4x4x4_16b_bf16 v[84:87], v[24:25], v[52:53], 0
    v_mfma_f32_4x4x4_16b_bf16 v[88:91], v[24:25], v[54:55], 0
    v_mfma_f32_4x4x4_16b_bf16 v[92:95], v[24:25], v[56:57], 0
    v_mfma_f32_4x4x4_16b_bf16 v[96:99], v[24:25], v[58:59], 0
    v_mfma_f32_4x4x4_16b_bf16 v[100:103], v[24:25], v[60:61], 0
    v_mfma_f32_4x4x4_16b_bf16 v[104:107], v[24:25], v[62:63], 0
    v_mfma_f32_4x4x4_16b_bf16 v[108:111], v[24:25], v[64:65], 0
    v_mfma_f32_4x4x4_16b_bf16 v[112:115], v[24:25], v[66:67], 0
    s_branch c0_mx_run
c0_s_retry:
    s_add_u32 s62, s62, 1
    s_cmp_eq_u32 s55, 0
    s_cbranch_scc1 c0_s_ok
    s_sub_u32 s55, s55, 1
    buffer_load_dwordx4 v[44:47], v6, s[4:7], s46 offen sc1
    buffer_load_dword v125, v6, s[4:7], s46 offen offset:1024 sc1
    s_waitcnt vmcnt(0)
    s_branch c0_s_chk
c0_om0:
    buffer_load_dwordx4 v[76:79], v3, s[4:7], s46 offen offset:0 sc1
    s_bitset1_b32 s16, 0
    s_branch c0_ob0
c0_om1:
    buffer_load_dwordx4 v[80:83], v3, s[4:7], s46 offen offset:1024 sc1
    s_bitset1_b32 s16, 1
    s_branch c0_ob1
c0_om2:
    buffer_load_dwordx4 v[84:87], v3, s[4:7], s46 offen offset:2048 sc1
    s_bitset1_b32 s16, 2
    s_branch c0_ob2
c0_om3:
    buffer_load_dwordx4 v[88:91], v3, s[4:7], s46 offen offset:3072 sc1
    s_bitset1_b32 s16, 3
    s_branch c0_ob3
c0_om4:
    buffer_load_dwordx4 v[92:95], v3, s[4:7], s49 offen offset:0 sc1
    s_bitset1_b32 s16, 4
    s_branch c0_ob4
c0_om5:
    buffer_load_dwordx4 v[96:99], v3, s[4:7], s49 offen offset:1024 sc1
    s_bitset1_b32 s16, 5
    s_branch c0_ob5
c0_om6:
    buffer_load_dwordx4 v[100:103], v3, s[4:7], s49 offen offset:2048 sc1
    s_bitset1_b32 s16, 6
    s_branch c0_ob6
c0_om7:
    buffer_load_dwordx4 v[104:107], v3, s[4:7], s49 offen offset:3072 sc1
    s_bitset1_b32 s16, 7
    s_branch c0_ob7
c0_ofix:
    s_add_u32 s63, s63, 1
    s_cmp_eq_u32 s55, 0
    s_cbranch_scc1 c0_o_end
    s_sub_u32 s55, s55, 1
    s_waitcnt vmcnt(0)
    s_bitcmp1_b32 s16, 0
    s_cbranch_scc0 c0_on0
    v_max_u32 v22, v76, v78
    v_cmp_eq_u32 vcc, -1, v22
    s_cbranch_vccnz c0_of0
    s_and_b32 s16, s16, 0x1fe
    v_smfmac_f32_16x16x64_bf16 v[40:43], v[76:79], v[128:135], v20
    v_smfmac_f32_16x16x64_bf16 v[44:47], v[76:79], v[136:143], v20
    s_cbranch_scc0 c0_o_end
c0_on0:
    s_bitcmp1_b32 s16, 1
    s_cbranch_scc0 c0_on1
    v_max_u32 v22, v80, v82
    v_cmp_eq_u32 vcc, -1, v22
    s_cbranch_vccnz c0_of1
    s_and_b32 s16, s16, 0x1fd
    v_smfmac_f32_16x16x64_bf16 v[40:43], v[80:83], v[144:151], v20
    v_smfmac_f32_16x16x64_bf16 v[44:47], v[80:83], v[152:159], v20
    s_cbranch_scc0 c0_o_end
c0_on1:
    s_bitcmp1_b32 s16, 2
    s_cbranch_scc0 c0_on2
    v_max_u32 v22, v84, v86
    v_cmp_eq_u32 vcc, -1, v22
    s_cbranch_vccnz c0_of2
    s_and_b32 s16, s16, 0x1fb
    v_smfmac_f32_16x16x64_bf16 v[40:43], v[84:87], v[160:167], v20
    v_smfmac_f32_16x16x64_bf16 v[44:47], v[84:87], v[168:175], v20
    s_cbranch_scc0 c0_o_end
c0_on2:
    s_bitcmp1_b32 s16, 3
    s_cbranch_scc0 c0_on3
    v_max_u32 v22, v88, v90
    v_cmp_eq_u32 vcc, -1, v22
    s_cbranch_vccnz c0_of3
    s_and_b32 s16, s16, 0x1f7
    v_smfmac_f32_16x16x64_bf16 v[40:43], v[88:91], v[176:183], v20
    v_smfmac_f32_16x16x64_bf16 v[44:47], v[88:91], v[184:191], v20
    s_cbranch_scc0 c0_o_end
c0_on3:
    s_bitcmp1_b32 s16, 4
    s_cbranch_scc0 c0_on4
    v_max_u32 v22, v92, v94
    v_cmp_eq_u32 vcc, -1, v22
    s_cbranch_vccnz c0_of4
    s_and_b32 s16, s16, 0x1ef
    v_smfmac_f32_16x16x64_bf16 v[40:43], v[92:95], v[192:199], v20
    v_smfmac_f32_16x16x64_bf16 v[44:47], v[92:95], v[200:207], v20
    s_cbranch_scc0 c0_o_end
c0_on4:
    s_bitcmp1_b32 s16, 5
    s_cbranch_scc0 c0_on5
    v_max_u32 v22, v96, v98
    v_cmp_eq_u32 vcc, -1, v22
    s_cbranch_vccnz c0_of5
    s_and_b32 s16, s16, 0x1df
    v_smfmac_f32_16x16x64_bf16 v[40:43], v[96:99], v[208:215], v20
    v_smfmac_f32_16x16x64_bf16 v[44:47], v[96:99], v[216:223], v20
    s_cbranch_scc0 c0_o_end
c0_on5:
    s_bitcmp1_b32 s16, 6
    s_cbranch_scc0 c0_on6
    v_max_u32 v22, v100, v102
    v_cmp_eq_u32 vcc, -1, v22
    s_cbranch_vccnz c0_of6
    s_and_b32 s16, s16, 0x1bf
    v_smfmac_f32_16x16x64_bf16 v[40:43], v[100:103], v[224:231], v20
    v_smfmac_f32_16x16x64_bf16 v[44:47], v[100:103], v[232:239], v20
    s_cbranch_scc0 c0_o_end
c0_on6:
    s_bitcmp1_b32 s16, 7
    s_cbranch_scc0 c0_on7
    v_max_u32 v22, v104, v106
    v_cmp_eq_u32 vcc, -1, v22
    s_cbranch_vccnz c0_of7
    s_and_b32 s16, s16, 0x17f
    v_smfmac_f32_16x16x64_bf16 v[40:43], v[104:107], v[240:247], v20
    v_smfmac_f32_16x16x64_bf16 v[44:47], v[104:107], v[248:255], v20
    s_cbranch_scc0 c0_o_end
c0_on7:
    s_branch c0_ofix
c0_of0:
    buffer_load_dwordx4 v[76:79], v3, s[4:7], s46 offen offset:0 sc1
    s_branch c0_on0
c0_of1:
    buffer_load_dwordx4 v[80:83], v3, s[4:7], s46 offen offset:1024 sc1
    s_branch c0_on1
c0_of2:
    buffer_load_dwordx4 v[84:87], v3, s[4:7], s46 offen offset:2048 sc1
    s_branch c0_on2
c0_of3:
    buffer_load_dwordx4 v[88:91], v3, s[4:7], s46 offen offset:3072 sc1
    s_branch c0_on3
c0_of4:
    buffer_load_dwordx4 v[92:95], v3, s[4:7], s49 offen offset:0 sc1
    s_branch c0_on4
c0_of5:
    buffer_load_dwordx4 v[96:99], v3, s[4:7], s49 offen offset:1024 sc1
    s_branch c0_on5
c0_of6:
    buffer_load_dwordx4 v[100:103], v3, s[4:7], s49 offen offset:2048 sc1
    s_branch c0_on6
c0_of7:
    buffer_load_dwordx4 v[104:107], v3, s[4:7], s49 offen offset:3072 sc1
    s_branch c0_on7
c1_entry:
    ds_write_b128 v13, v[52:55] offset:4096
    ds_write_b128 v13, v[56:59] offset:5120
    ds_write_b128 v13, v[60:63] offset:6144
    ds_write_b128 v13, v[64:67] offset:7168
    s_branch c1_apost
.p2align 6
c1_top:
    ds_read_b64_tr_b16 v[116:117], v15 offset:2560
    ds_read_b64_tr_b16 v[118:119], v15 offset:2816
    v_mov_b32 v40, 0
    v_mov_b32 v41, 0
    v_mov_b32 v42, 0
    v_mov_b32 v43, 0
    v_mov_b32 v44, 0
    v_mov_b32 v45, 0
    v_mov_b32 v46, 0
    v_mov_b32 v47, 0
    v_mov_b32 v48, 0
    v_mov_b32 v49, 0
    v_mov_b32 v50, 0
    v_mov_b32 v51, 0
    s_nop 13
    s_nop 13
    s_nop 13
    s_nop 13
    s_nop 13
    s_nop 12
    s_nop 12
    buffer_load_dwordx4 v[52:55], v2, s[4:7], s46 offen offset:0 sc1
    buffer_load_dwordx4 v[56:59], v2, s[4:7], s46 offen offset:1024 sc1
    buffer_load_dwordx4 v[60:63], v2, s[4:7], s46 offen offset:2048 sc1
    buffer_load_dwordx4 v[64:67], v2, s[4:7], s46 offen offset:3072 sc1
    s_barrier
    buffer_load_dwordx4 v[68:71], v1, s[4:7], s46 offen offset:0 sc1
    buffer_load_dwordx4 v[72:75], v1, s[4:7], s46 offen offset:1024 sc1
    buffer_load_dwordx4 v[76:79], v1, s[4:7], s46 offen offset:2048 sc1
    buffer_load_dwordx4 v[80:83], v1, s[4:7], s46 offen offset:3072 sc1
    s_waitcnt vmcnt(4)
c1_mo_chk:
    v_max3_u32 v22, v52, v56, v60
    v_max_u32 v22, v22, v64
    v_cmp_eq_u32 vcc, -1, v22
    s_cbranch_vccnz c1_mo_retry
c1_mo_ok:
    v_mfma_f32_4x4x4_16b_bf16 v[84:87], v[24:25], v[52:53], 0
    v_mfma_f32_4x4x4_16b_bf16 v[88:91], v[24:25], v[54:55], 0
    v_mfma_f32_4x4x4_16b_bf16 v[92:95], v[24:25], v[56:57], 0
    v_mfma_f32_4x4x4_16b_bf16 v[96:99], v[24:25], v[58:59], 0
    v_mfma_f32_4x4x4_16b_bf16 v[100:103], v[24:25], v[60:61], 0
    v_mfma_f32_4x4x4_16b_bf16 v[104:107], v[24:25], v[62:63], 0
    v_mfma_f32_4x4x4_16b_bf16 v[108:111], v[24:25], v[64:65], 0
    v_mfma_f32_4x4x4_16b_bf16 v[112:115], v[24:25], v[66:67], 0
c1_mx_run:
    s_waitcnt vmcnt(3) lgkmcnt(0)
    v_mfma_f32_4x4x4_16b_bf16 v[84:87], v[24:25], v[68:69], v[84:87]
    v_mfma_f32_4x4x4_16b_bf16 v[88:91], v[24:25], v[70:71], v[88:91]
    s_waitcnt vmcnt(2)
    v_mfma_f32_4x4x4_16b_bf16 v[92:95], v[24:25], v[72:73], v[92:95]
    v_mfma_f32_4x4x4_16b_bf16 v[96:99], v[24:25], v[74:75], v[96:99]
    v_max_u32 v22, v68, v72
    v_cvt_pk_bf16_f32 v52, v84, v85
    v_cvt_pk_bf16_f32 v53, v86, v87
    v_cvt_pk_bf16_f32 v54, v88, v89
    v_cvt_pk_bf16_f32 v55, v90, v91
    ds_write_b128 v13, v[52:55] offset:4096
    s_waitcnt vmcnt(1)
    v_mfma_f32_4x4x4_16b_bf16 v[100:103], v[24:25], v[76:77], v[100:103]
    v_mfma_f32_4x4x4_16b_bf16 v[104:107], v[24:25], v[78:79], v[104:107]
    v_cvt_pk_bf16_f32 v56, v92, v93
    v_cvt_pk_bf16_f32 v57, v94, v95
    v_cvt_pk_bf16_f32 v58, v96, v97
    v_cvt_pk_bf16_f32 v59, v98, v99
    ds_write_b128 v13, v[56:59] offset:5120
    s_waitcnt vmcnt(0)
    v_mfma_f32_4x4x4_16b_bf16 v[108:111], v[24:25], v[80:81], v[108:111]
    v_mfma_f32_4x4x4_16b_bf16 v[112:115], v[24:25], v[82:83], v[112:115]
    v_max3_u32 v22, v22, v76, v80
    v_cvt_pk_bf16_f32 v60, v100, v101
    v_cvt_pk_bf16_f32 v61, v102, v103
    v_cmp_eq_u32 vcc, -1, v22
    v_cvt_pk_bf16_f32 v62, v104, v105
    v_cvt_pk_bf16_f32 v63, v106, v107
    ds_write_b128 v13, v[60:63] offset:6144
    v_cvt_pk_bf16_f32 v64, v108, v109
    v_cvt_pk_bf16_f32 v65, v110, v111
    v_cvt_pk_bf16_f32 v66, v112, v113
    v_cvt_pk_bf16_f32 v67, v114, v115
    ds_write_b128 v13, v[64:67] offset:7168
    s_cbranch_vccnz c1_mx_retry
c1_mx_ok:
c1_apost:
    v_smfmac_f32_16x16x64_bf16 v[40:43], v[52:55], a[32:39], v20
    v_smfmac_f32_16x16x64_bf16 v[44:47], v[52:55], a[160:167], v20
    v_smfmac_f32_16x16x64_bf16 v[40:43], v[56:59], a[40:47], v20
    v_smfmac_f32_16x16x64_bf16 v[44:47], v[56:59], a[168:175], v20
    s_mov_b32 m0, s54
    s_xor_b32 s54, s54, 4096
    buffer_load_dwordx4 v11, s[4:7], s52 offen sc1 lds
    buffer_load_dwordx4 v[36:39], v10, s[4:7], s51 offen sc1
    s_waitcnt lgkmcnt(0)
    s_barrier
    ds_read_b128 v[68:71], v13 offset:8192
    ds_read_b128 v[72:75], v13 offset:9216
    ds_read_b128 v[76:79], v13 offset:10240
    ds_read_b128 v[80:83], v13 offset:11264
    v_smfmac_f32_16x16x64_bf16 v[40:43], v[60:63], a[48:55], v20
    ds_read_b128 v[84:87], v13 offset:12288
    ds_read_b128 v[88:91], v13 offset:13312
    ds_read_b128 v[92:95], v13 offset:14336
    v_smfmac_f32_16x16x64_bf16 v[44:47], v[60:63], a[176:183], v20
    ds_read_b128 v[96:99], v13 offset:15360
    ds_read_b128 v[100:103], v13 offset:0
    ds_read_b128 v[104:107], v13 offset:1024
    v_smfmac_f32_16x16x64_bf16 v[40:43], v[64:67], a[56:63], v20
    ds_read_b128 v[108:111], v13 offset:2048
    ds_read_b128 v[112:115], v13 offset:3072
    v_smfmac_f32_16x16x64_bf16 v[44:47], v[64:67], a[184:191], v20
    s_waitcnt lgkmcnt(11)
    v_smfmac_f32_16x16x64_bf16 v[40:43], v[68:71], a[64:71], v20
    buffer_store_dwordx4 v[116:119], v8, s[4:7], s3 offen sc1
    v_smfmac_f32_16x16x64_bf16 v[44:47], v[68:71], a[192:199], v20
    s_waitcnt lgkmcnt(10)
    v_smfmac_f32_16x16x64_bf16 v[40:43], v[72:75], a[72:79], v20
    buffer_store_dword v30, v9, s[4:7], s3 offen sc1
    v_smfmac_f32_16x16x64_bf16 v[44:47], v[72:75], a[200:207], v20
    s_waitcnt lgkmcnt(9)
    v_smfmac_f32_16x16x64_bf16 v[40:43], v[76:79], a[80:87], v20
    buffer_store_dwordx4 v[32:35], v12, s[4:7], s48 offen
    v_smfmac_f32_16x16x64_bf16 v[44:47], v[76:79], a[208:215], v20
    s_waitcnt lgkmcnt(8)
    v_smfmac_f32_16x16x64_bf16 v[40:43], v[80:83], a[88:95], v20
    v_smfmac_f32_16x16x64_bf16 v[44:47], v[80:83], a[216:223], v20
    s_waitcnt lgkmcnt(7)
    v_smfmac_f32_16x16x64_bf16 v[40:43], v[84:87], a[96:103], v20
    ds_read_b128 v[68:71], v19 offset:18432
    v_smfmac_f32_16x16x64_bf16 v[44:47], v[84:87], a[224:231], v20
    s_waitcnt lgkmcnt(7)
    v_smfmac_f32_16x16x64_bf16 v[40:43], v[88:91], a[104:111], v20
    ds_read_b128 v[72:75], v19 offset:19456
    v_smfmac_f32_16x16x64_bf16 v[44:47], v[88:91], a[232:239], v20
    s_waitcnt lgkmcnt(7)
    v_smfmac_f32_16x16x64_bf16 v[40:43], v[92:95], a[112:119], v20
    ds_read_b128 v[116:119], v19 offset:26624
    v_smfmac_f32_16x16x64_bf16 v[44:47], v[92:95], a[240:247], v20
    s_waitcnt lgkmcnt(7)
    v_smfmac_f32_16x16x64_bf16 v[40:43], v[96:99], a[120:127], v20
    ds_read_b128 v[120:123], v19 offset:27648
    v_smfmac_f32_16x16x64_bf16 v[44:47], v[96:99], a[248:255], v20
    s_waitcnt lgkmcnt(7)
    v_smfmac_f32_16x16x64_bf16 v[40:43], v[100:103], a[0:7], v20
    ds_read_b128 v[52:55], v16 offset:0
    v_smfmac_f32_16x16x64_bf16 v[44:47], v[100:103], a[128:135], v20
    s_waitcnt lgkmcnt(7)
    v_smfmac_f32_16x16x64_bf16 v[40:43], v[104:107], a[8:15], v20
    ds_read_b128 v[56:59], v16 offset:1024
    v_smfmac_f32_16x16x64_bf16 v[44:47], v[104:107], a[136:143], v20
    s_waitcnt lgkmcnt(7)
    v_smfmac_f32_16x16x64_bf16 v[40:43], v[108:111], a[16:23], v20
    ds_read_b128 v[60:63], v16 offset:2048
    v_smfmac_f32_16x16x64_bf16 v[44:47], v[108:111], a[144:151], v20
    s_waitcnt lgkmcnt(7)
    v_smfmac_f32_16x16x64_bf16 v[40:43], v[112:115], a[24:31], v20
    ds_read_b128 v[64:67], v16 offset:3072
    s_cmp_eq_u32 s45, 63
    v_smfmac_f32_16x16x64_bf16 v[44:47], v[112:115], a[152:159], v20
    s_cbranch_scc1 c1_last
    s_waitcnt lgkmcnt(6)
    v_smfmac_f32_16x16x64_bf16 v[48:51], v[76:79], v[68:75], v20
    v_pk_add_f32 v[40:41], v[40:41], v[42:43]
    v_cvt_pk_bf16_f32 v40, v40, v41
    ds_write2_b32 v14, v40, v40 offset0:0 offset1:1
    s_nop 0
    v_pk_add_f32 v[44:45], v[44:45], v[46:47]
    v_cvt_pk_bf16_f32 v44, v44, v45
    ds_write2_b32 v14, v44, v44 offset0:128 offset1:129
    s_waitcnt lgkmcnt(6)
    v_smfmac_f32_16x16x64_bf16 v[48:51], v[80:83], v[116:123], v20
    v_xor_b32 v16, 4096, v16
    s_waitcnt lgkmcnt(0)
    s_barrier
    ds_read_b64_tr_b16 v[116:117], v15 offset:0
    ds_read_b64_tr_b16 v[118:119], v15 offset:256
    ds_read_b64_tr_b16 v[120:121], v15 offset:2048
    ds_read_b64_tr_b16 v[122:123], v15 offset:2304
    ds_read_b64_tr_b16 v[68:69], v15 offset:512
    ds_read_b64_tr_b16 v[70:71], v15 offset:768
    ds_read_b64_tr_b16 v[72:73], v15 offset:2560
    ds_read_b64_tr_b16 v[74:75], v15 offset:2816
    ds_read_b128 v[76:79], v19 offset:34816
    ds_read_b128 v[80:83], v19 offset:35840
    s_waitcnt lgkmcnt(2)
    v_mfma_f32_16x16x32_bf16 v[124:127], v[68:71], v[116:119], 0
    v_mfma_f32_16x16x32_bf16 v[124:127], v[72:75], v[120:123], v[124:127]
    v_mfma_f32_16x16x32_bf16 v[40:43], v[52:55], v[116:119], 0
    v_mfma_f32_16x16x32_bf16 v[40:43], v[56:59], v[120:123], v[40:43]
    buffer_store_dword v124, v5, s[4:7], s46 offen
    v_mfma_f32_16x16x32_bf16 v[44:47], v[60:63], v[116:119], 0
    v_mfma_f32_16x16x32_bf16 v[44:47], v[64:67], v[120:123], v[44:47]
    ds_read_b128 v[52:55], v19 offset:43008
    ds_read_b128 v[56:59], v19 offset:44032
    ds_read_b128 v[60:63], v19 offset:51200
    ds_read_b128 v[64:67], v19 offset:52224
    ds_read_b128 v[68:71], v19 offset:59392
    ds_read_b128 v[72:75], v19 offset:60416
    ds_read_b128 v[116:119], v19 offset:0
    ds_read_b128 v[120:123], v19 offset:1024
    v_cndmask_b32 v40, v40, v44, s[32:33]
    v_cndmask_b32 v41, v41, v45, s[32:33]
    v_cndmask_b32 v42, v42, v46, s[32:33]
    v_cndmask_b32 v43, v43, v47, s[32:33]
    v_cndmask_b32 v124, v124, v125, s[32:33]
    v_mov_b32 v127, 0
    s_waitcnt lgkmcnt(8)
    v_smfmac_f32_16x16x64_bf16 v[48:51], v[84:87], v[76:83], v20
    ds_read_b128 v[76:79], v19 offset:8192
    ds_read_b128 v[80:83], v19 offset:9216
    s_waitcnt lgkmcnt(8)
    v_smfmac_f32_16x16x64_bf16 v[48:51], v[88:91], v[52:59], v20
    ds_read_b128 v[52:55], v19 offset:16384
    ds_read_b128 v[56:59], v19 offset:17408
    ds_read_b128 v[84:87], v13 offset:4096
    ds_read_b128 v[88:91], v13 offset:5120
    s_waitcnt lgkmcnt(10)
    v_smfmac_f32_16x16x64_bf16 v[48:51], v[92:95], v[60:67], v20
    ds_read_b128 v[60:63], v19 offset:24576
    ds_read_b128 v[64:67], v19 offset:25600
    s_waitcnt lgkmcnt(10)
    v_smfmac_f32_16x16x64_bf16 v[48:51], v[96:99], v[68:75], v20
    ds_read_b128 v[68:71], v19 offset:32768
    ds_read_b128 v[72:75], v19 offset:33792
    ds_read_b128 v[92:95], v13 offset:6144
    ds_read_b128 v[96:99], v13 offset:7168
    s_waitcnt lgkmcnt(12)
    v_smfmac_f32_16x16x64_bf16 v[48:51], v[100:103], v[116:123], v20
    ds_read_b128 v[116:119], v19 offset:40960
    ds_read_b128 v[120:123], v19 offset:41984
    s_waitcnt vmcnt(0)
    buffer_load_dwordx4 v[44:47], v6, s[4:7], s46 offen sc1
    buffer_load_dword v125, v6, s[4:7], s46 offen offset:1024 sc1
    s_waitcnt lgkmcnt(12)
    v_smfmac_f32_16x16x64_bf16 v[48:51], v[104:107], v[76:83], v20
    ds_read_b128 v[76:79], v19 offset:49152
    ds_read_b128 v[80:83], v19 offset:50176
    ds_read_b128 v[100:103], v13 offset:8192
    ds_read_b128 v[104:107], v13 offset:9216
    s_waitcnt lgkmcnt(14)
    v_smfmac_f32_16x16x64_bf16 v[48:51], v[108:111], v[52:59], v20
    ds_read_b128 v[52:55], v19 offset:57344
    ds_read_b128 v[56:59], v19 offset:58368
    s_waitcnt lgkmcnt(12)
    v_smfmac_f32_16x16x64_bf16 v[48:51], v[112:115], v[60:67], v20
    ds_read_b128 v[60:63], v19 offset:2048
    ds_read_b128 v[64:67], v19 offset:3072
    s_waitcnt lgkmcnt(12)
    v_smfmac_f32_16x16x64_bf16 v[48:51], v[84:87], v[68:75], v20
    ds_read_b128 v[68:71], v19 offset:10240
    ds_read_b128 v[72:75], v19 offset:11264
    s_waitcnt lgkmcnt(10)
    v_smfmac_f32_16x16x64_bf16 v[48:51], v[88:91], v[116:123], v20
    s_waitcnt lgkmcnt(8)
    v_smfmac_f32_16x16x64_bf16 v[48:51], v[92:95], v[76:83], v20
    s_waitcnt lgkmcnt(4)
    v_smfmac_f32_16x16x64_bf16 v[48:51], v[96:99], v[52:59], v20
    s_waitcnt lgkmcnt(2)
    v_smfmac_f32_16x16x64_bf16 v[48:51], v[100:103], v[60:67], v20
    s_waitcnt lgkmcnt(0)
    v_smfmac_f32_16x16x64_bf16 v[48:51], v[104:107], v[68:75], v20
    s_mov_b32 s56, 0x3e0293ee
    s_nop 6
    v_pk_add_f32 v[48:49], v[48:49], v[50:51]
    v_cvt_pk_bf16_f32 v30, v48, v49
    s_waitcnt vmcnt(0)
c1_s_chk:
    v_pk_add_f32 v[44:45], v[44:45], v[40:41]
    v_pk_add_f32 v[46:47], v[46:47], v[42:43]
    v_add_f32 v125, v125, v124
    v_maximum3_f32 v22, v44, v45, v46
    v_maximum3_f32 v22, v22, v47, v125
    v_cmp_u_f32 vcc, v22, v22
    s_cbranch_vccnz c1_s_retry
c1_s_ok:
    v_max_f32_dpp v23, v22, v22 quad_perm:[2,3,0,1] row_mask:0xf bank_mask:0xf
    v_max_f32_dpp v21, v22, v22 quad_perm:[2,3,0,1] row_mask:0xf bank_mask:0xf
    v_mov_b32 v40, 0
    v_mov_b32 v41, 0
    v_permlane32_swap_b32 v23, v21
    v_max_f32 v22, v23, v21
    v_max_f32 v23, v23, v21
    v_mov_b32 v42, 0
    v_mov_b32 v43, 0
    v_permlane16_swap_b32 v22, v23
    v_max_f32 v22, v22, v23
    v_mul_f32 v22, 0xbe0293ee, v22
    v_fma_f32 v125, v125, s56, v22
    v_pk_fma_f32 v[44:45], v[44:45], s[56:57], v[22:23] op_sel_hi:[1,0,0]
    v_exp_f32 v125, v125
    v_pk_fma_f32 v[46:47], v[46:47], s[56:57], v[22:23] op_sel_hi:[1,0,0]
    v_exp_f32 v44, v44
    v_mov_b32_dpp v23, v125 quad_perm:[2,3,2,3] row_mask:0xf bank_mask:0xf
    v_exp_f32 v45, v45
    v_cvt_pk_bf16_f32 v126, v125, v23
    v_exp_f32 v46, v46
    v_cvt_pk_bf16_f32 v52, v44, v45
    v_exp_f32 v47, v47
    v_mfma_f32_16x16x16_bf16 v[56:59], v[26:27], v[126:127], 0
    v_cvt_pk_bf16_f32 v53, v46, v47
    v_mov_b32_dpp v54, v52 quad_perm:[2,3,2,3] row_mask:0xf bank_mask:0xf
    v_mfma_f32_16x16x16_bf16 v[60:63], v[30:31], v[126:127], 0
    v_mov_b32_dpp v55, v53 quad_perm:[2,3,2,3] row_mask:0xf bank_mask:0xf
    v_mov_b32 v44, 0
    v_mov_b32 v45, 0
    v_mfma_f32_16x16x32_bf16 v[56:59], v[26:29], v[52:55], v[56:59]
    v_mfma_f32_16x16x32_bf16 v[60:63], v[36:39], v[52:55], v[60:63]
    v_mov_b32 v46, 0
    v_mov_b32 v47, 0
    s_nop 1
    v_rcp_f32 v22, v56
    s_nop 2
    v_pk_mul_f32 v[60:61], v[60:61], v[22:23] op_sel_hi:[1,0]
    v_pk_mul_f32 v[62:63], v[62:63], v[22:23] op_sel_hi:[1,0]
    v_cvt_pk_bf16_f32 v48, v60, v61
    v_cvt_pk_bf16_f32 v49, v62, v63
    buffer_store_dwordx2 v[48:49], v4, s[4:7], s46 offen
    s_mov_b32 s16, 0
    s_barrier
    s_nop 9
    s_nop 9
    s_nop 9
    s_nop 9
    s_nop 9
    buffer_load_dwordx4 v[76:79], v3, s[4:7], s46 offen offset:0 sc1
    s_nop 5
    buffer_load_dwordx4 v[80:83], v3, s[4:7], s46 offen offset:1024 sc1
    s_nop 5
    buffer_load_dwordx4 v[84:87], v3, s[4:7], s46 offen offset:2048 sc1
    s_nop 5
    buffer_load_dwordx4 v[88:91], v3, s[4:7], s46 offen offset:3072 sc1
    s_nop 5
    buffer_load_dwordx4 v[92:95], v3, s[4:7], s49 offen offset:0 sc1
    s_nop 5
    buffer_load_dwordx4 v[96:99], v3, s[4:7], s49 offen offset:1024 sc1
    s_nop 5
    buffer_load_dwordx4 v[100:103], v3, s[4:7], s49 offen offset:2048 sc1
    s_nop 5
    buffer_load_dwordx4 v[104:107], v3, s[4:7], s49 offen offset:3072 sc1
    s_waitcnt vmcnt(7)
    v_max_u32 v22, v76, v78
    v_cmp_eq_u32 vcc, -1, v22
    s_cbranch_vccnz c1_om0
    v_smfmac_f32_16x16x64_bf16 v[40:43], v[76:79], v[128:135], v20
    v_smfmac_f32_16x16x64_bf16 v[44:47], v[76:79], v[136:143], v20
c1_ob0:
    s_waitcnt vmcnt(6)
    v_max_u32 v22, v80, v82
    v_cmp_eq_u32 vcc, -1, v22
    s_cbranch_vccnz c1_om1
    v_smfmac_f32_16x16x64_bf16 v[40:43], v[80:83], v[144:151], v20
    v_smfmac_f32_16x16x64_bf16 v[44:47], v[80:83], v[152:159], v20
c1_ob1:
    s_waitcnt vmcnt(5)
    v_max_u32 v22, v84, v86
    v_cmp_eq_u32 vcc, -1, v22
    s_cbranch_vccnz c1_om2
    v_smfmac_f32_16x16x64_bf16 v[40:43], v[84:87], v[160:167], v20
    v_smfmac_f32_16x16x64_bf16 v[44:47], v[84:87], v[168:175], v20
c1_ob2:
    s_waitcnt vmcnt(4)
    v_max_u32 v22, v88, v90
    v_cmp_eq_u32 vcc, -1, v22
    s_cbranch_vccnz c1_om3
    v_smfmac_f32_16x16x64_bf16 v[40:43], v[88:91], v[176:183], v20
    v_smfmac_f32_16x16x64_bf16 v[44:47], v[88:91], v[184:191], v20
c1_ob3:
    s_waitcnt vmcnt(3)
    v_max_u32 v22, v92, v94
    v_cmp_eq_u32 vcc, -1, v22
    s_cbranch_vccnz c1_om4
    v_smfmac_f32_16x16x64_bf16 v[40:43], v[92:95], v[192:199], v20
    v_smfmac_f32_16x16x64_bf16 v[44:47], v[92:95], v[200:207], v20
c1_ob4:
    s_waitcnt vmcnt(2)
    v_max_u32 v22, v96, v98
    v_cmp_eq_u32 vcc, -1, v22
    s_cbranch_vccnz c1_om5
    v_smfmac_f32_16x16x64_bf16 v[40:43], v[96:99], v[208:215], v20
    v_smfmac_f32_16x16x64_bf16 v[44:47], v[96:99], v[216:223], v20
c1_ob5:
    s_waitcnt vmcnt(1)
    v_max_u32 v22, v100, v102
    v_cmp_eq_u32 vcc, -1, v22
    s_cbranch_vccnz c1_om6
    v_smfmac_f32_16x16x64_bf16 v[40:43], v[100:103], v[224:231], v20
    v_smfmac_f32_16x16x64_bf16 v[44:47], v[100:103], v[232:239], v20
c1_ob6:
    s_waitcnt vmcnt(0)
    v_max_u32 v22, v104, v106
    v_cmp_eq_u32 vcc, -1, v22
    s_cbranch_vccnz c1_om7
    v_smfmac_f32_16x16x64_bf16 v[40:43], v[104:107], v[240:247], v20
    v_smfmac_f32_16x16x64_bf16 v[44:47], v[104:107], v[248:255], v20
c1_ob7:
    s_cmp_lg_u32 s16, 0
    s_cbranch_scc1 c1_ofix
c1_o_end:
    s_mov_b32 s48, s46
    s_mov_b32 s46, s50
    s_nop 0
    v_pk_add_f32 v[40:41], v[40:41], v[42:43]
    ds_write2st64_b32 v17, v40, v41 offset0:0 offset1:1
    s_add_u32 s49, s46, 4096
    s_nop 0
    v_pk_add_f32 v[44:45], v[44:45], v[46:47]
    ds_write2st64_b32 v17, v44, v45 offset0:8 offset1:9
    s_mov_b32 s45, s92
    s_add_u32 s92, s92, 1
    s_add_u32 s50, s50, 0x80000
    s_and_b32 s50, s50, 0x1c2000
    s_mov_b32 s51, s52
    s_add_u32 s52, s52, 0x40000
    s_mov_b32 s3, s53
    s_add_u32 s53, s53, 0x10000
    s_waitcnt lgkmcnt(0)
    s_barrier
    ds_read_b128 v[52:55], v18 offset:0
    ds_read_b128 v[56:59], v18 offset:16
    s_waitcnt lgkmcnt(1)
    v_pk_add_f32 v[52:53], v[52:53], v[54:55]
    s_waitcnt lgkmcnt(0)
    v_pk_add_f32 v[56:57], v[56:57], v[58:59]
    v_pk_add_f32 v[52:53], v[52:53], v[56:57]
    v_cvt_pk_bf16_f32 v23, v52, v53
    buffer_store_dword v23, v7, s[4:7], s46 offen sc1
    s_branch c1_top
c1_last:
    s_waitcnt lgkmcnt(0)
    v_smfmac_f32_16x16x64_bf16 v[48:51], v[76:79], v[68:75], v20
    v_smfmac_f32_16x16x64_bf16 v[48:51], v[80:83], v[116:123], v20
    v_pk_add_f32 v[44:45], v[44:45], v[46:47]
    v_cvt_pk_bf16_f32 v44, v44, v45
    ds_write2_b32 v14, v44, v44 offset0:128 offset1:129
    ds_read_b128 v[76:79], v19 offset:34816
    ds_read_b128 v[80:83], v19 offset:35840
    ds_read_b128 v[52:55], v19 offset:43008
    ds_read_b128 v[56:59], v19 offset:44032
    ds_read_b128 v[60:63], v19 offset:51200
    ds_read_b128 v[64:67], v19 offset:52224
    ds_read_b128 v[68:71], v19 offset:59392
    ds_read_b128 v[72:75], v19 offset:60416
    s_waitcnt lgkmcnt(8)
    s_barrier
    ds_read_b64_tr_b16 v[124:125], v15 offset:2560
    ds_read_b64_tr_b16 v[126:127], v15 offset:2816
    ds_read_b128 v[116:119], v19 offset:0
    ds_read_b128 v[120:123], v19 offset:1024
    s_waitcnt lgkmcnt(2)
    buffer_store_dwordx4 v[124:127], v8, s[4:7], s53 offen sc1
    v_smfmac_f32_16x16x64_bf16 v[48:51], v[84:87], v[76:83], v20
    ds_read_b128 v[76:79], v19 offset:8192
    ds_read_b128 v[80:83], v19 offset:9216
    v_smfmac_f32_16x16x64_bf16 v[48:51], v[88:91], v[52:59], v20
    ds_read_b128 v[52:55], v19 offset:16384
    ds_read_b128 v[56:59], v19 offset:17408
    ds_read_b128 v[84:87], v13 offset:4096
    ds_read_b128 v[88:91], v13 offset:5120
    v_smfmac_f32_16x16x64_bf16 v[48:51], v[92:95], v[60:67], v20
    ds_read_b128 v[60:63], v19 offset:24576
    ds_read_b128 v[64:67], v19 offset:25600
    v_smfmac_f32_16x16x64_bf16 v[48:51], v[96:99], v[68:75], v20
    ds_read_b128 v[68:71], v19 offset:32768
    ds_read_b128 v[72:75], v19 offset:33792
    ds_read_b128 v[92:95], v13 offset:6144
    ds_read_b128 v[96:99], v13 offset:7168
    s_waitcnt lgkmcnt(12)
    v_smfmac_f32_16x16x64_bf16 v[48:51], v[100:103], v[116:123], v20
    ds_read_b128 v[116:119], v19 offset:40960
    ds_read_b128 v[120:123], v19 offset:41984
    s_waitcnt lgkmcnt(12)
    v_smfmac_f32_16x16x64_bf16 v[48:51], v[104:107], v[76:83], v20
    ds_read_b128 v[76:79], v19 offset:49152
    ds_read_b128 v[80:83], v19 offset:50176
    ds_read_b128 v[100:103], v13 offset:8192
    ds_read_b128 v[104:107], v13 offset:9216
    s_waitcnt lgkmcnt(14)
    v_smfmac_f32_16x16x64_bf16 v[48:51], v[108:111], v[52:59], v20
    ds_read_b128 v[52:55], v19 offset:57344
    ds_read_b128 v[56:59], v19 offset:58368
    s_waitcnt lgkmcnt(12)
    v_smfmac_f32_16x16x64_bf16 v[48:51], v[112:115], v[60:67], v20
    ds_read_b128 v[60:63], v19 offset:2048
    ds_read_b128 v[64:67], v19 offset:3072
    s_waitcnt lgkmcnt(12)
    v_smfmac_f32_16x16x64_bf16 v[48:51], v[84:87], v[68:75], v20
    ds_read_b128 v[68:71], v19 offset:10240
    ds_read_b128 v[72:75], v19 offset:11264
    s_waitcnt lgkmcnt(10)
    v_smfmac_f32_16x16x64_bf16 v[48:51], v[88:91], v[116:123], v20
    s_waitcnt lgkmcnt(8)
    v_smfmac_f32_16x16x64_bf16 v[48:51], v[92:95], v[76:83], v20
    s_waitcnt lgkmcnt(4)
    v_smfmac_f32_16x16x64_bf16 v[48:51], v[96:99], v[52:59], v20
    s_waitcnt lgkmcnt(2)
    v_smfmac_f32_16x16x64_bf16 v[48:51], v[100:103], v[60:67], v20
    s_waitcnt lgkmcnt(0)
    v_smfmac_f32_16x16x64_bf16 v[48:51], v[104:107], v[68:75], v20
    s_nop 7
    v_pk_add_f32 v[48:49], v[48:49], v[50:51]
    v_cvt_pk_bf16_f32 v30, v48, v49
    buffer_store_dword v30, v9, s[4:7], s53 offen sc1
    s_branch CDONE
c1_mo_retry:
    s_add_u32 s60, s60, 1
    s_cmp_eq_u32 s55, 0
    s_cbranch_scc1 c1_mo_ok
    s_sub_u32 s55, s55, 1
    v_cmp_eq_u32 s[16:17], -1, v52
    v_cmp_eq_u32 s[18:19], -1, v56
    v_cmp_eq_u32 s[20:21], -1, v60
    v_cmp_eq_u32 s[22:23], -1, v64
    s_mov_b64 exec, s[16:17]
    buffer_load_dwordx4 v[52:55], v2, s[4:7], s46 offen offset:0 sc1
    s_mov_b64 exec, s[18:19]
    buffer_load_dwordx4 v[56:59], v2, s[4:7], s46 offen offset:1024 sc1
    s_mov_b64 exec, s[20:21]
    buffer_load_dwordx4 v[60:63], v2, s[4:7], s46 offen offset:2048 sc1
    s_mov_b64 exec, s[22:23]
    buffer_load_dwordx4 v[64:67], v2, s[4:7], s46 offen offset:3072 sc1
    s_mov_b64 exec, -1
    s_waitcnt vmcnt(0)
    s_branch c1_mo_chk
c1_mx_retry:
    s_add_u32 s61, s61, 1
    s_cmp_eq_u32 s55, 0
    s_cbranch_scc1 c1_mx_ok
    s_sub_u32 s55, s55, 1
    v_cmp_eq_u32 s[16:17], -1, v68
    v_cmp_eq_u32 s[18:19], -1, v72
    v_cmp_eq_u32 s[20:21], -1, v76
    v_cmp_eq_u32 s[22:23], -1, v80
    s_mov_b64 exec, s[16:17]
    buffer_load_dwordx4 v[68:71], v1, s[4:7], s46 offen offset:0 sc1
    s_mov_b64 exec, s[18:19]
    buffer_load_dwordx4 v[72:75], v1, s[4:7], s46 offen offset:1024 sc1
    s_mov_b64 exec, s[20:21]
    buffer_load_dwordx4 v[76:79], v1, s[4:7], s46 offen offset:2048 sc1
    s_mov_b64 exec, s[22:23]
    buffer_load_dwordx4 v[80:83], v1, s[4:7], s46 offen offset:3072 sc1
    s_mov_b64 exec, -1
    s_waitcnt lgkmcnt(0)
    buffer_load_dwordx4 v[52:55], v2, s[4:7], s46 offen offset:0 sc1
    buffer_load_dwordx4 v[56:59], v2, s[4:7], s46 offen offset:1024 sc1
    buffer_load_dwordx4 v[60:63], v2, s[4:7], s46 offen offset:2048 sc1
    buffer_load_dwordx4 v[64:67], v2, s[4:7], s46 offen offset:3072 sc1
    s_waitcnt vmcnt(0)
    v_mfma_f32_4x4x4_16b_bf16 v[84:87], v[24:25], v[52:53], 0
    v_mfma_f32_4x4x4_16b_bf16 v[88:91], v[24:25], v[54:55], 0
    v_mfma_f32_4x4x4_16b_bf16 v[92:95], v[24:25], v[56:57], 0
    v_mfma_f32_4x4x4_16b_bf16 v[96:99], v[24:25], v[58:59], 0
    v_mfma_f32_4x4x4_16b_bf16 v[100:103], v[24:25], v[60:61], 0
    v_mfma_f32_4x4x4_16b_bf16 v[104:107], v[24:25], v[62:63], 0
    v_mfma_f32_4x4x4_16b_bf16 v[108:111], v[24:25], v[64:65], 0
    v_mfma_f32_4x4x4_16b_bf16 v[112:115], v[24:25], v[66:67], 0
    s_branch c1_mx_run
c1_s_retry:
    s_add_u32 s62, s62, 1
    s_cmp_eq_u32 s55, 0
    s_cbranch_scc1 c1_s_ok
    s_sub_u32 s55, s55, 1
    buffer_load_dwordx4 v[44:47], v6, s[4:7], s46 offen sc1
    buffer_load_dword v125, v6, s[4:7], s46 offen offset:1024 sc1
    s_waitcnt vmcnt(0)
    s_branch c1_s_chk
c1_om0:
    buffer_load_dwordx4 v[76:79], v3, s[4:7], s46 offen offset:0 sc1
    s_bitset1_b32 s16, 0
    s_branch c1_ob0
c1_om1:
    buffer_load_dwordx4 v[80:83], v3, s[4:7], s46 offen offset:1024 sc1
    s_bitset1_b32 s16, 1
    s_branch c1_ob1
c1_om2:
    buffer_load_dwordx4 v[84:87], v3, s[4:7], s46 offen offset:2048 sc1
    s_bitset1_b32 s16, 2
    s_branch c1_ob2
c1_om3:
    buffer_load_dwordx4 v[88:91], v3, s[4:7], s46 offen offset:3072 sc1
    s_bitset1_b32 s16, 3
    s_branch c1_ob3
c1_om4:
    buffer_load_dwordx4 v[92:95], v3, s[4:7], s49 offen offset:0 sc1
    s_bitset1_b32 s16, 4
    s_branch c1_ob4
c1_om5:
    buffer_load_dwordx4 v[96:99], v3, s[4:7], s49 offen offset:1024 sc1
    s_bitset1_b32 s16, 5
    s_branch c1_ob5
c1_om6:
    buffer_load_dwordx4 v[100:103], v3, s[4:7], s49 offen offset:2048 sc1
    s_bitset1_b32 s16, 6
    s_branch c1_ob6
c1_om7:
    buffer_load_dwordx4 v[104:107], v3, s[4:7], s49 offen offset:3072 sc1
    s_bitset1_b32 s16, 7
    s_branch c1_ob7
c1_ofix:
    s_add_u32 s63, s63, 1
    s_cmp_eq_u32 s55, 0
    s_cbranch_scc1 c1_o_end
    s_sub_u32 s55, s55, 1
    s_waitcnt vmcnt(0)
    s_bitcmp1_b32 s16, 0
    s_cbranch_scc0 c1_on0
    v_max_u32 v22, v76, v78
    v_cmp_eq_u32 vcc, -1, v22
    s_cbranch_vccnz c1_of0
    s_and_b32 s16, s16, 0x1fe
    v_smfmac_f32_16x16x64_bf16 v[40:43], v[76:79], v[128:135], v20
    v_smfmac_f32_16x16x64_bf16 v[44:47], v[76:79], v[136:143], v20
    s_cbranch_scc0 c1_o_end
c1_on0:
    s_bitcmp1_b32 s16, 1
    s_cbranch_scc0 c1_on1
    v_max_u32 v22, v80, v82
    v_cmp_eq_u32 vcc, -1, v22
    s_cbranch_vccnz c1_of1
    s_and_b32 s16, s16, 0x1fd
    v_smfmac_f32_16x16x64_bf16 v[40:43], v[80:83], v[144:151], v20
    v_smfmac_f32_16x16x64_bf16 v[44:47], v[80:83], v[152:159], v20
    s_cbranch_scc0 c1_o_end
c1_on1:
    s_bitcmp1_b32 s16, 2
    s_cbranch_scc0 c1_on2
    v_max_u32 v22, v84, v86
    v_cmp_eq_u32 vcc, -1, v22
    s_cbranch_vccnz c1_of2
    s_and_b32 s16, s16, 0x1fb
    v_smfmac_f32_16x16x64_bf16 v[40:43], v[84:87], v[160:167], v20
    v_smfmac_f32_16x16x64_bf16 v[44:47], v[84:87], v[168:175], v20
    s_cbranch_scc0 c1_o_end
c1_on2:
    s_bitcmp1_b32 s16, 3
    s_cbranch_scc0 c1_on3
    v_max_u32 v22, v88, v90
    v_cmp_eq_u32 vcc, -1, v22
    s_cbranch_vccnz c1_of3
    s_and_b32 s16, s16, 0x1f7
    v_smfmac_f32_16x16x64_bf16 v[40:43], v[88:91], v[176:183], v20
    v_smfmac_f32_16x16x64_bf16 v[44:47], v[88:91], v[184:191], v20
    s_cbranch_scc0 c1_o_end
c1_on3:
    s_bitcmp1_b32 s16, 4
    s_cbranch_scc0 c1_on4
    v_max_u32 v22, v92, v94
    v_cmp_eq_u32 vcc, -1, v22
    s_cbranch_vccnz c1_of4
    s_and_b32 s16, s16, 0x1ef
    v_smfmac_f32_16x16x64_bf16 v[40:43], v[92:95], v[192:199], v20
    v_smfmac_f32_16x16x64_bf16 v[44:47], v[92:95], v[200:207], v20
    s_cbranch_scc0 c1_o_end
c1_on4:
    s_bitcmp1_b32 s16, 5
    s_cbranch_scc0 c1_on5
    v_max_u32 v22, v96, v98
    v_cmp_eq_u32 vcc, -1, v22
    s_cbranch_vccnz c1_of5
    s_and_b32 s16, s16, 0x1df
    v_smfmac_f32_16x16x64_bf16 v[40:43], v[96:99], v[208:215], v20
    v_smfmac_f32_16x16x64_bf16 v[44:47], v[96:99], v[216:223], v20
    s_cbranch_scc0 c1_o_end
c1_on5:
    s_bitcmp1_b32 s16, 6
    s_cbranch_scc0 c1_on6
    v_max_u32 v22, v100, v102
    v_cmp_eq_u32 vcc, -1, v22
    s_cbranch_vccnz c1_of6
    s_and_b32 s16, s16, 0x1bf
    v_smfmac_f32_16x16x64_bf16 v[40:43], v[100:103], v[224:231], v20
    v_smfmac_f32_16x16x64_bf16 v[44:47], v[100:103], v[232:239], v20
    s_cbranch_scc0 c1_o_end
c1_on6:
    s_bitcmp1_b32 s16, 7
    s_cbranch_scc0 c1_on7
    v_max_u32 v22, v104, v106
    v_cmp_eq_u32 vcc, -1, v22
    s_cbranch_vccnz c1_of7
    s_and_b32 s16, s16, 0x17f
    v_smfmac_f32_16x16x64_bf16 v[40:43], v[104:107], v[240:247], v20
    v_smfmac_f32_16x16x64_bf16 v[44:47], v[104:107], v[248:255], v20
    s_cbranch_scc0 c1_o_end
c1_on7:
    s_branch c1_ofix
c1_of0:
    buffer_load_dwordx4 v[76:79], v3, s[4:7], s46 offen offset:0 sc1
    s_branch c1_on0
c1_of1:
    buffer_load_dwordx4 v[80:83], v3, s[4:7], s46 offen offset:1024 sc1
    s_branch c1_on1
c1_of2:
    buffer_load_dwordx4 v[84:87], v3, s[4:7], s46 offen offset:2048 sc1
    s_branch c1_on2
c1_of3:
    buffer_load_dwordx4 v[88:91], v3, s[4:7], s46 offen offset:3072 sc1
    s_branch c1_on3
c1_of4:
    buffer_load_dwordx4 v[92:95], v3, s[4:7], s49 offen offset:0 sc1
    s_branch c1_on4
c1_of5:
    buffer_load_dwordx4 v[96:99], v3, s[4:7], s49 offen offset:1024 sc1
    s_branch c1_on5
c1_of6:
    buffer_load_dwordx4 v[100:103], v3, s[4:7], s49 offen offset:2048 sc1
    s_branch c1_on6
c1_of7:
    buffer_load_dwordx4 v[104:107], v3, s[4:7], s49 offen offset:3072 sc1
    s_branch c1_on7
c2_entry:
    ds_write_b128 v13, v[52:55] offset:8192
    ds_write_b128 v13, v[56:59] offset:9216
    ds_write_b128 v13, v[60:63] offset:10240
    ds_write_b128 v13, v[64:67] offset:11264
    s_branch c2_apost
.p2align 6
    s_nop 0
    s_nop 0
    s_nop 0
    s_nop 0
    s_nop 0
c2_top:
    v_mov_b32 v40, 0
    v_mov_b32 v41, 0
    v_mov_b32 v42, 0
    v_mov_b32 v43, 0
    v_mov_b32 v44, 0
    v_mov_b32 v45, 0
    v_mov_b32 v46, 0
    v_mov_b32 v47, 0
    v_mov_b32 v48, 0
    v_mov_b32 v49, 0
    v_mov_b32 v50, 0
    v_mov_b32 v51, 0
    s_nop 8
    s_nop 8
    s_nop 8
    s_nop 8
    s_nop 8
    s_nop 8
    s_nop 8
    s_nop 8
    s_nop 7
    buffer_load_dwordx4 v[52:55], v2, s[4:7], s46 offen offset:0 sc1
    buffer_load_dwordx4 v[56:59], v2, s[4:7], s46 offen offset:1024 sc1
    buffer_load_dwordx4 v[60:63], v2, s[4:7], s46 offen offset:2048 sc1
    buffer_load_dwordx4 v[64:67], v2, s[4:7], s46 offen offset:3072 sc1
    s_barrier
    buffer_load_dwordx4 v[68:71], v1, s[4:7], s46 offen offset:0 sc1
    buffer_load_dwordx4 v[72:75], v1, s[4:7], s46 offen offset:1024 sc1
    buffer_load_dwordx4 v[76:79], v1, s[4:7], s46 offen offset:2048 sc1
    buffer_load_dwordx4 v[80:83], v1, s[4:7], s46 offen offset:3072 sc1
    s_waitcnt vmcnt(4)
c2_mo_chk:
    v_max3_u32 v22, v52, v56, v60
    v_max_u32 v22, v22, v64
    v_cmp_eq_u32 vcc, -1, v22
    s_cbranch_vccnz c2_mo_retry
c2_mo_ok:
    v_mfma_f32_4x4x4_16b_bf16 v[84:87], v[24:25], v[52:53], 0
    v_mfma_f32_4x4x4_16b_bf16 v[88:91], v[24:25], v[54:55], 0
    v_mfma_f32_4x4x4_16b_bf16 v[92:95], v[24:25], v[56:57], 0
    v_mfma_f32_4x4x4_16b_bf16 v[96:99], v[24:25], v[58:59], 0
    v_mfma_f32_4x4x4_16b_bf16 v[100:103], v[24:25], v[60:61], 0
    v_mfma_f32_4x4x4_16b_bf16 v[104:107], v[24:25], v[62:63], 0
    v_mfma_f32_4x4x4_16b_bf16 v[108:111], v[24:25], v[64:65], 0
    v_mfma_f32_4x4x4_16b_bf16 v[112:115], v[24:25], v[66:67], 0
c2_mx_run:
    s_waitcnt vmcnt(3) lgkmcnt(0)
    v_mfma_f32_4x4x4_16b_bf16 v[84:87], v[24:25], v[68:69], v[84:87]
    v_mfma_f32_4x4x4_16b_bf16 v[88:91], v[24:25], v[70:71], v[88:91]
    s_waitcnt vmcnt(2)
    v_mfma_f32_4x4x4_16b_bf16 v[92:95], v[24:25], v[72:73], v[92:95]
    v_mfma_f32_4x4x4_16b_bf16 v[96:99], v[24:25], v[74:75], v[96:99]
    v_max_u32 v22, v68, v72
    v_cvt_pk_bf16_f32 v52, v84, v85
    v_cvt_pk_bf16_f32 v53, v86, v87
    v_cvt_pk_bf16_f32 v54, v88, v89
    v_cvt_pk_bf16_f32 v55, v90, v91
    ds_write_b128 v13, v[52:55] offset:8192
    s_waitcnt vmcnt(1)
    v_mfma_f32_4x4x4_16b_bf16 v[100:103], v[24:25], v[76:77], v[100:103]
    v_mfma_f32_4x4x4_16b_bf16 v[104:107], v[24:25], v[78:79], v[104:107]
    v_cvt_pk_bf16_f32 v56, v92, v93
    v_cvt_pk_bf16_f32 v57, v94, v95
    v_cvt_pk_bf16_f32 v58, v96, v97
    v_cvt_pk_bf16_f32 v59, v98, v99
    ds_write_b128 v13, v[56:59] offset:9216
    s_waitcnt vmcnt(0)
    v_mfma_f32_4x4x4_16b_bf16 v[108:111], v[24:25], v[80:81], v[108:111]
    v_mfma_f32_4x4x4_16b_bf16 v[112:115], v[24:25], v[82:83], v[112:115]
    v_max3_u32 v22, v22, v76, v80
    v_cvt_pk_bf16_f32 v60, v100, v101
    v_cvt_pk_bf16_f32 v61, v102, v103
    v_cmp_eq_u32 vcc, -1, v22
    v_cvt_pk_bf16_f32 v62, v104, v105
    v_cvt_pk_bf16_f32 v63, v106, v107
    ds_write_b128 v13, v[60:63] offset:10240
    v_cvt_pk_bf16_f32 v64, v108, v109
    v_cvt_pk_bf16_f32 v65, v110, v111
    v_cvt_pk_bf16_f32 v66, v112, v113
    v_cvt_pk_bf16_f32 v67, v114, v115
    ds_write_b128 v13, v[64:67] offset:11264
    s_cbranch_vccnz c2_mx_retry
c2_mx_ok:
c2_apost:
    v_smfmac_f32_16x16x64_bf16 v[40:43], v[52:55], a[64:71], v20
    v_smfmac_f32_16x16x64_bf16 v[44:47], v[52:55], a[192:199], v20
    v_smfmac_f32_16x16x64_bf16 v[40:43], v[56:59], a[72:79], v20
    v_smfmac_f32_16x16x64_bf16 v[44:47], v[56:59], a[200:207], v20
    s_mov_b32 m0, s54
    s_xor_b32 s54, s54, 4096
    buffer_load_dwordx4 v11, s[4:7], s52 offen sc1 lds
    buffer_load_dwordx4 v[36:39], v10, s[4:7], s51 offen sc1
    s_waitcnt lgkmcnt(0)
    s_barrier
    ds_read_b128 v[68:71], v13 offset:12288
    ds_read_b128 v[72:75], v13 offset:13312
    ds_read_b128 v[76:79], v13 offset:14336
    ds_read_b128 v[80:83], v13 offset:15360
    v_smfmac_f32_16x16x64_bf16 v[40:43], v[60:63], a[80:87], v20
    ds_read_b128 v[84:87], v13 offset:0
    ds_read_b128 v[88:91], v13 offset:1024
    ds_read_b128 v[92:95], v13 offset:2048
    v_smfmac_f32_16x16x64_bf16 v[44:47], v[60:63], a[208:215], v20
    ds_read_b128 v[96:99], v13 offset:3072
    ds_read_b128 v[100:103], v13 offset:4096
    ds_read_b128 v[104:107], v13 offset:5120
    v_smfmac_f32_16x16x64_bf16 v[40:43], v[64:67], a[88:95], v20
    ds_read_b128 v[108:111], v13 offset:6144
    ds_read_b128 v[112:115], v13 offset:7168
    v_smfmac_f32_16x16x64_bf16 v[44:47], v[64:67], a[216:223], v20
    s_waitcnt lgkmcnt(11)
    v_smfmac_f32_16x16x64_bf16 v[40:43], v[68:71], a[96:103], v20
    buffer_store_dword v30, v9, s[4:7], s3 offen sc1
    v_smfmac_f32_16x16x64_bf16 v[44:47], v[68:71], a[224:231], v20
    s_waitcnt lgkmcnt(10)
    v_smfmac_f32_16x16x64_bf16 v[40:43], v[72:75], a[104:111], v20
    buffer_store_dwordx4 v[32:35], v12, s[4:7], s48 offen
    v_smfmac_f32_16x16x64_bf16 v[44:47], v[72:75], a[232:239], v20
    s_waitcnt lgkmcnt(9)
    v_smfmac_f32_16x16x64_bf16 v[40:43], v[76:79], a[112:119], v20
    v_smfmac_f32_16x16x64_bf16 v[44:47], v[76:79], a[240:247], v20
    s_waitcnt lgkmcnt(8)
    v_smfmac_f32_16x16x64_bf16 v[40:43], v[80:83], a[120:127], v20
    v_smfmac_f32_16x16x64_bf16 v[44:47], v[80:83], a[248:255], v20
    s_waitcnt lgkmcnt(7)
    v_smfmac_f32_16x16x64_bf16 v[40:43], v[84:87], a[0:7], v20
    ds_read_b128 v[68:71], v19 offset:51200
    v_smfmac_f32_16x16x64_bf16 v[44:47], v[84:87], a[128:135], v20
    s_waitcnt lgkmcnt(7)
    v_smfmac_f32_16x16x64_bf16 v[40:43], v[88:91], a[8:15], v20
    ds_read_b128 v[72:75], v19 offset:52224
    v_smfmac_f32_16x16x64_bf16 v[44:47], v[88:91], a[136:143], v20
    s_waitcnt lgkmcnt(7)
    v_smfmac_f32_16x16x64_bf16 v[40:43], v[92:95], a[16:23], v20
    ds_read_b128 v[116:119], v19 offset:59392
    v_smfmac_f32_16x16x64_bf16 v[44:47], v[92:95], a[144:151], v20
    s_waitcnt lgkmcnt(7)
    v_smfmac_f32_16x16x64_bf16 v[40:43], v[96:99], a[24:31], v20
    ds_read_b128 v[120:123], v19 offset:60416
    v_smfmac_f32_16x16x64_bf16 v[44:47], v[96:99], a[152:159], v20
    s_waitcnt lgkmcnt(7)
    v_smfmac_f32_16x16x64_bf16 v[40:43], v[100:103], a[32:39], v20
    ds_read_b128 v[52:55], v16 offset:0
    v_smfmac_f32_16x16x64_bf16 v[44:47], v[100:103], a[160:167], v20
    s_waitcnt lgkmcnt(7)
    v_smfmac_f32_16x16x64_bf16 v[40:43], v[104:107], a[40:47], v20
    ds_read_b128 v[56:59], v16 offset:1024
    v_smfmac_f32_16x16x64_bf16 v[44:47], v[104:107], a[168:175], v20
    s_waitcnt lgkmcnt(7)
    v_smfmac_f32_16x16x64_bf16 v[40:43], v[108:111], a[48:55], v20
    ds_read_b128 v[60:63], v16 offset:2048
    v_smfmac_f32_16x16x64_bf16 v[44:47], v[108:111], a[176:183], v20
    s_waitcnt lgkmcnt(7)
    v_smfmac_f32_16x16x64_bf16 v[40:43], v[112:115], a[56:63], v20
    ds_read_b128 v[64:67], v16 offset:3072
    s_cmp_eq_u32 s45, 63
    v_smfmac_f32_16x16x64_bf16 v[44:47], v[112:115], a[184:191], v20
    s_cbranch_scc1 c2_last
    s_waitcnt lgkmcnt(6)
    v_smfmac_f32_16x16x64_bf16 v[48:51], v[76:79], v[68:75], v20
    v_pk_add_f32 v[40:41], v[40:41], v[42:43]
    v_cvt_pk_bf16_f32 v40, v40, v41
    ds_write2_b32 v14, v40, v40 offset0:0 offset1:1
    s_nop 0
    v_pk_add_f32 v[44:45], v[44:45], v[46:47]
    v_cvt_pk_bf16_f32 v44, v44, v45
    ds_write2_b32 v14, v44, v44 offset0:128 offset1:129
    s_waitcnt lgkmcnt(6)
    v_smfmac_f32_16x16x64_bf16 v[48:51], v[80:83], v[116:123], v20
    v_xor_b32 v16, 4096, v16
    s_waitcnt lgkmcnt(0)
    s_barrier
    ds_read_b64_tr_b16 v[116:117], v15 offset:0
    ds_read_b64_tr_b16 v[118:119], v15 offset:256
    ds_read_b64_tr_b16 v[120:121], v15 offset:2048
    ds_read_b64_tr_b16 v[122:123], v15 offset:2304
    ds_read_b64_tr_b16 v[68:69], v15 offset:512
    ds_read_b64_tr_b16 v[70:71], v15 offset:768
    ds_read_b64_tr_b16 v[72:73], v15 offset:2560
    ds_read_b64_tr_b16 v[74:75], v15 offset:2816
    ds_read_b128 v[76:79], v19 offset:0
    ds_read_b128 v[80:83], v19 offset:1024
    s_waitcnt lgkmcnt(6)
    v_mfma_f32_16x16x32_bf16 v[44:47], v[60:63], v[116:119], 0
    v_mfma_f32_16x16x32_bf16 v[44:47], v[64:67], v[120:123], v[44:47]
    v_mfma_f32_16x16x32_bf16 v[40:43], v[52:55], v[116:119], 0
    v_mfma_f32_16x16x32_bf16 v[40:43], v[56:59], v[120:123], v[40:43]
    buffer_store_dwordx4 v[44:47], v5, s[4:7], s46 offen
    s_waitcnt lgkmcnt(2)
    v_mfma_f32_16x16x32_bf16 v[124:127], v[68:71], v[116:119], 0
    v_mfma_f32_16x16x32_bf16 v[124:127], v[72:75], v[120:123], v[124:127]
    ds_read_b128 v[52:55], v19 offset:8192
    ds_read_b128 v[56:59], v19 offset:9216
    ds_read_b128 v[60:63], v19 offset:16384
    ds_read_b128 v[64:67], v19 offset:17408
    ds_read_b128 v[68:71], v19 offset:24576
    ds_read_b128 v[72:75], v19 offset:25600
    ds_read_b128 v[116:119], v19 offset:32768
    ds_read_b128 v[120:123], v19 offset:33792
    v_cndmask_b32 v40, v40, v44, s[32:33]
    v_cndmask_b32 v41, v41, v45, s[32:33]
    v_cndmask_b32 v42, v42, v46, s[32:33]
    v_cndmask_b32 v43, v43, v47, s[32:33]
    v_cndmask_b32 v124, v124, v125, s[32:33]
    v_mov_b32 v127, 0
    s_waitcnt lgkmcnt(8)
    v_smfmac_f32_16x16x64_bf16 v[48:51], v[84:87], v[76:83], v20
    ds_read_b128 v[76:79], v19 offset:40960
    ds_read_b128 v[80:83], v19 offset:41984
    s_waitcnt lgkmcnt(8)
    v_smfmac_f32_16x16x64_bf16 v[48:51], v[88:91], v[52:59], v20
    ds_read_b128 v[52:55], v19 offset:49152
    ds_read_b128 v[56:59], v19 offset:50176
    ds_read_b128 v[84:87], v13 offset:8192
    ds_read_b128 v[88:91], v13 offset:9216
    s_waitcnt lgkmcnt(10)
    v_smfmac_f32_16x16x64_bf16 v[48:51], v[92:95], v[60:67], v20
    ds_read_b128 v[60:63], v19 offset:57344
    ds_read_b128 v[64:67], v19 offset:58368
    s_waitcnt lgkmcnt(10)
    v_smfmac_f32_16x16x64_bf16 v[48:51], v[96:99], v[68:75], v20
    ds_read_b128 v[68:71], v19 offset:2048
    ds_read_b128 v[72:75], v19 offset:3072
    ds_read_b128 v[92:95], v13 offset:10240
    ds_read_b128 v[96:99], v13 offset:11264
    s_waitcnt lgkmcnt(12)
    v_smfmac_f32_16x16x64_bf16 v[48:51], v[100:103], v[116:123], v20
    ds_read_b128 v[116:119], v19 offset:10240
    ds_read_b128 v[120:123], v19 offset:11264
    s_waitcnt vmcnt(0)
    buffer_load_dwordx4 v[44:47], v6, s[4:7], s46 offen sc1
    buffer_load_dword v125, v6, s[4:7], s46 offen offset:1024 sc1
    s_waitcnt lgkmcnt(12)
    v_smfmac_f32_16x16x64_bf16 v[48:51], v[104:107], v[76:83], v20
    ds_read_b128 v[76:79], v19 offset:18432
    ds_read_b128 v[80:83], v19 offset:19456
    ds_read_b128 v[100:103], v13 offset:12288
    ds_read_b128 v[104:107], v13 offset:13312
    s_waitcnt lgkmcnt(14)
    v_smfmac_f32_16x16x64_bf16 v[48:51], v[108:111], v[52:59], v20
    ds_read_b128 v[52:55], v19 offset:26624
    ds_read_b128 v[56:59], v19 offset:27648
    s_waitcnt lgkmcnt(12)
    v_smfmac_f32_16x16x64_bf16 v[48:51], v[112:115], v[60:67], v20
    ds_read_b128 v[60:63], v19 offset:34816
    ds_read_b128 v[64:67], v19 offset:35840
    s_waitcnt lgkmcnt(12)
    v_smfmac_f32_16x16x64_bf16 v[48:51], v[84:87], v[68:75], v20
    ds_read_b128 v[68:71], v19 offset:43008
    ds_read_b128 v[72:75], v19 offset:44032
    s_waitcnt lgkmcnt(10)
    v_smfmac_f32_16x16x64_bf16 v[48:51], v[88:91], v[116:123], v20
    s_waitcnt lgkmcnt(8)
    v_smfmac_f32_16x16x64_bf16 v[48:51], v[92:95], v[76:83], v20
    s_waitcnt lgkmcnt(4)
    v_smfmac_f32_16x16x64_bf16 v[48:51], v[96:99], v[52:59], v20
    s_waitcnt lgkmcnt(2)
    v_smfmac_f32_16x16x64_bf16 v[48:51], v[100:103], v[60:67], v20
    s_waitcnt lgkmcnt(0)
    v_smfmac_f32_16x16x64_bf16 v[48:51], v[104:107], v[68:75], v20
    s_mov_b32 s56, 0x3e0293ee
    s_nop 6
    v_pk_add_f32 v[48:49], v[48:49], v[50:51]
    v_cvt_pk_bf16_f32 v30, v48, v49
    s_waitcnt vmcnt(0)
c2_s_chk:
    v_pk_add_f32 v[44:45], v[44:45], v[40:41]
    v_pk_add_f32 v[46:47], v[46:47], v[42:43]
    v_add_f32 v125, v125, v124
    v_maximum3_f32 v22, v44, v45, v46
    v_maximum3_f32 v22, v22, v47, v125
    v_cmp_u_f32 vcc, v22, v22
    s_cbranch_vccnz c2_s_retry
c2_s_ok:
    v_max_f32_dpp v23, v22, v22 quad_perm:[2,3,0,1] row_mask:0xf bank_mask:0xf
    v_max_f32_dpp v21, v22, v22 quad_perm:[2,3,0,1] row_mask:0xf bank_mask:0xf
    v_mov_b32 v40, 0
    v_mov_b32 v41, 0
    v_permlane32_swap_b32 v23, v21
    v_max_f32 v22, v23, v21
    v_max_f32 v23, v23, v21
    v_mov_b32 v42, 0
    v_mov_b32 v43, 0
    v_permlane16_swap_b32 v22, v23
    v_max_f32 v22, v22, v23
    v_mul_f32 v22, 0xbe0293ee, v22
    v_fma_f32 v125, v125, s56, v22
    v_pk_fma_f32 v[44:45], v[44:45], s[56:57], v[22:23] op_sel_hi:[1,0,0]
    v_exp_f32 v125, v125
    v_pk_fma_f32 v[46:47], v[46:47], s[56:57], v[22:23] op_sel_hi:[1,0,0]
    v_exp_f32 v44, v44
    v_mov_b32_dpp v23, v125 quad_perm:[2,3,2,3] row_mask:0xf bank_mask:0xf
    v_exp_f32 v45, v45
    v_cvt_pk_bf16_f32 v126, v125, v23
    v_exp_f32 v46, v46
    v_cvt_pk_bf16_f32 v52, v44, v45
    v_exp_f32 v47, v47
    v_mfma_f32_16x16x16_bf16 v[56:59], v[26:27], v[126:127], 0
    v_cvt_pk_bf16_f32 v53, v46, v47
    v_mov_b32_dpp v54, v52 quad_perm:[2,3,2,3] row_mask:0xf bank_mask:0xf
    v_mfma_f32_16x16x16_bf16 v[60:63], v[30:31], v[126:127], 0
    v_mov_b32_dpp v55, v53 quad_perm:[2,3,2,3] row_mask:0xf bank_mask:0xf
    v_mov_b32 v44, 0
    v_mov_b32 v45, 0
    v_mfma_f32_16x16x32_bf16 v[56:59], v[26:29], v[52:55], v[56:59]
    v_mfma_f32_16x16x32_bf16 v[60:63], v[36:39], v[52:55], v[60:63]
    v_mov_b32 v46, 0
    v_mov_b32 v47, 0
    s_nop 1
    v_rcp_f32 v22, v56
    s_nop 2
    v_pk_mul_f32 v[60:61], v[60:61], v[22:23] op_sel_hi:[1,0]
    v_pk_mul_f32 v[62:63], v[62:63], v[22:23] op_sel_hi:[1,0]
    v_cvt_pk_bf16_f32 v48, v60, v61
    v_cvt_pk_bf16_f32 v49, v62, v63
    buffer_store_dwordx2 v[48:49], v4, s[4:7], s46 offen
    s_mov_b32 s16, 0
    s_barrier
    s_nop 4
    s_nop 4
    s_nop 4
    s_nop 4
    s_nop 4
    s_nop 4
    s_nop 3
    s_nop 3
    s_nop 3
    s_nop 3
    s_nop 3
    buffer_load_dwordx4 v[76:79], v3, s[4:7], s46 offen offset:0 sc1
    s_nop 5
    buffer_load_dwordx4 v[80:83], v3, s[4:7], s46 offen offset:1024 sc1
    s_nop 5
    buffer_load_dwordx4 v[84:87], v3, s[4:7], s46 offen offset:2048 sc1
    s_nop 5
    buffer_load_dwordx4 v[88:91], v3, s[4:7], s46 offen offset:3072 sc1
    s_nop 5
    buffer_load_dwordx4 v[92:95], v3, s[4:7], s49 offen offset:0 sc1
    s_nop 5
    buffer_load_dwordx4 v[96:99], v3, s[4:7], s49 offen offset:1024 sc1
    s_nop 5
    buffer_load_dwordx4 v[100:103], v3, s[4:7], s49 offen offset:2048 sc1
    s_nop 5
    buffer_load_dwordx4 v[104:107], v3, s[4:7], s49 offen offset:3072 sc1
    s_waitcnt vmcnt(7)
    v_max_u32 v22, v76, v78
    v_cmp_eq_u32 vcc, -1, v22
    s_cbranch_vccnz c2_om0
    v_smfmac_f32_16x16x64_bf16 v[40:43], v[76:79], v[128:135], v20
    v_smfmac_f32_16x16x64_bf16 v[44:47], v[76:79], v[136:143], v20
c2_ob0:
    s_waitcnt vmcnt(6)
    v_max_u32 v22, v80, v82
    v_cmp_eq_u32 vcc, -1, v22
    s_cbranch_vccnz c2_om1
    v_smfmac_f32_16x16x64_bf16 v[40:43], v[80:83], v[144:151], v20
    v_smfmac_f32_16x16x64_bf16 v[44:47], v[80:83], v[152:159], v20
c2_ob1:
    s_waitcnt vmcnt(5)
    v_max_u32 v22, v84, v86
    v_cmp_eq_u32 vcc, -1, v22
    s_cbranch_vccnz c2_om2
    v_smfmac_f32_16x16x64_bf16 v[40:43], v[84:87], v[160:167], v20
    v_smfmac_f32_16x16x64_bf16 v[44:47], v[84:87], v[168:175], v20
c2_ob2:
    s_waitcnt vmcnt(4)
    v_max_u32 v22, v88, v90
    v_cmp_eq_u32 vcc, -1, v22
    s_cbranch_vccnz c2_om3
    v_smfmac_f32_16x16x64_bf16 v[40:43], v[88:91], v[176:183], v20
    v_smfmac_f32_16x16x64_bf16 v[44:47], v[88:91], v[184:191], v20
c2_ob3:
    s_waitcnt vmcnt(3)
    v_max_u32 v22, v92, v94
    v_cmp_eq_u32 vcc, -1, v22
    s_cbranch_vccnz c2_om4
    v_smfmac_f32_16x16x64_bf16 v[40:43], v[92:95], v[192:199], v20
    v_smfmac_f32_16x16x64_bf16 v[44:47], v[92:95], v[200:207], v20
c2_ob4:
    s_waitcnt vmcnt(2)
    v_max_u32 v22, v96, v98
    v_cmp_eq_u32 vcc, -1, v22
    s_cbranch_vccnz c2_om5
    v_smfmac_f32_16x16x64_bf16 v[40:43], v[96:99], v[208:215], v20
    v_smfmac_f32_16x16x64_bf16 v[44:47], v[96:99], v[216:223], v20
c2_ob5:
    s_waitcnt vmcnt(1)
    v_max_u32 v22, v100, v102
    v_cmp_eq_u32 vcc, -1, v22
    s_cbranch_vccnz c2_om6
    v_smfmac_f32_16x16x64_bf16 v[40:43], v[100:103], v[224:231], v20
    v_smfmac_f32_16x16x64_bf16 v[44:47], v[100:103], v[232:239], v20
c2_ob6:
    s_waitcnt vmcnt(0)
    v_max_u32 v22, v104, v106
    v_cmp_eq_u32 vcc, -1, v22
    s_cbranch_vccnz c2_om7
    v_smfmac_f32_16x16x64_bf16 v[40:43], v[104:107], v[240:247], v20
    v_smfmac_f32_16x16x64_bf16 v[44:47], v[104:107], v[248:255], v20
c2_ob7:
    s_cmp_lg_u32 s16, 0
    s_cbranch_scc1 c2_ofix
c2_o_end:
    s_mov_b32 s48, s46
    s_mov_b32 s46, s50
    s_nop 0
    v_pk_add_f32 v[40:41], v[40:41], v[42:43]
    ds_write2st64_b32 v17, v40, v41 offset0:0 offset1:1
    s_add_u32 s49, s46, 4096
    s_nop 0
    v_pk_add_f32 v[44:45], v[44:45], v[46:47]
    ds_write2st64_b32 v17, v44, v45 offset0:8 offset1:9
    s_mov_b32 s45, s92
    s_add_u32 s92, s92, 1
    s_add_u32 s50, s50, 0x80000
    s_and_b32 s50, s50, 0x1c2000
    s_mov_b32 s51, s52
    s_add_u32 s52, s52, 0x40000
    s_mov_b32 s3, s53
    s_add_u32 s53, s53, 0x10000
    s_waitcnt lgkmcnt(0)
    s_barrier
    ds_read_b128 v[52:55], v18 offset:0
    ds_read_b128 v[56:59], v18 offset:16
    s_waitcnt lgkmcnt(1)
    v_pk_add_f32 v[52:53], v[52:53], v[54:55]
    s_waitcnt lgkmcnt(0)
    v_pk_add_f32 v[56:57], v[56:57], v[58:59]
    v_pk_add_f32 v[52:53], v[52:53], v[56:57]
    v_cvt_pk_bf16_f32 v23, v52, v53
    buffer_store_dword v23, v7, s[4:7], s46 offen sc1
    s_branch c2_top
c2_last:
    s_waitcnt lgkmcnt(0)
    v_smfmac_f32_16x16x64_bf16 v[48:51], v[76:79], v[68:75], v20
    v_smfmac_f32_16x16x64_bf16 v[48:51], v[80:83], v[116:123], v20
    v_pk_add_f32 v[44:45], v[44:45], v[46:47]
    v_cvt_pk_bf16_f32 v44, v44, v45
    ds_write2_b32 v14, v44, v44 offset0:128 offset1:129
    ds_read_b128 v[76:79], v19 offset:0
    ds_read_b128 v[80:83], v19 offset:1024
    ds_read_b128 v[52:55], v19 offset:8192
    ds_read_b128 v[56:59], v19 offset:9216
    ds_read_b128 v[60:63], v19 offset:16384
    ds_read_b128 v[64:67], v19 offset:17408
    ds_read_b128 v[68:71], v19 offset:24576
    ds_read_b128 v[72:75], v19 offset:25600
    s_waitcnt lgkmcnt(8)
    s_barrier
    ds_read_b128 v[116:119], v19 offset:32768
    ds_read_b128 v[120:123], v19 offset:33792
    s_waitcnt lgkmcnt(8)
    v_smfmac_f32_16x16x64_bf16 v[48:51], v[84:87], v[76:83], v20
    ds_read_b128 v[76:79], v19 offset:40960
    ds_read_b128 v[80:83], v19 offset:41984
    s_waitcnt lgkmcnt(8)
    v_smfmac_f32_16x16x64_bf16 v[48:51], v[88:91], v[52:59], v20
    ds_read_b128 v[52:55], v19 offset:49152
    ds_read_b128 v[56:59], v19 offset:50176
    ds_read_b128 v[84:87], v13 offset:8192
    ds_read_b128 v[88:91], v13 offset:9216
    s_waitcnt lgkmcnt(10)
    v_smfmac_f32_16x16x64_bf16 v[48:51], v[92:95], v[60:67], v20
    ds_read_b128 v[60:63], v19 offset:57344
    ds_read_b128 v[64:67], v19 offset:58368
    s_waitcnt lgkmcnt(10)
    v_smfmac_f32_16x16x64_bf16 v[48:51], v[96:99], v[68:75], v20
    ds_read_b128 v[68:71], v19 offset:2048
    ds_read_b128 v[72:75], v19 offset:3072
    ds_read_b128 v[92:95], v13 offset:10240
    ds_read_b128 v[96:99], v13 offset:11264
    s_waitcnt lgkmcnt(12)
    v_smfmac_f32_16x16x64_bf16 v[48:51], v[100:103], v[116:123], v20
    ds_read_b128 v[116:119], v19 offset:10240
    ds_read_b128 v[120:123], v19 offset:11264
    s_waitcnt lgkmcnt(12)
    v_smfmac_f32_16x16x64_bf16 v[48:51], v[104:107], v[76:83], v20
    ds_read_b128 v[76:79], v19 offset:18432
    ds_read_b128 v[80:83], v19 offset:19456
    ds_read_b128 v[100:103], v13 offset:12288
    ds_read_b128 v[104:107], v13 offset:13312
    s_waitcnt lgkmcnt(14)
    v_smfmac_f32_16x16x64_bf16 v[48:51], v[108:111], v[52:59], v20
    ds_read_b128 v[52:55], v19 offset:26624
    ds_read_b128 v[56:59], v19 offset:27648
    s_waitcnt lgkmcnt(12)
    v_smfmac_f32_16x16x64_bf16 v[48:51], v[112:115], v[60:67], v20
    ds_read_b128 v[60:63], v19 offset:34816
    ds_read_b128 v[64:67], v19 offset:35840
    s_waitcnt lgkmcnt(12)
    v_smfmac_f32_16x16x64_bf16 v[48:51], v[84:87], v[68:75], v20
    ds_read_b128 v[68:71], v19 offset:43008
    ds_read_b128 v[72:75], v19 offset:44032
    s_waitcnt lgkmcnt(10)
    v_smfmac_f32_16x16x64_bf16 v[48:51], v[88:91], v[116:123], v20
    s_waitcnt lgkmcnt(8)
    v_smfmac_f32_16x16x64_bf16 v[48:51], v[92:95], v[76:83], v20
    s_waitcnt lgkmcnt(4)
    v_smfmac_f32_16x16x64_bf16 v[48:51], v[96:99], v[52:59], v20
    s_waitcnt lgkmcnt(2)
    v_smfmac_f32_16x16x64_bf16 v[48:51], v[100:103], v[60:67], v20
    s_waitcnt lgkmcnt(0)
    v_smfmac_f32_16x16x64_bf16 v[48:51], v[104:107], v[68:75], v20
    s_nop 7
    v_pk_add_f32 v[48:49], v[48:49], v[50:51]
    v_cvt_pk_bf16_f32 v30, v48, v49
    buffer_store_dword v30, v9, s[4:7], s53 offen sc1
    s_branch CDONE
c2_mo_retry:
    s_add_u32 s60, s60, 1
    s_cmp_eq_u32 s55, 0
    s_cbranch_scc1 c2_mo_ok
    s_sub_u32 s55, s55, 1
    v_cmp_eq_u32 s[16:17], -1, v52
    v_cmp_eq_u32 s[18:19], -1, v56
    v_cmp_eq_u32 s[20:21], -1, v60
    v_cmp_eq_u32 s[22:23], -1, v64
    s_mov_b64 exec, s[16:17]
    buffer_load_dwordx4 v[52:55], v2, s[4:7], s46 offen offset:0 sc1
    s_mov_b64 exec, s[18:19]
    buffer_load_dwordx4 v[56:59], v2, s[4:7], s46 offen offset:1024 sc1
    s_mov_b64 exec, s[20:21]
    buffer_load_dwordx4 v[60:63], v2, s[4:7], s46 offen offset:2048 sc1
    s_mov_b64 exec, s[22:23]
    buffer_load_dwordx4 v[64:67], v2, s[4:7], s46 offen offset:3072 sc1
    s_mov_b64 exec, -1
    s_waitcnt vmcnt(0)
    s_branch c2_mo_chk
c2_mx_retry:
    s_add_u32 s61, s61, 1
    s_cmp_eq_u32 s55, 0
    s_cbranch_scc1 c2_mx_ok
    s_sub_u32 s55, s55, 1
    v_cmp_eq_u32 s[16:17], -1, v68
    v_cmp_eq_u32 s[18:19], -1, v72
    v_cmp_eq_u32 s[20:21], -1, v76
    v_cmp_eq_u32 s[22:23], -1, v80
    s_mov_b64 exec, s[16:17]
    buffer_load_dwordx4 v[68:71], v1, s[4:7], s46 offen offset:0 sc1
    s_mov_b64 exec, s[18:19]
    buffer_load_dwordx4 v[72:75], v1, s[4:7], s46 offen offset:1024 sc1
    s_mov_b64 exec, s[20:21]
    buffer_load_dwordx4 v[76:79], v1, s[4:7], s46 offen offset:2048 sc1
    s_mov_b64 exec, s[22:23]
    buffer_load_dwordx4 v[80:83], v1, s[4:7], s46 offen offset:3072 sc1
    s_mov_b64 exec, -1
    s_waitcnt lgkmcnt(0)
    buffer_load_dwordx4 v[52:55], v2, s[4:7], s46 offen offset:0 sc1
    buffer_load_dwordx4 v[56:59], v2, s[4:7], s46 offen offset:1024 sc1
    buffer_load_dwordx4 v[60:63], v2, s[4:7], s46 offen offset:2048 sc1
    buffer_load_dwordx4 v[64:67], v2, s[4:7], s46 offen offset:3072 sc1
    s_waitcnt vmcnt(0)
    v_mfma_f32_4x4x4_16b_bf16 v[84:87], v[24:25], v[52:53], 0
    v_mfma_f32_4x4x4_16b_bf16 v[88:91], v[24:25], v[54:55], 0
    v_mfma_f32_4x4x4_16b_bf16 v[92:95], v[24:25], v[56:57], 0
    v_mfma_f32_4x4x4_16b_bf16 v[96:99], v[24:25], v[58:59], 0
    v_mfma_f32_4x4x4_16b_bf16 v[100:103], v[24:25], v[60:61], 0
    v_mfma_f32_4x4x4_16b_bf16 v[104:107], v[24:25], v[62:63], 0
    v_mfma_f32_4x4x4_16b_bf16 v[108:111], v[24:25], v[64:65], 0
    v_mfma_f32_4x4x4_16b_bf16 v[112:115], v[24:25], v[66:67], 0
    s_branch c2_mx_run
c2_s_retry:
    s_add_u32 s62, s62, 1
    s_cmp_eq_u32 s55, 0
    s_cbranch_scc1 c2_s_ok
    s_sub_u32 s55, s55, 1
    buffer_load_dwordx4 v[44:47], v6, s[4:7], s46 offen sc1
    buffer_load_dword v125, v6, s[4:7], s46 offen offset:1024 sc1
    s_waitcnt vmcnt(0)
    s_branch c2_s_chk
c2_om0:
    buffer_load_dwordx4 v[76:79], v3, s[4:7], s46 offen offset:0 sc1
    s_bitset1_b32 s16, 0
    s_branch c2_ob0
c2_om1:
    buffer_load_dwordx4 v[80:83], v3, s[4:7], s46 offen offset:1024 sc1
    s_bitset1_b32 s16, 1
    s_branch c2_ob1
c2_om2:
    buffer_load_dwordx4 v[84:87], v3, s[4:7], s46 offen offset:2048 sc1
    s_bitset1_b32 s16, 2
    s_branch c2_ob2
c2_om3:
    buffer_load_dwordx4 v[88:91], v3, s[4:7], s46 offen offset:3072 sc1
    s_bitset1_b32 s16, 3
    s_branch c2_ob3
c2_om4:
    buffer_load_dwordx4 v[92:95], v3, s[4:7], s49 offen offset:0 sc1
    s_bitset1_b32 s16, 4
    s_branch c2_ob4
c2_om5:
    buffer_load_dwordx4 v[96:99], v3, s[4:7], s49 offen offset:1024 sc1
    s_bitset1_b32 s16, 5
    s_branch c2_ob5
c2_om6:
    buffer_load_dwordx4 v[100:103], v3, s[4:7], s49 offen offset:2048 sc1
    s_bitset1_b32 s16, 6
    s_branch c2_ob6
c2_om7:
    buffer_load_dwordx4 v[104:107], v3, s[4:7], s49 offen offset:3072 sc1
    s_bitset1_b32 s16, 7
    s_branch c2_ob7
c2_ofix:
    s_add_u32 s63, s63, 1
    s_cmp_eq_u32 s55, 0
    s_cbranch_scc1 c2_o_end
    s_sub_u32 s55, s55, 1
    s_waitcnt vmcnt(0)
    s_bitcmp1_b32 s16, 0
    s_cbranch_scc0 c2_on0
    v_max_u32 v22, v76, v78
    v_cmp_eq_u32 vcc, -1, v22
    s_cbranch_vccnz c2_of0
    s_and_b32 s16, s16, 0x1fe
    v_smfmac_f32_16x16x64_bf16 v[40:43], v[76:79], v[128:135], v20
    v_smfmac_f32_16x16x64_bf16 v[44:47], v[76:79], v[136:143], v20
    s_cbranch_scc0 c2_o_end
c2_on0:
    s_bitcmp1_b32 s16, 1
    s_cbranch_scc0 c2_on1
    v_max_u32 v22, v80, v82
    v_cmp_eq_u32 vcc, -1, v22
    s_cbranch_vccnz c2_of1
    s_and_b32 s16, s16, 0x1fd
    v_smfmac_f32_16x16x64_bf16 v[40:43], v[80:83], v[144:151], v20
    v_smfmac_f32_16x16x64_bf16 v[44:47], v[80:83], v[152:159], v20
    s_cbranch_scc0 c2_o_end
c2_on1:
    s_bitcmp1_b32 s16, 2
    s_cbranch_scc0 c2_on2
    v_max_u32 v22, v84, v86
    v_cmp_eq_u32 vcc, -1, v22
    s_cbranch_vccnz c2_of2
    s_and_b32 s16, s16, 0x1fb
    v_smfmac_f32_16x16x64_bf16 v[40:43], v[84:87], v[160:167], v20
    v_smfmac_f32_16x16x64_bf16 v[44:47], v[84:87], v[168:175], v20
    s_cbranch_scc0 c2_o_end
c2_on2:
    s_bitcmp1_b32 s16, 3
    s_cbranch_scc0 c2_on3
    v_max_u32 v22, v88, v90
    v_cmp_eq_u32 vcc, -1, v22
    s_cbranch_vccnz c2_of3
    s_and_b32 s16, s16, 0x1f7
    v_smfmac_f32_16x16x64_bf16 v[40:43], v[88:91], v[176:183], v20
    v_smfmac_f32_16x16x64_bf16 v[44:47], v[88:91], v[184:191], v20
    s_cbranch_scc0 c2_o_end
c2_on3:
    s_bitcmp1_b32 s16, 4
    s_cbranch_scc0 c2_on4
    v_max_u32 v22, v92, v94
    v_cmp_eq_u32 vcc, -1, v22
    s_cbranch_vccnz c2_of4
    s_and_b32 s16, s16, 0x1ef
    v_smfmac_f32_16x16x64_bf16 v[40:43], v[92:95], v[192:199], v20
    v_smfmac_f32_16x16x64_bf16 v[44:47], v[92:95], v[200:207], v20
    s_cbranch_scc0 c2_o_end
c2_on4:
    s_bitcmp1_b32 s16, 5
    s_cbranch_scc0 c2_on5
    v_max_u32 v22, v96, v98
    v_cmp_eq_u32 vcc, -1, v22
    s_cbranch_vccnz c2_of5
    s_and_b32 s16, s16, 0x1df
    v_smfmac_f32_16x16x64_bf16 v[40:43], v[96:99], v[208:215], v20
    v_smfmac_f32_16x16x64_bf16 v[44:47], v[96:99], v[216:223], v20
    s_cbranch_scc0 c2_o_end
c2_on5:
    s_bitcmp1_b32 s16, 6
    s_cbranch_scc0 c2_on6
    v_max_u32 v22, v100, v102
    v_cmp_eq_u32 vcc, -1, v22
    s_cbranch_vccnz c2_of6
    s_and_b32 s16, s16, 0x1bf
    v_smfmac_f32_16x16x64_bf16 v[40:43], v[100:103], v[224:231], v20
    v_smfmac_f32_16x16x64_bf16 v[44:47], v[100:103], v[232:239], v20
    s_cbranch_scc0 c2_o_end
c2_on6:
    s_bitcmp1_b32 s16, 7
    s_cbranch_scc0 c2_on7
    v_max_u32 v22, v104, v106
    v_cmp_eq_u32 vcc, -1, v22
    s_cbranch_vccnz c2_of7
    s_and_b32 s16, s16, 0x17f
    v_smfmac_f32_16x16x64_bf16 v[40:43], v[104:107], v[240:247], v20
    v_smfmac_f32_16x16x64_bf16 v[44:47], v[104:107], v[248:255], v20
    s_cbranch_scc0 c2_o_end
c2_on7:
    s_branch c2_ofix
c2_of0:
    buffer_load_dwordx4 v[76:79], v3, s[4:7], s46 offen offset:0 sc1
    s_branch c2_on0
c2_of1:
    buffer_load_dwordx4 v[80:83], v3, s[4:7], s46 offen offset:1024 sc1
    s_branch c2_on1
c2_of2:
    buffer_load_dwordx4 v[84:87], v3, s[4:7], s46 offen offset:2048 sc1
    s_branch c2_on2
c2_of3:
    buffer_load_dwordx4 v[88:91], v3, s[4:7], s46 offen offset:3072 sc1
    s_branch c2_on3
c2_of4:
    buffer_load_dwordx4 v[92:95], v3, s[4:7], s49 offen offset:0 sc1
    s_branch c2_on4
c2_of5:
    buffer_load_dwordx4 v[96:99], v3, s[4:7], s49 offen offset:1024 sc1
    s_branch c2_on5
c2_of6:
    buffer_load_dwordx4 v[100:103], v3, s[4:7], s49 offen offset:2048 sc1
    s_branch c2_on6
c2_of7:
    buffer_load_dwordx4 v[104:107], v3, s[4:7], s49 offen offset:3072 sc1
    s_branch c2_on7
c3_entry:
    v_mov_b32 v8, 1
    ds_write_b128 v13, v[52:55] offset:12288
    ds_write_b128 v13, v[56:59] offset:13312
    ds_write_b128 v13, v[60:63] offset:14336
    ds_write_b128 v13, v[64:67] offset:15360
    s_branch c3_apost
.p2align 6
    s_nop 0
    s_nop 0
    s_nop 0
    s_nop 0
    s_nop 0
    s_nop 0
c3_top:
    v_mov_b32 v40, 0
    v_mov_b32 v41, 0
    v_mov_b32 v42, 0
    v_mov_b32 v43, 0
    v_mov_b32 v44, 0
    v_mov_b32 v45, 0
    v_mov_b32 v46, 0
    v_mov_b32 v47, 0
    v_mov_b32 v48, 0
    v_mov_b32 v49, 0
    v_mov_b32 v50, 0
    v_mov_b32 v51, 0
    s_nop 15
    s_nop 15
    s_nop 15
    s_nop 15
    s_nop 15
    s_nop 15
    s_nop 15
    s_nop 15
    s_nop 15
    buffer_load_dwordx4 v[52:55], v2, s[4:7], s46 offen offset:0 sc1
    buffer_load_dwordx4 v[56:59], v2, s[4:7], s46 offen offset:1024 sc1
    buffer_load_dwordx4 v[60:63], v2, s[4:7], s46 offen offset:2048 sc1
    buffer_load_dwordx4 v[64:67], v2, s[4:7], s46 offen offset:3072 sc1
    s_barrier
    buffer_load_dwordx4 v[68:71], v1, s[4:7], s46 offen offset:0 sc1
    buffer_load_dwordx4 v[72:75], v1, s[4:7], s46 offen offset:1024 sc1
    buffer_load_dwordx4 v[76:79], v1, s[4:7], s46 offen offset:2048 sc1
    buffer_load_dwordx4 v[80:83], v1, s[4:7], s46 offen offset:3072 sc1
    s_waitcnt vmcnt(4)
c3_mo_chk:
    v_max3_u32 v22, v52, v56, v60
    v_max_u32 v22, v22, v64
    v_cmp_eq_u32 vcc, -1, v22
    s_cbranch_vccnz c3_mo_retry
c3_mo_ok:
    v_mfma_f32_4x4x4_16b_bf16 v[84:87], v[24:25], v[52:53], 0
    v_mfma_f32_4x4x4_16b_bf16 v[88:91], v[24:25], v[54:55], 0
    v_mfma_f32_4x4x4_16b_bf16 v[92:95], v[24:25], v[56:57], 0
    v_mfma_f32_4x4x4_16b_bf16 v[96:99], v[24:25], v[58:59], 0
    v_mfma_f32_4x4x4_16b_bf16 v[100:103], v[24:25], v[60:61], 0
    v_mfma_f32_4x4x4_16b_bf16 v[104:107], v[24:25], v[62:63], 0
    v_mfma_f32_4x4x4_16b_bf16 v[108:111], v[24:25], v[64:65], 0
    v_mfma_f32_4x4x4_16b_bf16 v[112:115], v[24:25], v[66:67], 0
c3_mx_run:
    s_waitcnt vmcnt(3) lgkmcnt(0)
    v_mfma_f32_4x4x4_16b_bf16 v[84:87], v[24:25], v[68:69], v[84:87]
    v_mfma_f32_4x4x4_16b_bf16 v[88:91], v[24:25], v[70:71], v[88:91]
    s_waitcnt vmcnt(2)
    v_mfma_f32_4x4x4_16b_bf16 v[92:95], v[24:25], v[72:73], v[92:95]
    v_mfma_f32_4x4x4_16b_bf16 v[96:99], v[24:25], v[74:75], v[96:99]
    v_max_u32 v22, v68, v72
    v_cvt_pk_bf16_f32 v52, v84, v85
    v_cvt_pk_bf16_f32 v53, v86, v87
    v_cvt_pk_bf16_f32 v54, v88, v89
    v_cvt_pk_bf16_f32 v55, v90, v91
    ds_write_b128 v13, v[52:55] offset:12288
    s_waitcnt vmcnt(1)
    v_mfma_f32_4x4x4_16b_bf16 v[100:103], v[24:25], v[76:77], v[100:103]
    v_mfma_f32_4x4x4_16b_bf16 v[104:107], v[24:25], v[78:79], v[104:107]
    v_cvt_pk_bf16_f32 v56, v92, v93
    v_cvt_pk_bf16_f32 v57, v94, v95
    v_cvt_pk_bf16_f32 v58, v96, v97
    v_cvt_pk_bf16_f32 v59, v98, v99
    ds_write_b128 v13, v[56:59] offset:13312
    s_waitcnt vmcnt(0)
    v_mfma_f32_4x4x4_16b_bf16 v[108:111], v[24:25], v[80:81], v[108:111]
    v_mfma_f32_4x4x4_16b_bf16 v[112:115], v[24:25], v[82:83], v[112:115]
    v_max3_u32 v22, v22, v76, v80
    v_cvt_pk_bf16_f32 v60, v100, v101
    v_cvt_pk_bf16_f32 v61, v102, v103
    v_cmp_eq_u32 vcc, -1, v22
    v_cvt_pk_bf16_f32 v62, v104, v105
    v_cvt_pk_bf16_f32 v63, v106, v107
    ds_write_b128 v13, v[60:63] offset:14336
    v_cvt_pk_bf16_f32 v64, v108, v109
    v_cvt_pk_bf16_f32 v65, v110, v111
    v_cvt_pk_bf16_f32 v66, v112, v113
    v_cvt_pk_bf16_f32 v67, v114, v115
    ds_write_b128 v13, v[64:67] offset:15360
    s_cbranch_vccnz c3_mx_retry
c3_mx_ok:
c3_apost:
    v_smfmac_f32_16x16x64_bf16 v[40:43], v[52:55], a[96:103], v20
    v_smfmac_f32_16x16x64_bf16 v[44:47], v[52:55], a[224:231], v20
    v_smfmac_f32_16x16x64_bf16 v[40:43], v[56:59], a[104:111], v20
    v_smfmac_f32_16x16x64_bf16 v[44:47], v[56:59], a[232:239], v20
    s_mov_b32 m0, s54
    s_xor_b32 s54, s54, 4096
    buffer_load_dwordx4 v11, s[4:7], s52 offen sc1 lds
    buffer_load_dwordx4 v[36:39], v10, s[4:7], s51 offen sc1
    s_waitcnt lgkmcnt(0)
    s_barrier
    ds_read_b128 v[68:71], v13 offset:0
    ds_read_b128 v[72:75], v13 offset:1024
    ds_read_b128 v[76:79], v13 offset:2048
    ds_read_b128 v[80:83], v13 offset:3072
    v_smfmac_f32_16x16x64_bf16 v[40:43], v[60:63], a[112:119], v20
    ds_read_b128 v[84:87], v13 offset:4096
    ds_read_b128 v[88:91], v13 offset:5120
    ds_read_b128 v[92:95], v13 offset:6144
    v_smfmac_f32_16x16x64_bf16 v[44:47], v[60:63], a[240:247], v20
    ds_read_b128 v[96:99], v13 offset:7168
    ds_read_b128 v[100:103], v13 offset:8192
    ds_read_b128 v[104:107], v13 offset:9216
    v_smfmac_f32_16x16x64_bf16 v[40:43], v[64:67], a[120:127], v20
    ds_read_b128 v[108:111], v13 offset:10240
    ds_read_b128 v[112:115], v13 offset:11264
    v_smfmac_f32_16x16x64_bf16 v[44:47], v[64:67], a[248:255], v20
    s_waitcnt lgkmcnt(11)
    v_smfmac_f32_16x16x64_bf16 v[40:43], v[68:71], a[0:7], v20
    buffer_store_dword v30, v9, s[4:7], s3 offen sc1
    v_smfmac_f32_16x16x64_bf16 v[44:47], v[68:71], a[128:135], v20
    s_waitcnt lgkmcnt(10)
    v_smfmac_f32_16x16x64_bf16 v[40:43], v[72:75], a[8:15], v20
    buffer_store_dwordx4 v[32:35], v12, s[4:7], s48 offen sc1
    v_smfmac_f32_16x16x64_bf16 v[44:47], v[72:75], a[136:143], v20
    s_waitcnt lgkmcnt(9)
    v_smfmac_f32_16x16x64_bf16 v[40:43], v[76:79], a[16:23], v20
    s_mov_b64 exec, 3
    buffer_load_ubyte v8, v0, s[4:7], s47 offen sc1
    s_mov_b64 exec, -1
    v_smfmac_f32_16x16x64_bf16 v[44:47], v[76:79], a[144:151], v20
    s_waitcnt lgkmcnt(8)
    v_smfmac_f32_16x16x64_bf16 v[40:43], v[80:83], a[24:31], v20
    v_smfmac_f32_16x16x64_bf16 v[44:47], v[80:83], a[152:159], v20
    s_waitcnt lgkmcnt(7)
    v_smfmac_f32_16x16x64_bf16 v[40:43], v[84:87], a[32:39], v20
    ds_read_b128 v[68:71], v19 offset:16384
    v_smfmac_f32_16x16x64_bf16 v[44:47], v[84:87], a[160:167], v20
    s_waitcnt lgkmcnt(7)
    v_smfmac_f32_16x16x64_bf16 v[40:43], v[88:91], a[40:47], v20
    ds_read_b128 v[72:75], v19 offset:17408
    v_smfmac_f32_16x16x64_bf16 v[44:47], v[88:91], a[168:175], v20
    s_waitcnt lgkmcnt(7)
    v_smfmac_f32_16x16x64_bf16 v[40:43], v[92:95], a[48:55], v20
    ds_read_b128 v[116:119], v19 offset:24576
    v_smfmac_f32_16x16x64_bf16 v[44:47], v[92:95], a[176:183], v20
    s_waitcnt lgkmcnt(7)
    v_smfmac_f32_16x16x64_bf16 v[40:43], v[96:99], a[56:63], v20
    ds_read_b128 v[120:123], v19 offset:25600
    v_smfmac_f32_16x16x64_bf16 v[44:47], v[96:99], a[184:191], v20
    s_waitcnt lgkmcnt(7)
    v_smfmac_f32_16x16x64_bf16 v[40:43], v[100:103], a[64:71], v20
    ds_read_b128 v[52:55], v16 offset:0
    v_smfmac_f32_16x16x64_bf16 v[44:47], v[100:103], a[192:199], v20
    s_waitcnt lgkmcnt(7)
    v_smfmac_f32_16x16x64_bf16 v[40:43], v[104:107], a[72:79], v20
    ds_read_b128 v[56:59], v16 offset:1024
    v_smfmac_f32_16x16x64_bf16 v[44:47], v[104:107], a[200:207], v20
    s_waitcnt lgkmcnt(7)
    v_smfmac_f32_16x16x64_bf16 v[40:43], v[108:111], a[80:87], v20
    ds_read_b128 v[60:63], v16 offset:2048
    v_smfmac_f32_16x16x64_bf16 v[44:47], v[108:111], a[208:215], v20
    s_waitcnt lgkmcnt(7)
    v_smfmac_f32_16x16x64_bf16 v[40:43], v[112:115], a[88:95], v20
    ds_read_b128 v[64:67], v16 offset:3072
    s_cmp_eq_u32 s45, 63
    v_smfmac_f32_16x16x64_bf16 v[44:47], v[112:115], a[216:223], v20
    s_cbranch_scc1 c3_last
    s_waitcnt lgkmcnt(6)
    v_smfmac_f32_16x16x64_bf16 v[48:51], v[76:79], v[68:75], v20
    v_pk_add_f32 v[40:41], v[40:41], v[42:43]
    v_cvt_pk_bf16_f32 v40, v40, v41
    ds_write2_b32 v14, v40, v40 offset0:0 offset1:1
    s_nop 0
    v_pk_add_f32 v[44:45], v[44:45], v[46:47]
    v_cvt_pk_bf16_f32 v44, v44, v45
    ds_write2_b32 v14, v44, v44 offset0:128 offset1:129
    s_waitcnt lgkmcnt(6)
    v_smfmac_f32_16x16x64_bf16 v[48:51], v[80:83], v[116:123], v20
    v_xor_b32 v16, 4096, v16
    s_waitcnt lgkmcnt(0)
    s_barrier
    ds_read_b64_tr_b16 v[116:117], v15 offset:0
    ds_read_b64_tr_b16 v[118:119], v15 offset:256
    ds_read_b64_tr_b16 v[120:121], v15 offset:2048
    ds_read_b64_tr_b16 v[122:123], v15 offset:2304
    ds_read_b64_tr_b16 v[68:69], v15 offset:512
    ds_read_b64_tr_b16 v[70:71], v15 offset:768
    ds_read_b64_tr_b16 v[72:73], v15 offset:2560
    ds_read_b64_tr_b16 v[74:75], v15 offset:2816
    ds_read_b128 v[76:79], v19 offset:32768
    ds_read_b128 v[80:83], v19 offset:33792
    s_waitcnt lgkmcnt(2)
    v_mfma_f32_16x16x32_bf16 v[124:127], v[68:71], v[116:119], 0
    v_mfma_f32_16x16x32_bf16 v[124:127], v[72:75], v[120:123], v[124:127]
    v_mfma_f32_16x16x32_bf16 v[40:43], v[52:55], v[116:119], 0
    v_mfma_f32_16x16x32_bf16 v[40:43], v[56:59], v[120:123], v[40:43]
    buffer_store_dword v125, v5, s[4:7], s46 offen
    v_mfma_f32_16x16x32_bf16 v[44:47], v[60:63], v[116:119], 0
    v_mfma_f32_16x16x32_bf16 v[44:47], v[64:67], v[120:123], v[44:47]
    ds_read_b128 v[52:55], v19 offset:40960
    ds_read_b128 v[56:59], v19 offset:41984
    ds_read_b128 v[60:63], v19 offset:49152
    ds_read_b128 v[64:67], v19 offset:50176
    ds_read_b128 v[68:71], v19 offset:57344
    ds_read_b128 v[72:75], v19 offset:58368
    ds_read_b128 v[116:119], v19 offset:2048
    ds_read_b128 v[120:123], v19 offset:3072
    v_cndmask_b32 v40, v40, v44, s[32:33]
    v_cndmask_b32 v41, v41, v45, s[32:33]
    v_cndmask_b32 v42, v42, v46, s[32:33]
    v_cndmask_b32 v43, v43, v47, s[32:33]
    v_cndmask_b32 v124, v124, v125, s[32:33]
    v_mov_b32 v127, 0
    s_waitcnt lgkmcnt(8)
    v_smfmac_f32_16x16x64_bf16 v[48:51], v[84:87], v[76:83], v20
    ds_read_b128 v[76:79], v19 offset:10240
    ds_read_b128 v[80:83], v19 offset:11264
    s_waitcnt lgkmcnt(8)
    v_smfmac_f32_16x16x64_bf16 v[48:51], v[88:91], v[52:59], v20
    ds_read_b128 v[52:55], v19 offset:18432
    ds_read_b128 v[56:59], v19 offset:19456
    ds_read_b128 v[84:87], v13 offset:12288
    ds_read_b128 v[88:91], v13 offset:13312
    s_waitcnt lgkmcnt(10)
    v_smfmac_f32_16x16x64_bf16 v[48:51], v[92:95], v[60:67], v20
    ds_read_b128 v[60:63], v19 offset:26624
    ds_read_b128 v[64:67], v19 offset:27648
    s_waitcnt lgkmcnt(10)
    v_smfmac_f32_16x16x64_bf16 v[48:51], v[96:99], v[68:75], v20
    ds_read_b128 v[68:71], v19 offset:34816
    ds_read_b128 v[72:75], v19 offset:35840
    ds_read_b128 v[92:95], v13 offset:14336
    ds_read_b128 v[96:99], v13 offset:15360
    s_waitcnt lgkmcnt(12)
    v_smfmac_f32_16x16x64_bf16 v[48:51], v[100:103], v[116:123], v20
    ds_read_b128 v[116:119], v19 offset:43008
    ds_read_b128 v[120:123], v19 offset:44032
    s_waitcnt lgkmcnt(12)
    v_smfmac_f32_16x16x64_bf16 v[48:51], v[104:107], v[76:83], v20
    ds_read_b128 v[76:79], v19 offset:51200
    ds_read_b128 v[80:83], v19 offset:52224
    ds_read_b128 v[100:103], v13 offset:0
    ds_read_b128 v[104:107], v13 offset:1024
    buffer_load_dwordx4 v[44:47], v6, s[4:7], s46 offen sc1
    buffer_load_dword v125, v6, s[4:7], s46 offen offset:1024 sc1
    s_waitcnt lgkmcnt(14)
    v_smfmac_f32_16x16x64_bf16 v[48:51], v[108:111], v[52:59], v20
    ds_read_b128 v[52:55], v19 offset:59392
    ds_read_b128 v[56:59], v19 offset:60416
    s_waitcnt lgkmcnt(12)
    v_smfmac_f32_16x16x64_bf16 v[48:51], v[112:115], v[60:67], v20
    ds_read_b128 v[60:63], v19 offset:0
    ds_read_b128 v[64:67], v19 offset:1024
    s_waitcnt lgkmcnt(12)
    v_smfmac_f32_16x16x64_bf16 v[48:51], v[84:87], v[68:75], v20
    ds_read_b128 v[68:71], v19 offset:8192
    ds_read_b128 v[72:75], v19 offset:9216
    s_waitcnt lgkmcnt(10)
    v_smfmac_f32_16x16x64_bf16 v[48:51], v[88:91], v[116:123], v20
    s_waitcnt lgkmcnt(8)
    v_smfmac_f32_16x16x64_bf16 v[48:51], v[92:95], v[76:83], v20
    s_waitcnt lgkmcnt(4)
    v_smfmac_f32_16x16x64_bf16 v[48:51], v[96:99], v[52:59], v20
    s_waitcnt lgkmcnt(2)
    v_smfmac_f32_16x16x64_bf16 v[48:51], v[100:103], v[60:67], v20
    s_waitcnt lgkmcnt(0)
    v_smfmac_f32_16x16x64_bf16 v[48:51], v[104:107], v[68:75], v20
    s_mov_b32 s56, 0x3e0293ee
    s_nop 6
    v_pk_add_f32 v[48:49], v[48:49], v[50:51]
    v_cvt_pk_bf16_f32 v30, v48, v49
    s_nop 0
    s_waitcnt vmcnt(0)
c3_s_chk:
    v_pk_add_f32 v[44:45], v[44:45], v[40:41]
    v_pk_add_f32 v[46:47], v[46:47], v[42:43]
    v_add_f32 v125, v125, v124
    v_maximum3_f32 v22, v44, v45, v46
    v_maximum3_f32 v22, v22, v47, v125
    v_cmp_u_f32 vcc, v22, v22
    s_cbranch_vccnz c3_s_retry
c3_s_ok:
    v_max_f32_dpp v23, v22, v22 quad_perm:[2,3,0,1] row_mask:0xf bank_mask:0xf
    v_max_f32_dpp v21, v22, v22 quad_perm:[2,3,0,1] row_mask:0xf bank_mask:0xf
    v_mov_b32 v40, 0
    v_mov_b32 v41, 0
    v_permlane32_swap_b32 v23, v21
    v_max_f32 v22, v23, v21
    v_max_f32 v23, v23, v21
    v_mov_b32 v42, 0
    v_mov_b32 v43, 0
    v_permlane16_swap_b32 v22, v23
    v_max_f32 v22, v22, v23
    v_mul_f32 v22, 0xbe0293ee, v22
    v_fma_f32 v125, v125, s56, v22
    v_pk_fma_f32 v[44:45], v[44:45], s[56:57], v[22:23] op_sel_hi:[1,0,0]
    v_exp_f32 v125, v125
    v_pk_fma_f32 v[46:47], v[46:47], s[56:57], v[22:23] op_sel_hi:[1,0,0]
    v_exp_f32 v44, v44
    v_mov_b32_dpp v23, v125 quad_perm:[2,3,2,3] row_mask:0xf bank_mask:0xf
    v_exp_f32 v45, v45
    v_cvt_pk_bf16_f32 v126, v125, v23
    v_exp_f32 v46, v46
    v_cvt_pk_bf16_f32 v52, v44, v45
    v_exp_f32 v47, v47
    v_mfma_f32_16x16x16_bf16 v[56:59], v[26:27], v[126:127], 0
    v_cvt_pk_bf16_f32 v53, v46, v47
    v_mov_b32_dpp v54, v52 quad_perm:[2,3,2,3] row_mask:0xf bank_mask:0xf
    v_mfma_f32_16x16x16_bf16 v[60:63], v[30:31], v[126:127], 0
    v_mov_b32_dpp v55, v53 quad_perm:[2,3,2,3] row_mask:0xf bank_mask:0xf
    v_mov_b32 v44, 0
    v_mov_b32 v45, 0
    v_mfma_f32_16x16x32_bf16 v[56:59], v[26:29], v[52:55], v[56:59]
    v_mfma_f32_16x16x32_bf16 v[60:63], v[36:39], v[52:55], v[60:63]
    v_mov_b32 v46, 0
    v_mov_b32 v47, 0
    s_nop 1
    v_rcp_f32 v22, v56
    s_nop 2
    v_pk_mul_f32 v[60:61], v[60:61], v[22:23] op_sel_hi:[1,0]
    v_pk_mul_f32 v[62:63], v[62:63], v[22:23] op_sel_hi:[1,0]
    v_cvt_pk_bf16_f32 v48, v60, v61
    v_cvt_pk_bf16_f32 v49, v62, v63
    buffer_store_dwordx2 v[48:49], v4, s[4:7], s46 offen
    s_mov_b32 s16, 0
    s_barrier
    s_nop 10
    s_nop 10
    s_nop 10
    s_nop 10
    buffer_load_dwordx4 v[76:79], v3, s[4:7], s46 offen offset:0 sc1
    s_nop 5
    buffer_load_dwordx4 v[80:83], v3, s[4:7], s46 offen offset:1024 sc1
    s_nop 5
    buffer_load_dwordx4 v[84:87], v3, s[4:7], s46 offen offset:2048 sc1
    s_nop 5
    buffer_load_dwordx4 v[88:91], v3, s[4:7], s46 offen offset:3072 sc1
    s_nop 5
    buffer_load_dwordx4 v[92:95], v3, s[4:7], s49 offen offset:0 sc1
    s_nop 5
    buffer_load_dwordx4 v[96:99], v3, s[4:7], s49 offen offset:1024 sc1
    s_nop 5
    buffer_load_dwordx4 v[100:103], v3, s[4:7], s49 offen offset:2048 sc1
    s_nop 5
    buffer_load_dwordx4 v[104:107], v3, s[4:7], s49 offen offset:3072 sc1
    s_waitcnt vmcnt(7)
    v_max_u32 v22, v76, v78
    v_cmp_eq_u32 vcc, -1, v22
    s_cbranch_vccnz c3_om0
    v_smfmac_f32_16x16x64_bf16 v[40:43], v[76:79], v[128:135], v20
    v_smfmac_f32_16x16x64_bf16 v[44:47], v[76:79], v[136:143], v20
c3_ob0:
    s_waitcnt vmcnt(6)
    v_max_u32 v22, v80, v82
    v_cmp_eq_u32 vcc, -1, v22
    s_cbranch_vccnz c3_om1
    v_smfmac_f32_16x16x64_bf16 v[40:43], v[80:83], v[144:151], v20
    v_smfmac_f32_16x16x64_bf16 v[44:47], v[80:83], v[152:159], v20
c3_ob1:
    s_waitcnt vmcnt(5)
    v_max_u32 v22, v84, v86
    v_cmp_eq_u32 vcc, -1, v22
    s_cbranch_vccnz c3_om2
    v_smfmac_f32_16x16x64_bf16 v[40:43], v[84:87], v[160:167], v20
    v_smfmac_f32_16x16x64_bf16 v[44:47], v[84:87], v[168:175], v20
c3_ob2:
    s_waitcnt vmcnt(4)
    v_max_u32 v22, v88, v90
    v_cmp_eq_u32 vcc, -1, v22
    s_cbranch_vccnz c3_om3
    v_smfmac_f32_16x16x64_bf16 v[40:43], v[88:91], v[176:183], v20
    v_smfmac_f32_16x16x64_bf16 v[44:47], v[88:91], v[184:191], v20
c3_ob3:
    s_waitcnt vmcnt(3)
    v_max_u32 v22, v92, v94
    v_cmp_eq_u32 vcc, -1, v22
    s_cbranch_vccnz c3_om4
    v_smfmac_f32_16x16x64_bf16 v[40:43], v[92:95], v[192:199], v20
    v_smfmac_f32_16x16x64_bf16 v[44:47], v[92:95], v[200:207], v20
c3_ob4:
    s_waitcnt vmcnt(2)
    v_max_u32 v22, v96, v98
    v_cmp_eq_u32 vcc, -1, v22
    s_cbranch_vccnz c3_om5
    v_smfmac_f32_16x16x64_bf16 v[40:43], v[96:99], v[208:215], v20
    v_smfmac_f32_16x16x64_bf16 v[44:47], v[96:99], v[216:223], v20
c3_ob5:
    s_waitcnt vmcnt(1)
    v_max_u32 v22, v100, v102
    v_cmp_eq_u32 vcc, -1, v22
    s_cbranch_vccnz c3_om6
    v_smfmac_f32_16x16x64_bf16 v[40:43], v[100:103], v[224:231], v20
    v_smfmac_f32_16x16x64_bf16 v[44:47], v[100:103], v[232:239], v20
c3_ob6:
    s_waitcnt vmcnt(0)
    v_max_u32 v22, v104, v106
    v_cmp_eq_u32 vcc, -1, v22
    s_cbranch_vccnz c3_om7
    v_smfmac_f32_16x16x64_bf16 v[40:43], v[104:107], v[240:247], v20
    v_smfmac_f32_16x16x64_bf16 v[44:47], v[104:107], v[248:255], v20
c3_ob7:
    s_cmp_lg_u32 s16, 0
    s_cbranch_scc1 c3_ofix
c3_o_end:
c3_kv_chk:
    v_cmp_eq_u32 vcc, 0, v8
    s_cbranch_vccnz c3_kv_retry
c3_kv_ok:
    s_mov_b32 s48, s46
    s_mov_b32 s46, s50
    v_pk_add_f32 v[40:41], v[40:41], v[42:43]
    ds_write2st64_b32 v17, v40, v41 offset0:0 offset1:1
    s_add_u32 s49, s46, 4096
    v_pk_add_f32 v[44:45], v[44:45], v[46:47]
    ds_write2st64_b32 v17, v44, v45 offset0:8 offset1:9
    s_mov_b32 s45, s92
    s_add_u32 s92, s92, 1
    s_add_u32 s50, s50, 0x80000
    s_and_b32 s50, s50, 0x1c2000
    s_mov_b32 s51, s52
    s_add_u32 s52, s52, 0x40000
    s_mov_b32 s3, s53
    s_add_u32 s53, s53, 0x10000
    s_waitcnt lgkmcnt(0)
    s_barrier
    ds_read_b128 v[52:55], v18 offset:0
    ds_read_b128 v[56:59], v18 offset:16
    s_add_u32 s56, s45, 2
    s_min_u32 s56, s56, 63
    s_lshr_b32 s47, s56, 3
    s_lshl_b32 s47, s47, 11
    s_add_u32 s47, s47, s24
    s_bitcmp1_b32 s56, 2
    s_cselect_b32 s56, 12, 0
    s_add_u32 s47, s47, s56
    s_waitcnt lgkmcnt(1)
    v_pk_add_f32 v[52:53], v[52:53], v[54:55]
    s_waitcnt lgkmcnt(0)
    v_pk_add_f32 v[56:57], v[56:57], v[58:59]
    v_pk_add_f32 v[52:53], v[52:53], v[56:57]
    v_cvt_pk_bf16_f32 v23, v52, v53
    buffer_store_dword v23, v7, s[4:7], s46 offen
    s_branch c3_top
c3_last:
    s_waitcnt lgkmcnt(0)
    v_smfmac_f32_16x16x64_bf16 v[48:51], v[76:79], v[68:75], v20
    v_smfmac_f32_16x16x64_bf16 v[48:51], v[80:83], v[116:123], v20
    v_pk_add_f32 v[44:45], v[44:45], v[46:47]
    v_cvt_pk_bf16_f32 v44, v44, v45
    ds_write2_b32 v14, v44, v44 offset0:128 offset1:129
    ds_read_b128 v[76:79], v19 offset:32768
    ds_read_b128 v[80:83], v19 offset:33792
    ds_read_b128 v[52:55], v19 offset:40960
    ds_read_b128 v[56:59], v19 offset:41984
    ds_read_b128 v[60:63], v19 offset:49152
    ds_read_b128 v[64:67], v19 offset:50176
    ds_read_b128 v[68:71], v19 offset:57344
    ds_read_b128 v[72:75], v19 offset:58368
    s_waitcnt lgkmcnt(8)
    s_barrier
    ds_read_b128 v[116:119], v19 offset:2048
    ds_read_b128 v[120:123], v19 offset:3072
    s_waitcnt lgkmcnt(8)
    v_smfmac_f32_16x16x64_bf16 v[48:51], v[84:87], v[76:83], v20
    ds_read_b128 v[76:79], v19 offset:10240
    ds_read_b128 v[80:83], v19 offset:11264
    s_waitcnt lgkmcnt(8)
    v_smfmac_f32_16x16x64_bf16 v[48:51], v[88:91], v[52:59], v20
    ds_read_b128 v[52:55], v19 offset:18432
    ds_read_b128 v[56:59], v19 offset:19456
    ds_read_b128 v[84:87], v13 offset:12288
    ds_read_b128 v[88:91], v13 offset:13312
    s_waitcnt lgkmcnt(10)
    v_smfmac_f32_16x16x64_bf16 v[48:51], v[92:95], v[60:67], v20
    ds_read_b128 v[60:63], v19 offset:26624
    ds_read_b128 v[64:67], v19 offset:27648
    s_waitcnt lgkmcnt(10)
    v_smfmac_f32_16x16x64_bf16 v[48:51], v[96:99], v[68:75], v20
    ds_read_b128 v[68:71], v19 offset:34816
    ds_read_b128 v[72:75], v19 offset:35840
    ds_read_b128 v[92:95], v13 offset:14336
    ds_read_b128 v[96:99], v13 offset:15360
    s_waitcnt lgkmcnt(12)
    v_smfmac_f32_16x16x64_bf16 v[48:51], v[100:103], v[116:123], v20
    ds_read_b128 v[116:119], v19 offset:43008
    ds_read_b128 v[120:123], v19 offset:44032
    s_waitcnt lgkmcnt(12)
    v_smfmac_f32_16x16x64_bf16 v[48:51], v[104:107], v[76:83], v20
    ds_read_b128 v[76:79], v19 offset:51200
    ds_read_b128 v[80:83], v19 offset:52224
    ds_read_b128 v[100:103], v13 offset:0
    ds_read_b128 v[104:107], v13 offset:1024
    s_waitcnt lgkmcnt(14)
    v_smfmac_f32_16x16x64_bf16 v[48:51], v[108:111], v[52:59], v20
    ds_read_b128 v[52:55], v19 offset:59392
    ds_read_b128 v[56:59], v19 offset:60416
    s_waitcnt lgkmcnt(12)
    v_smfmac_f32_16x16x64_bf16 v[48:51], v[112:115], v[60:67], v20
    ds_read_b128 v[60:63], v19 offset:0
    ds_read_b128 v[64:67], v19 offset:1024
    s_waitcnt lgkmcnt(12)
    v_smfmac_f32_16x16x64_bf16 v[48:51], v[84:87], v[68:75], v20
    ds_read_b128 v[68:71], v19 offset:8192
    ds_read_b128 v[72:75], v19 offset:9216
    s_waitcnt lgkmcnt(10)
    v_smfmac_f32_16x16x64_bf16 v[48:51], v[88:91], v[116:123], v20
    s_waitcnt lgkmcnt(8)
    v_smfmac_f32_16x16x64_bf16 v[48:51], v[92:95], v[76:83], v20
    s_waitcnt lgkmcnt(4)
    v_smfmac_f32_16x16x64_bf16 v[48:51], v[96:99], v[52:59], v20
    s_waitcnt lgkmcnt(2)
    v_smfmac_f32_16x16x64_bf16 v[48:51], v[100:103], v[60:67], v20
    s_waitcnt lgkmcnt(0)
    v_smfmac_f32_16x16x64_bf16 v[48:51], v[104:107], v[68:75], v20
    s_nop 7
    v_pk_add_f32 v[48:49], v[48:49], v[50:51]
    v_cvt_pk_bf16_f32 v30, v48, v49
    buffer_store_dword v30, v9, s[4:7], s53 offen sc1
    s_branch CDONE
c3_mo_retry:
    s_add_u32 s60, s60, 1
    s_cmp_eq_u32 s55, 0
    s_cbranch_scc1 c3_mo_ok
    s_sub_u32 s55, s55, 1
    v_cmp_eq_u32 s[16:17], -1, v52
    v_cmp_eq_u32 s[18:19], -1, v56
    v_cmp_eq_u32 s[20:21], -1, v60
    v_cmp_eq_u32 s[22:23], -1, v64
    s_mov_b64 exec, s[16:17]
    buffer_load_dwordx4 v[52:55], v2, s[4:7], s46 offen offset:0 sc1
    s_mov_b64 exec, s[18:19]
    buffer_load_dwordx4 v[56:59], v2, s[4:7], s46 offen offset:1024 sc1
    s_mov_b64 exec, s[20:21]
    buffer_load_dwordx4 v[60:63], v2, s[4:7], s46 offen offset:2048 sc1
    s_mov_b64 exec, s[22:23]
    buffer_load_dwordx4 v[64:67], v2, s[4:7], s46 offen offset:3072 sc1
    s_mov_b64 exec, -1
    s_waitcnt vmcnt(0)
    s_branch c3_mo_chk
c3_mx_retry:
    s_add_u32 s61, s61, 1
    s_cmp_eq_u32 s55, 0
    s_cbranch_scc1 c3_mx_ok
    s_sub_u32 s55, s55, 1
    v_cmp_eq_u32 s[16:17], -1, v68
    v_cmp_eq_u32 s[18:19], -1, v72
    v_cmp_eq_u32 s[20:21], -1, v76
    v_cmp_eq_u32 s[22:23], -1, v80
    s_mov_b64 exec, s[16:17]
    buffer_load_dwordx4 v[68:71], v1, s[4:7], s46 offen offset:0 sc1
    s_mov_b64 exec, s[18:19]
    buffer_load_dwordx4 v[72:75], v1, s[4:7], s46 offen offset:1024 sc1
    s_mov_b64 exec, s[20:21]
    buffer_load_dwordx4 v[76:79], v1, s[4:7], s46 offen offset:2048 sc1
    s_mov_b64 exec, s[22:23]
    buffer_load_dwordx4 v[80:83], v1, s[4:7], s46 offen offset:3072 sc1
    s_mov_b64 exec, -1
    s_waitcnt lgkmcnt(0)
    buffer_load_dwordx4 v[52:55], v2, s[4:7], s46 offen offset:0 sc1
    buffer_load_dwordx4 v[56:59], v2, s[4:7], s46 offen offset:1024 sc1
    buffer_load_dwordx4 v[60:63], v2, s[4:7], s46 offen offset:2048 sc1
    buffer_load_dwordx4 v[64:67], v2, s[4:7], s46 offen offset:3072 sc1
    s_waitcnt vmcnt(0)
    v_mfma_f32_4x4x4_16b_bf16 v[84:87], v[24:25], v[52:53], 0
    v_mfma_f32_4x4x4_16b_bf16 v[88:91], v[24:25], v[54:55], 0
    v_mfma_f32_4x4x4_16b_bf16 v[92:95], v[24:25], v[56:57], 0
    v_mfma_f32_4x4x4_16b_bf16 v[96:99], v[24:25], v[58:59], 0
    v_mfma_f32_4x4x4_16b_bf16 v[100:103], v[24:25], v[60:61], 0
    v_mfma_f32_4x4x4_16b_bf16 v[104:107], v[24:25], v[62:63], 0
    v_mfma_f32_4x4x4_16b_bf16 v[108:111], v[24:25], v[64:65], 0
    v_mfma_f32_4x4x4_16b_bf16 v[112:115], v[24:25], v[66:67], 0
    s_branch c3_mx_run
c3_s_retry:
    s_add_u32 s62, s62, 1
    s_cmp_eq_u32 s55, 0
    s_cbranch_scc1 c3_s_ok
    s_sub_u32 s55, s55, 1
    buffer_load_dwordx4 v[44:47], v6, s[4:7], s46 offen sc1
    buffer_load_dword v125, v6, s[4:7], s46 offen offset:1024 sc1
    s_waitcnt vmcnt(0)
    s_branch c3_s_chk
c3_om0:
    buffer_load_dwordx4 v[76:79], v3, s[4:7], s46 offen offset:0 sc1
    s_bitset1_b32 s16, 0
    s_branch c3_ob0
c3_om1:
    buffer_load_dwordx4 v[80:83], v3, s[4:7], s46 offen offset:1024 sc1
    s_bitset1_b32 s16, 1
    s_branch c3_ob1
c3_om2:
    buffer_load_dwordx4 v[84:87], v3, s[4:7], s46 offen offset:2048 sc1
    s_bitset1_b32 s16, 2
    s_branch c3_ob2
c3_om3:
    buffer_load_dwordx4 v[88:91], v3, s[4:7], s46 offen offset:3072 sc1
    s_bitset1_b32 s16, 3
    s_branch c3_ob3
c3_om4:
    buffer_load_dwordx4 v[92:95], v3, s[4:7], s49 offen offset:0 sc1
    s_bitset1_b32 s16, 4
    s_branch c3_ob4
c3_om5:
    buffer_load_dwordx4 v[96:99], v3, s[4:7], s49 offen offset:1024 sc1
    s_bitset1_b32 s16, 5
    s_branch c3_ob5
c3_om6:
    buffer_load_dwordx4 v[100:103], v3, s[4:7], s49 offen offset:2048 sc1
    s_bitset1_b32 s16, 6
    s_branch c3_ob6
c3_om7:
    buffer_load_dwordx4 v[104:107], v3, s[4:7], s49 offen offset:3072 sc1
    s_bitset1_b32 s16, 7
    s_branch c3_ob7
c3_ofix:
    s_add_u32 s63, s63, 1
    s_cmp_eq_u32 s55, 0
    s_cbranch_scc1 c3_o_end
    s_sub_u32 s55, s55, 1
    s_waitcnt vmcnt(0)
    s_bitcmp1_b32 s16, 0
    s_cbranch_scc0 c3_on0
    v_max_u32 v22, v76, v78
    v_cmp_eq_u32 vcc, -1, v22
    s_cbranch_vccnz c3_of0
    s_and_b32 s16, s16, 0x1fe
    v_smfmac_f32_16x16x64_bf16 v[40:43], v[76:79], v[128:135], v20
    v_smfmac_f32_16x16x64_bf16 v[44:47], v[76:79], v[136:143], v20
    s_cbranch_scc0 c3_o_end
c3_on0:
    s_bitcmp1_b32 s16, 1
    s_cbranch_scc0 c3_on1
    v_max_u32 v22, v80, v82
    v_cmp_eq_u32 vcc, -1, v22
    s_cbranch_vccnz c3_of1
    s_and_b32 s16, s16, 0x1fd
    v_smfmac_f32_16x16x64_bf16 v[40:43], v[80:83], v[144:151], v20
    v_smfmac_f32_16x16x64_bf16 v[44:47], v[80:83], v[152:159], v20
    s_cbranch_scc0 c3_o_end
c3_on1:
    s_bitcmp1_b32 s16, 2
    s_cbranch_scc0 c3_on2
    v_max_u32 v22, v84, v86
    v_cmp_eq_u32 vcc, -1, v22
    s_cbranch_vccnz c3_of2
    s_and_b32 s16, s16, 0x1fb
    v_smfmac_f32_16x16x64_bf16 v[40:43], v[84:87], v[160:167], v20
    v_smfmac_f32_16x16x64_bf16 v[44:47], v[84:87], v[168:175], v20
    s_cbranch_scc0 c3_o_end
c3_on2:
    s_bitcmp1_b32 s16, 3
    s_cbranch_scc0 c3_on3
    v_max_u32 v22, v88, v90
    v_cmp_eq_u32 vcc, -1, v22
    s_cbranch_vccnz c3_of3
    s_and_b32 s16, s16, 0x1f7
    v_smfmac_f32_16x16x64_bf16 v[40:43], v[88:91], v[176:183], v20
    v_smfmac_f32_16x16x64_bf16 v[44:47], v[88:91], v[184:191], v20
    s_cbranch_scc0 c3_o_end
c3_on3:
    s_bitcmp1_b32 s16, 4
    s_cbranch_scc0 c3_on4
    v_max_u32 v22, v92, v94
    v_cmp_eq_u32 vcc, -1, v22
    s_cbranch_vccnz c3_of4
    s_and_b32 s16, s16, 0x1ef
    v_smfmac_f32_16x16x64_bf16 v[40:43], v[92:95], v[192:199], v20
    v_smfmac_f32_16x16x64_bf16 v[44:47], v[92:95], v[200:207], v20
    s_cbranch_scc0 c3_o_end
c3_on4:
    s_bitcmp1_b32 s16, 5
    s_cbranch_scc0 c3_on5
    v_max_u32 v22, v96, v98
    v_cmp_eq_u32 vcc, -1, v22
    s_cbranch_vccnz c3_of5
    s_and_b32 s16, s16, 0x1df
    v_smfmac_f32_16x16x64_bf16 v[40:43], v[96:99], v[208:215], v20
    v_smfmac_f32_16x16x64_bf16 v[44:47], v[96:99], v[216:223], v20
    s_cbranch_scc0 c3_o_end
c3_on5:
    s_bitcmp1_b32 s16, 6
    s_cbranch_scc0 c3_on6
    v_max_u32 v22, v100, v102
    v_cmp_eq_u32 vcc, -1, v22
    s_cbranch_vccnz c3_of6
    s_and_b32 s16, s16, 0x1bf
    v_smfmac_f32_16x16x64_bf16 v[40:43], v[100:103], v[224:231], v20
    v_smfmac_f32_16x16x64_bf16 v[44:47], v[100:103], v[232:239], v20
    s_cbranch_scc0 c3_o_end
c3_on6:
    s_bitcmp1_b32 s16, 7
    s_cbranch_scc0 c3_on7
    v_max_u32 v22, v104, v106
    v_cmp_eq_u32 vcc, -1, v22
    s_cbranch_vccnz c3_of7
    s_and_b32 s16, s16, 0x17f
    v_smfmac_f32_16x16x64_bf16 v[40:43], v[104:107], v[240:247], v20
    v_smfmac_f32_16x16x64_bf16 v[44:47], v[104:107], v[248:255], v20
    s_cbranch_scc0 c3_o_end
c3_on7:
    s_branch c3_ofix
c3_of0:
    buffer_load_dwordx4 v[76:79], v3, s[4:7], s46 offen offset:0 sc1
    s_branch c3_on0
c3_of1:
    buffer_load_dwordx4 v[80:83], v3, s[4:7], s46 offen offset:1024 sc1
    s_branch c3_on1
c3_of2:
    buffer_load_dwordx4 v[84:87], v3, s[4:7], s46 offen offset:2048 sc1
    s_branch c3_on2
c3_of3:
    buffer_load_dwordx4 v[88:91], v3, s[4:7], s46 offen offset:3072 sc1
    s_branch c3_on3
c3_of4:
    buffer_load_dwordx4 v[92:95], v3, s[4:7], s49 offen offset:0 sc1
    s_branch c3_on4
c3_of5:
    buffer_load_dwordx4 v[96:99], v3, s[4:7], s49 offen offset:1024 sc1
    s_branch c3_on5
c3_of6:
    buffer_load_dwordx4 v[100:103], v3, s[4:7], s49 offen offset:2048 sc1
    s_branch c3_on6
c3_of7:
    buffer_load_dwordx4 v[104:107], v3, s[4:7], s49 offen offset:3072 sc1
    s_branch c3_on7
c3_kv_retry:
    s_cmp_eq_u32 s55, 0
    s_cbranch_scc1 c3_kv_ok
    s_sub_u32 s55, s55, 1
    s_mov_b64 exec, 3
    buffer_load_ubyte v8, v0, s[4:7], s47 offen sc1
    s_mov_b64 exec, -1
    s_waitcnt vmcnt(0)
    s_branch c3_kv_chk
CDONE:
    s_endpgm
WORKER:
    s_sub_u32 s42, s42, 2
    v_and_b32 v1, 63, v0
    v_lshlrev_b32 v2, 4, v1
    v_bfe_u32 v13, v1, 2, 2
    v_lshrrev_b32 v14, 5, v1
    v_lshl_add_u32 v14, v14, 2, v13
    v_lshlrev_b32 v14, 8, v14
    v_bfe_u32 v17, v1, 4, 1
    v_lshl_add_u32 v14, v17, 5, v14
    v_and_b32 v17, 3, v1
    v_lshl_add_u32 v14, v17, 3, v14
    v_xor_b32 v17, 0, v13
    v_lshl_add_u32 v3, v17, 6, v14
    v_xor_b32 v17, 1, v13
    v_lshl_add_u32 v4, v17, 6, v14
    v_xor_b32 v17, 2, v13
    v_lshl_add_u32 v5, v17, 6, v14
    v_xor_b32 v17, 3, v13
    v_lshl_add_u32 v6, v17, 6, v14
    v_lshrrev_b32 v16, 4, v1
    v_and_b32 v13, 15, v1
    v_lshlrev_b32 v14, 2, v16
    v_xor_b32 v13, v13, v14
    v_lshlrev_b32 v15, 4, v13
    s_lshl_b32 s56, s44, 4
    v_add_u32 v16, s56, v16
    s_lshl_b32 s64, s44, 12
    s_mov_b32 s48, s4
    s_mov_b32 s49, s5
    s_mov_b32 s51, 0x20000
    s_mov_b32 s63, 1
    s_mov_b32 s73, 0
    s_and_b32 s62, s42, 1
    s_lshl_b32 s62, s62, 5
    s_add_u32 s62, s62, s43
    s_bitcmp1_b32 s42, 1
    s_cbranch_scc1 WS_H1
    s_lshl_b32 s57, s42, 4
    s_and_b32 s57, s57, 64
    s_add_u32 s62, s62, s57
    s_mov_b32 s54, 16
    s_and_b32 s60, s62, 1
    s_lshr_b32 s62, s62, 1
    s_cmp_eq_u32 s60, 1
    s_cbranch_scc1 WS_V1
    s_mov_b32 s12, s22
    s_and_b32 s13, s23, 0xffff
    s_mov_b32 s14, 0x800000
    s_mov_b32 s15, 0x20000
    s_branch WS_KV1
WS_V1:
    s_mov_b32 s12, s24
    s_and_b32 s13, s25, 0xffff
    s_mov_b32 s14, 0x800000
    s_mov_b32 s15, 0x20000
WS_KV1:
    v_lshrrev_b32 v13, 3, v1
    s_lshl_b32 s56, s44, 3
    v_add_u32 v13, s56, v13
    v_mul_u32_u24 v13, 8192, v13
    v_bfe_u32 v14, v1, 4, 1
    v_lshlrev_b32 v14, 2, v14
    v_and_b32 v17, 7, v1
    v_xor_b32 v14, v14, v17
    v_lshlrev_b32 v14, 4, v14
    s_lshl_b32 s56, s62, 7
    v_add3_u32 v7, v13, v14, s56
    s_lshl_b32 s76, s44, 10
    s_add_u32 s76, s76, 32768
    v_bfe_u32 v13, v1, 2, 2
    v_lshrrev_b32 v14, 5, v1
    v_lshl_add_u32 v14, v14, 2, v13
    v_lshlrev_b32 v14, 7, v14
    v_bfe_u32 v17, v1, 4, 1
    v_lshl_add_u32 v14, v17, 5, v14
    v_and_b32 v17, 3, v1
    v_lshl_add_u32 v14, v17, 3, v14
    v_bfe_u32 v17, v1, 3, 1
    v_lshl_add_u32 v20, v17, 6, v14
    v_add_u32 v20, 32768, v20
    v_xor_b32 v21, 64, v20
    s_lshl_b32 s56, s44, 16
    v_add_u32 v11, s56, v2
    s_lshl_b32 s56, s73, 2
    s_add_u32 s56, s56, s44
    s_mul_i32 s66, s56, 262144
    s_lshl_b32 s57, s62, 12
    s_add_u32 s66, s66, s57
    s_mov_b32 s67, 1048576
    s_lshl_b32 s69, s73, 4
    s_lshr_b32 s57, s62, 1
    s_add_u32 s69, s69, s57
    s_lshl_b32 s69, s69, 6
    s_and_b32 s57, s62, 1
    s_add_u32 s69, s69, s57
    s_lshl_b32 s57, s60, 24
    s_add_u32 s66, s66, s57
    s_add_u32 s66, s66, 0x400000
    s_lshl_b32 s57, s60, 2
    s_add_u32 s69, s69, s57
    s_add_u32 s69, s69, 0x5200028
    s_mov_b32 s72, 12
    s_lshl_b32 s70, s56, 16
    s_lshl_b32 s57, s62, 10
    s_add_u32 s70, s70, s57
    s_lshl_b32 s57, s60, 22
    s_add_u32 s70, s70, s57
    s_add_u32 s70, s70, 0x2400000
    s_mov_b32 s71, 0x5208000
    s_mov_b32 s50, 0x10000000
    v_and_b32 v58, 7, v61
    v_lshlrev_b32 v58, 4, v58
    s_lshl_b32 s57, s44, 2
    v_add_u32 v59, s57, v58
    s_waitcnt vmcnt(0)
    s_cmp_lg_u32 s44, 0
    s_cbranch_scc1 clm_10_x
    s_mov_b32 s59, s43
clm_10:
    v_readfirstlane_b32 s56, v126
    s_bitcmp1_b32 s56, s59
    s_cbranch_scc0 clm_10_ok
    s_mov_b32 s59, 32
    s_cmp_eq_u32 s56, -1
    s_cbranch_scc1 clm_10_ok
    s_ff0_i32_b32 s59, s56
    s_add_u32 s57, s42, 2
    s_min_u32 s57, s57, 8
    s_lshl_b32 s57, s57, 2
    s_lshl_b32 s58, 1, s59
    s_mov_b64 exec, 1
    v_mov_b32 v126, s58
    buffer_atomic_or v126, off, s[8:11], s57 sc0 sc1
    s_mov_b64 exec, -1
    s_waitcnt vmcnt(0)
    s_branch clm_10
clm_10_ok:
    v_mov_b32 v52, s59
    v_mov_b32 v53, 0
    ds_write_b32 v53, v52 offset:48
clm_10_x:
    v_lshlrev_b32 v80, 16, v64
    v_and_b32 v81, 0xffff0000, v64
    v_lshlrev_b32 v82, 16, v65
    v_and_b32 v83, 0xffff0000, v65
    v_lshlrev_b32 v84, 16, v66
    v_and_b32 v85, 0xffff0000, v66
    v_lshlrev_b32 v86, 16, v67
    v_and_b32 v87, 0xffff0000, v67
    v_lshlrev_b32 v88, 16, v68
    v_and_b32 v89, 0xffff0000, v68
    v_lshlrev_b32 v90, 16, v69
    v_and_b32 v91, 0xffff0000, v69
    v_lshlrev_b32 v92, 16, v70
    v_and_b32 v93, 0xffff0000, v70
    v_lshlrev_b32 v94, 16, v71
    v_and_b32 v95, 0xffff0000, v71
    v_lshlrev_b32 v96, 16, v72
    v_and_b32 v97, 0xffff0000, v72
    v_lshlrev_b32 v98, 16, v73
    v_and_b32 v99, 0xffff0000, v73
    v_lshlrev_b32 v100, 16, v74
    v_and_b32 v101, 0xffff0000, v74
    v_lshlrev_b32 v102, 16, v75
    v_and_b32 v103, 0xffff0000, v75
    v_lshlrev_b32 v104, 16, v76
    v_and_b32 v105, 0xffff0000, v76
    v_lshlrev_b32 v106, 16, v77
    v_and_b32 v107, 0xffff0000, v77
    v_lshlrev_b32 v108, 16, v78
    v_and_b32 v109, 0xffff0000, v78
    v_lshlrev_b32 v110, 16, v79
    v_and_b32 v111, 0xffff0000, v79
    v_add_f32 v52, v80, v84
    v_add_f32 v53, v81, v85
    v_add_f32 v54, v82, v86
    v_add_f32 v55, v83, v87
    v_add_f32 v52, v52, v88
    v_add_f32 v53, v53, v89
    v_add_f32 v54, v54, v90
    v_add_f32 v55, v55, v91
    v_add_f32 v52, v52, v92
    v_add_f32 v53, v53, v93
    v_add_f32 v54, v54, v94
    v_add_f32 v55, v55, v95
    v_add_f32 v52, v52, v96
    v_add_f32 v53, v53, v97
    v_add_f32 v54, v54, v98
    v_add_f32 v55, v55, v99
    v_add_f32 v52, v52, v100
    v_add_f32 v53, v53, v101
    v_add_f32 v54, v54, v102
    v_add_f32 v55, v55, v103
    v_add_f32 v52, v52, v104
    v_add_f32 v53, v53, v105
    v_add_f32 v54, v54, v106
    v_add_f32 v55, v55, v107
    v_add_f32 v52, v52, v108
    v_add_f32 v53, v53, v109
    v_add_f32 v54, v54, v110
    v_add_f32 v55, v55, v111
    v_add_f32 v52, v52, v53
    v_add_f32 v54, v54, v55
    v_add_f32 v56, v52, v54
    s_nop 1
    v_add_f32_dpp v56, v56, v56 row_ror:8 row_mask:0xf bank_mask:0xf
    v_mov_b32 v57, v56
    s_nop 1
    v_permlane16_swap_b32 v56, v57
    v_add_f32 v56, v56, v57
    v_mov_b32 v57, v56
    s_nop 1
    v_permlane32_swap_b32 v56, v57
    v_add_f32 v56, v56, v57
    ds_write_b32 v59, v56 offset:64
    s_waitcnt lgkmcnt(0)
    s_barrier
    ds_read_b128 v[52:55], v58 offset:64
    v_mov_b32 v57, 0
    ds_read_b32 v57, v57 offset:48
    s_waitcnt lgkmcnt(0)
    v_readfirstlane_b32 s59, v57
    s_cmp_eq_u32 s59, s43
    s_cbranch_scc1 keep_11
    s_waitcnt vmcnt(0)
    s_barrier
    s_cmp_ge_u32 s59, 32
    s_cbranch_scc1 EXIT
    s_mov_b32 s43, s59
    s_add_u32 s42, s42, 2
    v_mov_b32 v126, 0
    s_branch RESTART
keep_11:
    v_add_f32 v52, v52, v53
    v_add_f32 v54, v54, v55
    v_add_f32 v56, v52, v54
    v_mul_f32 v56, 0x3a800000, v56
    v_cvt_pk_bf16_f32 v50, v56, v56
    v_and_b32 v50, 0xffff0000, v50
    v_sub_f32 v64, v80, v56
    v_mul_f32 v52, v64, v64
    v_sub_f32 v65, v81, v56
    v_mul_f32 v53, v65, v65
    v_sub_f32 v66, v82, v56
    v_mul_f32 v54, v66, v66
    v_sub_f32 v67, v83, v56
    v_mul_f32 v55, v67, v67
    v_sub_f32 v68, v84, v56
    v_fmac_f32 v52, v68, v68
    v_sub_f32 v69, v85, v56
    v_fmac_f32 v53, v69, v69
    v_sub_f32 v70, v86, v56
    v_fmac_f32 v54, v70, v70
    v_sub_f32 v71, v87, v56
    v_fmac_f32 v55, v71, v71
    v_sub_f32 v64, v88, v56
    v_fmac_f32 v52, v64, v64
    v_sub_f32 v65, v89, v56
    v_fmac_f32 v53, v65, v65
    v_sub_f32 v66, v90, v56
    v_fmac_f32 v54, v66, v66
    v_sub_f32 v67, v91, v56
    v_fmac_f32 v55, v67, v67
    v_sub_f32 v68, v92, v56
    v_fmac_f32 v52, v68, v68
    v_sub_f32 v69, v93, v56
    v_fmac_f32 v53, v69, v69
    v_sub_f32 v70, v94, v56
    v_fmac_f32 v54, v70, v70
    v_sub_f32 v71, v95, v56
    v_fmac_f32 v55, v71, v71
    v_sub_f32 v64, v96, v56
    v_fmac_f32 v52, v64, v64
    v_sub_f32 v65, v97, v56
    v_fmac_f32 v53, v65, v65
    v_sub_f32 v66, v98, v56
    v_fmac_f32 v54, v66, v66
    v_sub_f32 v67, v99, v56
    v_fmac_f32 v55, v67, v67
    v_sub_f32 v68, v100, v56
    v_fmac_f32 v52, v68, v68
    v_sub_f32 v69, v101, v56
    v_fmac_f32 v53, v69, v69
    v_sub_f32 v70, v102, v56
    v_fmac_f32 v54, v70, v70
    v_sub_f32 v71, v103, v56
    v_fmac_f32 v55, v71, v71
    v_sub_f32 v64, v104, v56
    v_fmac_f32 v52, v64, v64
    v_sub_f32 v65, v105, v56
    v_fmac_f32 v53, v65, v65
    v_sub_f32 v66, v106, v56
    v_fmac_f32 v54, v66, v66
    v_sub_f32 v67, v107, v56
    v_fmac_f32 v55, v67, v67
    v_sub_f32 v68, v108, v56
    v_fmac_f32 v52, v68, v68
    v_sub_f32 v69, v109, v56
    v_fmac_f32 v53, v69, v69
    v_sub_f32 v70, v110, v56
    v_fmac_f32 v54, v70, v70
    v_sub_f32 v71, v111, v56
    v_fmac_f32 v55, v71, v71
    v_add_f32 v52, v52, v53
    v_add_f32 v54, v54, v55
    v_add_f32 v56, v52, v54
    v_sub_f32 v80, v80, v50
    v_sub_f32 v81, v81, v50
    v_sub_f32 v82, v82, v50
    v_sub_f32 v83, v83, v50
    v_sub_f32 v84, v84, v50
    v_sub_f32 v85, v85, v50
    v_sub_f32 v86, v86, v50
    v_sub_f32 v87, v87, v50
    v_sub_f32 v88, v88, v50
    v_sub_f32 v89, v89, v50
    v_sub_f32 v90, v90, v50
    v_sub_f32 v91, v91, v50
    v_sub_f32 v92, v92, v50
    v_sub_f32 v93, v93, v50
    v_sub_f32 v94, v94, v50
    v_sub_f32 v95, v95, v50
    v_sub_f32 v96, v96, v50
    v_sub_f32 v97, v97, v50
    v_sub_f32 v98, v98, v50
    v_sub_f32 v99, v99, v50
    v_sub_f32 v100, v100, v50
    v_sub_f32 v101, v101, v50
    v_sub_f32 v102, v102, v50
    v_sub_f32 v103, v103, v50
    v_sub_f32 v104, v104, v50
    v_sub_f32 v105, v105, v50
    v_sub_f32 v106, v106, v50
    v_sub_f32 v107, v107, v50
    v_sub_f32 v108, v108, v50
    v_sub_f32 v109, v109, v50
    v_sub_f32 v110, v110, v50
    v_sub_f32 v111, v111, v50
    v_cvt_pk_bf16_f32 v64, v80, v81
    v_cvt_pk_bf16_f32 v65, v82, v83
    v_cvt_pk_bf16_f32 v66, v84, v85
    v_cvt_pk_bf16_f32 v67, v86, v87
    v_cvt_pk_bf16_f32 v68, v88, v89
    v_cvt_pk_bf16_f32 v69, v90, v91
    v_cvt_pk_bf16_f32 v70, v92, v93
    v_cvt_pk_bf16_f32 v71, v94, v95
    v_cvt_pk_bf16_f32 v72, v96, v97
    v_cvt_pk_bf16_f32 v73, v98, v99
    v_cvt_pk_bf16_f32 v74, v100, v101
    v_cvt_pk_bf16_f32 v75, v102, v103
    v_cvt_pk_bf16_f32 v76, v104, v105
    v_cvt_pk_bf16_f32 v77, v106, v107
    v_cvt_pk_bf16_f32 v78, v108, v109
    v_cvt_pk_bf16_f32 v79, v110, v111
    v_add_f32_dpp v56, v56, v56 row_ror:8 row_mask:0xf bank_mask:0xf
    v_mov_b32 v57, v56
    s_nop 1
    v_permlane16_swap_b32 v56, v57
    v_add_f32 v56, v56, v57
    v_mov_b32 v57, v56
    s_nop 1
    v_permlane32_swap_b32 v56, v57
    v_add_f32 v56, v56, v57
    ds_write_b32 v59, v56 offset:192
    s_waitcnt lgkmcnt(0)
    s_barrier
    ds_read_b128 v[52:55], v58 offset:192
    s_waitcnt lgkmcnt(0)
    v_add_f32 v52, v52, v53
    v_add_f32 v54, v54, v55
    v_add_f32 v56, v52, v54
    v_mul_f32 v56, 0x3a800000, v56
    v_cvt_pk_bf16_f32 v56, v56, v56
    v_and_b32 v56, 0xffff0000, v56
    v_add_f32 v56, 0x3727c5ac, v56
    v_cvt_pk_bf16_f32 v56, v56, v56
    v_and_b32 v56, 0xffff0000, v56
    v_sqrt_f32 v56, v56
    s_nop 0
    v_cvt_pk_bf16_f32 v56, v56, v56
    v_and_b32 v56, 0xffff0000, v56
    v_rcp_f32 v56, v56
    v_lshlrev_b32 v80, 16, v64
    v_and_b32 v81, 0xffff0000, v64
    v_lshlrev_b32 v82, 16, v65
    v_and_b32 v83, 0xffff0000, v65
    v_lshlrev_b32 v84, 16, v66
    v_and_b32 v85, 0xffff0000, v66
    v_lshlrev_b32 v86, 16, v67
    v_and_b32 v87, 0xffff0000, v67
    v_lshlrev_b32 v88, 16, v68
    v_and_b32 v89, 0xffff0000, v68
    v_lshlrev_b32 v90, 16, v69
    v_and_b32 v91, 0xffff0000, v69
    v_lshlrev_b32 v92, 16, v70
    v_and_b32 v93, 0xffff0000, v70
    v_lshlrev_b32 v94, 16, v71
    v_and_b32 v95, 0xffff0000, v71
    v_lshlrev_b32 v96, 16, v72
    v_and_b32 v97, 0xffff0000, v72
    v_lshlrev_b32 v98, 16, v73
    v_and_b32 v99, 0xffff0000, v73
    v_lshlrev_b32 v100, 16, v74
    v_and_b32 v101, 0xffff0000, v74
    v_lshlrev_b32 v102, 16, v75
    v_and_b32 v103, 0xffff0000, v75
    v_lshlrev_b32 v104, 16, v76
    v_and_b32 v105, 0xffff0000, v76
    v_lshlrev_b32 v106, 16, v77
    v_and_b32 v107, 0xffff0000, v77
    v_lshlrev_b32 v108, 16, v78
    v_and_b32 v109, 0xffff0000, v78
    v_lshlrev_b32 v110, 16, v79
    v_and_b32 v111, 0xffff0000, v79
    v_mul_f32 v80, v80, v56
    v_mul_f32 v81, v81, v56
    v_mul_f32 v82, v82, v56
    v_mul_f32 v83, v83, v56
    v_mul_f32 v84, v84, v56
    v_mul_f32 v85, v85, v56
    v_mul_f32 v86, v86, v56
    v_mul_f32 v87, v87, v56
    v_mul_f32 v88, v88, v56
    v_mul_f32 v89, v89, v56
    v_mul_f32 v90, v90, v56
    v_mul_f32 v91, v91, v56
    v_mul_f32 v92, v92, v56
    v_mul_f32 v93, v93, v56
    v_mul_f32 v94, v94, v56
    v_mul_f32 v95, v95, v56
    v_mul_f32 v96, v96, v56
    v_mul_f32 v97, v97, v56
    v_mul_f32 v98, v98, v56
    v_mul_f32 v99, v99, v56
    v_mul_f32 v100, v100, v56
    v_mul_f32 v101, v101, v56
    v_mul_f32 v102, v102, v56
    v_mul_f32 v103, v103, v56
    v_mul_f32 v104, v104, v56
    v_mul_f32 v105, v105, v56
    v_mul_f32 v106, v106, v56
    v_mul_f32 v107, v107, v56
    v_mul_f32 v108, v108, v56
    v_mul_f32 v109, v109, v56
    v_mul_f32 v110, v110, v56
    v_mul_f32 v111, v111, v56
    v_lshrrev_b32 v60, 3, v61
    v_lshlrev_b32 v60, 9, v60
    v_add_u32 v60, v60, v58
    s_lshr_b32 s56, s2, 2
    s_lshl_b32 s56, s56, 16
    s_and_b32 s57, s2, 3
    s_lshl_b32 s57, s57, 7
    s_add_u32 s56, s56, s57
    s_lshl_b32 s57, s44, 14
    s_add_u32 s56, s56, s57
    v_cvt_pk_bf16_f32 v64, v80, v81
    v_cvt_pk_bf16_f32 v65, v82, v83
    v_cvt_pk_bf16_f32 v66, v84, v85
    v_cvt_pk_bf16_f32 v67, v86, v87
    buffer_store_dwordx4 v[64:67], v60, s[4:7], s56 offen sc1
    s_add_u32 s56, s56, 4096
    v_cvt_pk_bf16_f32 v68, v88, v89
    v_cvt_pk_bf16_f32 v69, v90, v91
    v_cvt_pk_bf16_f32 v70, v92, v93
    v_cvt_pk_bf16_f32 v71, v94, v95
    buffer_store_dwordx4 v[68:71], v60, s[4:7], s56 offen sc1
    s_add_u32 s56, s56, 4096
    v_cvt_pk_bf16_f32 v72, v96, v97
    v_cvt_pk_bf16_f32 v73, v98, v99
    v_cvt_pk_bf16_f32 v74, v100, v101
    v_cvt_pk_bf16_f32 v75, v102, v103
    buffer_store_dwordx4 v[72:75], v60, s[4:7], s56 offen sc1
    s_add_u32 s56, s56, 4096
    v_cvt_pk_bf16_f32 v76, v104, v105
    v_cvt_pk_bf16_f32 v77, v106, v107
    v_cvt_pk_bf16_f32 v78, v108, v109
    v_cvt_pk_bf16_f32 v79, v110, v111
    buffer_store_dwordx4 v[76:79], v60, s[4:7], s56 offen sc1
    v_lshlrev_b32 v60, 2, v61
    v_mov_b32 v57, 0
    s_lshl_b32 s56, s2, 6
    s_add_u32 s56, s56, 0x5200000
    s_mov_b64 exec, 0xffff
    buffer_store_dword v57, v60, s[4:7], s56 offen sc1
    s_mov_b64 exec, -1
    s_lshr_b32 s56, s2, 5
    s_sub_u32 s56, s56, 1
    s_and_b32 s56, s56, 7
    s_lshl_b32 s56, s56, 2
    s_add_u32 s56, s56, 100
    s_add_u32 m0, s76, 0
    s_mov_b32 s58, 0x0
    buffer_load_dwordx4 v7, s[12:15], s58 offen lds
    s_add_u32 m0, s76, 4096
    s_mov_b32 s58, 0x40000
    buffer_load_dwordx4 v7, s[12:15], s58 offen lds
    s_add_u32 m0, s76, 8192
    s_mov_b32 s58, 0x80000
    buffer_load_dwordx4 v7, s[12:15], s58 offen lds
    s_add_u32 m0, s76, 12288
    s_mov_b32 s58, 0xc0000
    buffer_load_dwordx4 v7, s[12:15], s58 offen lds
    s_add_u32 m0, s76, 16384
    s_mov_b32 s58, 0x100000
    buffer_load_dwordx4 v7, s[12:15], s58 offen lds
    s_add_u32 m0, s76, 20480
    s_mov_b32 s58, 0x140000
    buffer_load_dwordx4 v7, s[12:15], s58 offen lds
    s_add_u32 m0, s76, 24576
    s_mov_b32 s58, 0x180000
    buffer_load_dwordx4 v7, s[12:15], s58 offen lds
    s_add_u32 m0, s76, 28672
    s_mov_b32 s58, 0x1c0000
    buffer_load_dwordx4 v7, s[12:15], s58 offen lds
    s_add_u32 m0, s76, 32768
    s_mov_b32 s58, 0x200000
    buffer_load_dwordx4 v7, s[12:15], s58 offen lds
    s_add_u32 m0, s76, 36864
    s_mov_b32 s58, 0x240000
    buffer_load_dwordx4 v7, s[12:15], s58 offen lds
    s_add_u32 m0, s76, 40960
    s_mov_b32 s58, 0x280000
    buffer_load_dwordx4 v7, s[12:15], s58 offen lds
    s_add_u32 m0, s76, 45056
    s_mov_b32 s58, 0x2c0000
    buffer_load_dwordx4 v7, s[12:15], s58 offen lds
    s_add_u32 m0, s76, 49152
    s_mov_b32 s58, 0x300000
    buffer_load_dwordx4 v7, s[12:15], s58 offen lds
    s_add_u32 m0, s76, 53248
    s_mov_b32 s58, 0x340000
    buffer_load_dwordx4 v7, s[12:15], s58 offen lds
    s_add_u32 m0, s76, 57344
    s_mov_b32 s58, 0x380000
    buffer_load_dwordx4 v7, s[12:15], s58 offen lds
    s_add_u32 m0, s76, 61440
    s_mov_b32 s58, 0x3c0000
    buffer_load_dwordx4 v7, s[12:15], s58 offen lds
    s_add_u32 m0, s76, 65536
    s_mov_b32 s58, 0x400000
    buffer_load_dwordx4 v7, s[12:15], s58 offen lds
    s_add_u32 m0, s76, 69632
    s_mov_b32 s58, 0x440000
    buffer_load_dwordx4 v7, s[12:15], s58 offen lds
    s_add_u32 m0, s76, 73728
    s_mov_b32 s58, 0x480000
    buffer_load_dwordx4 v7, s[12:15], s58 offen lds
    s_add_u32 m0, s76, 77824
    s_mov_b32 s58, 0x4c0000
    buffer_load_dwordx4 v7, s[12:15], s58 offen lds
    s_add_u32 m0, s76, 81920
    s_mov_b32 s58, 0x500000
    buffer_load_dwordx4 v7, s[12:15], s58 offen lds
    s_add_u32 m0, s76, 86016
    s_mov_b32 s58, 0x540000
    buffer_load_dwordx4 v7, s[12:15], s58 offen lds
    s_add_u32 m0, s76, 90112
    s_mov_b32 s58, 0x580000
    buffer_load_dwordx4 v7, s[12:15], s58 offen lds
    s_add_u32 m0, s76, 94208
    s_mov_b32 s58, 0x5c0000
    buffer_load_dwordx4 v7, s[12:15], s58 offen lds
    s_add_u32 m0, s76, 98304
    s_mov_b32 s58, 0x600000
    buffer_load_dwordx4 v7, s[12:15], s58 offen lds
    s_add_u32 m0, s76, 102400
    s_mov_b32 s58, 0x640000
    buffer_load_dwordx4 v7, s[12:15], s58 offen lds
    s_add_u32 m0, s76, 106496
    s_mov_b32 s58, 0x680000
    buffer_load_dwordx4 v7, s[12:15], s58 offen lds
    s_add_u32 m0, s76, 110592
    s_mov_b32 s58, 0x6c0000
    buffer_load_dwordx4 v7, s[12:15], s58 offen lds
    s_add_u32 m0, s76, 114688
    s_mov_b32 s58, 0x700000
    buffer_load_dwordx4 v7, s[12:15], s58 offen lds
    s_add_u32 m0, s76, 118784
    s_mov_b32 s58, 0x740000
    buffer_load_dwordx4 v7, s[12:15], s58 offen lds
    s_add_u32 m0, s76, 122880
    s_mov_b32 s58, 0x780000
    buffer_load_dwordx4 v7, s[12:15], s58 offen lds
    s_add_u32 m0, s76, 126976
    s_mov_b32 s58, 0x7c0000
    buffer_load_dwordx4 v7, s[12:15], s58 offen lds
    s_waitcnt vmcnt(32)
    s_barrier
    s_cmp_lg_u32 s44, 0
    s_cbranch_scc1 lnsig_12
    v_mov_b32 v13, 1
    s_mov_b64 exec, 1
    buffer_atomic_add v13, off, s[8:11], s56 sc1
    s_mov_b64 exec, -1
lnsig_12:
    s_branch WS_GO
WS_H1:
    s_mov_b32 s54, 16
    s_mov_b32 s60, 2
    s_mov_b32 s12, s32
    s_and_b32 s13, s33, 0xffff
    s_mov_b32 s14, 0x700000
    s_mov_b32 s15, 0x20000
    s_cmp_ge_u32 s62, 56
    s_cselect_b32 s14, 0, s14
    v_lshrrev_b32 v13, 3, v1
    s_lshl_b32 s56, s44, 3
    v_add_u32 v13, s56, v13
    v_mul_u32_u24 v13, 7168, v13
    v_bfe_u32 v14, v1, 4, 1
    v_lshlrev_b32 v14, 2, v14
    v_and_b32 v17, 7, v1
    v_xor_b32 v14, v14, v17
    v_lshlrev_b32 v14, 4, v14
    s_lshl_b32 s56, s62, 7
    v_add3_u32 v7, v13, v14, s56
    s_lshl_b32 s76, s44, 10
    s_add_u32 s76, s76, 32768
    v_bfe_u32 v13, v1, 2, 2
    v_lshrrev_b32 v14, 5, v1
    v_lshl_add_u32 v14, v14, 2, v13
    v_lshlrev_b32 v14, 7, v14
    v_bfe_u32 v17, v1, 4, 1
    v_lshl_add_u32 v14, v17, 5, v14
    v_and_b32 v17, 3, v1
    v_lshl_add_u32 v14, v17, 3, v14
    v_bfe_u32 v17, v1, 3, 1
    v_lshl_add_u32 v20, v17, 6, v14
    v_add_u32 v20, 32768, v20
    v_xor_b32 v21, 64, v20
    s_lshl_b32 s56, s44, 16
    v_add_u32 v11, s56, v2
    s_lshl_b32 s56, s73, 2
    s_add_u32 s56, s56, s44
    s_mul_i32 s66, s56, 229376
    s_lshl_b32 s57, s62, 12
    s_add_u32 s66, s66, s57
    s_mov_b32 s67, 917504
    s_lshl_b32 s69, s73, 4
    s_lshr_b32 s57, s62, 1
    s_add_u32 s69, s69, s57
    s_lshl_b32 s69, s69, 6
    s_and_b32 s57, s62, 1
    s_add_u32 s69, s69, s57
    s_add_u32 s66, s66, 0x3c00000
    s_add_u32 s69, s69, 0x5200030
    s_mov_b32 s72, 2
    s_mov_b32 s71, 0x5208000
    s_mov_b32 s50, 0x10000000
    v_and_b32 v58, 7, v61
    v_lshlrev_b32 v58, 4, v58
    s_lshl_b32 s57, s44, 2
    v_add_u32 v59, s57, v58
    s_waitcnt vmcnt(0)
    s_cmp_lg_u32 s44, 0
    s_cbranch_scc1 clm_13_x
    s_mov_b32 s59, s43
clm_13:
    v_readfirstlane_b32 s56, v126
    s_bitcmp1_b32 s56, s59
    s_cbranch_scc0 clm_13_ok
    s_mov_b32 s59, 32
    s_cmp_eq_u32 s56, -1
    s_cbranch_scc1 clm_13_ok
    s_ff0_i32_b32 s59, s56
    s_add_u32 s57, s42, 2
    s_min_u32 s57, s57, 8
    s_lshl_b32 s57, s57, 2
    s_lshl_b32 s58, 1, s59
    s_mov_b64 exec, 1
    v_mov_b32 v126, s58
    buffer_atomic_or v126, off, s[8:11], s57 sc0 sc1
    s_mov_b64 exec, -1
    s_waitcnt vmcnt(0)
    s_branch clm_13
clm_13_ok:
    v_mov_b32 v52, s59
    v_mov_b32 v53, 0
    ds_write_b32 v53, v52 offset:48
clm_13_x:
    v_lshlrev_b32 v80, 16, v64
    v_and_b32 v81, 0xffff0000, v64
    v_lshlrev_b32 v82, 16, v65
    v_and_b32 v83, 0xffff0000, v65
    v_lshlrev_b32 v84, 16, v66
    v_and_b32 v85, 0xffff0000, v66
    v_lshlrev_b32 v86, 16, v67
    v_and_b32 v87, 0xffff0000, v67
    v_lshlrev_b32 v88, 16, v68
    v_and_b32 v89, 0xffff0000, v68
    v_lshlrev_b32 v90, 16, v69
    v_and_b32 v91, 0xffff0000, v69
    v_lshlrev_b32 v92, 16, v70
    v_and_b32 v93, 0xffff0000, v70
    v_lshlrev_b32 v94, 16, v71
    v_and_b32 v95, 0xffff0000, v71
    v_lshlrev_b32 v96, 16, v72
    v_and_b32 v97, 0xffff0000, v72
    v_lshlrev_b32 v98, 16, v73
    v_and_b32 v99, 0xffff0000, v73
    v_lshlrev_b32 v100, 16, v74
    v_and_b32 v101, 0xffff0000, v74
    v_lshlrev_b32 v102, 16, v75
    v_and_b32 v103, 0xffff0000, v75
    v_lshlrev_b32 v104, 16, v76
    v_and_b32 v105, 0xffff0000, v76
    v_lshlrev_b32 v106, 16, v77
    v_and_b32 v107, 0xffff0000, v77
    v_lshlrev_b32 v108, 16, v78
    v_and_b32 v109, 0xffff0000, v78
    v_lshlrev_b32 v110, 16, v79
    v_and_b32 v111, 0xffff0000, v79
    v_add_f32 v52, v80, v84
    v_add_f32 v53, v81, v85
    v_add_f32 v54, v82, v86
    v_add_f32 v55, v83, v87
    v_add_f32 v52, v52, v88
    v_add_f32 v53, v53, v89
    v_add_f32 v54, v54, v90
    v_add_f32 v55, v55, v91
    v_add_f32 v52, v52, v92
    v_add_f32 v53, v53, v93
    v_add_f32 v54, v54, v94
    v_add_f32 v55, v55, v95
    v_add_f32 v52, v52, v96
    v_add_f32 v53, v53, v97
    v_add_f32 v54, v54, v98
    v_add_f32 v55, v55, v99
    v_add_f32 v52, v52, v100
    v_add_f32 v53, v53, v101
    v_add_f32 v54, v54, v102
    v_add_f32 v55, v55, v103
    v_add_f32 v52, v52, v104
    v_add_f32 v53, v53, v105
    v_add_f32 v54, v54, v106
    v_add_f32 v55, v55, v107
    v_add_f32 v52, v52, v108
    v_add_f32 v53, v53, v109
    v_add_f32 v54, v54, v110
    v_add_f32 v55, v55, v111
    v_add_f32 v52, v52, v53
    v_add_f32 v54, v54, v55
    v_add_f32 v56, v52, v54
    s_nop 1
    v_add_f32_dpp v56, v56, v56 row_ror:8 row_mask:0xf bank_mask:0xf
    v_mov_b32 v57, v56
    s_nop 1
    v_permlane16_swap_b32 v56, v57
    v_add_f32 v56, v56, v57
    v_mov_b32 v57, v56
    s_nop 1
    v_permlane32_swap_b32 v56, v57
    v_add_f32 v56, v56, v57
    ds_write_b32 v59, v56 offset:64
    s_waitcnt lgkmcnt(0)
    s_barrier
    ds_read_b128 v[52:55], v58 offset:64
    v_mov_b32 v57, 0
    ds_read_b32 v57, v57 offset:48
    s_waitcnt lgkmcnt(0)
    v_readfirstlane_b32 s59, v57
    s_cmp_eq_u32 s59, s43
    s_cbranch_scc1 keep_14
    s_waitcnt vmcnt(0)
    s_barrier
    s_cmp_ge_u32 s59, 32
    s_cbranch_scc1 EXIT
    s_mov_b32 s43, s59
    s_add_u32 s42, s42, 2
    v_mov_b32 v126, 0
    s_branch RESTART
keep_14:
    v_add_f32 v52, v52, v53
    v_add_f32 v54, v54, v55
    v_add_f32 v56, v52, v54
    v_mul_f32 v56, 0x3a800000, v56
    v_cvt_pk_bf16_f32 v50, v56, v56
    v_and_b32 v50, 0xffff0000, v50
    v_sub_f32 v64, v80, v56
    v_mul_f32 v52, v64, v64
    v_sub_f32 v65, v81, v56
    v_mul_f32 v53, v65, v65
    v_sub_f32 v66, v82, v56
    v_mul_f32 v54, v66, v66
    v_sub_f32 v67, v83, v56
    v_mul_f32 v55, v67, v67
    v_sub_f32 v68, v84, v56
    v_fmac_f32 v52, v68, v68
    v_sub_f32 v69, v85, v56
    v_fmac_f32 v53, v69, v69
    v_sub_f32 v70, v86, v56
    v_fmac_f32 v54, v70, v70
    v_sub_f32 v71, v87, v56
    v_fmac_f32 v55, v71, v71
    v_sub_f32 v64, v88, v56
    v_fmac_f32 v52, v64, v64
    v_sub_f32 v65, v89, v56
    v_fmac_f32 v53, v65, v65
    v_sub_f32 v66, v90, v56
    v_fmac_f32 v54, v66, v66
    v_sub_f32 v67, v91, v56
    v_fmac_f32 v55, v67, v67
    v_sub_f32 v68, v92, v56
    v_fmac_f32 v52, v68, v68
    v_sub_f32 v69, v93, v56
    v_fmac_f32 v53, v69, v69
    v_sub_f32 v70, v94, v56
    v_fmac_f32 v54, v70, v70
    v_sub_f32 v71, v95, v56
    v_fmac_f32 v55, v71, v71
    v_sub_f32 v64, v96, v56
    v_fmac_f32 v52, v64, v64
    v_sub_f32 v65, v97, v56
    v_fmac_f32 v53, v65, v65
    v_sub_f32 v66, v98, v56
    v_fmac_f32 v54, v66, v66
    v_sub_f32 v67, v99, v56
    v_fmac_f32 v55, v67, v67
    v_sub_f32 v68, v100, v56
    v_fmac_f32 v52, v68, v68
    v_sub_f32 v69, v101, v56
    v_fmac_f32 v53, v69, v69
    v_sub_f32 v70, v102, v56
    v_fmac_f32 v54, v70, v70
    v_sub_f32 v71, v103, v56
    v_fmac_f32 v55, v71, v71
    v_sub_f32 v64, v104, v56
    v_fmac_f32 v52, v64, v64
    v_sub_f32 v65, v105, v56
    v_fmac_f32 v53, v65, v65
    v_sub_f32 v66, v106, v56
    v_fmac_f32 v54, v66, v66
    v_sub_f32 v67, v107, v56
    v_fmac_f32 v55, v67, v67
    v_sub_f32 v68, v108, v56
    v_fmac_f32 v52, v68, v68
    v_sub_f32 v69, v109, v56
    v_fmac_f32 v53, v69, v69
    v_sub_f32 v70, v110, v56
    v_fmac_f32 v54, v70, v70
    v_sub_f32 v71, v111, v56
    v_fmac_f32 v55, v71, v71
    v_add_f32 v52, v52, v53
    v_add_f32 v54, v54, v55
    v_add_f32 v56, v52, v54
    v_sub_f32 v80, v80, v50
    v_sub_f32 v81, v81, v50
    v_sub_f32 v82, v82, v50
    v_sub_f32 v83, v83, v50
    v_sub_f32 v84, v84, v50
    v_sub_f32 v85, v85, v50
    v_sub_f32 v86, v86, v50
    v_sub_f32 v87, v87, v50
    v_sub_f32 v88, v88, v50
    v_sub_f32 v89, v89, v50
    v_sub_f32 v90, v90, v50
    v_sub_f32 v91, v91, v50
    v_sub_f32 v92, v92, v50
    v_sub_f32 v93, v93, v50
    v_sub_f32 v94, v94, v50
    v_sub_f32 v95, v95, v50
    v_sub_f32 v96, v96, v50
    v_sub_f32 v97, v97, v50
    v_sub_f32 v98, v98, v50
    v_sub_f32 v99, v99, v50
    v_sub_f32 v100, v100, v50
    v_sub_f32 v101, v101, v50
    v_sub_f32 v102, v102, v50
    v_sub_f32 v103, v103, v50
    v_sub_f32 v104, v104, v50
    v_sub_f32 v105, v105, v50
    v_sub_f32 v106, v106, v50
    v_sub_f32 v107, v107, v50
    v_sub_f32 v108, v108, v50
    v_sub_f32 v109, v109, v50
    v_sub_f32 v110, v110, v50
    v_sub_f32 v111, v111, v50
    v_cvt_pk_bf16_f32 v64, v80, v81
    v_cvt_pk_bf16_f32 v65, v82, v83
    v_cvt_pk_bf16_f32 v66, v84, v85
    v_cvt_pk_bf16_f32 v67, v86, v87
    v_cvt_pk_bf16_f32 v68, v88, v89
    v_cvt_pk_bf16_f32 v69, v90, v91
    v_cvt_pk_bf16_f32 v70, v92, v93
    v_cvt_pk_bf16_f32 v71, v94, v95
    v_cvt_pk_bf16_f32 v72, v96, v97
    v_cvt_pk_bf16_f32 v73, v98, v99
    v_cvt_pk_bf16_f32 v74, v100, v101
    v_cvt_pk_bf16_f32 v75, v102, v103
    v_cvt_pk_bf16_f32 v76, v104, v105
    v_cvt_pk_bf16_f32 v77, v106, v107
    v_cvt_pk_bf16_f32 v78, v108, v109
    v_cvt_pk_bf16_f32 v79, v110, v111
    v_add_f32_dpp v56, v56, v56 row_ror:8 row_mask:0xf bank_mask:0xf
    v_mov_b32 v57, v56
    s_nop 1
    v_permlane16_swap_b32 v56, v57
    v_add_f32 v56, v56, v57
    v_mov_b32 v57, v56
    s_nop 1
    v_permlane32_swap_b32 v56, v57
    v_add_f32 v56, v56, v57
    ds_write_b32 v59, v56 offset:192
    s_waitcnt lgkmcnt(0)
    s_barrier
    ds_read_b128 v[52:55], v58 offset:192
    s_waitcnt lgkmcnt(0)
    v_add_f32 v52, v52, v53
    v_add_f32 v54, v54, v55
    v_add_f32 v56, v52, v54
    v_mul_f32 v56, 0x3a800000, v56
    v_cvt_pk_bf16_f32 v56, v56, v56
    v_and_b32 v56, 0xffff0000, v56
    v_add_f32 v56, 0x3727c5ac, v56
    v_cvt_pk_bf16_f32 v56, v56, v56
    v_and_b32 v56, 0xffff0000, v56
    v_sqrt_f32 v56, v56
    s_nop 0
    v_cvt_pk_bf16_f32 v56, v56, v56
    v_and_b32 v56, 0xffff0000, v56
    v_rcp_f32 v56, v56
    v_lshlrev_b32 v80, 16, v64
    v_and_b32 v81, 0xffff0000, v64
    v_lshlrev_b32 v82, 16, v65
    v_and_b32 v83, 0xffff0000, v65
    v_lshlrev_b32 v84, 16, v66
    v_and_b32 v85, 0xffff0000, v66
    v_lshlrev_b32 v86, 16, v67
    v_and_b32 v87, 0xffff0000, v67
    v_lshlrev_b32 v88, 16, v68
    v_and_b32 v89, 0xffff0000, v68
    v_lshlrev_b32 v90, 16, v69
    v_and_b32 v91, 0xffff0000, v69
    v_lshlrev_b32 v92, 16, v70
    v_and_b32 v93, 0xffff0000, v70
    v_lshlrev_b32 v94, 16, v71
    v_and_b32 v95, 0xffff0000, v71
    v_lshlrev_b32 v96, 16, v72
    v_and_b32 v97, 0xffff0000, v72
    v_lshlrev_b32 v98, 16, v73
    v_and_b32 v99, 0xffff0000, v73
    v_lshlrev_b32 v100, 16, v74
    v_and_b32 v101, 0xffff0000, v74
    v_lshlrev_b32 v102, 16, v75
    v_and_b32 v103, 0xffff0000, v75
    v_lshlrev_b32 v104, 16, v76
    v_and_b32 v105, 0xffff0000, v76
    v_lshlrev_b32 v106, 16, v77
    v_and_b32 v107, 0xffff0000, v77
    v_lshlrev_b32 v108, 16, v78
    v_and_b32 v109, 0xffff0000, v78
    v_lshlrev_b32 v110, 16, v79
    v_and_b32 v111, 0xffff0000, v79
    v_mul_f32 v80, v80, v56
    v_mul_f32 v81, v81, v56
    v_mul_f32 v82, v82, v56
    v_mul_f32 v83, v83, v56
    v_mul_f32 v84, v84, v56
    v_mul_f32 v85, v85, v56
    v_mul_f32 v86, v86, v56
    v_mul_f32 v87, v87, v56
    v_mul_f32 v88, v88, v56
    v_mul_f32 v89, v89, v56
    v_mul_f32 v90, v90, v56
    v_mul_f32 v91, v91, v56
    v_mul_f32 v92, v92, v56
    v_mul_f32 v93, v93, v56
    v_mul_f32 v94, v94, v56
    v_mul_f32 v95, v95, v56
    v_mul_f32 v96, v96, v56
    v_mul_f32 v97, v97, v56
    v_mul_f32 v98, v98, v56
    v_mul_f32 v99, v99, v56
    v_mul_f32 v100, v100, v56
    v_mul_f32 v101, v101, v56
    v_mul_f32 v102, v102, v56
    v_mul_f32 v103, v103, v56
    v_mul_f32 v104, v104, v56
    v_mul_f32 v105, v105, v56
    v_mul_f32 v106, v106, v56
    v_mul_f32 v107, v107, v56
    v_mul_f32 v108, v108, v56
    v_mul_f32 v109, v109, v56
    v_mul_f32 v110, v110, v56
    v_mul_f32 v111, v111, v56
    v_lshrrev_b32 v60, 3, v61
    v_lshlrev_b32 v60, 9, v60
    v_add_u32 v60, v60, v58
    s_lshr_b32 s56, s2, 2
    s_lshl_b32 s56, s56, 16
    s_and_b32 s57, s2, 3
    s_lshl_b32 s57, s57, 7
    s_add_u32 s56, s56, s57
    s_lshl_b32 s57, s44, 14
    s_add_u32 s56, s56, s57
    v_cvt_pk_bf16_f32 v64, v80, v81
    v_cvt_pk_bf16_f32 v65, v82, v83
    v_cvt_pk_bf16_f32 v66, v84, v85
    v_cvt_pk_bf16_f32 v67, v86, v87
    buffer_store_dwordx4 v[64:67], v60, s[4:7], s56 offen sc1
    s_add_u32 s56, s56, 4096
    v_cvt_pk_bf16_f32 v68, v88, v89
    v_cvt_pk_bf16_f32 v69, v90, v91
    v_cvt_pk_bf16_f32 v70, v92, v93
    v_cvt_pk_bf16_f32 v71, v94, v95
    buffer_store_dwordx4 v[68:71], v60, s[4:7], s56 offen sc1
    s_add_u32 s56, s56, 4096
    v_cvt_pk_bf16_f32 v72, v96, v97
    v_cvt_pk_bf16_f32 v73, v98, v99
    v_cvt_pk_bf16_f32 v74, v100, v101
    v_cvt_pk_bf16_f32 v75, v102, v103
    buffer_store_dwordx4 v[72:75], v60, s[4:7], s56 offen sc1
    s_add_u32 s56, s56, 4096
    v_cvt_pk_bf16_f32 v76, v104, v105
    v_cvt_pk_bf16_f32 v77, v106, v107
    v_cvt_pk_bf16_f32 v78, v108, v109
    v_cvt_pk_bf16_f32 v79, v110, v111
    buffer_store_dwordx4 v[76:79], v60, s[4:7], s56 offen sc1
    v_lshlrev_b32 v60, 2, v61
    v_mov_b32 v57, 0
    s_lshl_b32 s56, s2, 6
    s_add_u32 s56, s56, 0x5200000
    s_mov_b64 exec, 0xffff
    buffer_store_dword v57, v60, s[4:7], s56 offen sc1
    s_mov_b64 exec, -1
    s_lshr_b32 s56, s2, 5
    s_sub_u32 s56, s56, 1
    s_and_b32 s56, s56, 7
    s_lshl_b32 s56, s56, 2
    s_add_u32 s56, s56, 100
    s_waitcnt vmcnt(0)
    s_barrier
    s_cmp_lg_u32 s44, 0
    s_cbranch_scc1 lnsig_15
    v_mov_b32 v13, 1
    s_mov_b64 exec, 1
    buffer_atomic_add v13, off, s[8:11], s56 sc1
    s_mov_b64 exec, -1
lnsig_15:
    s_sub_u32 s56, s42, 2
    s_lshl_b32 s56, s56, 5
    s_add_u32 s56, s56, s43
    s_lshl_b32 s56, s56, 2
    s_add_u32 s56, s56, s44
    v_lshlrev_b32 v46, 7, v1
    v_add_u32 v46, 60, v46
    s_mov_b32 s80, s26
    s_and_b32 s81, s27, 0xffff
    s_mov_b32 s82, 0x800000
    s_mov_b32 s83, 0x20000
    s_add_u32 s57, s56, 0x0
    s_lshl_b32 s57, s57, 13
    v_add_u32 v47, s57, v46
    buffer_load_dwordx2 v[44:45], v47, s[80:83], 0 offen
sw_16_x:
    s_mov_b32 s80, s26
    s_and_b32 s81, s27, 0xffff
    s_mov_b32 s82, 0x800000
    s_mov_b32 s83, 0x20000
    s_add_u32 s57, s56, 0x100
    s_lshl_b32 s57, s57, 13
    v_add_u32 v47, s57, v46
    buffer_load_dwordx2 v[44:45], v47, s[80:83], 0 offen
sw_17_x:
    s_mov_b32 s80, s26
    s_and_b32 s81, s27, 0xffff
    s_mov_b32 s82, 0x800000
    s_mov_b32 s83, 0x20000
    s_add_u32 s57, s56, 0x200
    s_lshl_b32 s57, s57, 13
    v_add_u32 v47, s57, v46
    buffer_load_dwordx2 v[44:45], v47, s[80:83], 0 offen
sw_18_x:
    s_mov_b32 s80, s26
    s_and_b32 s81, s27, 0xffff
    s_mov_b32 s82, 0x800000
    s_mov_b32 s83, 0x20000
    s_add_u32 s57, s56, 0x300
    s_lshl_b32 s57, s57, 13
    v_add_u32 v47, s57, v46
    buffer_load_dwordx2 v[44:45], v47, s[80:83], 0 offen
sw_19_x:
    s_cmp_lg_u32 s44, 0
    s_cbranch_scc1 WS_H2
    v_and_b32 v14, 28, v1
    v_mov_b32 v14, 28
    s_mov_b32 s68, 0x80000
xnh_20:
    buffer_load_dword v13, v14, s[8:11], 0 offen offset:100 sc1
    s_waitcnt vmcnt(0)
    v_cmp_gt_u32 vcc, 32, v13
    s_cbranch_vccz xnh_20_ok
    s_sub_u32 s68, s68, 1
    s_cmp_lg_u32 s68, 0
    s_cbranch_scc1 xnh_20
xnh_20_ok:
WS_H2:
    s_barrier
    s_add_u32 m0, s76, 0
    s_mov_b32 s58, 0x0
    buffer_load_dwordx4 v7, s[12:15], s58 offen lds
    s_add_u32 m0, s76, 4096
    s_mov_b32 s58, 0x38000
    buffer_load_dwordx4 v7, s[12:15], s58 offen lds
    s_add_u32 m0, s76, 8192
    s_mov_b32 s58, 0x70000
    buffer_load_dwordx4 v7, s[12:15], s58 offen lds
    s_add_u32 m0, s76, 12288
    s_mov_b32 s58, 0xa8000
    buffer_load_dwordx4 v7, s[12:15], s58 offen lds
    s_add_u32 m0, s76, 16384
    s_mov_b32 s58, 0xe0000
    buffer_load_dwordx4 v7, s[12:15], s58 offen lds
    s_add_u32 m0, s76, 20480
    s_mov_b32 s58, 0x118000
    buffer_load_dwordx4 v7, s[12:15], s58 offen lds
    s_add_u32 m0, s76, 24576
    s_mov_b32 s58, 0x150000
    buffer_load_dwordx4 v7, s[12:15], s58 offen lds
    s_add_u32 m0, s76, 28672
    s_mov_b32 s58, 0x188000
    buffer_load_dwordx4 v7, s[12:15], s58 offen lds
    s_add_u32 m0, s76, 32768
    s_mov_b32 s58, 0x1c0000
    buffer_load_dwordx4 v7, s[12:15], s58 offen lds
    s_add_u32 m0, s76, 36864
    s_mov_b32 s58, 0x1f8000
    buffer_load_dwordx4 v7, s[12:15], s58 offen lds
    s_add_u32 m0, s76, 40960
    s_mov_b32 s58, 0x230000
    buffer_load_dwordx4 v7, s[12:15], s58 offen lds
    s_add_u32 m0, s76, 45056
    s_mov_b32 s58, 0x268000
    buffer_load_dwordx4 v7, s[12:15], s58 offen lds
    s_add_u32 m0, s76, 49152
    s_mov_b32 s58, 0x2a0000
    buffer_load_dwordx4 v7, s[12:15], s58 offen lds
    s_add_u32 m0, s76, 53248
    s_mov_b32 s58, 0x2d8000
    buffer_load_dwordx4 v7, s[12:15], s58 offen lds
    s_add_u32 m0, s76, 57344
    s_mov_b32 s58, 0x310000
    buffer_load_dwordx4 v7, s[12:15], s58 offen lds
    s_add_u32 m0, s76, 61440
    s_mov_b32 s58, 0x348000
    buffer_load_dwordx4 v7, s[12:15], s58 offen lds
    s_add_u32 m0, s76, 65536
    s_mov_b32 s58, 0x380000
    buffer_load_dwordx4 v7, s[12:15], s58 offen lds
    s_add_u32 m0, s76, 69632
    s_mov_b32 s58, 0x3b8000
    buffer_load_dwordx4 v7, s[12:15], s58 offen lds
    s_add_u32 m0, s76, 73728
    s_mov_b32 s58, 0x3f0000
    buffer_load_dwordx4 v7, s[12:15], s58 offen lds
    s_add_u32 m0, s76, 77824
    s_mov_b32 s58, 0x428000
    buffer_load_dwordx4 v7, s[12:15], s58 offen lds
    s_add_u32 m0, s76, 81920
    s_mov_b32 s58, 0x460000
    buffer_load_dwordx4 v7, s[12:15], s58 offen lds
    s_add_u32 m0, s76, 86016
    s_mov_b32 s58, 0x498000
    buffer_load_dwordx4 v7, s[12:15], s58 offen lds
    s_add_u32 m0, s76, 90112
    s_mov_b32 s58, 0x4d0000
    buffer_load_dwordx4 v7, s[12:15], s58 offen lds
    s_add_u32 m0, s76, 94208
    s_mov_b32 s58, 0x508000
    buffer_load_dwordx4 v7, s[12:15], s58 offen lds
    s_add_u32 m0, s76, 98304
    s_mov_b32 s58, 0x540000
    buffer_load_dwordx4 v7, s[12:15], s58 offen lds
    s_add_u32 m0, s76, 102400
    s_mov_b32 s58, 0x578000
    buffer_load_dwordx4 v7, s[12:15], s58 offen lds
    s_add_u32 m0, s76, 106496
    s_mov_b32 s58, 0x5b0000
    buffer_load_dwordx4 v7, s[12:15], s58 offen lds
    s_add_u32 m0, s76, 110592
    s_mov_b32 s58, 0x5e8000
    buffer_load_dwordx4 v7, s[12:15], s58 offen lds
    s_add_u32 m0, s76, 114688
    s_mov_b32 s58, 0x620000
    buffer_load_dwordx4 v7, s[12:15], s58 offen lds
    s_add_u32 m0, s76, 118784
    s_mov_b32 s58, 0x658000
    buffer_load_dwordx4 v7, s[12:15], s58 offen lds
    s_add_u32 m0, s76, 122880
    s_mov_b32 s58, 0x690000
    buffer_load_dwordx4 v7, s[12:15], s58 offen lds
    s_add_u32 m0, s76, 126976
    s_mov_b32 s58, 0x6c8000
    buffer_load_dwordx4 v7, s[12:15], s58 offen lds
    s_cmp_lt_u32 s62, 56
    s_cbranch_scc1 WS_GO
    v_and_b32 v14, 28, v1
    s_mov_b32 s68, 0x80000
xni_21:
    buffer_load_dword v13, v14, s[8:11], 0 offen offset:100 sc1
    s_waitcnt vmcnt(0)
    v_cmp_gt_u32 vcc, 32, v13
    s_cbranch_vccz xni_21_ok
    s_sub_u32 s68, s68, 1
    s_cmp_lg_u32 s68, 0
    s_cbranch_scc1 xni_21
xni_21_ok:
    s_branch W_NEXT
WS_GO:
    s_cmp_lg_u32 s44, 0
    s_cbranch_scc1 xn1_22
    s_mov_b32 s68, 0x80000
xn_23:
    buffer_load_dword v13, off, s[8:11], 0 offset:128 sc1
    s_waitcnt vmcnt(0)
    v_cmp_gt_u32 vcc, 32, v13
    s_cbranch_vccz xn_23_ok
    s_sub_u32 s68, s68, 1
    s_cmp_lg_u32 s68, 0
    s_cbranch_scc1 xn_23
xn_23_ok:
xn1_22:
    s_waitcnt vmcnt(0)
    s_barrier
    s_add_u32 s74, s73, 15
    s_lshl_b32 s74, s74, 1
    s_and_b32 s74, s74, 28
    buffer_load_dword v22, off, s[8:11], s74 offset:100 sc1
    s_lshl_b32 s52, s73, 18
    buffer_load_dwordx4 a[0:3], v11, s[48:51], s52 offen offset:0 sc1
    buffer_load_dwordx4 a[4:7], v11, s[48:51], s52 offen offset:1024 sc1
    buffer_load_dwordx4 a[8:11], v11, s[48:51], s52 offen offset:2048 sc1
    buffer_load_dwordx4 a[12:15], v11, s[48:51], s52 offen offset:3072 sc1
    s_add_u32 s52, s52, 4096
    buffer_load_dwordx4 a[16:19], v11, s[48:51], s52 offen offset:0 sc1
    buffer_load_dwordx4 a[20:23], v11, s[48:51], s52 offen offset:1024 sc1
    buffer_load_dwordx4 a[24:27], v11, s[48:51], s52 offen offset:2048 sc1
    buffer_load_dwordx4 a[28:31], v11, s[48:51], s52 offen offset:3072 sc1
    s_add_u32 s52, s52, 4096
    buffer_load_dwordx4 a[32:35], v11, s[48:51], s52 offen offset:0 sc1
    buffer_load_dwordx4 a[36:39], v11, s[48:51], s52 offen offset:1024 sc1
    buffer_load_dwordx4 a[40:43], v11, s[48:51], s52 offen offset:2048 sc1
    buffer_load_dwordx4 a[44:47], v11, s[48:51], s52 offen offset:3072 sc1
    s_add_u32 s52, s52, 4096
    buffer_load_dwordx4 a[48:51], v11, s[48:51], s52 offen offset:0 sc1
    buffer_load_dwordx4 a[52:55], v11, s[48:51], s52 offen offset:1024 sc1
    buffer_load_dwordx4 a[56:59], v11, s[48:51], s52 offen offset:2048 sc1
    buffer_load_dwordx4 a[60:63], v11, s[48:51], s52 offen offset:3072 sc1
    s_add_u32 s52, s52, 4096
    buffer_load_dwordx4 a[64:67], v11, s[48:51], s52 offen offset:0 sc1
    buffer_load_dwordx4 a[68:71], v11, s[48:51], s52 offen offset:1024 sc1
    buffer_load_dwordx4 a[72:75], v11, s[48:51], s52 offen offset:2048 sc1
    buffer_load_dwordx4 a[76:79], v11, s[48:51], s52 offen offset:3072 sc1
    s_add_u32 s52, s52, 4096
    buffer_load_dwordx4 a[80:83], v11, s[48:51], s52 offen offset:0 sc1
    buffer_load_dwordx4 a[84:87], v11, s[48:51], s52 offen offset:1024 sc1
    buffer_load_dwordx4 a[88:91], v11, s[48:51], s52 offen offset:2048 sc1
    buffer_load_dwordx4 a[92:95], v11, s[48:51], s52 offen offset:3072 sc1
    s_add_u32 s52, s52, 4096
    buffer_load_dwordx4 a[96:99], v11, s[48:51], s52 offen offset:0 sc1
    buffer_load_dwordx4 a[100:103], v11, s[48:51], s52 offen offset:1024 sc1
    buffer_load_dwordx4 a[104:107], v11, s[48:51], s52 offen offset:2048 sc1
    buffer_load_dwordx4 a[108:111], v11, s[48:51], s52 offen offset:3072 sc1
    s_add_u32 s52, s52, 4096
    buffer_load_dwordx4 a[112:115], v11, s[48:51], s52 offen offset:0 sc1
    buffer_load_dwordx4 a[116:119], v11, s[48:51], s52 offen offset:1024 sc1
    buffer_load_dwordx4 a[120:123], v11, s[48:51], s52 offen offset:2048 sc1
    buffer_load_dwordx4 a[124:127], v11, s[48:51], s52 offen offset:3072 sc1
    ds_read_b64_tr_b16 v[64:65], v20 offset:0
    ds_read_b64_tr_b16 v[66:67], v20 offset:1024
    ds_read_b64_tr_b16 v[68:69], v21 offset:0
    ds_read_b64_tr_b16 v[70:71], v21 offset:1024
    ds_read_b64_tr_b16 v[72:73], v20 offset:2048
    ds_read_b64_tr_b16 v[74:75], v20 offset:3072
    ds_read_b64_tr_b16 v[76:77], v21 offset:2048
    ds_read_b64_tr_b16 v[78:79], v21 offset:3072
WS_GO2:
    s_cmp_eq_u32 s60, 1
    s_cbranch_scc1 WS_N
WS_T:
    s_waitcnt vmcnt(31) lgkmcnt(4)
    v_mfma_f32_32x32x16_bf16 v[128:143], v[64:67], a[0:3], 0
    ds_read_b64_tr_b16 v[80:81], v20 offset:4096
    ds_read_b64_tr_b16 v[82:83], v20 offset:5120
    s_add_u32 s52, s52, 4096
    v_mfma_f32_32x32x16_bf16 v[144:159], v[68:71], a[0:3], 0
    ds_read_b64_tr_b16 v[84:85], v21 offset:4096
    ds_read_b64_tr_b16 v[86:87], v21 offset:5120
    buffer_load_dwordx4 a[128:131], v11, s[48:51], s52 offen offset:0 sc1
    s_waitcnt vmcnt(31) lgkmcnt(4)
    v_mfma_f32_32x32x16_bf16 v[128:143], v[72:75], a[4:7], v[128:143]
    ds_read_b64_tr_b16 v[88:89], v20 offset:6144
    ds_read_b64_tr_b16 v[90:91], v20 offset:7168
    v_mfma_f32_32x32x16_bf16 v[144:159], v[76:79], a[4:7], v[144:159]
    ds_read_b64_tr_b16 v[92:93], v21 offset:6144
    ds_read_b64_tr_b16 v[94:95], v21 offset:7168
    buffer_load_dwordx4 a[132:135], v11, s[48:51], s52 offen offset:1024 sc1
    s_waitcnt vmcnt(31) lgkmcnt(4)
    v_mfma_f32_32x32x16_bf16 v[128:143], v[80:83], a[8:11], v[128:143]
    ds_read_b64_tr_b16 v[64:65], v20 offset:8192
    ds_read_b64_tr_b16 v[66:67], v20 offset:9216
    v_mfma_f32_32x32x16_bf16 v[144:159], v[84:87], a[8:11], v[144:159]
    ds_read_b64_tr_b16 v[68:69], v21 offset:8192
    ds_read_b64_tr_b16 v[70:71], v21 offset:9216
    buffer_load_dwordx4 a[136:139], v11, s[48:51], s52 offen offset:2048 sc1
    s_waitcnt vmcnt(31) lgkmcnt(4)
    v_mfma_f32_32x32x16_bf16 v[128:143], v[88:91], a[12:15], v[128:143]
    ds_read_b64_tr_b16 v[72:73], v20 offset:10240
    ds_read_b64_tr_b16 v[74:75], v20 offset:11264
    v_mfma_f32_32x32x16_bf16 v[144:159], v[92:95], a[12:15], v[144:159]
    ds_read_b64_tr_b16 v[76:77], v21 offset:10240
    ds_read_b64_tr_b16 v[78:79], v21 offset:11264
    buffer_load_dwordx4 a[140:143], v11, s[48:51], s52 offen offset:3072 sc1
    s_waitcnt vmcnt(31) lgkmcnt(4)
    v_mfma_f32_32x32x16_bf16 v[128:143], v[64:67], a[16:19], v[128:143]
    ds_read_b64_tr_b16 v[80:81], v20 offset:12288
    ds_read_b64_tr_b16 v[82:83], v20 offset:13312
    s_add_u32 s52, s52, 4096
    v_mfma_f32_32x32x16_bf16 v[144:159], v[68:71], a[16:19], v[144:159]
    ds_read_b64_tr_b16 v[84:85], v21 offset:12288
    ds_read_b64_tr_b16 v[86:87], v21 offset:13312
    buffer_load_dwordx4 a[144:147], v11, s[48:51], s52 offen offset:0 sc1
    s_waitcnt vmcnt(31) lgkmcnt(4)
    v_mfma_f32_32x32x16_bf16 v[128:143], v[72:75], a[20:23], v[128:143]
    ds_read_b64_tr_b16 v[88:89], v20 offset:14336
    ds_read_b64_tr_b16 v[90:91], v20 offset:15360
    v_mfma_f32_32x32x16_bf16 v[144:159], v[76:79], a[20:23], v[144:159]
    ds_read_b64_tr_b16 v[92:93], v21 offset:14336
    ds_read_b64_tr_b16 v[94:95], v21 offset:15360
    buffer_load_dwordx4 a[148:151], v11, s[48:51], s52 offen offset:1024 sc1
    s_waitcnt vmcnt(31) lgkmcnt(4)
    v_mfma_f32_32x32x16_bf16 v[128:143], v[80:83], a[24:27], v[128:143]
    ds_read_b64_tr_b16 v[64:65], v20 offset:16384
    ds_read_b64_tr_b16 v[66:67], v20 offset:17408
    v_mfma_f32_32x32x16_bf16 v[144:159], v[84:87], a[24:27], v[144:159]
    ds_read_b64_tr_b16 v[68:69], v21 offset:16384
    ds_read_b64_tr_b16 v[70:71], v21 offset:17408
    buffer_load_dwordx4 a[152:155], v11, s[48:51], s52 offen offset:2048 sc1
    s_waitcnt vmcnt(31) lgkmcnt(4)
    v_mfma_f32_32x32x16_bf16 v[128:143], v[88:91], a[28:31], v[128:143]
    ds_read_b64_tr_b16 v[72:73], v20 offset:18432
    ds_read_b64_tr_b16 v[74:75], v20 offset:19456
    v_mfma_f32_32x32x16_bf16 v[144:159], v[92:95], a[28:31], v[144:159]
    ds_read_b64_tr_b16 v[76:77], v21 offset:18432
    ds_read_b64_tr_b16 v[78:79], v21 offset:19456
    buffer_load_dwordx4 a[156:159], v11, s[48:51], s52 offen offset:3072 sc1
    s_waitcnt vmcnt(31) lgkmcnt(4)
    v_mfma_f32_32x32x16_bf16 v[128:143], v[64:67], a[32:35], v[128:143]
    ds_read_b64_tr_b16 v[80:81], v20 offset:20480
    ds_read_b64_tr_b16 v[82:83], v20 offset:21504
    s_add_u32 s52, s52, 4096
    v_mfma_f32_32x32x16_bf16 v[144:159], v[68:71], a[32:35], v[144:159]
    ds_read_b64_tr_b16 v[84:85], v21 offset:20480
    ds_read_b64_tr_b16 v[86:87], v21 offset:21504
    buffer_load_dwordx4 a[160:163], v11, s[48:51], s52 offen offset:0 sc1
    s_waitcnt vmcnt(31) lgkmcnt(4)
    v_mfma_f32_32x32x16_bf16 v[128:143], v[72:75], a[36:39], v[128:143]
    ds_read_b64_tr_b16 v[88:89], v20 offset:22528
    ds_read_b64_tr_b16 v[90:91], v20 offset:23552
    v_mfma_f32_32x32x16_bf16 v[144:159], v[76:79], a[36:39], v[144:159]
    ds_read_b64_tr_b16 v[92:93], v21 offset:22528
    ds_read_b64_tr_b16 v[94:95], v21 offset:23552
    buffer_load_dwordx4 a[164:167], v11, s[48:51], s52 offen offset:1024 sc1
    s_waitcnt vmcnt(31) lgkmcnt(4)
    v_mfma_f32_32x32x16_bf16 v[128:143], v[80:83], a[40:43], v[128:143]
    ds_read_b64_tr_b16 v[64:65], v20 offset:24576
    ds_read_b64_tr_b16 v[66:67], v20 offset:25600
    v_mfma_f32_32x32x16_bf16 v[144:159], v[84:87], a[40:43], v[144:159]
    ds_read_b64_tr_b16 v[68:69], v21 offset:24576
    ds_read_b64_tr_b16 v[70:71], v21 offset:25600
    buffer_load_dwordx4 a[168:171], v11, s[48:51], s52 offen offset:2048 sc1
    s_waitcnt vmcnt(31) lgkmcnt(4)
    v_mfma_f32_32x32x16_bf16 v[128:143], v[88:91], a[44:47], v[128:143]
    ds_read_b64_tr_b16 v[72:73], v20 offset:26624
    ds_read_b64_tr_b16 v[74:75], v20 offset:27648
    v_mfma_f32_32x32x16_bf16 v[144:159], v[92:95], a[44:47], v[144:159]
    ds_read_b64_tr_b16 v[76:77], v21 offset:26624
    ds_read_b64_tr_b16 v[78:79], v21 offset:27648
    buffer_load_dwordx4 a[172:175], v11, s[48:51], s52 offen offset:3072 sc1
    s_waitcnt vmcnt(31) lgkmcnt(4)
    v_mfma_f32_32x32x16_bf16 v[128:143], v[64:67], a[48:51], v[128:143]
    ds_read_b64_tr_b16 v[80:81], v20 offset:28672
    ds_read_b64_tr_b16 v[82:83], v20 offset:29696
    s_add_u32 s52, s52, 4096
    v_mfma_f32_32x32x16_bf16 v[144:159], v[68:71], a[48:51], v[144:159]
    ds_read_b64_tr_b16 v[84:85], v21 offset:28672
    ds_read_b64_tr_b16 v[86:87], v21 offset:29696
    buffer_load_dwordx4 a[176:179], v11, s[48:51], s52 offen offset:0 sc1
    s_waitcnt vmcnt(31) lgkmcnt(4)
    v_mfma_f32_32x32x16_bf16 v[128:143], v[72:75], a[52:55], v[128:143]
    ds_read_b64_tr_b16 v[88:89], v20 offset:30720
    ds_read_b64_tr_b16 v[90:91], v20 offset:31744
    v_mfma_f32_32x32x16_bf16 v[144:159], v[76:79], a[52:55], v[144:159]
    ds_read_b64_tr_b16 v[92:93], v21 offset:30720
    ds_read_b64_tr_b16 v[94:95], v21 offset:31744
    buffer_load_dwordx4 a[180:183], v11, s[48:51], s52 offen offset:1024 sc1
    s_waitcnt vmcnt(31) lgkmcnt(4)
    v_mfma_f32_32x32x16_bf16 v[128:143], v[80:83], a[56:59], v[128:143]
    ds_read_b64_tr_b16 v[64:65], v20 offset:32768
    ds_read_b64_tr_b16 v[66:67], v20 offset:33792
    v_mfma_f32_32x32x16_bf16 v[144:159], v[84:87], a[56:59], v[144:159]
    ds_read_b64_tr_b16 v[68:69], v21 offset:32768
    ds_read_b64_tr_b16 v[70:71], v21 offset:33792
    buffer_load_dwordx4 a[184:187], v11, s[48:51], s52 offen offset:2048 sc1
    s_waitcnt vmcnt(31) lgkmcnt(4)
    v_mfma_f32_32x32x16_bf16 v[128:143], v[88:91], a[60:63], v[128:143]
    ds_read_b64_tr_b16 v[72:73], v20 offset:34816
    ds_read_b64_tr_b16 v[74:75], v20 offset:35840
    v_mfma_f32_32x32x16_bf16 v[144:159], v[92:95], a[60:63], v[144:159]
    ds_read_b64_tr_b16 v[76:77], v21 offset:34816
    ds_read_b64_tr_b16 v[78:79], v21 offset:35840
    buffer_load_dwordx4 a[188:191], v11, s[48:51], s52 offen offset:3072 sc1
    s_waitcnt vmcnt(16)
    v_cmp_gt_u32 vcc, 32, v22
    s_cbranch_vccnz WS_T_xn
WS_T_xn_ok:
    s_barrier
    s_cmp_lg_u32 s44, 0
    s_cbranch_scc1 wsf_24
    v_mov_b32 v13, 1
    s_mov_b64 exec, 1
    buffer_store_byte v13, off, s[4:7], s71 sc1
    s_mov_b64 exec, -1
wsf_24:
    s_waitcnt vmcnt(31) lgkmcnt(4)
    v_mfma_f32_32x32x16_bf16 v[128:143], v[64:67], a[64:67], v[128:143]
    ds_read_b64_tr_b16 v[80:81], v20 offset:36864
    ds_read_b64_tr_b16 v[82:83], v20 offset:37888
    s_add_u32 s52, s52, 4096
    v_mfma_f32_32x32x16_bf16 v[144:159], v[68:71], a[64:67], v[144:159]
    ds_read_b64_tr_b16 v[84:85], v21 offset:36864
    ds_read_b64_tr_b16 v[86:87], v21 offset:37888
    buffer_load_dwordx4 a[192:195], v11, s[48:51], s52 offen offset:0 sc1
    s_waitcnt vmcnt(31) lgkmcnt(4)
    v_mfma_f32_32x32x16_bf16 v[128:143], v[72:75], a[68:71], v[128:143]
    ds_read_b64_tr_b16 v[88:89], v20 offset:38912
    ds_read_b64_tr_b16 v[90:91], v20 offset:39936
    v_mfma_f32_32x32x16_bf16 v[144:159], v[76:79], a[68:71], v[144:159]
    ds_read_b64_tr_b16 v[92:93], v21 offset:38912
    ds_read_b64_tr_b16 v[94:95], v21 offset:39936
    buffer_load_dwordx4 a[196:199], v11, s[48:51], s52 offen offset:1024 sc1
    s_waitcnt vmcnt(31) lgkmcnt(4)
    v_mfma_f32_32x32x16_bf16 v[128:143], v[80:83], a[72:75], v[128:143]
    ds_read_b64_tr_b16 v[64:65], v20 offset:40960
    ds_read_b64_tr_b16 v[66:67], v20 offset:41984
    v_mfma_f32_32x32x16_bf16 v[144:159], v[84:87], a[72:75], v[144:159]
    ds_read_b64_tr_b16 v[68:69], v21 offset:40960
    ds_read_b64_tr_b16 v[70:71], v21 offset:41984
    buffer_load_dwordx4 a[200:203], v11, s[48:51], s52 offen offset:2048 sc1
    s_waitcnt vmcnt(31) lgkmcnt(4)
    v_mfma_f32_32x32x16_bf16 v[128:143], v[88:91], a[76:79], v[128:143]
    ds_read_b64_tr_b16 v[72:73], v20 offset:43008
    ds_read_b64_tr_b16 v[74:75], v20 offset:44032
    v_mfma_f32_32x32x16_bf16 v[144:159], v[92:95], a[76:79], v[144:159]
    ds_read_b64_tr_b16 v[76:77], v21 offset:43008
    ds_read_b64_tr_b16 v[78:79], v21 offset:44032
    buffer_load_dwordx4 a[204:207], v11, s[48:51], s52 offen offset:3072 sc1
    s_waitcnt vmcnt(31) lgkmcnt(4)
    v_mfma_f32_32x32x16_bf16 v[128:143], v[64:67], a[80:83], v[128:143]
    ds_read_b64_tr_b16 v[80:81], v20 offset:45056
    ds_read_b64_tr_b16 v[82:83], v20 offset:46080
    s_add_u32 s52, s52, 4096
    v_mfma_f32_32x32x16_bf16 v[144:159], v[68:71], a[80:83], v[144:159]
    ds_read_b64_tr_b16 v[84:85], v21 offset:45056
    ds_read_b64_tr_b16 v[86:87], v21 offset:46080
    buffer_load_dwordx4 a[208:211], v11, s[48:51], s52 offen offset:0 sc1
    s_waitcnt vmcnt(31) lgkmcnt(4)
    v_mfma_f32_32x32x16_bf16 v[128:143], v[72:75], a[84:87], v[128:143]
    ds_read_b64_tr_b16 v[88:89], v20 offset:47104
    ds_read_b64_tr_b16 v[90:91], v20 offset:48128
    v_mfma_f32_32x32x16_bf16 v[144:159], v[76:79], a[84:87], v[144:159]
    ds_read_b64_tr_b16 v[92:93], v21 offset:47104
    ds_read_b64_tr_b16 v[94:95], v21 offset:48128
    buffer_load_dwordx4 a[212:215], v11, s[48:51], s52 offen offset:1024 sc1
    s_waitcnt vmcnt(31) lgkmcnt(4)
    v_mfma_f32_32x32x16_bf16 v[128:143], v[80:83], a[88:91], v[128:143]
    ds_read_b64_tr_b16 v[64:65], v20 offset:49152
    ds_read_b64_tr_b16 v[66:67], v20 offset:50176
    v_mfma_f32_32x32x16_bf16 v[144:159], v[84:87], a[88:91], v[144:159]
    ds_read_b64_tr_b16 v[68:69], v21 offset:49152
    ds_read_b64_tr_b16 v[70:71], v21 offset:50176
    buffer_load_dwordx4 a[216:219], v11, s[48:51], s52 offen offset:2048 sc1
    s_waitcnt vmcnt(31) lgkmcnt(4)
    v_mfma_f32_32x32x16_bf16 v[128:143], v[88:91], a[92:95], v[128:143]
    ds_read_b64_tr_b16 v[72:73], v20 offset:51200
    ds_read_b64_tr_b16 v[74:75], v20 offset:52224
    v_mfma_f32_32x32x16_bf16 v[144:159], v[92:95], a[92:95], v[144:159]
    ds_read_b64_tr_b16 v[76:77], v21 offset:51200
    ds_read_b64_tr_b16 v[78:79], v21 offset:52224
    buffer_load_dwordx4 a[220:223], v11, s[48:51], s52 offen offset:3072 sc1
    s_waitcnt vmcnt(31) lgkmcnt(4)
    v_mfma_f32_32x32x16_bf16 v[128:143], v[64:67], a[96:99], v[128:143]
    ds_read_b64_tr_b16 v[80:81], v20 offset:53248
    ds_read_b64_tr_b16 v[82:83], v20 offset:54272
    s_add_u32 s52, s52, 4096
    v_mfma_f32_32x32x16_bf16 v[144:159], v[68:71], a[96:99], v[144:159]
    ds_read_b64_tr_b16 v[84:85], v21 offset:53248
    ds_read_b64_tr_b16 v[86:87], v21 offset:54272
    buffer_load_dwordx4 a[224:227], v11, s[48:51], s52 offen offset:0 sc1
    s_waitcnt vmcnt(31) lgkmcnt(4)
    v_mfma_f32_32x32x16_bf16 v[128:143], v[72:75], a[100:103], v[128:143]
    ds_read_b64_tr_b16 v[88:89], v20 offset:55296
    ds_read_b64_tr_b16 v[90:91], v20 offset:56320
    v_mfma_f32_32x32x16_bf16 v[144:159], v[76:79], a[100:103], v[144:159]
    ds_read_b64_tr_b16 v[92:93], v21 offset:55296
    ds_read_b64_tr_b16 v[94:95], v21 offset:56320
    buffer_load_dwordx4 a[228:231], v11, s[48:51], s52 offen offset:1024 sc1
    s_waitcnt vmcnt(31) lgkmcnt(4)
    v_mfma_f32_32x32x16_bf16 v[128:143], v[80:83], a[104:107], v[128:143]
    ds_read_b64_tr_b16 v[64:65], v20 offset:57344
    ds_read_b64_tr_b16 v[66:67], v20 offset:58368
    v_mfma_f32_32x32x16_bf16 v[144:159], v[84:87], a[104:107], v[144:159]
    ds_read_b64_tr_b16 v[68:69], v21 offset:57344
    ds_read_b64_tr_b16 v[70:71], v21 offset:58368
    buffer_load_dwordx4 a[232:235], v11, s[48:51], s52 offen offset:2048 sc1
    s_waitcnt vmcnt(31) lgkmcnt(4)
    v_mfma_f32_32x32x16_bf16 v[128:143], v[88:91], a[108:111], v[128:143]
    ds_read_b64_tr_b16 v[72:73], v20 offset:59392
    ds_read_b64_tr_b16 v[74:75], v20 offset:60416
    v_mfma_f32_32x32x16_bf16 v[144:159], v[92:95], a[108:111], v[144:159]
    ds_read_b64_tr_b16 v[76:77], v21 offset:59392
    ds_read_b64_tr_b16 v[78:79], v21 offset:60416
    buffer_load_dwordx4 a[236:239], v11, s[48:51], s52 offen offset:3072 sc1
    s_waitcnt vmcnt(31) lgkmcnt(4)
    v_mfma_f32_32x32x16_bf16 v[128:143], v[64:67], a[112:115], v[128:143]
    ds_read_b64_tr_b16 v[80:81], v20 offset:61440
    ds_read_b64_tr_b16 v[82:83], v20 offset:62464
    s_add_u32 s52, s52, 4096
    v_mfma_f32_32x32x16_bf16 v[144:159], v[68:71], a[112:115], v[144:159]
    ds_read_b64_tr_b16 v[84:85], v21 offset:61440
    ds_read_b64_tr_b16 v[86:87], v21 offset:62464
    buffer_load_dwordx4 a[240:243], v11, s[48:51], s52 offen offset:0 sc1
    s_waitcnt vmcnt(31) lgkmcnt(4)
    v_mfma_f32_32x32x16_bf16 v[128:143], v[72:75], a[116:119], v[128:143]
    ds_read_b64_tr_b16 v[88:89], v20 offset:63488
    ds_read_b64_tr_b16 v[90:91], v20 offset:64512
    v_mfma_f32_32x32x16_bf16 v[144:159], v[76:79], a[116:119], v[144:159]
    ds_read_b64_tr_b16 v[92:93], v21 offset:63488
    ds_read_b64_tr_b16 v[94:95], v21 offset:64512
    buffer_load_dwordx4 a[244:247], v11, s[48:51], s52 offen offset:1024 sc1
    s_waitcnt vmcnt(31) lgkmcnt(4)
    v_mfma_f32_32x32x16_bf16 v[128:143], v[80:83], a[120:123], v[128:143]
    v_add_u32 v20, 0x10000, v20
    v_add_u32 v21, 0x10000, v21
    ds_read_b64_tr_b16 v[64:65], v20 offset:0
    ds_read_b64_tr_b16 v[66:67], v20 offset:1024
    v_mfma_f32_32x32x16_bf16 v[144:159], v[84:87], a[120:123], v[144:159]
    ds_read_b64_tr_b16 v[68:69], v21 offset:0
    ds_read_b64_tr_b16 v[70:71], v21 offset:1024
    buffer_load_dwordx4 a[248:251], v11, s[48:51], s52 offen offset:2048 sc1
    s_waitcnt vmcnt(31) lgkmcnt(4)
    v_mfma_f32_32x32x16_bf16 v[128:143], v[88:91], a[124:127], v[128:143]
    ds_read_b64_tr_b16 v[72:73], v20 offset:2048
    ds_read_b64_tr_b16 v[74:75], v20 offset:3072
    v_mfma_f32_32x32x16_bf16 v[144:159], v[92:95], a[124:127], v[144:159]
    ds_read_b64_tr_b16 v[76:77], v21 offset:2048
    ds_read_b64_tr_b16 v[78:79], v21 offset:3072
    buffer_load_dwordx4 a[252:255], v11, s[48:51], s52 offen offset:3072 sc1
    s_waitcnt vmcnt(31) lgkmcnt(4)
    v_mfma_f32_32x32x16_bf16 v[128:143], v[64:67], a[128:131], v[128:143]
    ds_read_b64_tr_b16 v[80:81], v20 offset:4096
    ds_read_b64_tr_b16 v[82:83], v20 offset:5120
    s_add_u32 s56, s73, 1
    s_cmp_eq_u32 s56, s54
    s_cselect_b32 s50, 0, s50
    s_add_u32 s52, s52, 200704
    v_mfma_f32_32x32x16_bf16 v[144:159], v[68:71], a[128:131], v[144:159]
    ds_read_b64_tr_b16 v[84:85], v21 offset:4096
    ds_read_b64_tr_b16 v[86:87], v21 offset:5120
    buffer_load_dwordx4 a[0:3], v11, s[48:51], s52 offen offset:0 sc1
    s_waitcnt vmcnt(31) lgkmcnt(4)
    v_mfma_f32_32x32x16_bf16 v[128:143], v[72:75], a[132:135], v[128:143]
    ds_read_b64_tr_b16 v[88:89], v20 offset:6144
    ds_read_b64_tr_b16 v[90:91], v20 offset:7168
    v_mfma_f32_32x32x16_bf16 v[144:159], v[76:79], a[132:135], v[144:159]
    ds_read_b64_tr_b16 v[92:93], v21 offset:6144
    ds_read_b64_tr_b16 v[94:95], v21 offset:7168
    buffer_load_dwordx4 a[4:7], v11, s[48:51], s52 offen offset:1024 sc1
    s_waitcnt vmcnt(31) lgkmcnt(4)
    v_mfma_f32_32x32x16_bf16 v[128:143], v[80:83], a[136:139], v[128:143]
    ds_read_b64_tr_b16 v[64:65], v20 offset:8192
    ds_read_b64_tr_b16 v[66:67], v20 offset:9216
    v_mfma_f32_32x32x16_bf16 v[144:159], v[84:87], a[136:139], v[144:159]
    ds_read_b64_tr_b16 v[68:69], v21 offset:8192
    ds_read_b64_tr_b16 v[70:71], v21 offset:9216
    buffer_load_dwordx4 a[8:11], v11, s[48:51], s52 offen offset:2048 sc1
    s_waitcnt vmcnt(31) lgkmcnt(4)
    v_mfma_f32_32x32x16_bf16 v[128:143], v[88:91], a[140:143], v[128:143]
    ds_read_b64_tr_b16 v[72:73], v20 offset:10240
    ds_read_b64_tr_b16 v[74:75], v20 offset:11264
    v_mfma_f32_32x32x16_bf16 v[144:159], v[92:95], a[140:143], v[144:159]
    ds_read_b64_tr_b16 v[76:77], v21 offset:10240
    ds_read_b64_tr_b16 v[78:79], v21 offset:11264
    buffer_load_dwordx4 a[12:15], v11, s[48:51], s52 offen offset:3072 sc1
    s_waitcnt vmcnt(31) lgkmcnt(4)
    v_mfma_f32_32x32x16_bf16 v[128:143], v[64:67], a[144:147], v[128:143]
    ds_read_b64_tr_b16 v[80:81], v20 offset:12288
    ds_read_b64_tr_b16 v[82:83], v20 offset:13312
    s_add_u32 s52, s52, 4096
    v_mfma_f32_32x32x16_bf16 v[144:159], v[68:71], a[144:147], v[144:159]
    ds_read_b64_tr_b16 v[84:85], v21 offset:12288
    ds_read_b64_tr_b16 v[86:87], v21 offset:13312
    buffer_load_dwordx4 a[16:19], v11, s[48:51], s52 offen offset:0 sc1
    s_waitcnt vmcnt(31) lgkmcnt(4)
    v_mfma_f32_32x32x16_bf16 v[128:143], v[72:75], a[148:151], v[128:143]
    ds_read_b64_tr_b16 v[88:89], v20 offset:14336
    ds_read_b64_tr_b16 v[90:91], v20 offset:15360
    v_mfma_f32_32x32x16_bf16 v[144:159], v[76:79], a[148:151], v[144:159]
    ds_read_b64_tr_b16 v[92:93], v21 offset:14336
    ds_read_b64_tr_b16 v[94:95], v21 offset:15360
    buffer_load_dwordx4 a[20:23], v11, s[48:51], s52 offen offset:1024 sc1
    s_waitcnt vmcnt(31) lgkmcnt(4)
    v_mfma_f32_32x32x16_bf16 v[128:143], v[80:83], a[152:155], v[128:143]
    ds_read_b64_tr_b16 v[64:65], v20 offset:16384
    ds_read_b64_tr_b16 v[66:67], v20 offset:17408
    v_mfma_f32_32x32x16_bf16 v[144:159], v[84:87], a[152:155], v[144:159]
    ds_read_b64_tr_b16 v[68:69], v21 offset:16384
    ds_read_b64_tr_b16 v[70:71], v21 offset:17408
    buffer_load_dwordx4 a[24:27], v11, s[48:51], s52 offen offset:2048 sc1
    s_waitcnt vmcnt(31) lgkmcnt(4)
    v_mfma_f32_32x32x16_bf16 v[128:143], v[88:91], a[156:159], v[128:143]
    ds_read_b64_tr_b16 v[72:73], v20 offset:18432
    ds_read_b64_tr_b16 v[74:75], v20 offset:19456
    v_mfma_f32_32x32x16_bf16 v[144:159], v[92:95], a[156:159], v[144:159]
    ds_read_b64_tr_b16 v[76:77], v21 offset:18432
    ds_read_b64_tr_b16 v[78:79], v21 offset:19456
    buffer_load_dwordx4 a[28:31], v11, s[48:51], s52 offen offset:3072 sc1
    s_waitcnt vmcnt(31) lgkmcnt(4)
    v_mfma_f32_32x32x16_bf16 v[128:143], v[64:67], a[160:163], v[128:143]
    ds_read_b64_tr_b16 v[80:81], v20 offset:20480
    ds_read_b64_tr_b16 v[82:83], v20 offset:21504
    s_add_u32 s52, s52, 4096
    v_mfma_f32_32x32x16_bf16 v[144:159], v[68:71], a[160:163], v[144:159]
    ds_read_b64_tr_b16 v[84:85], v21 offset:20480
    ds_read_b64_tr_b16 v[86:87], v21 offset:21504
    buffer_load_dwordx4 a[32:35], v11, s[48:51], s52 offen offset:0 sc1
    s_waitcnt vmcnt(31) lgkmcnt(4)
    v_mfma_f32_32x32x16_bf16 v[128:143], v[72:75], a[164:167], v[128:143]
    ds_read_b64_tr_b16 v[88:89], v20 offset:22528
    ds_read_b64_tr_b16 v[90:91], v20 offset:23552
    v_mfma_f32_32x32x16_bf16 v[144:159], v[76:79], a[164:167], v[144:159]
    ds_read_b64_tr_b16 v[92:93], v21 offset:22528
    ds_read_b64_tr_b16 v[94:95], v21 offset:23552
    buffer_load_dwordx4 a[36:39], v11, s[48:51], s52 offen offset:1024 sc1
    s_waitcnt vmcnt(31) lgkmcnt(4)
    v_mfma_f32_32x32x16_bf16 v[128:143], v[80:83], a[168:171], v[128:143]
    ds_read_b64_tr_b16 v[64:65], v20 offset:24576
    ds_read_b64_tr_b16 v[66:67], v20 offset:25600
    v_mfma_f32_32x32x16_bf16 v[144:159], v[84:87], a[168:171], v[144:159]
    ds_read_b64_tr_b16 v[68:69], v21 offset:24576
    ds_read_b64_tr_b16 v[70:71], v21 offset:25600
    buffer_load_dwordx4 a[40:43], v11, s[48:51], s52 offen offset:2048 sc1
    s_waitcnt vmcnt(31) lgkmcnt(4)
    v_mfma_f32_32x32x16_bf16 v[128:143], v[88:91], a[172:175], v[128:143]
    ds_read_b64_tr_b16 v[72:73], v20 offset:26624
    ds_read_b64_tr_b16 v[74:75], v20 offset:27648
    v_mfma_f32_32x32x16_bf16 v[144:159], v[92:95], a[172:175], v[144:159]
    ds_read_b64_tr_b16 v[76:77], v21 offset:26624
    ds_read_b64_tr_b16 v[78:79], v21 offset:27648
    buffer_load_dwordx4 a[44:47], v11, s[48:51], s52 offen offset:3072 sc1
    s_waitcnt vmcnt(31) lgkmcnt(4)
    v_mfma_f32_32x32x16_bf16 v[128:143], v[64:67], a[176:179], v[128:143]
    ds_read_b64_tr_b16 v[80:81], v20 offset:28672
    ds_read_b64_tr_b16 v[82:83], v20 offset:29696
    s_add_u32 s52, s52, 4096
    v_mfma_f32_32x32x16_bf16 v[144:159], v[68:71], a[176:179], v[144:159]
    ds_read_b64_tr_b16 v[84:85], v21 offset:28672
    ds_read_b64_tr_b16 v[86:87], v21 offset:29696
    buffer_load_dwordx4 a[48:51], v11, s[48:51], s52 offen offset:0 sc1
    s_waitcnt vmcnt(31) lgkmcnt(4)
    v_mfma_f32_32x32x16_bf16 v[128:143], v[72:75], a[180:183], v[128:143]
    ds_read_b64_tr_b16 v[88:89], v20 offset:30720
    ds_read_b64_tr_b16 v[90:91], v20 offset:31744
    v_mfma_f32_32x32x16_bf16 v[144:159], v[76:79], a[180:183], v[144:159]
    ds_read_b64_tr_b16 v[92:93], v21 offset:30720
    ds_read_b64_tr_b16 v[94:95], v21 offset:31744
    buffer_load_dwordx4 a[52:55], v11, s[48:51], s52 offen offset:1024 sc1
    s_waitcnt vmcnt(31) lgkmcnt(4)
    v_mfma_f32_32x32x16_bf16 v[128:143], v[80:83], a[184:187], v[128:143]
    ds_read_b64_tr_b16 v[64:65], v20 offset:32768
    ds_read_b64_tr_b16 v[66:67], v20 offset:33792
    v_mfma_f32_32x32x16_bf16 v[144:159], v[84:87], a[184:187], v[144:159]
    ds_read_b64_tr_b16 v[68:69], v21 offset:32768
    ds_read_b64_tr_b16 v[70:71], v21 offset:33792
    buffer_load_dwordx4 a[56:59], v11, s[48:51], s52 offen offset:2048 sc1
    s_waitcnt vmcnt(31) lgkmcnt(4)
    v_mfma_f32_32x32x16_bf16 v[128:143], v[88:91], a[188:191], v[128:143]
    ds_read_b64_tr_b16 v[72:73], v20 offset:34816
    ds_read_b64_tr_b16 v[74:75], v20 offset:35840
    v_mfma_f32_32x32x16_bf16 v[144:159], v[92:95], a[188:191], v[144:159]
    ds_read_b64_tr_b16 v[76:77], v21 offset:34816
    ds_read_b64_tr_b16 v[78:79], v21 offset:35840
    buffer_load_dwordx4 a[60:63], v11, s[48:51], s52 offen offset:3072 sc1
    s_waitcnt vmcnt(31) lgkmcnt(4)
    v_mfma_f32_32x32x16_bf16 v[128:143], v[64:67], a[192:195], v[128:143]
    ds_read_b64_tr_b16 v[80:81], v20 offset:36864
    ds_read_b64_tr_b16 v[82:83], v20 offset:37888
    s_add_u32 s52, s52, 4096
    v_mfma_f32_32x32x16_bf16 v[144:159], v[68:71], a[192:195], v[144:159]
    ds_read_b64_tr_b16 v[84:85], v21 offset:36864
    ds_read_b64_tr_b16 v[86:87], v21 offset:37888
    buffer_load_dwordx4 a[64:67], v11, s[48:51], s52 offen offset:0 sc1
    s_waitcnt vmcnt(31) lgkmcnt(4)
    v_mfma_f32_32x32x16_bf16 v[128:143], v[72:75], a[196:199], v[128:143]
    ds_read_b64_tr_b16 v[88:89], v20 offset:38912
    ds_read_b64_tr_b16 v[90:91], v20 offset:39936
    v_mfma_f32_32x32x16_bf16 v[144:159], v[76:79], a[196:199], v[144:159]
    ds_read_b64_tr_b16 v[92:93], v21 offset:38912
    ds_read_b64_tr_b16 v[94:95], v21 offset:39936
    buffer_load_dwordx4 a[68:71], v11, s[48:51], s52 offen offset:1024 sc1
    s_waitcnt vmcnt(31) lgkmcnt(4)
    v_mfma_f32_32x32x16_bf16 v[128:143], v[80:83], a[200:203], v[128:143]
    ds_read_b64_tr_b16 v[64:65], v20 offset:40960
    ds_read_b64_tr_b16 v[66:67], v20 offset:41984
    v_mfma_f32_32x32x16_bf16 v[144:159], v[84:87], a[200:203], v[144:159]
    ds_read_b64_tr_b16 v[68:69], v21 offset:40960
    ds_read_b64_tr_b16 v[70:71], v21 offset:41984
    buffer_load_dwordx4 a[72:75], v11, s[48:51], s52 offen offset:2048 sc1
    s_waitcnt vmcnt(31) lgkmcnt(4)
    v_mfma_f32_32x32x16_bf16 v[128:143], v[88:91], a[204:207], v[128:143]
    ds_read_b64_tr_b16 v[72:73], v20 offset:43008
    ds_read_b64_tr_b16 v[74:75], v20 offset:44032
    v_mfma_f32_32x32x16_bf16 v[144:159], v[92:95], a[204:207], v[144:159]
    ds_read_b64_tr_b16 v[76:77], v21 offset:43008
    ds_read_b64_tr_b16 v[78:79], v21 offset:44032
    buffer_load_dwordx4 a[76:79], v11, s[48:51], s52 offen offset:3072 sc1
    s_waitcnt vmcnt(31) lgkmcnt(4)
    v_mfma_f32_32x32x16_bf16 v[128:143], v[64:67], a[208:211], v[128:143]
    ds_read_b64_tr_b16 v[80:81], v20 offset:45056
    ds_read_b64_tr_b16 v[82:83], v20 offset:46080
    s_add_u32 s52, s52, 4096
    v_mfma_f32_32x32x16_bf16 v[144:159], v[68:71], a[208:211], v[144:159]
    ds_read_b64_tr_b16 v[84:85], v21 offset:45056
    ds_read_b64_tr_b16 v[86:87], v21 offset:46080
    buffer_load_dwordx4 a[80:83], v11, s[48:51], s52 offen offset:0 sc1
    s_waitcnt vmcnt(31) lgkmcnt(4)
    v_mfma_f32_32x32x16_bf16 v[128:143], v[72:75], a[212:215], v[128:143]
    ds_read_b64_tr_b16 v[88:89], v20 offset:47104
    ds_read_b64_tr_b16 v[90:91], v20 offset:48128
    v_mfma_f32_32x32x16_bf16 v[144:159], v[76:79], a[212:215], v[144:159]
    ds_read_b64_tr_b16 v[92:93], v21 offset:47104
    ds_read_b64_tr_b16 v[94:95], v21 offset:48128
    buffer_load_dwordx4 a[84:87], v11, s[48:51], s52 offen offset:1024 sc1
    s_waitcnt vmcnt(31) lgkmcnt(4)
    v_mfma_f32_32x32x16_bf16 v[128:143], v[80:83], a[216:219], v[128:143]
    ds_read_b64_tr_b16 v[64:65], v20 offset:49152
    ds_read_b64_tr_b16 v[66:67], v20 offset:50176
    v_mfma_f32_32x32x16_bf16 v[144:159], v[84:87], a[216:219], v[144:159]
    ds_read_b64_tr_b16 v[68:69], v21 offset:49152
    ds_read_b64_tr_b16 v[70:71], v21 offset:50176
    buffer_load_dwordx4 a[88:91], v11, s[48:51], s52 offen offset:2048 sc1
    s_waitcnt vmcnt(31) lgkmcnt(4)
    v_mfma_f32_32x32x16_bf16 v[128:143], v[88:91], a[220:223], v[128:143]
    ds_read_b64_tr_b16 v[72:73], v20 offset:51200
    ds_read_b64_tr_b16 v[74:75], v20 offset:52224
    v_mfma_f32_32x32x16_bf16 v[144:159], v[92:95], a[220:223], v[144:159]
    ds_read_b64_tr_b16 v[76:77], v21 offset:51200
    ds_read_b64_tr_b16 v[78:79], v21 offset:52224
    buffer_load_dwordx4 a[92:95], v11, s[48:51], s52 offen offset:3072 sc1
    s_waitcnt vmcnt(31) lgkmcnt(4)
    v_mfma_f32_32x32x16_bf16 v[128:143], v[64:67], a[224:227], v[128:143]
    ds_read_b64_tr_b16 v[80:81], v20 offset:53248
    ds_read_b64_tr_b16 v[82:83], v20 offset:54272
    s_add_u32 s52, s52, 4096
    v_mfma_f32_32x32x16_bf16 v[144:159], v[68:71], a[224:227], v[144:159]
    ds_read_b64_tr_b16 v[84:85], v21 offset:53248
    ds_read_b64_tr_b16 v[86:87], v21 offset:54272
    buffer_load_dwordx4 a[96:99], v11, s[48:51], s52 offen offset:0 sc1
    s_waitcnt vmcnt(31) lgkmcnt(4)
    v_mfma_f32_32x32x16_bf16 v[128:143], v[72:75], a[228:231], v[128:143]
    ds_read_b64_tr_b16 v[88:89], v20 offset:55296
    ds_read_b64_tr_b16 v[90:91], v20 offset:56320
    v_mfma_f32_32x32x16_bf16 v[144:159], v[76:79], a[228:231], v[144:159]
    ds_read_b64_tr_b16 v[92:93], v21 offset:55296
    ds_read_b64_tr_b16 v[94:95], v21 offset:56320
    buffer_load_dwordx4 a[100:103], v11, s[48:51], s52 offen offset:1024 sc1
    s_waitcnt vmcnt(31) lgkmcnt(4)
    v_mfma_f32_32x32x16_bf16 v[128:143], v[80:83], a[232:235], v[128:143]
    ds_read_b64_tr_b16 v[64:65], v20 offset:57344
    ds_read_b64_tr_b16 v[66:67], v20 offset:58368
    v_mfma_f32_32x32x16_bf16 v[144:159], v[84:87], a[232:235], v[144:159]
    ds_read_b64_tr_b16 v[68:69], v21 offset:57344
    ds_read_b64_tr_b16 v[70:71], v21 offset:58368
    buffer_load_dwordx4 a[104:107], v11, s[48:51], s52 offen offset:2048 sc1
    s_waitcnt vmcnt(31) lgkmcnt(4)
    v_mfma_f32_32x32x16_bf16 v[128:143], v[88:91], a[236:239], v[128:143]
    ds_read_b64_tr_b16 v[72:73], v20 offset:59392
    ds_read_b64_tr_b16 v[74:75], v20 offset:60416
    v_mfma_f32_32x32x16_bf16 v[144:159], v[92:95], a[236:239], v[144:159]
    ds_read_b64_tr_b16 v[76:77], v21 offset:59392
    ds_read_b64_tr_b16 v[78:79], v21 offset:60416
    buffer_load_dwordx4 a[108:111], v11, s[48:51], s52 offen offset:3072 sc1
    s_waitcnt vmcnt(31) lgkmcnt(4)
    v_mfma_f32_32x32x16_bf16 v[128:143], v[64:67], a[240:243], v[128:143]
    ds_read_b64_tr_b16 v[80:81], v20 offset:61440
    ds_read_b64_tr_b16 v[82:83], v20 offset:62464
    s_add_u32 s52, s52, 4096
    v_mfma_f32_32x32x16_bf16 v[144:159], v[68:71], a[240:243], v[144:159]
    ds_read_b64_tr_b16 v[84:85], v21 offset:61440
    ds_read_b64_tr_b16 v[86:87], v21 offset:62464
    buffer_load_dwordx4 a[112:115], v11, s[48:51], s52 offen offset:0 sc1
    s_waitcnt vmcnt(31) lgkmcnt(4)
    v_mfma_f32_32x32x16_bf16 v[128:143], v[72:75], a[244:247], v[128:143]
    ds_read_b64_tr_b16 v[88:89], v20 offset:63488
    ds_read_b64_tr_b16 v[90:91], v20 offset:64512
    v_mfma_f32_32x32x16_bf16 v[144:159], v[76:79], a[244:247], v[144:159]
    ds_read_b64_tr_b16 v[92:93], v21 offset:63488
    ds_read_b64_tr_b16 v[94:95], v21 offset:64512
    buffer_load_dwordx4 a[116:119], v11, s[48:51], s52 offen offset:1024 sc1
    s_waitcnt vmcnt(31) lgkmcnt(4)
    v_mfma_f32_32x32x16_bf16 v[128:143], v[80:83], a[248:251], v[128:143]
    v_add_u32 v20, 0xffff0000, v20
    v_add_u32 v21, 0xffff0000, v21
    ds_read_b64_tr_b16 v[64:65], v20 offset:0
    ds_read_b64_tr_b16 v[66:67], v20 offset:1024
    v_mfma_f32_32x32x16_bf16 v[144:159], v[84:87], a[248:251], v[144:159]
    ds_read_b64_tr_b16 v[68:69], v21 offset:0
    ds_read_b64_tr_b16 v[70:71], v21 offset:1024
    buffer_load_dwordx4 a[120:123], v11, s[48:51], s52 offen offset:2048 sc1
    s_waitcnt vmcnt(31) lgkmcnt(4)
    v_mfma_f32_32x32x16_bf16 v[128:143], v[88:91], a[252:255], v[128:143]
    ds_read_b64_tr_b16 v[72:73], v20 offset:2048
    ds_read_b64_tr_b16 v[74:75], v20 offset:3072
    v_mfma_f32_32x32x16_bf16 v[144:159], v[92:95], a[252:255], v[144:159]
    ds_read_b64_tr_b16 v[76:77], v21 offset:2048
    ds_read_b64_tr_b16 v[78:79], v21 offset:3072
    buffer_load_dwordx4 a[124:127], v11, s[48:51], s52 offen offset:3072 sc1
    s_cmp_eq_u32 s60, 2
    s_cbranch_scc1 WS_T_silu
    v_mov_b32 v192, -1
    v_mov_b32 v193, -1
    v_mov_b32 v194, -1
    v_mov_b32 v195, -1
    buffer_store_dwordx4 v[192:195], v2, s[4:7], s70 offen sc1
    s_add_u32 s70, s70, 0x40000
    v_cvt_pk_bf16_f32 v176, v128, v129
    v_cvt_pk_bf16_f32 v177, v130, v131
    v_cvt_pk_bf16_f32 v178, v132, v133
    v_cvt_pk_bf16_f32 v179, v134, v135
    buffer_store_dwordx4 v[176:179], v2, s[4:7], s66 offen offset:0 sc1
    v_cvt_pk_bf16_f32 v180, v136, v137
    v_cvt_pk_bf16_f32 v181, v138, v139
    v_cvt_pk_bf16_f32 v182, v140, v141
    v_cvt_pk_bf16_f32 v183, v142, v143
    buffer_store_dwordx4 v[180:183], v2, s[4:7], s66 offen offset:1024 sc1
    v_cvt_pk_bf16_f32 v184, v144, v145
    v_cvt_pk_bf16_f32 v185, v146, v147
    v_cvt_pk_bf16_f32 v186, v148, v149
    v_cvt_pk_bf16_f32 v187, v150, v151
    buffer_store_dwordx4 v[184:187], v2, s[4:7], s66 offen offset:2048 sc1
    v_cvt_pk_bf16_f32 v188, v152, v153
    v_cvt_pk_bf16_f32 v189, v154, v155
    v_cvt_pk_bf16_f32 v190, v156, v157
    v_cvt_pk_bf16_f32 v191, v158, v159
    buffer_store_dwordx4 v[188:191], v2, s[4:7], s66 offen offset:3072 sc1
WS_T_adv:
    s_add_u32 s66, s66, s67
    s_mov_b32 s71, s69
    s_sub_u32 s56, 2048, s72
    s_bitcmp1_b32 s73, 0
    s_cselect_b32 s56, s56, s72
    s_add_u32 s69, s69, s56
    s_add_u32 s73, s73, 1
    s_add_u32 s74, s73, 15
    s_lshl_b32 s74, s74, 1
    s_and_b32 s74, s74, 28
    buffer_load_dword v22, off, s[8:11], s74 offset:100 sc1
    s_cmp_lg_u32 s73, s54
    s_cbranch_scc1 WS_T
    s_waitcnt vmcnt(0) lgkmcnt(0)
    s_barrier
    s_cmp_lg_u32 s44, 0
    s_cbranch_scc1 wsl_25
    v_mov_b32 v13, 1
    s_mov_b64 exec, 1
    buffer_store_byte v13, off, s[4:7], s71 sc1
    s_mov_b64 exec, -1
wsl_25:
    s_branch W_NEXT
WS_T_silu:
    v_mul_f32 v160, 0xbfb8aa3b, v128
    v_mul_f32 v161, 0xbfb8aa3b, v129
    v_mul_f32 v162, 0xbfb8aa3b, v130
    v_mul_f32 v163, 0xbfb8aa3b, v131
    v_mul_f32 v164, 0xbfb8aa3b, v132
    v_mul_f32 v165, 0xbfb8aa3b, v133
    v_mul_f32 v166, 0xbfb8aa3b, v134
    v_mul_f32 v167, 0xbfb8aa3b, v135
    v_exp_f32 v160, v160
    v_exp_f32 v161, v161
    v_exp_f32 v162, v162
    v_exp_f32 v163, v163
    v_exp_f32 v164, v164
    v_exp_f32 v165, v165
    v_exp_f32 v166, v166
    v_exp_f32 v167, v167
    v_add_f32 v160, 1.0, v160
    v_add_f32 v161, 1.0, v161
    v_add_f32 v162, 1.0, v162
    v_add_f32 v163, 1.0, v163
    v_add_f32 v164, 1.0, v164
    v_add_f32 v165, 1.0, v165
    v_add_f32 v166, 1.0, v166
    v_add_f32 v167, 1.0, v167
    v_rcp_f32 v160, v160
    v_rcp_f32 v161, v161
    v_rcp_f32 v162, v162
    v_rcp_f32 v163, v163
    v_rcp_f32 v164, v164
    v_rcp_f32 v165, v165
    v_rcp_f32 v166, v166
    v_rcp_f32 v167, v167
    v_mul_f32 v128, v128, v160
    v_mul_f32 v129, v129, v161
    v_mul_f32 v130, v130, v162
    v_mul_f32 v131, v131, v163
    v_mul_f32 v132, v132, v164
    v_mul_f32 v133, v133, v165
    v_mul_f32 v134, v134, v166
    v_mul_f32 v135, v135, v167
    v_cvt_pk_bf16_f32 v176, v128, v129
    v_cvt_pk_bf16_f32 v177, v130, v131
    v_cvt_pk_bf16_f32 v178, v132, v133
    v_cvt_pk_bf16_f32 v179, v134, v135
    buffer_store_dwordx4 v[176:179], v2, s[4:7], s66 offen offset:0 sc1
    v_mul_f32 v168, 0xbfb8aa3b, v136
    v_mul_f32 v169, 0xbfb8aa3b, v137
    v_mul_f32 v170, 0xbfb8aa3b, v138
    v_mul_f32 v171, 0xbfb8aa3b, v139
    v_mul_f32 v172, 0xbfb8aa3b, v140
    v_mul_f32 v173, 0xbfb8aa3b, v141
    v_mul_f32 v174, 0xbfb8aa3b, v142
    v_mul_f32 v175, 0xbfb8aa3b, v143
    v_exp_f32 v168, v168
    v_exp_f32 v169, v169
    v_exp_f32 v170, v170
    v_exp_f32 v171, v171
    v_exp_f32 v172, v172
    v_exp_f32 v173, v173
    v_exp_f32 v174, v174
    v_exp_f32 v175, v175
    v_add_f32 v168, 1.0, v168
    v_add_f32 v169, 1.0, v169
    v_add_f32 v170, 1.0, v170
    v_add_f32 v171, 1.0, v171
    v_add_f32 v172, 1.0, v172
    v_add_f32 v173, 1.0, v173
    v_add_f32 v174, 1.0, v174
    v_add_f32 v175, 1.0, v175
    v_rcp_f32 v168, v168
    v_rcp_f32 v169, v169
    v_rcp_f32 v170, v170
    v_rcp_f32 v171, v171
    v_rcp_f32 v172, v172
    v_rcp_f32 v173, v173
    v_rcp_f32 v174, v174
    v_rcp_f32 v175, v175
    v_mul_f32 v136, v136, v168
    v_mul_f32 v137, v137, v169
    v_mul_f32 v138, v138, v170
    v_mul_f32 v139, v139, v171
    v_mul_f32 v140, v140, v172
    v_mul_f32 v141, v141, v173
    v_mul_f32 v142, v142, v174
    v_mul_f32 v143, v143, v175
    v_cvt_pk_bf16_f32 v180, v136, v137
    v_cvt_pk_bf16_f32 v181, v138, v139
    v_cvt_pk_bf16_f32 v182, v140, v141
    v_cvt_pk_bf16_f32 v183, v142, v143
    buffer_store_dwordx4 v[180:183], v2, s[4:7], s66 offen offset:1024 sc1
    v_mul_f32 v160, 0xbfb8aa3b, v144
    v_mul_f32 v161, 0xbfb8aa3b, v145
    v_mul_f32 v162, 0xbfb8aa3b, v146
    v_mul_f32 v163, 0xbfb8aa3b, v147
    v_mul_f32 v164, 0xbfb8aa3b, v148
    v_mul_f32 v165, 0xbfb8aa3b, v149
    v_mul_f32 v166, 0xbfb8aa3b, v150
    v_mul_f32 v167, 0xbfb8aa3b, v151
    v_exp_f32 v160, v160
    v_exp_f32 v161, v161
    v_exp_f32 v162, v162
    v_exp_f32 v163, v163
    v_exp_f32 v164, v164
    v_exp_f32 v165, v165
    v_exp_f32 v166, v166
    v_exp_f32 v167, v167
    v_add_f32 v160, 1.0, v160
    v_add_f32 v161, 1.0, v161
    v_add_f32 v162, 1.0, v162
    v_add_f32 v163, 1.0, v163
    v_add_f32 v164, 1.0, v164
    v_add_f32 v165, 1.0, v165
    v_add_f32 v166, 1.0, v166
    v_add_f32 v167, 1.0, v167
    v_rcp_f32 v160, v160
    v_rcp_f32 v161, v161
    v_rcp_f32 v162, v162
    v_rcp_f32 v163, v163
    v_rcp_f32 v164, v164
    v_rcp_f32 v165, v165
    v_rcp_f32 v166, v166
    v_rcp_f32 v167, v167
    v_mul_f32 v144, v144, v160
    v_mul_f32 v145, v145, v161
    v_mul_f32 v146, v146, v162
    v_mul_f32 v147, v147, v163
    v_mul_f32 v148, v148, v164
    v_mul_f32 v149, v149, v165
    v_mul_f32 v150, v150, v166
    v_mul_f32 v151, v151, v167
    v_cvt_pk_bf16_f32 v184, v144, v145
    v_cvt_pk_bf16_f32 v185, v146, v147
    v_cvt_pk_bf16_f32 v186, v148, v149
    v_cvt_pk_bf16_f32 v187, v150, v151
    buffer_store_dwordx4 v[184:187], v2, s[4:7], s66 offen offset:2048 sc1
    v_mul_f32 v168, 0xbfb8aa3b, v152
    v_mul_f32 v169, 0xbfb8aa3b, v153
    v_mul_f32 v170, 0xbfb8aa3b, v154
    v_mul_f32 v171, 0xbfb8aa3b, v155
    v_mul_f32 v172, 0xbfb8aa3b, v156
    v_mul_f32 v173, 0xbfb8aa3b, v157
    v_mul_f32 v174, 0xbfb8aa3b, v158
    v_mul_f32 v175, 0xbfb8aa3b, v159
    v_exp_f32 v168, v168
    v_exp_f32 v169, v169
    v_exp_f32 v170, v170
    v_exp_f32 v171, v171
    v_exp_f32 v172, v172
    v_exp_f32 v173, v173
    v_exp_f32 v174, v174
    v_exp_f32 v175, v175
    v_add_f32 v168, 1.0, v168
    v_add_f32 v169, 1.0, v169
    v_add_f32 v170, 1.0, v170
    v_add_f32 v171, 1.0, v171
    v_add_f32 v172, 1.0, v172
    v_add_f32 v173, 1.0, v173
    v_add_f32 v174, 1.0, v174
    v_add_f32 v175, 1.0, v175
    v_rcp_f32 v168, v168
    v_rcp_f32 v169, v169
    v_rcp_f32 v170, v170
    v_rcp_f32 v171, v171
    v_rcp_f32 v172, v172
    v_rcp_f32 v173, v173
    v_rcp_f32 v174, v174
    v_rcp_f32 v175, v175
    v_mul_f32 v152, v152, v168
    v_mul_f32 v153, v153, v169
    v_mul_f32 v154, v154, v170
    v_mul_f32 v155, v155, v171
    v_mul_f32 v156, v156, v172
    v_mul_f32 v157, v157, v173
    v_mul_f32 v158, v158, v174
    v_mul_f32 v159, v159, v175
    v_cvt_pk_bf16_f32 v188, v152, v153
    v_cvt_pk_bf16_f32 v189, v154, v155
    v_cvt_pk_bf16_f32 v190, v156, v157
    v_cvt_pk_bf16_f32 v191, v158, v159
    buffer_store_dwordx4 v[188:191], v2, s[4:7], s66 offen offset:3072 sc1
    s_branch WS_T_adv
WS_T_xn:
    s_mov_b32 s68, 0x80000
wsxn_26:
    buffer_load_dword v22, off, s[8:11], s74 offset:100 sc1
    s_waitcnt vmcnt(0)
    v_cmp_gt_u32 vcc, 32, v22
    s_cbranch_vccz wsxn_26_ok
    s_sub_u32 s68, s68, 1
    s_cmp_lg_u32 s68, 0
    s_cbranch_scc1 wsxn_26
wsxn_26_ok:
    s_branch WS_T_xn_ok
WS_N:
    s_waitcnt vmcnt(31) lgkmcnt(4)
    v_mfma_f32_32x32x16_bf16 v[128:143], a[0:3], v[64:67], 0
    ds_read_b64_tr_b16 v[80:81], v20 offset:4096
    ds_read_b64_tr_b16 v[82:83], v20 offset:5120
    s_add_u32 s52, s52, 4096
    v_mfma_f32_32x32x16_bf16 v[144:159], a[0:3], v[68:71], 0
    ds_read_b64_tr_b16 v[84:85], v21 offset:4096
    ds_read_b64_tr_b16 v[86:87], v21 offset:5120
    buffer_load_dwordx4 a[128:131], v11, s[48:51], s52 offen offset:0 sc1
    s_waitcnt vmcnt(31) lgkmcnt(4)
    v_mfma_f32_32x32x16_bf16 v[128:143], a[4:7], v[72:75], v[128:143]
    ds_read_b64_tr_b16 v[88:89], v20 offset:6144
    ds_read_b64_tr_b16 v[90:91], v20 offset:7168
    v_mfma_f32_32x32x16_bf16 v[144:159], a[4:7], v[76:79], v[144:159]
    ds_read_b64_tr_b16 v[92:93], v21 offset:6144
    ds_read_b64_tr_b16 v[94:95], v21 offset:7168
    buffer_load_dwordx4 a[132:135], v11, s[48:51], s52 offen offset:1024 sc1
    s_waitcnt vmcnt(31) lgkmcnt(4)
    v_mfma_f32_32x32x16_bf16 v[128:143], a[8:11], v[80:83], v[128:143]
    ds_read_b64_tr_b16 v[64:65], v20 offset:8192
    ds_read_b64_tr_b16 v[66:67], v20 offset:9216
    v_mfma_f32_32x32x16_bf16 v[144:159], a[8:11], v[84:87], v[144:159]
    ds_read_b64_tr_b16 v[68:69], v21 offset:8192
    ds_read_b64_tr_b16 v[70:71], v21 offset:9216
    buffer_load_dwordx4 a[136:139], v11, s[48:51], s52 offen offset:2048 sc1
    s_waitcnt vmcnt(31) lgkmcnt(4)
    v_mfma_f32_32x32x16_bf16 v[128:143], a[12:15], v[88:91], v[128:143]
    ds_read_b64_tr_b16 v[72:73], v20 offset:10240
    ds_read_b64_tr_b16 v[74:75], v20 offset:11264
    v_mfma_f32_32x32x16_bf16 v[144:159], a[12:15], v[92:95], v[144:159]
    ds_read_b64_tr_b16 v[76:77], v21 offset:10240
    ds_read_b64_tr_b16 v[78:79], v21 offset:11264
    buffer_load_dwordx4 a[140:143], v11, s[48:51], s52 offen offset:3072 sc1
    s_waitcnt vmcnt(31) lgkmcnt(4)
    v_mfma_f32_32x32x16_bf16 v[128:143], a[16:19], v[64:67], v[128:143]
    ds_read_b64_tr_b16 v[80:81], v20 offset:12288
    ds_read_b64_tr_b16 v[82:83], v20 offset:13312
    s_add_u32 s52, s52, 4096
    v_mfma_f32_32x32x16_bf16 v[144:159], a[16:19], v[68:71], v[144:159]
    ds_read_b64_tr_b16 v[84:85], v21 offset:12288
    ds_read_b64_tr_b16 v[86:87], v21 offset:13312
    buffer_load_dwordx4 a[144:147], v11, s[48:51], s52 offen offset:0 sc1
    s_waitcnt vmcnt(31) lgkmcnt(4)
    v_mfma_f32_32x32x16_bf16 v[128:143], a[20:23], v[72:75], v[128:143]
    ds_read_b64_tr_b16 v[88:89], v20 offset:14336
    ds_read_b64_tr_b16 v[90:91], v20 offset:15360
    v_mfma_f32_32x32x16_bf16 v[144:159], a[20:23], v[76:79], v[144:159]
    ds_read_b64_tr_b16 v[92:93], v21 offset:14336
    ds_read_b64_tr_b16 v[94:95], v21 offset:15360
    buffer_load_dwordx4 a[148:151], v11, s[48:51], s52 offen offset:1024 sc1
    s_waitcnt vmcnt(31) lgkmcnt(4)
    v_mfma_f32_32x32x16_bf16 v[128:143], a[24:27], v[80:83], v[128:143]
    ds_read_b64_tr_b16 v[64:65], v20 offset:16384
    ds_read_b64_tr_b16 v[66:67], v20 offset:17408
    v_mfma_f32_32x32x16_bf16 v[144:159], a[24:27], v[84:87], v[144:159]
    ds_read_b64_tr_b16 v[68:69], v21 offset:16384
    ds_read_b64_tr_b16 v[70:71], v21 offset:17408
    buffer_load_dwordx4 a[152:155], v11, s[48:51], s52 offen offset:2048 sc1
    s_waitcnt vmcnt(31) lgkmcnt(4)
    v_mfma_f32_32x32x16_bf16 v[128:143], a[28:31], v[88:91], v[128:143]
    ds_read_b64_tr_b16 v[72:73], v20 offset:18432
    ds_read_b64_tr_b16 v[74:75], v20 offset:19456
    v_mfma_f32_32x32x16_bf16 v[144:159], a[28:31], v[92:95], v[144:159]
    ds_read_b64_tr_b16 v[76:77], v21 offset:18432
    ds_read_b64_tr_b16 v[78:79], v21 offset:19456
    buffer_load_dwordx4 a[156:159], v11, s[48:51], s52 offen offset:3072 sc1
    s_waitcnt vmcnt(31) lgkmcnt(4)
    v_mfma_f32_32x32x16_bf16 v[128:143], a[32:35], v[64:67], v[128:143]
    ds_read_b64_tr_b16 v[80:81], v20 offset:20480
    ds_read_b64_tr_b16 v[82:83], v20 offset:21504
    s_add_u32 s52, s52, 4096
    v_mfma_f32_32x32x16_bf16 v[144:159], a[32:35], v[68:71], v[144:159]
    ds_read_b64_tr_b16 v[84:85], v21 offset:20480
    ds_read_b64_tr_b16 v[86:87], v21 offset:21504
    buffer_load_dwordx4 a[160:163], v11, s[48:51], s52 offen offset:0 sc1
    s_waitcnt vmcnt(31) lgkmcnt(4)
    v_mfma_f32_32x32x16_bf16 v[128:143], a[36:39], v[72:75], v[128:143]
    ds_read_b64_tr_b16 v[88:89], v20 offset:22528
    ds_read_b64_tr_b16 v[90:91], v20 offset:23552
    v_mfma_f32_32x32x16_bf16 v[144:159], a[36:39], v[76:79], v[144:159]
    ds_read_b64_tr_b16 v[92:93], v21 offset:22528
    ds_read_b64_tr_b16 v[94:95], v21 offset:23552
    buffer_load_dwordx4 a[164:167], v11, s[48:51], s52 offen offset:1024 sc1
    s_waitcnt vmcnt(31) lgkmcnt(4)
    v_mfma_f32_32x32x16_bf16 v[128:143], a[40:43], v[80:83], v[128:143]
    ds_read_b64_tr_b16 v[64:65], v20 offset:24576
    ds_read_b64_tr_b16 v[66:67], v20 offset:25600
    v_mfma_f32_32x32x16_bf16 v[144:159], a[40:43], v[84:87], v[144:159]
    ds_read_b64_tr_b16 v[68:69], v21 offset:24576
    ds_read_b64_tr_b16 v[70:71], v21 offset:25600
    buffer_load_dwordx4 a[168:171], v11, s[48:51], s52 offen offset:2048 sc1
    s_waitcnt vmcnt(31) lgkmcnt(4)
    v_mfma_f32_32x32x16_bf16 v[128:143], a[44:47], v[88:91], v[128:143]
    ds_read_b64_tr_b16 v[72:73], v20 offset:26624
    ds_read_b64_tr_b16 v[74:75], v20 offset:27648
    v_mfma_f32_32x32x16_bf16 v[144:159], a[44:47], v[92:95], v[144:159]
    ds_read_b64_tr_b16 v[76:77], v21 offset:26624
    ds_read_b64_tr_b16 v[78:79], v21 offset:27648
    buffer_load_dwordx4 a[172:175], v11, s[48:51], s52 offen offset:3072 sc1
    s_waitcnt vmcnt(31) lgkmcnt(4)
    v_mfma_f32_32x32x16_bf16 v[128:143], a[48:51], v[64:67], v[128:143]
    ds_read_b64_tr_b16 v[80:81], v20 offset:28672
    ds_read_b64_tr_b16 v[82:83], v20 offset:29696
    s_add_u32 s52, s52, 4096
    v_mfma_f32_32x32x16_bf16 v[144:159], a[48:51], v[68:71], v[144:159]
    ds_read_b64_tr_b16 v[84:85], v21 offset:28672
    ds_read_b64_tr_b16 v[86:87], v21 offset:29696
    buffer_load_dwordx4 a[176:179], v11, s[48:51], s52 offen offset:0 sc1
    s_waitcnt vmcnt(31) lgkmcnt(4)
    v_mfma_f32_32x32x16_bf16 v[128:143], a[52:55], v[72:75], v[128:143]
    ds_read_b64_tr_b16 v[88:89], v20 offset:30720
    ds_read_b64_tr_b16 v[90:91], v20 offset:31744
    v_mfma_f32_32x32x16_bf16 v[144:159], a[52:55], v[76:79], v[144:159]
    ds_read_b64_tr_b16 v[92:93], v21 offset:30720
    ds_read_b64_tr_b16 v[94:95], v21 offset:31744
    buffer_load_dwordx4 a[180:183], v11, s[48:51], s52 offen offset:1024 sc1
    s_waitcnt vmcnt(31) lgkmcnt(4)
    v_mfma_f32_32x32x16_bf16 v[128:143], a[56:59], v[80:83], v[128:143]
    ds_read_b64_tr_b16 v[64:65], v20 offset:32768
    ds_read_b64_tr_b16 v[66:67], v20 offset:33792
    v_mfma_f32_32x32x16_bf16 v[144:159], a[56:59], v[84:87], v[144:159]
    ds_read_b64_tr_b16 v[68:69], v21 offset:32768
    ds_read_b64_tr_b16 v[70:71], v21 offset:33792
    buffer_load_dwordx4 a[184:187], v11, s[48:51], s52 offen offset:2048 sc1
    s_waitcnt vmcnt(31) lgkmcnt(4)
    v_mfma_f32_32x32x16_bf16 v[128:143], a[60:63], v[88:91], v[128:143]
    ds_read_b64_tr_b16 v[72:73], v20 offset:34816
    ds_read_b64_tr_b16 v[74:75], v20 offset:35840
    v_mfma_f32_32x32x16_bf16 v[144:159], a[60:63], v[92:95], v[144:159]
    ds_read_b64_tr_b16 v[76:77], v21 offset:34816
    ds_read_b64_tr_b16 v[78:79], v21 offset:35840
    buffer_load_dwordx4 a[188:191], v11, s[48:51], s52 offen offset:3072 sc1
    s_waitcnt vmcnt(16)
    v_cmp_gt_u32 vcc, 32, v22
    s_cbranch_vccnz WS_N_xn
WS_N_xn_ok:
    s_barrier
    s_cmp_lg_u32 s44, 0
    s_cbranch_scc1 wsf_27
    v_mov_b32 v13, 1
    s_mov_b64 exec, 1
    buffer_store_byte v13, off, s[4:7], s71 sc1
    s_mov_b64 exec, -1
wsf_27:
    s_waitcnt vmcnt(31) lgkmcnt(4)
    v_mfma_f32_32x32x16_bf16 v[128:143], a[64:67], v[64:67], v[128:143]
    ds_read_b64_tr_b16 v[80:81], v20 offset:36864
    ds_read_b64_tr_b16 v[82:83], v20 offset:37888
    s_add_u32 s52, s52, 4096
    v_mfma_f32_32x32x16_bf16 v[144:159], a[64:67], v[68:71], v[144:159]
    ds_read_b64_tr_b16 v[84:85], v21 offset:36864
    ds_read_b64_tr_b16 v[86:87], v21 offset:37888
    buffer_load_dwordx4 a[192:195], v11, s[48:51], s52 offen offset:0 sc1
    s_waitcnt vmcnt(31) lgkmcnt(4)
    v_mfma_f32_32x32x16_bf16 v[128:143], a[68:71], v[72:75], v[128:143]
    ds_read_b64_tr_b16 v[88:89], v20 offset:38912
    ds_read_b64_tr_b16 v[90:91], v20 offset:39936
    v_mfma_f32_32x32x16_bf16 v[144:159], a[68:71], v[76:79], v[144:159]
    ds_read_b64_tr_b16 v[92:93], v21 offset:38912
    ds_read_b64_tr_b16 v[94:95], v21 offset:39936
    buffer_load_dwordx4 a[196:199], v11, s[48:51], s52 offen offset:1024 sc1
    s_waitcnt vmcnt(31) lgkmcnt(4)
    v_mfma_f32_32x32x16_bf16 v[128:143], a[72:75], v[80:83], v[128:143]
    ds_read_b64_tr_b16 v[64:65], v20 offset:40960
    ds_read_b64_tr_b16 v[66:67], v20 offset:41984
    v_mfma_f32_32x32x16_bf16 v[144:159], a[72:75], v[84:87], v[144:159]
    ds_read_b64_tr_b16 v[68:69], v21 offset:40960
    ds_read_b64_tr_b16 v[70:71], v21 offset:41984
    buffer_load_dwordx4 a[200:203], v11, s[48:51], s52 offen offset:2048 sc1
    s_waitcnt vmcnt(31) lgkmcnt(4)
    v_mfma_f32_32x32x16_bf16 v[128:143], a[76:79], v[88:91], v[128:143]
    ds_read_b64_tr_b16 v[72:73], v20 offset:43008
    ds_read_b64_tr_b16 v[74:75], v20 offset:44032
    v_mfma_f32_32x32x16_bf16 v[144:159], a[76:79], v[92:95], v[144:159]
    ds_read_b64_tr_b16 v[76:77], v21 offset:43008
    ds_read_b64_tr_b16 v[78:79], v21 offset:44032
    buffer_load_dwordx4 a[204:207], v11, s[48:51], s52 offen offset:3072 sc1
    s_waitcnt vmcnt(31) lgkmcnt(4)
    v_mfma_f32_32x32x16_bf16 v[128:143], a[80:83], v[64:67], v[128:143]
    ds_read_b64_tr_b16 v[80:81], v20 offset:45056
    ds_read_b64_tr_b16 v[82:83], v20 offset:46080
    s_add_u32 s52, s52, 4096
    v_mfma_f32_32x32x16_bf16 v[144:159], a[80:83], v[68:71], v[144:159]
    ds_read_b64_tr_b16 v[84:85], v21 offset:45056
    ds_read_b64_tr_b16 v[86:87], v21 offset:46080
    buffer_load_dwordx4 a[208:211], v11, s[48:51], s52 offen offset:0 sc1
    s_waitcnt vmcnt(31) lgkmcnt(4)
    v_mfma_f32_32x32x16_bf16 v[128:143], a[84:87], v[72:75], v[128:143]
    ds_read_b64_tr_b16 v[88:89], v20 offset:47104
    ds_read_b64_tr_b16 v[90:91], v20 offset:48128
    v_mfma_f32_32x32x16_bf16 v[144:159], a[84:87], v[76:79], v[144:159]
    ds_read_b64_tr_b16 v[92:93], v21 offset:47104
    ds_read_b64_tr_b16 v[94:95], v21 offset:48128
    buffer_load_dwordx4 a[212:215], v11, s[48:51], s52 offen offset:1024 sc1
    s_waitcnt vmcnt(31) lgkmcnt(4)
    v_mfma_f32_32x32x16_bf16 v[128:143], a[88:91], v[80:83], v[128:143]
    ds_read_b64_tr_b16 v[64:65], v20 offset:49152
    ds_read_b64_tr_b16 v[66:67], v20 offset:50176
    v_mfma_f32_32x32x16_bf16 v[144:159], a[88:91], v[84:87], v[144:159]
    ds_read_b64_tr_b16 v[68:69], v21 offset:49152
    ds_read_b64_tr_b16 v[70:71], v21 offset:50176
    buffer_load_dwordx4 a[216:219], v11, s[48:51], s52 offen offset:2048 sc1
    s_waitcnt vmcnt(31) lgkmcnt(4)
    v_mfma_f32_32x32x16_bf16 v[128:143], a[92:95], v[88:91], v[128:143]
    ds_read_b64_tr_b16 v[72:73], v20 offset:51200
    ds_read_b64_tr_b16 v[74:75], v20 offset:52224
    v_mfma_f32_32x32x16_bf16 v[144:159], a[92:95], v[92:95], v[144:159]
    ds_read_b64_tr_b16 v[76:77], v21 offset:51200
    ds_read_b64_tr_b16 v[78:79], v21 offset:52224
    buffer_load_dwordx4 a[220:223], v11, s[48:51], s52 offen offset:3072 sc1
    s_waitcnt vmcnt(31) lgkmcnt(4)
    v_mfma_f32_32x32x16_bf16 v[128:143], a[96:99], v[64:67], v[128:143]
    ds_read_b64_tr_b16 v[80:81], v20 offset:53248
    ds_read_b64_tr_b16 v[82:83], v20 offset:54272
    s_add_u32 s52, s52, 4096
    v_mfma_f32_32x32x16_bf16 v[144:159], a[96:99], v[68:71], v[144:159]
    ds_read_b64_tr_b16 v[84:85], v21 offset:53248
    ds_read_b64_tr_b16 v[86:87], v21 offset:54272
    buffer_load_dwordx4 a[224:227], v11, s[48:51], s52 offen offset:0 sc1
    s_waitcnt vmcnt(31) lgkmcnt(4)
    v_mfma_f32_32x32x16_bf16 v[128:143], a[100:103], v[72:75], v[128:143]
    ds_read_b64_tr_b16 v[88:89], v20 offset:55296
    ds_read_b64_tr_b16 v[90:91], v20 offset:56320
    v_mfma_f32_32x32x16_bf16 v[144:159], a[100:103], v[76:79], v[144:159]
    ds_read_b64_tr_b16 v[92:93], v21 offset:55296
    ds_read_b64_tr_b16 v[94:95], v21 offset:56320
    buffer_load_dwordx4 a[228:231], v11, s[48:51], s52 offen offset:1024 sc1
    s_waitcnt vmcnt(31) lgkmcnt(4)
    v_mfma_f32_32x32x16_bf16 v[128:143], a[104:107], v[80:83], v[128:143]
    ds_read_b64_tr_b16 v[64:65], v20 offset:57344
    ds_read_b64_tr_b16 v[66:67], v20 offset:58368
    v_mfma_f32_32x32x16_bf16 v[144:159], a[104:107], v[84:87], v[144:159]
    ds_read_b64_tr_b16 v[68:69], v21 offset:57344
    ds_read_b64_tr_b16 v[70:71], v21 offset:58368
    buffer_load_dwordx4 a[232:235], v11, s[48:51], s52 offen offset:2048 sc1
    s_waitcnt vmcnt(31) lgkmcnt(4)
    v_mfma_f32_32x32x16_bf16 v[128:143], a[108:111], v[88:91], v[128:143]
    ds_read_b64_tr_b16 v[72:73], v20 offset:59392
    ds_read_b64_tr_b16 v[74:75], v20 offset:60416
    v_mfma_f32_32x32x16_bf16 v[144:159], a[108:111], v[92:95], v[144:159]
    ds_read_b64_tr_b16 v[76:77], v21 offset:59392
    ds_read_b64_tr_b16 v[78:79], v21 offset:60416
    buffer_load_dwordx4 a[236:239], v11, s[48:51], s52 offen offset:3072 sc1
    s_waitcnt vmcnt(31) lgkmcnt(4)
    v_mfma_f32_32x32x16_bf16 v[128:143], a[112:115], v[64:67], v[128:143]
    ds_read_b64_tr_b16 v[80:81], v20 offset:61440
    ds_read_b64_tr_b16 v[82:83], v20 offset:62464
    s_add_u32 s52, s52, 4096
    v_mfma_f32_32x32x16_bf16 v[144:159], a[112:115], v[68:71], v[144:159]
    ds_read_b64_tr_b16 v[84:85], v21 offset:61440
    ds_read_b64_tr_b16 v[86:87], v21 offset:62464
    buffer_load_dwordx4 a[240:243], v11, s[48:51], s52 offen offset:0 sc1
    s_waitcnt vmcnt(31) lgkmcnt(4)
    v_mfma_f32_32x32x16_bf16 v[128:143], a[116:119], v[72:75], v[128:143]
    ds_read_b64_tr_b16 v[88:89], v20 offset:63488
    ds_read_b64_tr_b16 v[90:91], v20 offset:64512
    v_mfma_f32_32x32x16_bf16 v[144:159], a[116:119], v[76:79], v[144:159]
    ds_read_b64_tr_b16 v[92:93], v21 offset:63488
    ds_read_b64_tr_b16 v[94:95], v21 offset:64512
    buffer_load_dwordx4 a[244:247], v11, s[48:51], s52 offen offset:1024 sc1
    s_waitcnt vmcnt(31) lgkmcnt(4)
    v_mfma_f32_32x32x16_bf16 v[128:143], a[120:123], v[80:83], v[128:143]
    v_add_u32 v20, 0x10000, v20
    v_add_u32 v21, 0x10000, v21
    ds_read_b64_tr_b16 v[64:65], v20 offset:0
    ds_read_b64_tr_b16 v[66:67], v20 offset:1024
    v_mfma_f32_32x32x16_bf16 v[144:159], a[120:123], v[84:87], v[144:159]
    ds_read_b64_tr_b16 v[68:69], v21 offset:0
    ds_read_b64_tr_b16 v[70:71], v21 offset:1024
    buffer_load_dwordx4 a[248:251], v11, s[48:51], s52 offen offset:2048 sc1
    s_waitcnt vmcnt(31) lgkmcnt(4)
    v_mfma_f32_32x32x16_bf16 v[128:143], a[124:127], v[88:91], v[128:143]
    ds_read_b64_tr_b16 v[72:73], v20 offset:2048
    ds_read_b64_tr_b16 v[74:75], v20 offset:3072
    v_mfma_f32_32x32x16_bf16 v[144:159], a[124:127], v[92:95], v[144:159]
    ds_read_b64_tr_b16 v[76:77], v21 offset:2048
    ds_read_b64_tr_b16 v[78:79], v21 offset:3072
    buffer_load_dwordx4 a[252:255], v11, s[48:51], s52 offen offset:3072 sc1
    s_waitcnt vmcnt(31) lgkmcnt(4)
    v_mfma_f32_32x32x16_bf16 v[128:143], a[128:131], v[64:67], v[128:143]
    ds_read_b64_tr_b16 v[80:81], v20 offset:4096
    ds_read_b64_tr_b16 v[82:83], v20 offset:5120
    s_add_u32 s56, s73, 1
    s_cmp_eq_u32 s56, s54
    s_cselect_b32 s50, 0, s50
    s_add_u32 s52, s52, 200704
    v_mfma_f32_32x32x16_bf16 v[144:159], a[128:131], v[68:71], v[144:159]
    ds_read_b64_tr_b16 v[84:85], v21 offset:4096
    ds_read_b64_tr_b16 v[86:87], v21 offset:5120
    buffer_load_dwordx4 a[0:3], v11, s[48:51], s52 offen offset:0 sc1
    s_waitcnt vmcnt(31) lgkmcnt(4)
    v_mfma_f32_32x32x16_bf16 v[128:143], a[132:135], v[72:75], v[128:143]
    ds_read_b64_tr_b16 v[88:89], v20 offset:6144
    ds_read_b64_tr_b16 v[90:91], v20 offset:7168
    v_mfma_f32_32x32x16_bf16 v[144:159], a[132:135], v[76:79], v[144:159]
    ds_read_b64_tr_b16 v[92:93], v21 offset:6144
    ds_read_b64_tr_b16 v[94:95], v21 offset:7168
    buffer_load_dwordx4 a[4:7], v11, s[48:51], s52 offen offset:1024 sc1
    s_waitcnt vmcnt(31) lgkmcnt(4)
    v_mfma_f32_32x32x16_bf16 v[128:143], a[136:139], v[80:83], v[128:143]
    ds_read_b64_tr_b16 v[64:65], v20 offset:8192
    ds_read_b64_tr_b16 v[66:67], v20 offset:9216
    v_mfma_f32_32x32x16_bf16 v[144:159], a[136:139], v[84:87], v[144:159]
    ds_read_b64_tr_b16 v[68:69], v21 offset:8192
    ds_read_b64_tr_b16 v[70:71], v21 offset:9216
    buffer_load_dwordx4 a[8:11], v11, s[48:51], s52 offen offset:2048 sc1
    s_waitcnt vmcnt(31) lgkmcnt(4)
    v_mfma_f32_32x32x16_bf16 v[128:143], a[140:143], v[88:91], v[128:143]
    ds_read_b64_tr_b16 v[72:73], v20 offset:10240
    ds_read_b64_tr_b16 v[74:75], v20 offset:11264
    v_mfma_f32_32x32x16_bf16 v[144:159], a[140:143], v[92:95], v[144:159]
    ds_read_b64_tr_b16 v[76:77], v21 offset:10240
    ds_read_b64_tr_b16 v[78:79], v21 offset:11264
    buffer_load_dwordx4 a[12:15], v11, s[48:51], s52 offen offset:3072 sc1
    s_waitcnt vmcnt(31) lgkmcnt(4)
    v_mfma_f32_32x32x16_bf16 v[128:143], a[144:147], v[64:67], v[128:143]
    ds_read_b64_tr_b16 v[80:81], v20 offset:12288
    ds_read_b64_tr_b16 v[82:83], v20 offset:13312
    s_add_u32 s52, s52, 4096
    v_mfma_f32_32x32x16_bf16 v[144:159], a[144:147], v[68:71], v[144:159]
    ds_read_b64_tr_b16 v[84:85], v21 offset:12288
    ds_read_b64_tr_b16 v[86:87], v21 offset:13312
    buffer_load_dwordx4 a[16:19], v11, s[48:51], s52 offen offset:0 sc1
    s_waitcnt vmcnt(31) lgkmcnt(4)
    v_mfma_f32_32x32x16_bf16 v[128:143], a[148:151], v[72:75], v[128:143]
    ds_read_b64_tr_b16 v[88:89], v20 offset:14336
    ds_read_b64_tr_b16 v[90:91], v20 offset:15360
    v_mfma_f32_32x32x16_bf16 v[144:159], a[148:151], v[76:79], v[144:159]
    ds_read_b64_tr_b16 v[92:93], v21 offset:14336
    ds_read_b64_tr_b16 v[94:95], v21 offset:15360
    buffer_load_dwordx4 a[20:23], v11, s[48:51], s52 offen offset:1024 sc1
    s_waitcnt vmcnt(31) lgkmcnt(4)
    v_mfma_f32_32x32x16_bf16 v[128:143], a[152:155], v[80:83], v[128:143]
    ds_read_b64_tr_b16 v[64:65], v20 offset:16384
    ds_read_b64_tr_b16 v[66:67], v20 offset:17408
    v_mfma_f32_32x32x16_bf16 v[144:159], a[152:155], v[84:87], v[144:159]
    ds_read_b64_tr_b16 v[68:69], v21 offset:16384
    ds_read_b64_tr_b16 v[70:71], v21 offset:17408
    buffer_load_dwordx4 a[24:27], v11, s[48:51], s52 offen offset:2048 sc1
    s_waitcnt vmcnt(31) lgkmcnt(4)
    v_mfma_f32_32x32x16_bf16 v[128:143], a[156:159], v[88:91], v[128:143]
    ds_read_b64_tr_b16 v[72:73], v20 offset:18432
    ds_read_b64_tr_b16 v[74:75], v20 offset:19456
    v_mfma_f32_32x32x16_bf16 v[144:159], a[156:159], v[92:95], v[144:159]
    ds_read_b64_tr_b16 v[76:77], v21 offset:18432
    ds_read_b64_tr_b16 v[78:79], v21 offset:19456
    buffer_load_dwordx4 a[28:31], v11, s[48:51], s52 offen offset:3072 sc1
    s_waitcnt vmcnt(31) lgkmcnt(4)
    v_mfma_f32_32x32x16_bf16 v[128:143], a[160:163], v[64:67], v[128:143]
    ds_read_b64_tr_b16 v[80:81], v20 offset:20480
    ds_read_b64_tr_b16 v[82:83], v20 offset:21504
    s_add_u32 s52, s52, 4096
    v_mfma_f32_32x32x16_bf16 v[144:159], a[160:163], v[68:71], v[144:159]
    ds_read_b64_tr_b16 v[84:85], v21 offset:20480
    ds_read_b64_tr_b16 v[86:87], v21 offset:21504
    buffer_load_dwordx4 a[32:35], v11, s[48:51], s52 offen offset:0 sc1
    s_waitcnt vmcnt(31) lgkmcnt(4)
    v_mfma_f32_32x32x16_bf16 v[128:143], a[164:167], v[72:75], v[128:143]
    ds_read_b64_tr_b16 v[88:89], v20 offset:22528
    ds_read_b64_tr_b16 v[90:91], v20 offset:23552
    v_mfma_f32_32x32x16_bf16 v[144:159], a[164:167], v[76:79], v[144:159]
    ds_read_b64_tr_b16 v[92:93], v21 offset:22528
    ds_read_b64_tr_b16 v[94:95], v21 offset:23552
    buffer_load_dwordx4 a[36:39], v11, s[48:51], s52 offen offset:1024 sc1
    s_waitcnt vmcnt(31) lgkmcnt(4)
    v_mfma_f32_32x32x16_bf16 v[128:143], a[168:171], v[80:83], v[128:143]
    ds_read_b64_tr_b16 v[64:65], v20 offset:24576
    ds_read_b64_tr_b16 v[66:67], v20 offset:25600
    v_mfma_f32_32x32x16_bf16 v[144:159], a[168:171], v[84:87], v[144:159]
    ds_read_b64_tr_b16 v[68:69], v21 offset:24576
    ds_read_b64_tr_b16 v[70:71], v21 offset:25600
    buffer_load_dwordx4 a[40:43], v11, s[48:51], s52 offen offset:2048 sc1
    s_waitcnt vmcnt(31) lgkmcnt(4)
    v_mfma_f32_32x32x16_bf16 v[128:143], a[172:175], v[88:91], v[128:143]
    ds_read_b64_tr_b16 v[72:73], v20 offset:26624
    ds_read_b64_tr_b16 v[74:75], v20 offset:27648
    v_mfma_f32_32x32x16_bf16 v[144:159], a[172:175], v[92:95], v[144:159]
    ds_read_b64_tr_b16 v[76:77], v21 offset:26624
    ds_read_b64_tr_b16 v[78:79], v21 offset:27648
    buffer_load_dwordx4 a[44:47], v11, s[48:51], s52 offen offset:3072 sc1
    s_waitcnt vmcnt(31) lgkmcnt(4)
    v_mfma_f32_32x32x16_bf16 v[128:143], a[176:179], v[64:67], v[128:143]
    ds_read_b64_tr_b16 v[80:81], v20 offset:28672
    ds_read_b64_tr_b16 v[82:83], v20 offset:29696
    s_add_u32 s52, s52, 4096
    v_mfma_f32_32x32x16_bf16 v[144:159], a[176:179], v[68:71], v[144:159]
    ds_read_b64_tr_b16 v[84:85], v21 offset:28672
    ds_read_b64_tr_b16 v[86:87], v21 offset:29696
    buffer_load_dwordx4 a[48:51], v11, s[48:51], s52 offen offset:0 sc1
    s_waitcnt vmcnt(31) lgkmcnt(4)
    v_mfma_f32_32x32x16_bf16 v[128:143], a[180:183], v[72:75], v[128:143]
    ds_read_b64_tr_b16 v[88:89], v20 offset:30720
    ds_read_b64_tr_b16 v[90:91], v20 offset:31744
    v_mfma_f32_32x32x16_bf16 v[144:159], a[180:183], v[76:79], v[144:159]
    ds_read_b64_tr_b16 v[92:93], v21 offset:30720
    ds_read_b64_tr_b16 v[94:95], v21 offset:31744
    buffer_load_dwordx4 a[52:55], v11, s[48:51], s52 offen offset:1024 sc1
    s_waitcnt vmcnt(31) lgkmcnt(4)
    v_mfma_f32_32x32x16_bf16 v[128:143], a[184:187], v[80:83], v[128:143]
    ds_read_b64_tr_b16 v[64:65], v20 offset:32768
    ds_read_b64_tr_b16 v[66:67], v20 offset:33792
    v_mfma_f32_32x32x16_bf16 v[144:159], a[184:187], v[84:87], v[144:159]
    ds_read_b64_tr_b16 v[68:69], v21 offset:32768
    ds_read_b64_tr_b16 v[70:71], v21 offset:33792
    buffer_load_dwordx4 a[56:59], v11, s[48:51], s52 offen offset:2048 sc1
    s_waitcnt vmcnt(31) lgkmcnt(4)
    v_mfma_f32_32x32x16_bf16 v[128:143], a[188:191], v[88:91], v[128:143]
    ds_read_b64_tr_b16 v[72:73], v20 offset:34816
    ds_read_b64_tr_b16 v[74:75], v20 offset:35840
    v_mfma_f32_32x32x16_bf16 v[144:159], a[188:191], v[92:95], v[144:159]
    ds_read_b64_tr_b16 v[76:77], v21 offset:34816
    ds_read_b64_tr_b16 v[78:79], v21 offset:35840
    buffer_load_dwordx4 a[60:63], v11, s[48:51], s52 offen offset:3072 sc1
    s_waitcnt vmcnt(31) lgkmcnt(4)
    v_mfma_f32_32x32x16_bf16 v[128:143], a[192:195], v[64:67], v[128:143]
    ds_read_b64_tr_b16 v[80:81], v20 offset:36864
    ds_read_b64_tr_b16 v[82:83], v20 offset:37888
    s_add_u32 s52, s52, 4096
    v_mfma_f32_32x32x16_bf16 v[144:159], a[192:195], v[68:71], v[144:159]
    ds_read_b64_tr_b16 v[84:85], v21 offset:36864
    ds_read_b64_tr_b16 v[86:87], v21 offset:37888
    buffer_load_dwordx4 a[64:67], v11, s[48:51], s52 offen offset:0 sc1
    s_waitcnt vmcnt(31) lgkmcnt(4)
    v_mfma_f32_32x32x16_bf16 v[128:143], a[196:199], v[72:75], v[128:143]
    ds_read_b64_tr_b16 v[88:89], v20 offset:38912
    ds_read_b64_tr_b16 v[90:91], v20 offset:39936
    v_mfma_f32_32x32x16_bf16 v[144:159], a[196:199], v[76:79], v[144:159]
    ds_read_b64_tr_b16 v[92:93], v21 offset:38912
    ds_read_b64_tr_b16 v[94:95], v21 offset:39936
    buffer_load_dwordx4 a[68:71], v11, s[48:51], s52 offen offset:1024 sc1
    s_waitcnt vmcnt(31) lgkmcnt(4)
    v_mfma_f32_32x32x16_bf16 v[128:143], a[200:203], v[80:83], v[128:143]
    ds_read_b64_tr_b16 v[64:65], v20 offset:40960
    ds_read_b64_tr_b16 v[66:67], v20 offset:41984
    v_mfma_f32_32x32x16_bf16 v[144:159], a[200:203], v[84:87], v[144:159]
    ds_read_b64_tr_b16 v[68:69], v21 offset:40960
    ds_read_b64_tr_b16 v[70:71], v21 offset:41984
    buffer_load_dwordx4 a[72:75], v11, s[48:51], s52 offen offset:2048 sc1
    s_waitcnt vmcnt(31) lgkmcnt(4)
    v_mfma_f32_32x32x16_bf16 v[128:143], a[204:207], v[88:91], v[128:143]
    ds_read_b64_tr_b16 v[72:73], v20 offset:43008
    ds_read_b64_tr_b16 v[74:75], v20 offset:44032
    v_mfma_f32_32x32x16_bf16 v[144:159], a[204:207], v[92:95], v[144:159]
    ds_read_b64_tr_b16 v[76:77], v21 offset:43008
    ds_read_b64_tr_b16 v[78:79], v21 offset:44032
    buffer_load_dwordx4 a[76:79], v11, s[48:51], s52 offen offset:3072 sc1
    s_waitcnt vmcnt(31) lgkmcnt(4)
    v_mfma_f32_32x32x16_bf16 v[128:143], a[208:211], v[64:67], v[128:143]
    ds_read_b64_tr_b16 v[80:81], v20 offset:45056
    ds_read_b64_tr_b16 v[82:83], v20 offset:46080
    s_add_u32 s52, s52, 4096
    v_mfma_f32_32x32x16_bf16 v[144:159], a[208:211], v[68:71], v[144:159]
    ds_read_b64_tr_b16 v[84:85], v21 offset:45056
    ds_read_b64_tr_b16 v[86:87], v21 offset:46080
    buffer_load_dwordx4 a[80:83], v11, s[48:51], s52 offen offset:0 sc1
    s_waitcnt vmcnt(31) lgkmcnt(4)
    v_mfma_f32_32x32x16_bf16 v[128:143], a[212:215], v[72:75], v[128:143]
    ds_read_b64_tr_b16 v[88:89], v20 offset:47104
    ds_read_b64_tr_b16 v[90:91], v20 offset:48128
    v_mfma_f32_32x32x16_bf16 v[144:159], a[212:215], v[76:79], v[144:159]
    ds_read_b64_tr_b16 v[92:93], v21 offset:47104
    ds_read_b64_tr_b16 v[94:95], v21 offset:48128
    buffer_load_dwordx4 a[84:87], v11, s[48:51], s52 offen offset:1024 sc1
    s_waitcnt vmcnt(31) lgkmcnt(4)
    v_mfma_f32_32x32x16_bf16 v[128:143], a[216:219], v[80:83], v[128:143]
    ds_read_b64_tr_b16 v[64:65], v20 offset:49152
    ds_read_b64_tr_b16 v[66:67], v20 offset:50176
    v_mfma_f32_32x32x16_bf16 v[144:159], a[216:219], v[84:87], v[144:159]
    ds_read_b64_tr_b16 v[68:69], v21 offset:49152
    ds_read_b64_tr_b16 v[70:71], v21 offset:50176
    buffer_load_dwordx4 a[88:91], v11, s[48:51], s52 offen offset:2048 sc1
    s_waitcnt vmcnt(31) lgkmcnt(4)
    v_mfma_f32_32x32x16_bf16 v[128:143], a[220:223], v[88:91], v[128:143]
    ds_read_b64_tr_b16 v[72:73], v20 offset:51200
    ds_read_b64_tr_b16 v[74:75], v20 offset:52224
    v_mfma_f32_32x32x16_bf16 v[144:159], a[220:223], v[92:95], v[144:159]
    ds_read_b64_tr_b16 v[76:77], v21 offset:51200
    ds_read_b64_tr_b16 v[78:79], v21 offset:52224
    buffer_load_dwordx4 a[92:95], v11, s[48:51], s52 offen offset:3072 sc1
    s_waitcnt vmcnt(31) lgkmcnt(4)
    v_mfma_f32_32x32x16_bf16 v[128:143], a[224:227], v[64:67], v[128:143]
    ds_read_b64_tr_b16 v[80:81], v20 offset:53248
    ds_read_b64_tr_b16 v[82:83], v20 offset:54272
    s_add_u32 s52, s52, 4096
    v_mfma_f32_32x32x16_bf16 v[144:159], a[224:227], v[68:71], v[144:159]
    ds_read_b64_tr_b16 v[84:85], v21 offset:53248
    ds_read_b64_tr_b16 v[86:87], v21 offset:54272
    buffer_load_dwordx4 a[96:99], v11, s[48:51], s52 offen offset:0 sc1
    s_waitcnt vmcnt(31) lgkmcnt(4)
    v_mfma_f32_32x32x16_bf16 v[128:143], a[228:231], v[72:75], v[128:143]
    ds_read_b64_tr_b16 v[88:89], v20 offset:55296
    ds_read_b64_tr_b16 v[90:91], v20 offset:56320
    v_mfma_f32_32x32x16_bf16 v[144:159], a[228:231], v[76:79], v[144:159]
    ds_read_b64_tr_b16 v[92:93], v21 offset:55296
    ds_read_b64_tr_b16 v[94:95], v21 offset:56320
    buffer_load_dwordx4 a[100:103], v11, s[48:51], s52 offen offset:1024 sc1
    s_waitcnt vmcnt(31) lgkmcnt(4)
    v_mfma_f32_32x32x16_bf16 v[128:143], a[232:235], v[80:83], v[128:143]
    ds_read_b64_tr_b16 v[64:65], v20 offset:57344
    ds_read_b64_tr_b16 v[66:67], v20 offset:58368
    v_mfma_f32_32x32x16_bf16 v[144:159], a[232:235], v[84:87], v[144:159]
    ds_read_b64_tr_b16 v[68:69], v21 offset:57344
    ds_read_b64_tr_b16 v[70:71], v21 offset:58368
    buffer_load_dwordx4 a[104:107], v11, s[48:51], s52 offen offset:2048 sc1
    s_waitcnt vmcnt(31) lgkmcnt(4)
    v_mfma_f32_32x32x16_bf16 v[128:143], a[236:239], v[88:91], v[128:143]
    ds_read_b64_tr_b16 v[72:73], v20 offset:59392
    ds_read_b64_tr_b16 v[74:75], v20 offset:60416
    v_mfma_f32_32x32x16_bf16 v[144:159], a[236:239], v[92:95], v[144:159]
    ds_read_b64_tr_b16 v[76:77], v21 offset:59392
    ds_read_b64_tr_b16 v[78:79], v21 offset:60416
    buffer_load_dwordx4 a[108:111], v11, s[48:51], s52 offen offset:3072 sc1
    s_waitcnt vmcnt(31) lgkmcnt(4)
    v_mfma_f32_32x32x16_bf16 v[128:143], a[240:243], v[64:67], v[128:143]
    ds_read_b64_tr_b16 v[80:81], v20 offset:61440
    ds_read_b64_tr_b16 v[82:83], v20 offset:62464
    s_add_u32 s52, s52, 4096
    v_mfma_f32_32x32x16_bf16 v[144:159], a[240:243], v[68:71], v[144:159]
    ds_read_b64_tr_b16 v[84:85], v21 offset:61440
    ds_read_b64_tr_b16 v[86:87], v21 offset:62464
    buffer_load_dwordx4 a[112:115], v11, s[48:51], s52 offen offset:0 sc1
    s_waitcnt vmcnt(31) lgkmcnt(4)
    v_mfma_f32_32x32x16_bf16 v[128:143], a[244:247], v[72:75], v[128:143]
    ds_read_b64_tr_b16 v[88:89], v20 offset:63488
    ds_read_b64_tr_b16 v[90:91], v20 offset:64512
    v_mfma_f32_32x32x16_bf16 v[144:159], a[244:247], v[76:79], v[144:159]
    ds_read_b64_tr_b16 v[92:93], v21 offset:63488
    ds_read_b64_tr_b16 v[94:95], v21 offset:64512
    buffer_load_dwordx4 a[116:119], v11, s[48:51], s52 offen offset:1024 sc1
    s_waitcnt vmcnt(31) lgkmcnt(4)
    v_mfma_f32_32x32x16_bf16 v[128:143], a[248:251], v[80:83], v[128:143]
    v_add_u32 v20, 0xffff0000, v20
    v_add_u32 v21, 0xffff0000, v21
    ds_read_b64_tr_b16 v[64:65], v20 offset:0
    ds_read_b64_tr_b16 v[66:67], v20 offset:1024
    v_mfma_f32_32x32x16_bf16 v[144:159], a[248:251], v[84:87], v[144:159]
    ds_read_b64_tr_b16 v[68:69], v21 offset:0
    ds_read_b64_tr_b16 v[70:71], v21 offset:1024
    buffer_load_dwordx4 a[120:123], v11, s[48:51], s52 offen offset:2048 sc1
    s_waitcnt vmcnt(31) lgkmcnt(4)
    v_mfma_f32_32x32x16_bf16 v[128:143], a[252:255], v[88:91], v[128:143]
    ds_read_b64_tr_b16 v[72:73], v20 offset:2048
    ds_read_b64_tr_b16 v[74:75], v20 offset:3072
    v_mfma_f32_32x32x16_bf16 v[144:159], a[252:255], v[92:95], v[144:159]
    ds_read_b64_tr_b16 v[76:77], v21 offset:2048
    ds_read_b64_tr_b16 v[78:79], v21 offset:3072
    buffer_load_dwordx4 a[124:127], v11, s[48:51], s52 offen offset:3072 sc1
    v_mov_b32 v192, -1
    v_mov_b32 v193, -1
    v_mov_b32 v194, -1
    v_mov_b32 v195, -1
    buffer_store_dwordx4 v[192:195], v2, s[4:7], s70 offen sc1
    s_add_u32 s70, s70, 0x40000
    v_cvt_pk_bf16_f32 v176, v128, v129
    v_cvt_pk_bf16_f32 v177, v130, v131
    v_cvt_pk_bf16_f32 v178, v132, v133
    v_cvt_pk_bf16_f32 v179, v134, v135
    buffer_store_dwordx4 v[176:179], v2, s[4:7], s66 offen offset:0 sc1
    v_cvt_pk_bf16_f32 v180, v136, v137
    v_cvt_pk_bf16_f32 v181, v138, v139
    v_cvt_pk_bf16_f32 v182, v140, v141
    v_cvt_pk_bf16_f32 v183, v142, v143
    buffer_store_dwordx4 v[180:183], v2, s[4:7], s66 offen offset:1024 sc1
    v_cvt_pk_bf16_f32 v184, v144, v145
    v_cvt_pk_bf16_f32 v185, v146, v147
    v_cvt_pk_bf16_f32 v186, v148, v149
    v_cvt_pk_bf16_f32 v187, v150, v151
    buffer_store_dwordx4 v[184:187], v2, s[4:7], s66 offen offset:2048 sc1
    v_cvt_pk_bf16_f32 v188, v152, v153
    v_cvt_pk_bf16_f32 v189, v154, v155
    v_cvt_pk_bf16_f32 v190, v156, v157
    v_cvt_pk_bf16_f32 v191, v158, v159
    buffer_store_dwordx4 v[188:191], v2, s[4:7], s66 offen offset:3072 sc1
WS_N_adv:
    s_add_u32 s66, s66, s67
    s_mov_b32 s71, s69
    s_sub_u32 s56, 2048, s72
    s_bitcmp1_b32 s73, 0
    s_cselect_b32 s56, s56, s72
    s_add_u32 s69, s69, s56
    s_add_u32 s73, s73, 1
    s_add_u32 s74, s73, 15
    s_lshl_b32 s74, s74, 1
    s_and_b32 s74, s74, 28
    buffer_load_dword v22, off, s[8:11], s74 offset:100 sc1
    s_cmp_lg_u32 s73, s54
    s_cbranch_scc1 WS_N
    s_waitcnt vmcnt(0) lgkmcnt(0)
    s_barrier
    s_cmp_lg_u32 s44, 0
    s_cbranch_scc1 wsl_28
    v_mov_b32 v13, 1
    s_mov_b64 exec, 1
    buffer_store_byte v13, off, s[4:7], s71 sc1
    s_mov_b64 exec, -1
wsl_28:
    s_branch W_NEXT
WS_N_xn:
    s_mov_b32 s68, 0x80000
wsxn_29:
    buffer_load_dword v22, off, s[8:11], s74 offset:100 sc1
    s_waitcnt vmcnt(0)
    v_cmp_gt_u32 vcc, 32, v22
    s_cbranch_vccz wsxn_29_ok
    s_sub_u32 s68, s68, 1
    s_cmp_lg_u32 s68, 0
    s_cbranch_scc1 wsxn_29
wsxn_29_ok:
    s_branch WS_N_xn_ok
W_NEXT:
    s_cmp_lg_u32 s63, 1
    s_cbranch_scc1 W_XP
    s_mov_b32 s68, 0x80000
xp_30:
    buffer_load_dword v13, off, s[8:11], 0 offset:40 sc1
    s_waitcnt vmcnt(0)
    v_cmp_gt_u32 vcc, 1, v13
    s_cbranch_vccz xp_30_ok
    s_sub_u32 s68, s68, 1
    s_cmp_lg_u32 s68, 0
    s_cbranch_scc1 xp_30
xp_30_ok:
    v_readfirstlane_b32 s45, v13
    s_and_b32 s45, s45, 1
    s_xor_b32 s45, s45, 1
    s_lshl_b32 s45, s45, 13
W_XP:
    s_add_u32 s63, s63, 1
    s_lshl_b32 s57, s63, 3
    s_add_u32 s57, s57, s42
    s_cmp_eq_u32 s57, 16
    s_cbranch_scc1 W_T2_0
    s_cmp_eq_u32 s57, 17
    s_cbranch_scc1 W_T2_1
    s_cmp_eq_u32 s57, 18
    s_cbranch_scc1 W_T2_2
    s_cmp_eq_u32 s57, 19
    s_cbranch_scc1 W_T2_3
    s_cmp_eq_u32 s57, 20
    s_cbranch_scc1 W_T2_4
    s_cmp_eq_u32 s57, 21
    s_cbranch_scc1 W_T2_5
    s_cmp_eq_u32 s57, 24
    s_cbranch_scc1 W_T3_0
    s_cmp_eq_u32 s57, 25
    s_cbranch_scc1 W_T3_1
    s_cmp_eq_u32 s57, 32
    s_cbranch_scc1 W_T4_0
    s_cmp_eq_u32 s57, 33
    s_cbranch_scc1 W_T4_1
    s_cmp_eq_u32 s57, 40
    s_cbranch_scc1 W_T5_0
    s_cmp_eq_u32 s57, 41
    s_cbranch_scc1 W_T5_1
    s_cmp_ge_u32 s42, 2
    s_cbranch_scc1 W_WO
    s_branch WDONE
W_T2_0:
    s_mov_b32 s61, 0
    s_mov_b32 s62, s43
    s_branch W_SET_Q
W_T2_1:
    s_mov_b32 s61, 1
    s_mov_b32 s62, s43
    s_branch W_SET_Q
W_T2_2:
    s_lshr_b32 s61, s43, 3
    s_add_u32 s61, s61, 0
    s_and_b32 s62, s43, 7
    s_branch W_SET_YH
W_T2_3:
    s_lshr_b32 s61, s43, 3
    s_add_u32 s61, s61, 4
    s_and_b32 s62, s43, 7
    s_branch W_SET_YH
W_T2_4:
    s_lshr_b32 s61, s43, 3
    s_add_u32 s61, s61, 8
    s_and_b32 s62, s43, 7
    s_branch W_SET_YH
W_T2_5:
    s_lshr_b32 s61, s43, 3
    s_add_u32 s61, s61, 12
    s_and_b32 s62, s43, 7
    s_branch W_SET_YH
W_T3_0:
    s_mov_b32 s61, 2
    s_mov_b32 s62, s43
    s_branch W_SET_Q
W_T3_1:
    s_mov_b32 s61, 3
    s_mov_b32 s62, s43
    s_branch W_SET_Q
W_T4_0:
    s_mov_b32 s61, 4
    s_mov_b32 s62, s43
    s_branch W_SET_Q
W_T4_1:
    s_mov_b32 s61, 5
    s_mov_b32 s62, s43
    s_branch W_SET_Q
W_T5_0:
    s_mov_b32 s61, 6
    s_mov_b32 s62, s43
    s_branch W_SET_Q
W_T5_1:
    s_mov_b32 s61, 7
    s_mov_b32 s62, s43
    s_branch W_SET_Q
W_KV:
    s_bitcmp1_b32 s62, 0
    s_cselect_b32 s56, 1, 0
    s_lshr_b32 s62, s62, 1
    s_cmp_eq_u32 s56, 1
    s_cbranch_scc1 W_SET_V
    s_branch W_SET_K
W_SET_H:
    s_mov_b32 s60, 2
    s_mov_b32 s12, s32
    s_and_b32 s13, s33, 0xffff
    s_mov_b32 s14, 0x700000
    s_mov_b32 s15, 0x20000
    s_mov_b32 s50, 0x10000000
    s_mov_b32 s54, 458752
    s_mov_b32 s55, 4
    s_lshl_b32 s69, s61, 3
    s_lshl_b32 s56, s44, 1
    s_add_u32 s69, s69, s56
    s_mul_i32 s56, s69, 65536
    s_add_u32 s56, s56, 0x0
    v_add_u32 v11, s56, v2
    v_add_u32 v12, 65536, v11
    s_mul_i32 s66, s69, 229376
    s_mul_i32 s56, s62, 8192
    s_add_u32 s66, s66, s56
    s_add_u32 s66, s66, 0x3c00000
    s_mov_b32 s67, 229376
    s_lshl_b32 s56, s62, 8
    v_mul_u32_u24 v13, 7168, v16
    v_add3_u32 v7, v13, v15, s56
    v_add_u32 v8, 27648, v7
    v_add_u32 v9, 55296, v7
    v_add_u32 v10, 82944, v7
    s_mov_b32 s52, 0
    s_mov_b32 s53, 0
    s_cmp_gt_u32 s63, 2
    s_cbranch_scc1 xnw_31
    s_cmp_lg_u32 s44, 0
    s_cbranch_scc1 xnw_31
    v_and_b32 v14, 28, v1
    s_mov_b32 s68, 0x80000
xn_32:
    buffer_load_dword v13, v14, s[8:11], 0 offen offset:100 sc1
    s_waitcnt vmcnt(0)
    v_cmp_gt_u32 vcc, 32, v13
    s_cbranch_vccz xn_32_ok
    s_sub_u32 s68, s68, 1
    s_cmp_lg_u32 s68, 0
    s_cbranch_scc1 xn_32
xn_32_ok:
xnw_31:
    s_barrier
    s_branch W_GT
W_SET_K:
    s_mov_b32 s60, 0
    s_mov_b32 s12, s22
    s_and_b32 s13, s23, 0xffff
    s_mov_b32 s14, 0x800000
    s_mov_b32 s15, 0x20000
    s_mov_b32 s50, 0x10000000
    s_mov_b32 s54, 524288
    s_mov_b32 s55, 4
    s_lshl_b32 s69, s61, 3
    s_lshl_b32 s56, s44, 1
    s_add_u32 s69, s69, s56
    s_mul_i32 s56, s69, 65536
    s_add_u32 s56, s56, 0x0
    v_add_u32 v11, s56, v2
    v_add_u32 v12, 65536, v11
    s_mul_i32 s66, s69, 262144
    s_mul_i32 s56, s62, 8192
    s_add_u32 s66, s66, s56
    s_add_u32 s66, s66, 0x400000
    s_mov_b32 s67, 262144
    s_lshl_b32 s56, s62, 8
    v_mul_u32_u24 v13, 8192, v16
    v_add3_u32 v7, v13, v15, s56
    v_add_u32 v8, 31744, v7
    v_add_u32 v9, 63488, v7
    v_add_u32 v10, 95232, v7
    s_mov_b32 s52, 0
    s_mov_b32 s53, 0
    v_mov_b32 v64, -1
    v_mov_b32 v65, -1
    v_mov_b32 v66, -1
    v_mov_b32 v67, -1
    s_lshl_b32 s56, s69, 16
    s_lshl_b32 s57, s62, 11
    s_add_u32 s56, s56, s57
    s_add_u32 s56, s56, 0x2400000
    s_add_u32 s57, s56, 0x10000
    buffer_store_dwordx4 v[64:67], v2, s[4:7], s56 offen offset:0 sc1
    buffer_store_dwordx4 v[64:67], v2, s[4:7], s56 offen offset:1024 sc1
    buffer_store_dwordx4 v[64:67], v2, s[4:7], s57 offen offset:0 sc1
    buffer_store_dwordx4 v[64:67], v2, s[4:7], s57 offen offset:1024 sc1
    s_cmp_gt_u32 s63, 2
    s_cbranch_scc1 xnw_33
    s_cmp_lg_u32 s44, 0
    s_cbranch_scc1 xnw_33
    v_and_b32 v14, 28, v1
    s_mov_b32 s68, 0x80000
xn_34:
    buffer_load_dword v13, v14, s[8:11], 0 offen offset:100 sc1
    s_waitcnt vmcnt(0)
    v_cmp_gt_u32 vcc, 32, v13
    s_cbranch_vccz xn_34_ok
    s_sub_u32 s68, s68, 1
    s_cmp_lg_u32 s68, 0
    s_cbranch_scc1 xn_34
xn_34_ok:
xnw_33:
    s_barrier
    s_branch W_GT
W_SET_Q:
    s_mov_b32 s60, 4
    s_mov_b32 s12, s20
    s_and_b32 s13, s21, 0xffff
    s_mov_b32 s14, 0x800000
    s_mov_b32 s15, 0x20000
    s_mov_b32 s50, 0x10000000
    s_mov_b32 s54, 524288
    s_mov_b32 s55, 4
    s_lshl_b32 s69, s61, 3
    s_add_u32 s69, s69, s44
    s_mul_i32 s56, s69, 65536
    s_add_u32 s56, s56, 0x0
    v_add_u32 v11, s56, v2
    v_add_u32 v12, 262144, v11
    s_mul_i32 s66, s69, 262144
    s_mul_i32 s56, s62, 8192
    s_add_u32 s66, s66, s56
    s_add_u32 s66, s66, 0x2c00000
    s_mov_b32 s67, 262144
    s_lshl_b32 s56, s62, 8
    v_mul_u32_u24 v13, 8192, v16
    v_add3_u32 v7, v13, v15, s56
    v_add_u32 v8, 31744, v7
    v_add_u32 v9, 63488, v7
    v_add_u32 v10, 95232, v7
    s_mov_b32 s52, 0
    s_mov_b32 s53, 0
    s_barrier
    s_branch W_GT
W_SET_Y:
    s_mov_b32 s60, 3
    s_mov_b32 s12, s34
    s_and_b32 s13, s35, 0xffff
    s_mov_b32 s14, 0x700000
    s_mov_b32 s15, 0x20000
    s_mov_b32 s50, 0x10000000
    s_mov_b32 s54, 131072
    s_mov_b32 s55, 14
    s_lshl_b32 s69, s61, 3
    s_lshl_b32 s56, s44, 1
    s_add_u32 s69, s69, s56
    s_mul_i32 s56, s69, 229376
    s_add_u32 s56, s56, 0x3c00000
    v_add_u32 v11, s56, v2
    v_add_u32 v12, 229376, v11
    s_mul_i32 s66, s69, 65536
    s_mul_i32 s56, s62, 8192
    s_add_u32 s66, s66, s56
    s_add_u32 s66, s66, 0x4a00000
    s_mov_b32 s67, 65536
    s_lshl_b32 s56, s62, 8
    v_mul_u32_u24 v13, 2048, v16
    v_add3_u32 v7, v13, v15, s56
    v_add_u32 v8, 7168, v7
    v_add_u32 v9, 14336, v7
    v_add_u32 v10, 21504, v7
    s_mov_b32 s52, 0
    s_mov_b32 s53, 0
    s_lshl_b32 s56, s61, 11
    s_add_u32 s56, s56, 0x5200030
    v_min_u32 v14, 27, v1
    v_lshlrev_b32 v14, 6, v14
    s_cmp_lg_u32 s44, 0
    s_cbranch_scc1 hwait_35
    s_mov_b32 s68, 0x80000
hwait_36:
    buffer_load_dword v13, v14, s[4:7], s56 offen sc1
    s_waitcnt vmcnt(0)
    v_cmp_gt_u32 vcc, 16843009, v13
    s_cbranch_vccz hwait_36_ok
    s_sub_u32 s68, s68, 1
    s_cmp_lg_u32 s68, 0
    s_cbranch_scc1 hwait_36
hwait_36_ok:
hwait_35:
    s_barrier
    s_branch W_GT
W_SET_V:
    s_mov_b32 s60, 1
    s_mov_b32 s12, s24
    s_and_b32 s13, s25, 0xffff
    s_mov_b32 s14, 0x800000
    s_mov_b32 s15, 0x20000
    s_mov_b32 s50, 0x10000000
    s_mov_b32 s54, 524288
    s_mov_b32 s55, 4
    s_lshl_b32 s69, s61, 3
    s_lshl_b32 s56, s44, 1
    s_add_u32 s69, s69, s56
    s_mul_i32 s56, s69, 65536
    s_add_u32 s56, s56, 0x0
    v_add_u32 v11, s56, v2
    v_add_u32 v12, 65536, v11
    s_mul_i32 s66, s69, 262144
    s_mul_i32 s56, s62, 8192
    s_add_u32 s66, s66, s56
    s_add_u32 s66, s66, 0x1400000
    s_mov_b32 s67, 262144
    s_lshl_b32 s56, s62, 8
    v_mul_u32_u24 v13, 8192, v16
    v_add3_u32 v7, v13, v15, s56
    v_add_u32 v8, 31744, v7
    v_add_u32 v9, 63488, v7
    v_add_u32 v10, 95232, v7
    s_mov_b32 s52, 0
    s_mov_b32 s53, 0
    v_mov_b32 v64, -1
    v_mov_b32 v65, -1
    v_mov_b32 v66, -1
    v_mov_b32 v67, -1
    s_lshl_b32 s56, s69, 16
    s_lshl_b32 s57, s62, 11
    s_add_u32 s56, s56, s57
    s_add_u32 s56, s56, 0x2800000
    s_add_u32 s57, s56, 0x10000
    buffer_store_dwordx4 v[64:67], v2, s[4:7], s56 offen offset:0 sc1
    buffer_store_dwordx4 v[64:67], v2, s[4:7], s56 offen offset:1024 sc1
    buffer_store_dwordx4 v[64:67], v2, s[4:7], s57 offen offset:0 sc1
    buffer_store_dwordx4 v[64:67], v2, s[4:7], s57 offen offset:1024 sc1
    s_cmp_gt_u32 s63, 2
    s_cbranch_scc1 xnw_37
    s_cmp_lg_u32 s44, 0
    s_cbranch_scc1 xnw_37
    v_and_b32 v14, 28, v1
    s_mov_b32 s68, 0x80000
xn_38:
    buffer_load_dword v13, v14, s[8:11], 0 offen offset:100 sc1
    s_waitcnt vmcnt(0)
    v_cmp_gt_u32 vcc, 32, v13
    s_cbranch_vccz xn_38_ok
    s_sub_u32 s68, s68, 1
    s_cmp_lg_u32 s68, 0
    s_cbranch_scc1 xn_38
xn_38_ok:
xnw_37:
    s_barrier
    s_add_u32 m0, s64, 0
    buffer_load_dwordx4 a[0:3], v11, s[48:51], s52 offen offset:0 sc1
    buffer_load_dwordx4 a[4:7], v12, s[48:51], s52 offen offset:0 sc1
    buffer_load_dwordx4 v7, s[12:15], s53 offen offset:0 lds
    buffer_load_dwordx4 a[8:11], v11, s[48:51], s52 offen offset:1024 sc1
    buffer_load_dwordx4 a[12:15], v12, s[48:51], s52 offen offset:1024 sc1
    buffer_load_dwordx4 v8, s[12:15], s53 offen offset:1024 lds
    buffer_load_dwordx4 a[16:19], v11, s[48:51], s52 offen offset:2048 sc1
    buffer_load_dwordx4 a[20:23], v12, s[48:51], s52 offen offset:2048 sc1
    buffer_load_dwordx4 v9, s[12:15], s53 offen offset:2048 lds
    buffer_load_dwordx4 a[24:27], v11, s[48:51], s52 offen offset:3072 sc1
    buffer_load_dwordx4 a[28:31], v12, s[48:51], s52 offen offset:3072 sc1
    buffer_load_dwordx4 v10, s[12:15], s53 offen offset:3072 lds
    s_add_u32 s52, s52, 4096
    s_add_u32 s53, s53, s54
    s_add_u32 m0, s64, 16384
    buffer_load_dwordx4 a[32:35], v11, s[48:51], s52 offen offset:0 sc1
    buffer_load_dwordx4 a[36:39], v12, s[48:51], s52 offen offset:0 sc1
    buffer_load_dwordx4 v7, s[12:15], s53 offen offset:0 lds
    buffer_load_dwordx4 a[40:43], v11, s[48:51], s52 offen offset:1024 sc1
    buffer_load_dwordx4 a[44:47], v12, s[48:51], s52 offen offset:1024 sc1
    buffer_load_dwordx4 v8, s[12:15], s53 offen offset:1024 lds
    buffer_load_dwordx4 a[48:51], v11, s[48:51], s52 offen offset:2048 sc1
    buffer_load_dwordx4 a[52:55], v12, s[48:51], s52 offen offset:2048 sc1
    buffer_load_dwordx4 v9, s[12:15], s53 offen offset:2048 lds
    buffer_load_dwordx4 a[56:59], v11, s[48:51], s52 offen offset:3072 sc1
    buffer_load_dwordx4 a[60:63], v12, s[48:51], s52 offen offset:3072 sc1
    buffer_load_dwordx4 v10, s[12:15], s53 offen offset:3072 lds
    s_add_u32 s52, s52, 4096
    s_add_u32 s53, s53, s54
    s_add_u32 m0, s64, 32768
    buffer_load_dwordx4 a[64:67], v11, s[48:51], s52 offen offset:0 sc1
    buffer_load_dwordx4 a[68:71], v12, s[48:51], s52 offen offset:0 sc1
    buffer_load_dwordx4 v7, s[12:15], s53 offen offset:0 lds
    buffer_load_dwordx4 a[72:75], v11, s[48:51], s52 offen offset:1024 sc1
    buffer_load_dwordx4 a[76:79], v12, s[48:51], s52 offen offset:1024 sc1
    buffer_load_dwordx4 v8, s[12:15], s53 offen offset:1024 lds
    buffer_load_dwordx4 a[80:83], v11, s[48:51], s52 offen offset:2048 sc1
    buffer_load_dwordx4 a[84:87], v12, s[48:51], s52 offen offset:2048 sc1
    buffer_load_dwordx4 v9, s[12:15], s53 offen offset:2048 lds
    buffer_load_dwordx4 a[88:91], v11, s[48:51], s52 offen offset:3072 sc1
    buffer_load_dwordx4 a[92:95], v12, s[48:51], s52 offen offset:3072 sc1
    buffer_load_dwordx4 v10, s[12:15], s53 offen offset:3072 lds
    s_add_u32 s52, s52, 4096
    s_add_u32 s53, s53, s54
    v_mov_b32 v128, 0
    v_mov_b32 v129, 0
    v_mov_b32 v130, 0
    v_mov_b32 v131, 0
    v_mov_b32 v132, 0
    v_mov_b32 v133, 0
    v_mov_b32 v134, 0
    v_mov_b32 v135, 0
    v_mov_b32 v136, 0
    v_mov_b32 v137, 0
    v_mov_b32 v138, 0
    v_mov_b32 v139, 0
    v_mov_b32 v140, 0
    v_mov_b32 v141, 0
    v_mov_b32 v142, 0
    v_mov_b32 v143, 0
    v_mov_b32 v144, 0
    v_mov_b32 v145, 0
    v_mov_b32 v146, 0
    v_mov_b32 v147, 0
    v_mov_b32 v148, 0
    v_mov_b32 v149, 0
    v_mov_b32 v150, 0
    v_mov_b32 v151, 0
    v_mov_b32 v152, 0
    v_mov_b32 v153, 0
    v_mov_b32 v154, 0
    v_mov_b32 v155, 0
    v_mov_b32 v156, 0
    v_mov_b32 v157, 0
    v_mov_b32 v158, 0
    v_mov_b32 v159, 0
    v_mov_b32 v160, 0
    v_mov_b32 v161, 0
    v_mov_b32 v162, 0
    v_mov_b32 v163, 0
    v_mov_b32 v164, 0
    v_mov_b32 v165, 0
    v_mov_b32 v166, 0
    v_mov_b32 v167, 0
    v_mov_b32 v168, 0
    v_mov_b32 v169, 0
    v_mov_b32 v170, 0
    v_mov_b32 v171, 0
    v_mov_b32 v172, 0
    v_mov_b32 v173, 0
    v_mov_b32 v174, 0
    v_mov_b32 v175, 0
    v_mov_b32 v176, 0
    v_mov_b32 v177, 0
    v_mov_b32 v178, 0
    v_mov_b32 v179, 0
    v_mov_b32 v180, 0
    v_mov_b32 v181, 0
    v_mov_b32 v182, 0
    v_mov_b32 v183, 0
    v_mov_b32 v184, 0
    v_mov_b32 v185, 0
    v_mov_b32 v186, 0
    v_mov_b32 v187, 0
    v_mov_b32 v188, 0
    v_mov_b32 v189, 0
    v_mov_b32 v190, 0
    v_mov_b32 v191, 0
    v_mov_b32 v192, 0
    v_mov_b32 v193, 0
    v_mov_b32 v194, 0
    v_mov_b32 v195, 0
    v_mov_b32 v196, 0
    v_mov_b32 v197, 0
    v_mov_b32 v198, 0
    v_mov_b32 v199, 0
    v_mov_b32 v200, 0
    v_mov_b32 v201, 0
    v_mov_b32 v202, 0
    v_mov_b32 v203, 0
    v_mov_b32 v204, 0
    v_mov_b32 v205, 0
    v_mov_b32 v206, 0
    v_mov_b32 v207, 0
    v_mov_b32 v208, 0
    v_mov_b32 v209, 0
    v_mov_b32 v210, 0
    v_mov_b32 v211, 0
    v_mov_b32 v212, 0
    v_mov_b32 v213, 0
    v_mov_b32 v214, 0
    v_mov_b32 v215, 0
    v_mov_b32 v216, 0
    v_mov_b32 v217, 0
    v_mov_b32 v218, 0
    v_mov_b32 v219, 0
    v_mov_b32 v220, 0
    v_mov_b32 v221, 0
    v_mov_b32 v222, 0
    v_mov_b32 v223, 0
    v_mov_b32 v224, 0
    v_mov_b32 v225, 0
    v_mov_b32 v226, 0
    v_mov_b32 v227, 0
    v_mov_b32 v228, 0
    v_mov_b32 v229, 0
    v_mov_b32 v230, 0
    v_mov_b32 v231, 0
    v_mov_b32 v232, 0
    v_mov_b32 v233, 0
    v_mov_b32 v234, 0
    v_mov_b32 v235, 0
    v_mov_b32 v236, 0
    v_mov_b32 v237, 0
    v_mov_b32 v238, 0
    v_mov_b32 v239, 0
    v_mov_b32 v240, 0
    v_mov_b32 v241, 0
    v_mov_b32 v242, 0
    v_mov_b32 v243, 0
    v_mov_b32 v244, 0
    v_mov_b32 v245, 0
    v_mov_b32 v246, 0
    v_mov_b32 v247, 0
    v_mov_b32 v248, 0
    v_mov_b32 v249, 0
    v_mov_b32 v250, 0
    v_mov_b32 v251, 0
    v_mov_b32 v252, 0
    v_mov_b32 v253, 0
    v_mov_b32 v254, 0
    v_mov_b32 v255, 0
    s_waitcnt vmcnt(24)
    s_barrier
    ds_read_b64_tr_b16 v[64:65], v3 offset:0
    ds_read_b64_tr_b16 v[66:67], v3 offset:2048
    ds_read_b64_tr_b16 v[68:69], v4 offset:0
    ds_read_b64_tr_b16 v[70:71], v4 offset:2048
    ds_read_b64_tr_b16 v[72:73], v5 offset:0
    ds_read_b64_tr_b16 v[74:75], v5 offset:2048
    ds_read_b64_tr_b16 v[76:77], v6 offset:0
    ds_read_b64_tr_b16 v[78:79], v6 offset:2048
W_LOOP_N2:
    s_waitcnt lgkmcnt(0)
    v_mfma_f32_32x32x16_bf16 v[128:143], a[0:3], v[64:67], v[128:143]
    ds_read_b64_tr_b16 v[80:81], v3 offset:4096
    ds_read_b64_tr_b16 v[82:83], v3 offset:6144
    v_mfma_f32_32x32x16_bf16 v[192:207], a[4:7], v[64:67], v[192:207]
    ds_read_b64_tr_b16 v[84:85], v4 offset:4096
    ds_read_b64_tr_b16 v[86:87], v4 offset:6144
    v_mfma_f32_32x32x16_bf16 v[144:159], a[0:3], v[68:71], v[144:159]
    ds_read_b64_tr_b16 v[88:89], v5 offset:4096
    ds_read_b64_tr_b16 v[90:91], v5 offset:6144
    v_mfma_f32_32x32x16_bf16 v[208:223], a[4:7], v[68:71], v[208:223]
    ds_read_b64_tr_b16 v[92:93], v6 offset:4096
    ds_read_b64_tr_b16 v[94:95], v6 offset:6144
    s_add_u32 m0, s64, 49152
    v_mfma_f32_32x32x16_bf16 v[160:175], a[0:3], v[72:75], v[160:175]
    v_mfma_f32_32x32x16_bf16 v[224:239], a[4:7], v[72:75], v[224:239]
    buffer_load_dwordx4 a[96:99], v11, s[48:51], s52 offen offset:0 sc1
    v_mfma_f32_32x32x16_bf16 v[176:191], a[0:3], v[76:79], v[176:191]
    buffer_load_dwordx4 a[100:103], v12, s[48:51], s52 offen offset:0 sc1
    v_mfma_f32_32x32x16_bf16 v[240:255], a[4:7], v[76:79], v[240:255]
    buffer_load_dwordx4 v7, s[12:15], s53 offen offset:0 lds
    s_waitcnt lgkmcnt(0)
    v_mfma_f32_32x32x16_bf16 v[128:143], a[8:11], v[80:83], v[128:143]
    ds_read_b64_tr_b16 v[64:65], v3 offset:8192
    ds_read_b64_tr_b16 v[66:67], v3 offset:10240
    v_mfma_f32_32x32x16_bf16 v[192:207], a[12:15], v[80:83], v[192:207]
    ds_read_b64_tr_b16 v[68:69], v4 offset:8192
    ds_read_b64_tr_b16 v[70:71], v4 offset:10240
    v_mfma_f32_32x32x16_bf16 v[144:159], a[8:11], v[84:87], v[144:159]
    ds_read_b64_tr_b16 v[72:73], v5 offset:8192
    ds_read_b64_tr_b16 v[74:75], v5 offset:10240
    v_mfma_f32_32x32x16_bf16 v[208:223], a[12:15], v[84:87], v[208:223]
    ds_read_b64_tr_b16 v[76:77], v6 offset:8192
    ds_read_b64_tr_b16 v[78:79], v6 offset:10240
    v_mfma_f32_32x32x16_bf16 v[160:175], a[8:11], v[88:91], v[160:175]
    v_mfma_f32_32x32x16_bf16 v[224:239], a[12:15], v[88:91], v[224:239]
    buffer_load_dwordx4 a[104:107], v11, s[48:51], s52 offen offset:1024 sc1
    v_mfma_f32_32x32x16_bf16 v[176:191], a[8:11], v[92:95], v[176:191]
    buffer_load_dwordx4 a[108:111], v12, s[48:51], s52 offen offset:1024 sc1
    v_mfma_f32_32x32x16_bf16 v[240:255], a[12:15], v[92:95], v[240:255]
    buffer_load_dwordx4 v8, s[12:15], s53 offen offset:1024 lds
    s_waitcnt lgkmcnt(0)
    v_mfma_f32_32x32x16_bf16 v[128:143], a[16:19], v[64:67], v[128:143]
    ds_read_b64_tr_b16 v[80:81], v3 offset:12288
    ds_read_b64_tr_b16 v[82:83], v3 offset:14336
    v_mfma_f32_32x32x16_bf16 v[192:207], a[20:23], v[64:67], v[192:207]
    ds_read_b64_tr_b16 v[84:85], v4 offset:12288
    ds_read_b64_tr_b16 v[86:87], v4 offset:14336
    v_mfma_f32_32x32x16_bf16 v[144:159], a[16:19], v[68:71], v[144:159]
    ds_read_b64_tr_b16 v[88:89], v5 offset:12288
    ds_read_b64_tr_b16 v[90:91], v5 offset:14336
    v_mfma_f32_32x32x16_bf16 v[208:223], a[20:23], v[68:71], v[208:223]
    ds_read_b64_tr_b16 v[92:93], v6 offset:12288
    ds_read_b64_tr_b16 v[94:95], v6 offset:14336
    v_mfma_f32_32x32x16_bf16 v[160:175], a[16:19], v[72:75], v[160:175]
    v_mfma_f32_32x32x16_bf16 v[224:239], a[20:23], v[72:75], v[224:239]
    buffer_load_dwordx4 a[112:115], v11, s[48:51], s52 offen offset:2048 sc1
    v_mfma_f32_32x32x16_bf16 v[176:191], a[16:19], v[76:79], v[176:191]
    buffer_load_dwordx4 a[116:119], v12, s[48:51], s52 offen offset:2048 sc1
    v_mfma_f32_32x32x16_bf16 v[240:255], a[20:23], v[76:79], v[240:255]
    buffer_load_dwordx4 v9, s[12:15], s53 offen offset:2048 lds
    s_waitcnt lgkmcnt(0)
    v_mfma_f32_32x32x16_bf16 v[128:143], a[24:27], v[80:83], v[128:143]
    s_waitcnt vmcnt(21)
    s_barrier
    v_mfma_f32_32x32x16_bf16 v[192:207], a[28:31], v[80:83], v[192:207]
    ds_read_b64_tr_b16 v[64:65], v3 offset:16384
    ds_read_b64_tr_b16 v[66:67], v3 offset:18432
    v_mfma_f32_32x32x16_bf16 v[144:159], a[24:27], v[84:87], v[144:159]
    ds_read_b64_tr_b16 v[68:69], v4 offset:16384
    ds_read_b64_tr_b16 v[70:71], v4 offset:18432
    v_mfma_f32_32x32x16_bf16 v[208:223], a[28:31], v[84:87], v[208:223]
    ds_read_b64_tr_b16 v[72:73], v5 offset:16384
    ds_read_b64_tr_b16 v[74:75], v5 offset:18432
    v_mfma_f32_32x32x16_bf16 v[160:175], a[24:27], v[88:91], v[160:175]
    ds_read_b64_tr_b16 v[76:77], v6 offset:16384
    ds_read_b64_tr_b16 v[78:79], v6 offset:18432
    v_mfma_f32_32x32x16_bf16 v[224:239], a[28:31], v[88:91], v[224:239]
    buffer_load_dwordx4 a[120:123], v11, s[48:51], s52 offen offset:3072 sc1
    v_mfma_f32_32x32x16_bf16 v[176:191], a[24:27], v[92:95], v[176:191]
    buffer_load_dwordx4 a[124:127], v12, s[48:51], s52 offen offset:3072 sc1
    v_mfma_f32_32x32x16_bf16 v[240:255], a[28:31], v[92:95], v[240:255]
    buffer_load_dwordx4 v10, s[12:15], s53 offen offset:3072 lds
    s_add_u32 s52, s52, 4096
    s_add_u32 s53, s53, s54
    s_waitcnt lgkmcnt(0)
    v_mfma_f32_32x32x16_bf16 v[128:143], a[32:35], v[64:67], v[128:143]
    ds_read_b64_tr_b16 v[80:81], v3 offset:20480
    ds_read_b64_tr_b16 v[82:83], v3 offset:22528
    s_cmp_eq_u32 s55, 1
    v_mfma_f32_32x32x16_bf16 v[192:207], a[36:39], v[64:67], v[192:207]
    ds_read_b64_tr_b16 v[84:85], v4 offset:20480
    ds_read_b64_tr_b16 v[86:87], v4 offset:22528
    s_cselect_b32 s50, 0, s50
    v_mfma_f32_32x32x16_bf16 v[144:159], a[32:35], v[68:71], v[144:159]
    ds_read_b64_tr_b16 v[88:89], v5 offset:20480
    ds_read_b64_tr_b16 v[90:91], v5 offset:22528
    s_cselect_b32 s14, 0, s14
    v_mfma_f32_32x32x16_bf16 v[208:223], a[36:39], v[68:71], v[208:223]
    ds_read_b64_tr_b16 v[92:93], v6 offset:20480
    ds_read_b64_tr_b16 v[94:95], v6 offset:22528
    s_add_u32 m0, s64, 0
    v_mfma_f32_32x32x16_bf16 v[160:175], a[32:35], v[72:75], v[160:175]
    v_mfma_f32_32x32x16_bf16 v[224:239], a[36:39], v[72:75], v[224:239]
    buffer_load_dwordx4 a[0:3], v11, s[48:51], s52 offen offset:0 sc1
    v_mfma_f32_32x32x16_bf16 v[176:191], a[32:35], v[76:79], v[176:191]
    buffer_load_dwordx4 a[4:7], v12, s[48:51], s52 offen offset:0 sc1
    v_mfma_f32_32x32x16_bf16 v[240:255], a[36:39], v[76:79], v[240:255]
    buffer_load_dwordx4 v7, s[12:15], s53 offen offset:0 lds
    s_waitcnt lgkmcnt(0)
    v_mfma_f32_32x32x16_bf16 v[128:143], a[40:43], v[80:83], v[128:143]
    ds_read_b64_tr_b16 v[64:65], v3 offset:24576
    ds_read_b64_tr_b16 v[66:67], v3 offset:26624
    v_mfma_f32_32x32x16_bf16 v[192:207], a[44:47], v[80:83], v[192:207]
    ds_read_b64_tr_b16 v[68:69], v4 offset:24576
    ds_read_b64_tr_b16 v[70:71], v4 offset:26624
    v_mfma_f32_32x32x16_bf16 v[144:159], a[40:43], v[84:87], v[144:159]
    ds_read_b64_tr_b16 v[72:73], v5 offset:24576
    ds_read_b64_tr_b16 v[74:75], v5 offset:26624
    v_mfma_f32_32x32x16_bf16 v[208:223], a[44:47], v[84:87], v[208:223]
    ds_read_b64_tr_b16 v[76:77], v6 offset:24576
    ds_read_b64_tr_b16 v[78:79], v6 offset:26624
    v_mfma_f32_32x32x16_bf16 v[160:175], a[40:43], v[88:91], v[160:175]
    v_mfma_f32_32x32x16_bf16 v[224:239], a[44:47], v[88:91], v[224:239]
    buffer_load_dwordx4 a[8:11], v11, s[48:51], s52 offen offset:1024 sc1
    v_mfma_f32_32x32x16_bf16 v[176:191], a[40:43], v[92:95], v[176:191]
    buffer_load_dwordx4 a[12:15], v12, s[48:51], s52 offen offset:1024 sc1
    v_mfma_f32_32x32x16_bf16 v[240:255], a[44:47], v[92:95], v[240:255]
    buffer_load_dwordx4 v8, s[12:15], s53 offen offset:1024 lds
    s_waitcnt lgkmcnt(0)
    v_mfma_f32_32x32x16_bf16 v[128:143], a[48:51], v[64:67], v[128:143]
    ds_read_b64_tr_b16 v[80:81], v3 offset:28672
    ds_read_b64_tr_b16 v[82:83], v3 offset:30720
    v_mfma_f32_32x32x16_bf16 v[192:207], a[52:55], v[64:67], v[192:207]
    ds_read_b64_tr_b16 v[84:85], v4 offset:28672
    ds_read_b64_tr_b16 v[86:87], v4 offset:30720
    v_mfma_f32_32x32x16_bf16 v[144:159], a[48:51], v[68:71], v[144:159]
    ds_read_b64_tr_b16 v[88:89], v5 offset:28672
    ds_read_b64_tr_b16 v[90:91], v5 offset:30720
    v_mfma_f32_32x32x16_bf16 v[208:223], a[52:55], v[68:71], v[208:223]
    ds_read_b64_tr_b16 v[92:93], v6 offset:28672
    ds_read_b64_tr_b16 v[94:95], v6 offset:30720
    v_mfma_f32_32x32x16_bf16 v[160:175], a[48:51], v[72:75], v[160:175]
    v_mfma_f32_32x32x16_bf16 v[224:239], a[52:55], v[72:75], v[224:239]
    buffer_load_dwordx4 a[16:19], v11, s[48:51], s52 offen offset:2048 sc1
    v_mfma_f32_32x32x16_bf16 v[176:191], a[48:51], v[76:79], v[176:191]
    buffer_load_dwordx4 a[20:23], v12, s[48:51], s52 offen offset:2048 sc1
    v_mfma_f32_32x32x16_bf16 v[240:255], a[52:55], v[76:79], v[240:255]
    buffer_load_dwordx4 v9, s[12:15], s53 offen offset:2048 lds
    s_waitcnt lgkmcnt(0)
    v_mfma_f32_32x32x16_bf16 v[128:143], a[56:59], v[80:83], v[128:143]
    s_waitcnt vmcnt(21)
    s_barrier
    v_mfma_f32_32x32x16_bf16 v[192:207], a[60:63], v[80:83], v[192:207]
    ds_read_b64_tr_b16 v[64:65], v3 offset:32768
    ds_read_b64_tr_b16 v[66:67], v3 offset:34816
    v_mfma_f32_32x32x16_bf16 v[144:159], a[56:59], v[84:87], v[144:159]
    ds_read_b64_tr_b16 v[68:69], v4 offset:32768
    ds_read_b64_tr_b16 v[70:71], v4 offset:34816
    v_mfma_f32_32x32x16_bf16 v[208:223], a[60:63], v[84:87], v[208:223]
    ds_read_b64_tr_b16 v[72:73], v5 offset:32768
    ds_read_b64_tr_b16 v[74:75], v5 offset:34816
    v_mfma_f32_32x32x16_bf16 v[160:175], a[56:59], v[88:91], v[160:175]
    ds_read_b64_tr_b16 v[76:77], v6 offset:32768
    ds_read_b64_tr_b16 v[78:79], v6 offset:34816
    v_mfma_f32_32x32x16_bf16 v[224:239], a[60:63], v[88:91], v[224:239]
    buffer_load_dwordx4 a[24:27], v11, s[48:51], s52 offen offset:3072 sc1
    v_mfma_f32_32x32x16_bf16 v[176:191], a[56:59], v[92:95], v[176:191]
    buffer_load_dwordx4 a[28:31], v12, s[48:51], s52 offen offset:3072 sc1
    v_mfma_f32_32x32x16_bf16 v[240:255], a[60:63], v[92:95], v[240:255]
    buffer_load_dwordx4 v10, s[12:15], s53 offen offset:3072 lds
    s_add_u32 s52, s52, 4096
    s_add_u32 s53, s53, s54
    s_waitcnt lgkmcnt(0)
    v_mfma_f32_32x32x16_bf16 v[128:143], a[64:67], v[64:67], v[128:143]
    ds_read_b64_tr_b16 v[80:81], v3 offset:36864
    ds_read_b64_tr_b16 v[82:83], v3 offset:38912
    v_mfma_f32_32x32x16_bf16 v[192:207], a[68:71], v[64:67], v[192:207]
    ds_read_b64_tr_b16 v[84:85], v4 offset:36864
    ds_read_b64_tr_b16 v[86:87], v4 offset:38912
    v_mfma_f32_32x32x16_bf16 v[144:159], a[64:67], v[68:71], v[144:159]
    ds_read_b64_tr_b16 v[88:89], v5 offset:36864
    ds_read_b64_tr_b16 v[90:91], v5 offset:38912
    v_mfma_f32_32x32x16_bf16 v[208:223], a[68:71], v[68:71], v[208:223]
    ds_read_b64_tr_b16 v[92:93], v6 offset:36864
    ds_read_b64_tr_b16 v[94:95], v6 offset:38912
    s_add_u32 m0, s64, 16384
    v_mfma_f32_32x32x16_bf16 v[160:175], a[64:67], v[72:75], v[160:175]
    v_mfma_f32_32x32x16_bf16 v[224:239], a[68:71], v[72:75], v[224:239]
    buffer_load_dwordx4 a[32:35], v11, s[48:51], s52 offen offset:0 sc1
    v_mfma_f32_32x32x16_bf16 v[176:191], a[64:67], v[76:79], v[176:191]
    buffer_load_dwordx4 a[36:39], v12, s[48:51], s52 offen offset:0 sc1
    v_mfma_f32_32x32x16_bf16 v[240:255], a[68:71], v[76:79], v[240:255]
    buffer_load_dwordx4 v7, s[12:15], s53 offen offset:0 lds
    s_waitcnt lgkmcnt(0)
    v_mfma_f32_32x32x16_bf16 v[128:143], a[72:75], v[80:83], v[128:143]
    ds_read_b64_tr_b16 v[64:65], v3 offset:40960
    ds_read_b64_tr_b16 v[66:67], v3 offset:43008
    v_mfma_f32_32x32x16_bf16 v[192:207], a[76:79], v[80:83], v[192:207]
    ds_read_b64_tr_b16 v[68:69], v4 offset:40960
    ds_read_b64_tr_b16 v[70:71], v4 offset:43008
    v_mfma_f32_32x32x16_bf16 v[144:159], a[72:75], v[84:87], v[144:159]
    ds_read_b64_tr_b16 v[72:73], v5 offset:40960
    ds_read_b64_tr_b16 v[74:75], v5 offset:43008
    v_mfma_f32_32x32x16_bf16 v[208:223], a[76:79], v[84:87], v[208:223]
    ds_read_b64_tr_b16 v[76:77], v6 offset:40960
    ds_read_b64_tr_b16 v[78:79], v6 offset:43008
    v_mfma_f32_32x32x16_bf16 v[160:175], a[72:75], v[88:91], v[160:175]
    v_mfma_f32_32x32x16_bf16 v[224:239], a[76:79], v[88:91], v[224:239]
    buffer_load_dwordx4 a[40:43], v11, s[48:51], s52 offen offset:1024 sc1
    v_mfma_f32_32x32x16_bf16 v[176:191], a[72:75], v[92:95], v[176:191]
    buffer_load_dwordx4 a[44:47], v12, s[48:51], s52 offen offset:1024 sc1
    v_mfma_f32_32x32x16_bf16 v[240:255], a[76:79], v[92:95], v[240:255]
    buffer_load_dwordx4 v8, s[12:15], s53 offen offset:1024 lds
    s_waitcnt lgkmcnt(0)
    v_mfma_f32_32x32x16_bf16 v[128:143], a[80:83], v[64:67], v[128:143]
    ds_read_b64_tr_b16 v[80:81], v3 offset:45056
    ds_read_b64_tr_b16 v[82:83], v3 offset:47104
    v_mfma_f32_32x32x16_bf16 v[192:207], a[84:87], v[64:67], v[192:207]
    ds_read_b64_tr_b16 v[84:85], v4 offset:45056
    ds_read_b64_tr_b16 v[86:87], v4 offset:47104
    v_mfma_f32_32x32x16_bf16 v[144:159], a[80:83], v[68:71], v[144:159]
    ds_read_b64_tr_b16 v[88:89], v5 offset:45056
    ds_read_b64_tr_b16 v[90:91], v5 offset:47104
    v_mfma_f32_32x32x16_bf16 v[208:223], a[84:87], v[68:71], v[208:223]
    ds_read_b64_tr_b16 v[92:93], v6 offset:45056
    ds_read_b64_tr_b16 v[94:95], v6 offset:47104
    v_mfma_f32_32x32x16_bf16 v[160:175], a[80:83], v[72:75], v[160:175]
    v_mfma_f32_32x32x16_bf16 v[224:239], a[84:87], v[72:75], v[224:239]
    buffer_load_dwordx4 a[48:51], v11, s[48:51], s52 offen offset:2048 sc1
    v_mfma_f32_32x32x16_bf16 v[176:191], a[80:83], v[76:79], v[176:191]
    buffer_load_dwordx4 a[52:55], v12, s[48:51], s52 offen offset:2048 sc1
    v_mfma_f32_32x32x16_bf16 v[240:255], a[84:87], v[76:79], v[240:255]
    buffer_load_dwordx4 v9, s[12:15], s53 offen offset:2048 lds
    s_waitcnt lgkmcnt(0)
    v_mfma_f32_32x32x16_bf16 v[128:143], a[88:91], v[80:83], v[128:143]
    s_waitcnt vmcnt(21)
    s_barrier
    v_mfma_f32_32x32x16_bf16 v[192:207], a[92:95], v[80:83], v[192:207]
    ds_read_b64_tr_b16 v[64:65], v3 offset:49152
    ds_read_b64_tr_b16 v[66:67], v3 offset:51200
    v_mfma_f32_32x32x16_bf16 v[144:159], a[88:91], v[84:87], v[144:159]
    ds_read_b64_tr_b16 v[68:69], v4 offset:49152
    ds_read_b64_tr_b16 v[70:71], v4 offset:51200
    v_mfma_f32_32x32x16_bf16 v[208:223], a[92:95], v[84:87], v[208:223]
    ds_read_b64_tr_b16 v[72:73], v5 offset:49152
    ds_read_b64_tr_b16 v[74:75], v5 offset:51200
    v_mfma_f32_32x32x16_bf16 v[160:175], a[88:91], v[88:91], v[160:175]
    ds_read_b64_tr_b16 v[76:77], v6 offset:49152
    ds_read_b64_tr_b16 v[78:79], v6 offset:51200
    v_mfma_f32_32x32x16_bf16 v[224:239], a[92:95], v[88:91], v[224:239]
    buffer_load_dwordx4 a[56:59], v11, s[48:51], s52 offen offset:3072 sc1
    v_mfma_f32_32x32x16_bf16 v[176:191], a[88:91], v[92:95], v[176:191]
    buffer_load_dwordx4 a[60:63], v12, s[48:51], s52 offen offset:3072 sc1
    v_mfma_f32_32x32x16_bf16 v[240:255], a[92:95], v[92:95], v[240:255]
    buffer_load_dwordx4 v10, s[12:15], s53 offen offset:3072 lds
    s_add_u32 s52, s52, 4096
    s_add_u32 s53, s53, s54
    s_waitcnt lgkmcnt(0)
    v_mfma_f32_32x32x16_bf16 v[128:143], a[96:99], v[64:67], v[128:143]
    ds_read_b64_tr_b16 v[80:81], v3 offset:53248
    ds_read_b64_tr_b16 v[82:83], v3 offset:55296
    v_mfma_f32_32x32x16_bf16 v[192:207], a[100:103], v[64:67], v[192:207]
    ds_read_b64_tr_b16 v[84:85], v4 offset:53248
    ds_read_b64_tr_b16 v[86:87], v4 offset:55296
    v_mfma_f32_32x32x16_bf16 v[144:159], a[96:99], v[68:71], v[144:159]
    ds_read_b64_tr_b16 v[88:89], v5 offset:53248
    ds_read_b64_tr_b16 v[90:91], v5 offset:55296
    v_mfma_f32_32x32x16_bf16 v[208:223], a[100:103], v[68:71], v[208:223]
    ds_read_b64_tr_b16 v[92:93], v6 offset:53248
    ds_read_b64_tr_b16 v[94:95], v6 offset:55296
    s_add_u32 m0, s64, 32768
    v_mfma_f32_32x32x16_bf16 v[160:175], a[96:99], v[72:75], v[160:175]
    v_mfma_f32_32x32x16_bf16 v[224:239], a[100:103], v[72:75], v[224:239]
    buffer_load_dwordx4 a[64:67], v11, s[48:51], s52 offen offset:0 sc1
    v_mfma_f32_32x32x16_bf16 v[176:191], a[96:99], v[76:79], v[176:191]
    buffer_load_dwordx4 a[68:71], v12, s[48:51], s52 offen offset:0 sc1
    v_mfma_f32_32x32x16_bf16 v[240:255], a[100:103], v[76:79], v[240:255]
    buffer_load_dwordx4 v7, s[12:15], s53 offen offset:0 lds
    s_waitcnt lgkmcnt(0)
    v_mfma_f32_32x32x16_bf16 v[128:143], a[104:107], v[80:83], v[128:143]
    ds_read_b64_tr_b16 v[64:65], v3 offset:57344
    ds_read_b64_tr_b16 v[66:67], v3 offset:59392
    v_mfma_f32_32x32x16_bf16 v[192:207], a[108:111], v[80:83], v[192:207]
    ds_read_b64_tr_b16 v[68:69], v4 offset:57344
    ds_read_b64_tr_b16 v[70:71], v4 offset:59392
    v_mfma_f32_32x32x16_bf16 v[144:159], a[104:107], v[84:87], v[144:159]
    ds_read_b64_tr_b16 v[72:73], v5 offset:57344
    ds_read_b64_tr_b16 v[74:75], v5 offset:59392
    v_mfma_f32_32x32x16_bf16 v[208:223], a[108:111], v[84:87], v[208:223]
    ds_read_b64_tr_b16 v[76:77], v6 offset:57344
    ds_read_b64_tr_b16 v[78:79], v6 offset:59392
    v_mfma_f32_32x32x16_bf16 v[160:175], a[104:107], v[88:91], v[160:175]
    v_mfma_f32_32x32x16_bf16 v[224:239], a[108:111], v[88:91], v[224:239]
    buffer_load_dwordx4 a[72:75], v11, s[48:51], s52 offen offset:1024 sc1
    v_mfma_f32_32x32x16_bf16 v[176:191], a[104:107], v[92:95], v[176:191]
    buffer_load_dwordx4 a[76:79], v12, s[48:51], s52 offen offset:1024 sc1
    v_mfma_f32_32x32x16_bf16 v[240:255], a[108:111], v[92:95], v[240:255]
    buffer_load_dwordx4 v8, s[12:15], s53 offen offset:1024 lds
    s_waitcnt lgkmcnt(0)
    v_mfma_f32_32x32x16_bf16 v[128:143], a[112:115], v[64:67], v[128:143]
    ds_read_b64_tr_b16 v[80:81], v3 offset:61440
    ds_read_b64_tr_b16 v[82:83], v3 offset:63488
    v_mfma_f32_32x32x16_bf16 v[192:207], a[116:119], v[64:67], v[192:207]
    ds_read_b64_tr_b16 v[84:85], v4 offset:61440
    ds_read_b64_tr_b16 v[86:87], v4 offset:63488
    v_mfma_f32_32x32x16_bf16 v[144:159], a[112:115], v[68:71], v[144:159]
    ds_read_b64_tr_b16 v[88:89], v5 offset:61440
    ds_read_b64_tr_b16 v[90:91], v5 offset:63488
    v_mfma_f32_32x32x16_bf16 v[208:223], a[116:119], v[68:71], v[208:223]
    ds_read_b64_tr_b16 v[92:93], v6 offset:61440
    ds_read_b64_tr_b16 v[94:95], v6 offset:63488
    v_mfma_f32_32x32x16_bf16 v[160:175], a[112:115], v[72:75], v[160:175]
    v_mfma_f32_32x32x16_bf16 v[224:239], a[116:119], v[72:75], v[224:239]
    buffer_load_dwordx4 a[80:83], v11, s[48:51], s52 offen offset:2048 sc1
    v_mfma_f32_32x32x16_bf16 v[176:191], a[112:115], v[76:79], v[176:191]
    buffer_load_dwordx4 a[84:87], v12, s[48:51], s52 offen offset:2048 sc1
    v_mfma_f32_32x32x16_bf16 v[240:255], a[116:119], v[76:79], v[240:255]
    buffer_load_dwordx4 v9, s[12:15], s53 offen offset:2048 lds
    s_waitcnt lgkmcnt(0)
    v_mfma_f32_32x32x16_bf16 v[128:143], a[120:123], v[80:83], v[128:143]
    s_waitcnt vmcnt(21)
    s_barrier
    v_mfma_f32_32x32x16_bf16 v[192:207], a[124:127], v[80:83], v[192:207]
    ds_read_b64_tr_b16 v[64:65], v3 offset:0
    ds_read_b64_tr_b16 v[66:67], v3 offset:2048
    v_mfma_f32_32x32x16_bf16 v[144:159], a[120:123], v[84:87], v[144:159]
    ds_read_b64_tr_b16 v[68:69], v4 offset:0
    ds_read_b64_tr_b16 v[70:71], v4 offset:2048
    v_mfma_f32_32x32x16_bf16 v[208:223], a[124:127], v[84:87], v[208:223]
    ds_read_b64_tr_b16 v[72:73], v5 offset:0
    ds_read_b64_tr_b16 v[74:75], v5 offset:2048
    v_mfma_f32_32x32x16_bf16 v[160:175], a[120:123], v[88:91], v[160:175]
    ds_read_b64_tr_b16 v[76:77], v6 offset:0
    ds_read_b64_tr_b16 v[78:79], v6 offset:2048
    v_mfma_f32_32x32x16_bf16 v[224:239], a[124:127], v[88:91], v[224:239]
    buffer_load_dwordx4 a[88:91], v11, s[48:51], s52 offen offset:3072 sc1
    v_mfma_f32_32x32x16_bf16 v[176:191], a[120:123], v[92:95], v[176:191]
    buffer_load_dwordx4 a[92:95], v12, s[48:51], s52 offen offset:3072 sc1
    s_sub_u32 s55, s55, 1
    v_mfma_f32_32x32x16_bf16 v[240:255], a[124:127], v[92:95], v[240:255]
    buffer_load_dwordx4 v10, s[12:15], s53 offen offset:3072 lds
    s_add_u32 s52, s52, 4096
    s_add_u32 s53, s53, s54
    s_cmp_lg_u32 s55, 0
    s_cbranch_scc1 W_LOOP_N2
    s_waitcnt lgkmcnt(0)
    s_branch W_EP_ST
W_GT:
    s_add_u32 m0, s64, 0
    buffer_load_dwordx4 a[0:3], v11, s[48:51], s52 offen offset:0 sc1
    buffer_load_dwordx4 a[4:7], v12, s[48:51], s52 offen offset:0 sc1
    buffer_load_dwordx4 v7, s[12:15], s53 offen offset:0 lds
    buffer_load_dwordx4 a[8:11], v11, s[48:51], s52 offen offset:1024 sc1
    buffer_load_dwordx4 a[12:15], v12, s[48:51], s52 offen offset:1024 sc1
    buffer_load_dwordx4 v8, s[12:15], s53 offen offset:1024 lds
    buffer_load_dwordx4 a[16:19], v11, s[48:51], s52 offen offset:2048 sc1
    buffer_load_dwordx4 a[20:23], v12, s[48:51], s52 offen offset:2048 sc1
    buffer_load_dwordx4 v9, s[12:15], s53 offen offset:2048 lds
    buffer_load_dwordx4 a[24:27], v11, s[48:51], s52 offen offset:3072 sc1
    buffer_load_dwordx4 a[28:31], v12, s[48:51], s52 offen offset:3072 sc1
    buffer_load_dwordx4 v10, s[12:15], s53 offen offset:3072 lds
    s_add_u32 s52, s52, 4096
    s_add_u32 s53, s53, s54
    s_add_u32 m0, s64, 16384
    buffer_load_dwordx4 a[32:35], v11, s[48:51], s52 offen offset:0 sc1
    buffer_load_dwordx4 a[36:39], v12, s[48:51], s52 offen offset:0 sc1
    buffer_load_dwordx4 v7, s[12:15], s53 offen offset:0 lds
    buffer_load_dwordx4 a[40:43], v11, s[48:51], s52 offen offset:1024 sc1
    buffer_load_dwordx4 a[44:47], v12, s[48:51], s52 offen offset:1024 sc1
    buffer_load_dwordx4 v8, s[12:15], s53 offen offset:1024 lds
    buffer_load_dwordx4 a[48:51], v11, s[48:51], s52 offen offset:2048 sc1
    buffer_load_dwordx4 a[52:55], v12, s[48:51], s52 offen offset:2048 sc1
    buffer_load_dwordx4 v9, s[12:15], s53 offen offset:2048 lds
    buffer_load_dwordx4 a[56:59], v11, s[48:51], s52 offen offset:3072 sc1
    buffer_load_dwordx4 a[60:63], v12, s[48:51], s52 offen offset:3072 sc1
    buffer_load_dwordx4 v10, s[12:15], s53 offen offset:3072 lds
    s_add_u32 s52, s52, 4096
    s_add_u32 s53, s53, s54
    s_add_u32 m0, s64, 32768
    buffer_load_dwordx4 a[64:67], v11, s[48:51], s52 offen offset:0 sc1
    buffer_load_dwordx4 a[68:71], v12, s[48:51], s52 offen offset:0 sc1
    buffer_load_dwordx4 v7, s[12:15], s53 offen offset:0 lds
    buffer_load_dwordx4 a[72:75], v11, s[48:51], s52 offen offset:1024 sc1
    buffer_load_dwordx4 a[76:79], v12, s[48:51], s52 offen offset:1024 sc1
    buffer_load_dwordx4 v8, s[12:15], s53 offen offset:1024 lds
    buffer_load_dwordx4 a[80:83], v11, s[48:51], s52 offen offset:2048 sc1
    buffer_load_dwordx4 a[84:87], v12, s[48:51], s52 offen offset:2048 sc1
    buffer_load_dwordx4 v9, s[12:15], s53 offen offset:2048 lds
    buffer_load_dwordx4 a[88:91], v11, s[48:51], s52 offen offset:3072 sc1
    buffer_load_dwordx4 a[92:95], v12, s[48:51], s52 offen offset:3072 sc1
    buffer_load_dwordx4 v10, s[12:15], s53 offen offset:3072 lds
    s_add_u32 s52, s52, 4096
    s_add_u32 s53, s53, s54
    v_mov_b32 v128, 0
    v_mov_b32 v129, 0
    v_mov_b32 v130, 0
    v_mov_b32 v131, 0
    v_mov_b32 v132, 0
    v_mov_b32 v133, 0
    v_mov_b32 v134, 0
    v_mov_b32 v135, 0
    v_mov_b32 v136, 0
    v_mov_b32 v137, 0
    v_mov_b32 v138, 0
    v_mov_b32 v139, 0
    v_mov_b32 v140, 0
    v_mov_b32 v141, 0
    v_mov_b32 v142, 0
    v_mov_b32 v143, 0
    v_mov_b32 v144, 0
    v_mov_b32 v145, 0
    v_mov_b32 v146, 0
    v_mov_b32 v147, 0
    v_mov_b32 v148, 0
    v_mov_b32 v149, 0
    v_mov_b32 v150, 0
    v_mov_b32 v151, 0
    v_mov_b32 v152, 0
    v_mov_b32 v153, 0
    v_mov_b32 v154, 0
    v_mov_b32 v155, 0
    v_mov_b32 v156, 0
    v_mov_b32 v157, 0
    v_mov_b32 v158, 0
    v_mov_b32 v159, 0
    v_mov_b32 v160, 0
    v_mov_b32 v161, 0
    v_mov_b32 v162, 0
    v_mov_b32 v163, 0
    v_mov_b32 v164, 0
    v_mov_b32 v165, 0
    v_mov_b32 v166, 0
    v_mov_b32 v167, 0
    v_mov_b32 v168, 0
    v_mov_b32 v169, 0
    v_mov_b32 v170, 0
    v_mov_b32 v171, 0
    v_mov_b32 v172, 0
    v_mov_b32 v173, 0
    v_mov_b32 v174, 0
    v_mov_b32 v175, 0
    v_mov_b32 v176, 0
    v_mov_b32 v177, 0
    v_mov_b32 v178, 0
    v_mov_b32 v179, 0
    v_mov_b32 v180, 0
    v_mov_b32 v181, 0
    v_mov_b32 v182, 0
    v_mov_b32 v183, 0
    v_mov_b32 v184, 0
    v_mov_b32 v185, 0
    v_mov_b32 v186, 0
    v_mov_b32 v187, 0
    v_mov_b32 v188, 0
    v_mov_b32 v189, 0
    v_mov_b32 v190, 0
    v_mov_b32 v191, 0
    v_mov_b32 v192, 0
    v_mov_b32 v193, 0
    v_mov_b32 v194, 0
    v_mov_b32 v195, 0
    v_mov_b32 v196, 0
    v_mov_b32 v197, 0
    v_mov_b32 v198, 0
    v_mov_b32 v199, 0
    v_mov_b32 v200, 0
    v_mov_b32 v201, 0
    v_mov_b32 v202, 0
    v_mov_b32 v203, 0
    v_mov_b32 v204, 0
    v_mov_b32 v205, 0
    v_mov_b32 v206, 0
    v_mov_b32 v207, 0
    v_mov_b32 v208, 0
    v_mov_b32 v209, 0
    v_mov_b32 v210, 0
    v_mov_b32 v211, 0
    v_mov_b32 v212, 0
    v_mov_b32 v213, 0
    v_mov_b32 v214, 0
    v_mov_b32 v215, 0
    v_mov_b32 v216, 0
    v_mov_b32 v217, 0
    v_mov_b32 v218, 0
    v_mov_b32 v219, 0
    v_mov_b32 v220, 0
    v_mov_b32 v221, 0
    v_mov_b32 v222, 0
    v_mov_b32 v223, 0
    v_mov_b32 v224, 0
    v_mov_b32 v225, 0
    v_mov_b32 v226, 0
    v_mov_b32 v227, 0
    v_mov_b32 v228, 0
    v_mov_b32 v229, 0
    v_mov_b32 v230, 0
    v_mov_b32 v231, 0
    v_mov_b32 v232, 0
    v_mov_b32 v233, 0
    v_mov_b32 v234, 0
    v_mov_b32 v235, 0
    v_mov_b32 v236, 0
    v_mov_b32 v237, 0
    v_mov_b32 v238, 0
    v_mov_b32 v239, 0
    v_mov_b32 v240, 0
    v_mov_b32 v241, 0
    v_mov_b32 v242, 0
    v_mov_b32 v243, 0
    v_mov_b32 v244, 0
    v_mov_b32 v245, 0
    v_mov_b32 v246, 0
    v_mov_b32 v247, 0
    v_mov_b32 v248, 0
    v_mov_b32 v249, 0
    v_mov_b32 v250, 0
    v_mov_b32 v251, 0
    v_mov_b32 v252, 0
    v_mov_b32 v253, 0
    v_mov_b32 v254, 0
    v_mov_b32 v255, 0
    s_waitcnt vmcnt(24)
    s_barrier
    ds_read_b64_tr_b16 v[64:65], v3 offset:0
    ds_read_b64_tr_b16 v[66:67], v3 offset:2048
    ds_read_b64_tr_b16 v[68:69], v4 offset:0
    ds_read_b64_tr_b16 v[70:71], v4 offset:2048
    ds_read_b64_tr_b16 v[72:73], v5 offset:0
    ds_read_b64_tr_b16 v[74:75], v5 offset:2048
    ds_read_b64_tr_b16 v[76:77], v6 offset:0
    ds_read_b64_tr_b16 v[78:79], v6 offset:2048
W_LOOP_T2:
    s_waitcnt lgkmcnt(0)
    v_mfma_f32_32x32x16_bf16 v[128:143], v[64:67], a[0:3], v[128:143]
    ds_read_b64_tr_b16 v[80:81], v3 offset:4096
    ds_read_b64_tr_b16 v[82:83], v3 offset:6144
    v_mfma_f32_32x32x16_bf16 v[192:207], v[64:67], a[4:7], v[192:207]
    ds_read_b64_tr_b16 v[84:85], v4 offset:4096
    ds_read_b64_tr_b16 v[86:87], v4 offset:6144
    v_mfma_f32_32x32x16_bf16 v[144:159], v[68:71], a[0:3], v[144:159]
    ds_read_b64_tr_b16 v[88:89], v5 offset:4096
    ds_read_b64_tr_b16 v[90:91], v5 offset:6144
    v_mfma_f32_32x32x16_bf16 v[208:223], v[68:71], a[4:7], v[208:223]
    ds_read_b64_tr_b16 v[92:93], v6 offset:4096
    ds_read_b64_tr_b16 v[94:95], v6 offset:6144
    s_add_u32 m0, s64, 49152
    v_mfma_f32_32x32x16_bf16 v[160:175], v[72:75], a[0:3], v[160:175]
    v_mfma_f32_32x32x16_bf16 v[224:239], v[72:75], a[4:7], v[224:239]
    buffer_load_dwordx4 a[96:99], v11, s[48:51], s52 offen offset:0 sc1
    v_mfma_f32_32x32x16_bf16 v[176:191], v[76:79], a[0:3], v[176:191]
    buffer_load_dwordx4 a[100:103], v12, s[48:51], s52 offen offset:0 sc1
    v_mfma_f32_32x32x16_bf16 v[240:255], v[76:79], a[4:7], v[240:255]
    buffer_load_dwordx4 v7, s[12:15], s53 offen offset:0 lds
    s_waitcnt lgkmcnt(0)
    v_mfma_f32_32x32x16_bf16 v[128:143], v[80:83], a[8:11], v[128:143]
    ds_read_b64_tr_b16 v[64:65], v3 offset:8192
    ds_read_b64_tr_b16 v[66:67], v3 offset:10240
    v_mfma_f32_32x32x16_bf16 v[192:207], v[80:83], a[12:15], v[192:207]
    ds_read_b64_tr_b16 v[68:69], v4 offset:8192
    ds_read_b64_tr_b16 v[70:71], v4 offset:10240
    v_mfma_f32_32x32x16_bf16 v[144:159], v[84:87], a[8:11], v[144:159]
    ds_read_b64_tr_b16 v[72:73], v5 offset:8192
    ds_read_b64_tr_b16 v[74:75], v5 offset:10240
    v_mfma_f32_32x32x16_bf16 v[208:223], v[84:87], a[12:15], v[208:223]
    ds_read_b64_tr_b16 v[76:77], v6 offset:8192
    ds_read_b64_tr_b16 v[78:79], v6 offset:10240
    v_mfma_f32_32x32x16_bf16 v[160:175], v[88:91], a[8:11], v[160:175]
    v_mfma_f32_32x32x16_bf16 v[224:239], v[88:91], a[12:15], v[224:239]
    buffer_load_dwordx4 a[104:107], v11, s[48:51], s52 offen offset:1024 sc1
    v_mfma_f32_32x32x16_bf16 v[176:191], v[92:95], a[8:11], v[176:191]
    buffer_load_dwordx4 a[108:111], v12, s[48:51], s52 offen offset:1024 sc1
    v_mfma_f32_32x32x16_bf16 v[240:255], v[92:95], a[12:15], v[240:255]
    buffer_load_dwordx4 v8, s[12:15], s53 offen offset:1024 lds
    s_waitcnt lgkmcnt(0)
    v_mfma_f32_32x32x16_bf16 v[128:143], v[64:67], a[16:19], v[128:143]
    ds_read_b64_tr_b16 v[80:81], v3 offset:12288
    ds_read_b64_tr_b16 v[82:83], v3 offset:14336
    v_mfma_f32_32x32x16_bf16 v[192:207], v[64:67], a[20:23], v[192:207]
    ds_read_b64_tr_b16 v[84:85], v4 offset:12288
    ds_read_b64_tr_b16 v[86:87], v4 offset:14336
    v_mfma_f32_32x32x16_bf16 v[144:159], v[68:71], a[16:19], v[144:159]
    ds_read_b64_tr_b16 v[88:89], v5 offset:12288
    ds_read_b64_tr_b16 v[90:91], v5 offset:14336
    v_mfma_f32_32x32x16_bf16 v[208:223], v[68:71], a[20:23], v[208:223]
    ds_read_b64_tr_b16 v[92:93], v6 offset:12288
    ds_read_b64_tr_b16 v[94:95], v6 offset:14336
    v_mfma_f32_32x32x16_bf16 v[160:175], v[72:75], a[16:19], v[160:175]
    v_mfma_f32_32x32x16_bf16 v[224:239], v[72:75], a[20:23], v[224:239]
    buffer_load_dwordx4 a[112:115], v11, s[48:51], s52 offen offset:2048 sc1
    v_mfma_f32_32x32x16_bf16 v[176:191], v[76:79], a[16:19], v[176:191]
    buffer_load_dwordx4 a[116:119], v12, s[48:51], s52 offen offset:2048 sc1
    v_mfma_f32_32x32x16_bf16 v[240:255], v[76:79], a[20:23], v[240:255]
    buffer_load_dwordx4 v9, s[12:15], s53 offen offset:2048 lds
    s_waitcnt lgkmcnt(0)
    v_mfma_f32_32x32x16_bf16 v[128:143], v[80:83], a[24:27], v[128:143]
    s_waitcnt vmcnt(21)
    s_barrier
    v_mfma_f32_32x32x16_bf16 v[192:207], v[80:83], a[28:31], v[192:207]
    ds_read_b64_tr_b16 v[64:65], v3 offset:16384
    ds_read_b64_tr_b16 v[66:67], v3 offset:18432
    v_mfma_f32_32x32x16_bf16 v[144:159], v[84:87], a[24:27], v[144:159]
    ds_read_b64_tr_b16 v[68:69], v4 offset:16384
    ds_read_b64_tr_b16 v[70:71], v4 offset:18432
    v_mfma_f32_32x32x16_bf16 v[208:223], v[84:87], a[28:31], v[208:223]
    ds_read_b64_tr_b16 v[72:73], v5 offset:16384
    ds_read_b64_tr_b16 v[74:75], v5 offset:18432
    v_mfma_f32_32x32x16_bf16 v[160:175], v[88:91], a[24:27], v[160:175]
    ds_read_b64_tr_b16 v[76:77], v6 offset:16384
    ds_read_b64_tr_b16 v[78:79], v6 offset:18432
    v_mfma_f32_32x32x16_bf16 v[224:239], v[88:91], a[28:31], v[224:239]
    buffer_load_dwordx4 a[120:123], v11, s[48:51], s52 offen offset:3072 sc1
    v_mfma_f32_32x32x16_bf16 v[176:191], v[92:95], a[24:27], v[176:191]
    buffer_load_dwordx4 a[124:127], v12, s[48:51], s52 offen offset:3072 sc1
    v_mfma_f32_32x32x16_bf16 v[240:255], v[92:95], a[28:31], v[240:255]
    buffer_load_dwordx4 v10, s[12:15], s53 offen offset:3072 lds
    s_add_u32 s52, s52, 4096
    s_add_u32 s53, s53, s54
    s_waitcnt lgkmcnt(0)
    v_mfma_f32_32x32x16_bf16 v[128:143], v[64:67], a[32:35], v[128:143]
    ds_read_b64_tr_b16 v[80:81], v3 offset:20480
    ds_read_b64_tr_b16 v[82:83], v3 offset:22528
    s_cmp_eq_u32 s55, 1
    v_mfma_f32_32x32x16_bf16 v[192:207], v[64:67], a[36:39], v[192:207]
    ds_read_b64_tr_b16 v[84:85], v4 offset:20480
    ds_read_b64_tr_b16 v[86:87], v4 offset:22528
    s_cselect_b32 s50, 0, s50
    v_mfma_f32_32x32x16_bf16 v[144:159], v[68:71], a[32:35], v[144:159]
    ds_read_b64_tr_b16 v[88:89], v5 offset:20480
    ds_read_b64_tr_b16 v[90:91], v5 offset:22528
    s_cselect_b32 s14, 0, s14
    v_mfma_f32_32x32x16_bf16 v[208:223], v[68:71], a[36:39], v[208:223]
    ds_read_b64_tr_b16 v[92:93], v6 offset:20480
    ds_read_b64_tr_b16 v[94:95], v6 offset:22528
    s_add_u32 m0, s64, 0
    v_mfma_f32_32x32x16_bf16 v[160:175], v[72:75], a[32:35], v[160:175]
    v_mfma_f32_32x32x16_bf16 v[224:239], v[72:75], a[36:39], v[224:239]
    buffer_load_dwordx4 a[0:3], v11, s[48:51], s52 offen offset:0 sc1
    v_mfma_f32_32x32x16_bf16 v[176:191], v[76:79], a[32:35], v[176:191]
    buffer_load_dwordx4 a[4:7], v12, s[48:51], s52 offen offset:0 sc1
    v_mfma_f32_32x32x16_bf16 v[240:255], v[76:79], a[36:39], v[240:255]
    buffer_load_dwordx4 v7, s[12:15], s53 offen offset:0 lds
    s_waitcnt lgkmcnt(0)
    v_mfma_f32_32x32x16_bf16 v[128:143], v[80:83], a[40:43], v[128:143]
    ds_read_b64_tr_b16 v[64:65], v3 offset:24576
    ds_read_b64_tr_b16 v[66:67], v3 offset:26624
    v_mfma_f32_32x32x16_bf16 v[192:207], v[80:83], a[44:47], v[192:207]
    ds_read_b64_tr_b16 v[68:69], v4 offset:24576
    ds_read_b64_tr_b16 v[70:71], v4 offset:26624
    v_mfma_f32_32x32x16_bf16 v[144:159], v[84:87], a[40:43], v[144:159]
    ds_read_b64_tr_b16 v[72:73], v5 offset:24576
    ds_read_b64_tr_b16 v[74:75], v5 offset:26624
    v_mfma_f32_32x32x16_bf16 v[208:223], v[84:87], a[44:47], v[208:223]
    ds_read_b64_tr_b16 v[76:77], v6 offset:24576
    ds_read_b64_tr_b16 v[78:79], v6 offset:26624
    v_mfma_f32_32x32x16_bf16 v[160:175], v[88:91], a[40:43], v[160:175]
    v_mfma_f32_32x32x16_bf16 v[224:239], v[88:91], a[44:47], v[224:239]
    buffer_load_dwordx4 a[8:11], v11, s[48:51], s52 offen offset:1024 sc1
    v_mfma_f32_32x32x16_bf16 v[176:191], v[92:95], a[40:43], v[176:191]
    buffer_load_dwordx4 a[12:15], v12, s[48:51], s52 offen offset:1024 sc1
    v_mfma_f32_32x32x16_bf16 v[240:255], v[92:95], a[44:47], v[240:255]
    buffer_load_dwordx4 v8, s[12:15], s53 offen offset:1024 lds
    s_waitcnt lgkmcnt(0)
    v_mfma_f32_32x32x16_bf16 v[128:143], v[64:67], a[48:51], v[128:143]
    ds_read_b64_tr_b16 v[80:81], v3 offset:28672
    ds_read_b64_tr_b16 v[82:83], v3 offset:30720
    v_mfma_f32_32x32x16_bf16 v[192:207], v[64:67], a[52:55], v[192:207]
    ds_read_b64_tr_b16 v[84:85], v4 offset:28672
    ds_read_b64_tr_b16 v[86:87], v4 offset:30720
    v_mfma_f32_32x32x16_bf16 v[144:159], v[68:71], a[48:51], v[144:159]
    ds_read_b64_tr_b16 v[88:89], v5 offset:28672
    ds_read_b64_tr_b16 v[90:91], v5 offset:30720
    v_mfma_f32_32x32x16_bf16 v[208:223], v[68:71], a[52:55], v[208:223]
    ds_read_b64_tr_b16 v[92:93], v6 offset:28672
    ds_read_b64_tr_b16 v[94:95], v6 offset:30720
    v_mfma_f32_32x32x16_bf16 v[160:175], v[72:75], a[48:51], v[160:175]
    v_mfma_f32_32x32x16_bf16 v[224:239], v[72:75], a[52:55], v[224:239]
    buffer_load_dwordx4 a[16:19], v11, s[48:51], s52 offen offset:2048 sc1
    v_mfma_f32_32x32x16_bf16 v[176:191], v[76:79], a[48:51], v[176:191]
    buffer_load_dwordx4 a[20:23], v12, s[48:51], s52 offen offset:2048 sc1
    v_mfma_f32_32x32x16_bf16 v[240:255], v[76:79], a[52:55], v[240:255]
    buffer_load_dwordx4 v9, s[12:15], s53 offen offset:2048 lds
    s_waitcnt lgkmcnt(0)
    v_mfma_f32_32x32x16_bf16 v[128:143], v[80:83], a[56:59], v[128:143]
    s_waitcnt vmcnt(21)
    s_barrier
    v_mfma_f32_32x32x16_bf16 v[192:207], v[80:83], a[60:63], v[192:207]
    ds_read_b64_tr_b16 v[64:65], v3 offset:32768
    ds_read_b64_tr_b16 v[66:67], v3 offset:34816
    v_mfma_f32_32x32x16_bf16 v[144:159], v[84:87], a[56:59], v[144:159]
    ds_read_b64_tr_b16 v[68:69], v4 offset:32768
    ds_read_b64_tr_b16 v[70:71], v4 offset:34816
    v_mfma_f32_32x32x16_bf16 v[208:223], v[84:87], a[60:63], v[208:223]
    ds_read_b64_tr_b16 v[72:73], v5 offset:32768
    ds_read_b64_tr_b16 v[74:75], v5 offset:34816
    v_mfma_f32_32x32x16_bf16 v[160:175], v[88:91], a[56:59], v[160:175]
    ds_read_b64_tr_b16 v[76:77], v6 offset:32768
    ds_read_b64_tr_b16 v[78:79], v6 offset:34816
    v_mfma_f32_32x32x16_bf16 v[224:239], v[88:91], a[60:63], v[224:239]
    buffer_load_dwordx4 a[24:27], v11, s[48:51], s52 offen offset:3072 sc1
    v_mfma_f32_32x32x16_bf16 v[176:191], v[92:95], a[56:59], v[176:191]
    buffer_load_dwordx4 a[28:31], v12, s[48:51], s52 offen offset:3072 sc1
    v_mfma_f32_32x32x16_bf16 v[240:255], v[92:95], a[60:63], v[240:255]
    buffer_load_dwordx4 v10, s[12:15], s53 offen offset:3072 lds
    s_add_u32 s52, s52, 4096
    s_add_u32 s53, s53, s54
    s_waitcnt lgkmcnt(0)
    v_mfma_f32_32x32x16_bf16 v[128:143], v[64:67], a[64:67], v[128:143]
    ds_read_b64_tr_b16 v[80:81], v3 offset:36864
    ds_read_b64_tr_b16 v[82:83], v3 offset:38912
    v_mfma_f32_32x32x16_bf16 v[192:207], v[64:67], a[68:71], v[192:207]
    ds_read_b64_tr_b16 v[84:85], v4 offset:36864
    ds_read_b64_tr_b16 v[86:87], v4 offset:38912
    v_mfma_f32_32x32x16_bf16 v[144:159], v[68:71], a[64:67], v[144:159]
    ds_read_b64_tr_b16 v[88:89], v5 offset:36864
    ds_read_b64_tr_b16 v[90:91], v5 offset:38912
    v_mfma_f32_32x32x16_bf16 v[208:223], v[68:71], a[68:71], v[208:223]
    ds_read_b64_tr_b16 v[92:93], v6 offset:36864
    ds_read_b64_tr_b16 v[94:95], v6 offset:38912
    s_add_u32 m0, s64, 16384
    v_mfma_f32_32x32x16_bf16 v[160:175], v[72:75], a[64:67], v[160:175]
    v_mfma_f32_32x32x16_bf16 v[224:239], v[72:75], a[68:71], v[224:239]
    buffer_load_dwordx4 a[32:35], v11, s[48:51], s52 offen offset:0 sc1
    v_mfma_f32_32x32x16_bf16 v[176:191], v[76:79], a[64:67], v[176:191]
    buffer_load_dwordx4 a[36:39], v12, s[48:51], s52 offen offset:0 sc1
    v_mfma_f32_32x32x16_bf16 v[240:255], v[76:79], a[68:71], v[240:255]
    buffer_load_dwordx4 v7, s[12:15], s53 offen offset:0 lds
    s_waitcnt lgkmcnt(0)
    v_mfma_f32_32x32x16_bf16 v[128:143], v[80:83], a[72:75], v[128:143]
    ds_read_b64_tr_b16 v[64:65], v3 offset:40960
    ds_read_b64_tr_b16 v[66:67], v3 offset:43008
    v_mfma_f32_32x32x16_bf16 v[192:207], v[80:83], a[76:79], v[192:207]
    ds_read_b64_tr_b16 v[68:69], v4 offset:40960
    ds_read_b64_tr_b16 v[70:71], v4 offset:43008
    v_mfma_f32_32x32x16_bf16 v[144:159], v[84:87], a[72:75], v[144:159]
    ds_read_b64_tr_b16 v[72:73], v5 offset:40960
    ds_read_b64_tr_b16 v[74:75], v5 offset:43008
    v_mfma_f32_32x32x16_bf16 v[208:223], v[84:87], a[76:79], v[208:223]
    ds_read_b64_tr_b16 v[76:77], v6 offset:40960
    ds_read_b64_tr_b16 v[78:79], v6 offset:43008
    v_mfma_f32_32x32x16_bf16 v[160:175], v[88:91], a[72:75], v[160:175]
    v_mfma_f32_32x32x16_bf16 v[224:239], v[88:91], a[76:79], v[224:239]
    buffer_load_dwordx4 a[40:43], v11, s[48:51], s52 offen offset:1024 sc1
    v_mfma_f32_32x32x16_bf16 v[176:191], v[92:95], a[72:75], v[176:191]
    buffer_load_dwordx4 a[44:47], v12, s[48:51], s52 offen offset:1024 sc1
    v_mfma_f32_32x32x16_bf16 v[240:255], v[92:95], a[76:79], v[240:255]
    buffer_load_dwordx4 v8, s[12:15], s53 offen offset:1024 lds
    s_waitcnt lgkmcnt(0)
    v_mfma_f32_32x32x16_bf16 v[128:143], v[64:67], a[80:83], v[128:143]
    ds_read_b64_tr_b16 v[80:81], v3 offset:45056
    ds_read_b64_tr_b16 v[82:83], v3 offset:47104
    v_mfma_f32_32x32x16_bf16 v[192:207], v[64:67], a[84:87], v[192:207]
    ds_read_b64_tr_b16 v[84:85], v4 offset:45056
    ds_read_b64_tr_b16 v[86:87], v4 offset:47104
    v_mfma_f32_32x32x16_bf16 v[144:159], v[68:71], a[80:83], v[144:159]
    ds_read_b64_tr_b16 v[88:89], v5 offset:45056
    ds_read_b64_tr_b16 v[90:91], v5 offset:47104
    v_mfma_f32_32x32x16_bf16 v[208:223], v[68:71], a[84:87], v[208:223]
    ds_read_b64_tr_b16 v[92:93], v6 offset:45056
    ds_read_b64_tr_b16 v[94:95], v6 offset:47104
    v_mfma_f32_32x32x16_bf16 v[160:175], v[72:75], a[80:83], v[160:175]
    v_mfma_f32_32x32x16_bf16 v[224:239], v[72:75], a[84:87], v[224:239]
    buffer_load_dwordx4 a[48:51], v11, s[48:51], s52 offen offset:2048 sc1
    v_mfma_f32_32x32x16_bf16 v[176:191], v[76:79], a[80:83], v[176:191]
    buffer_load_dwordx4 a[52:55], v12, s[48:51], s52 offen offset:2048 sc1
    v_mfma_f32_32x32x16_bf16 v[240:255], v[76:79], a[84:87], v[240:255]
    buffer_load_dwordx4 v9, s[12:15], s53 offen offset:2048 lds
    s_waitcnt lgkmcnt(0)
    v_mfma_f32_32x32x16_bf16 v[128:143], v[80:83], a[88:91], v[128:143]
    s_waitcnt vmcnt(21)
    s_barrier
    v_mfma_f32_32x32x16_bf16 v[192:207], v[80:83], a[92:95], v[192:207]
    ds_read_b64_tr_b16 v[64:65], v3 offset:49152
    ds_read_b64_tr_b16 v[66:67], v3 offset:51200
    v_mfma_f32_32x32x16_bf16 v[144:159], v[84:87], a[88:91], v[144:159]
    ds_read_b64_tr_b16 v[68:69], v4 offset:49152
    ds_read_b64_tr_b16 v[70:71], v4 offset:51200
    v_mfma_f32_32x32x16_bf16 v[208:223], v[84:87], a[92:95], v[208:223]
    ds_read_b64_tr_b16 v[72:73], v5 offset:49152
    ds_read_b64_tr_b16 v[74:75], v5 offset:51200
    v_mfma_f32_32x32x16_bf16 v[160:175], v[88:91], a[88:91], v[160:175]
    ds_read_b64_tr_b16 v[76:77], v6 offset:49152
    ds_read_b64_tr_b16 v[78:79], v6 offset:51200
    v_mfma_f32_32x32x16_bf16 v[224:239], v[88:91], a[92:95], v[224:239]
    buffer_load_dwordx4 a[56:59], v11, s[48:51], s52 offen offset:3072 sc1
    v_mfma_f32_32x32x16_bf16 v[176:191], v[92:95], a[88:91], v[176:191]
    buffer_load_dwordx4 a[60:63], v12, s[48:51], s52 offen offset:3072 sc1
    v_mfma_f32_32x32x16_bf16 v[240:255], v[92:95], a[92:95], v[240:255]
    buffer_load_dwordx4 v10, s[12:15], s53 offen offset:3072 lds
    s_add_u32 s52, s52, 4096
    s_add_u32 s53, s53, s54
    s_waitcnt lgkmcnt(0)
    v_mfma_f32_32x32x16_bf16 v[128:143], v[64:67], a[96:99], v[128:143]
    ds_read_b64_tr_b16 v[80:81], v3 offset:53248
    ds_read_b64_tr_b16 v[82:83], v3 offset:55296
    v_mfma_f32_32x32x16_bf16 v[192:207], v[64:67], a[100:103], v[192:207]
    ds_read_b64_tr_b16 v[84:85], v4 offset:53248
    ds_read_b64_tr_b16 v[86:87], v4 offset:55296
    v_mfma_f32_32x32x16_bf16 v[144:159], v[68:71], a[96:99], v[144:159]
    ds_read_b64_tr_b16 v[88:89], v5 offset:53248
    ds_read_b64_tr_b16 v[90:91], v5 offset:55296
    v_mfma_f32_32x32x16_bf16 v[208:223], v[68:71], a[100:103], v[208:223]
    ds_read_b64_tr_b16 v[92:93], v6 offset:53248
    ds_read_b64_tr_b16 v[94:95], v6 offset:55296
    s_add_u32 m0, s64, 32768
    v_mfma_f32_32x32x16_bf16 v[160:175], v[72:75], a[96:99], v[160:175]
    v_mfma_f32_32x32x16_bf16 v[224:239], v[72:75], a[100:103], v[224:239]
    buffer_load_dwordx4 a[64:67], v11, s[48:51], s52 offen offset:0 sc1
    v_mfma_f32_32x32x16_bf16 v[176:191], v[76:79], a[96:99], v[176:191]
    buffer_load_dwordx4 a[68:71], v12, s[48:51], s52 offen offset:0 sc1
    v_mfma_f32_32x32x16_bf16 v[240:255], v[76:79], a[100:103], v[240:255]
    buffer_load_dwordx4 v7, s[12:15], s53 offen offset:0 lds
    s_waitcnt lgkmcnt(0)
    v_mfma_f32_32x32x16_bf16 v[128:143], v[80:83], a[104:107], v[128:143]
    ds_read_b64_tr_b16 v[64:65], v3 offset:57344
    ds_read_b64_tr_b16 v[66:67], v3 offset:59392
    v_mfma_f32_32x32x16_bf16 v[192:207], v[80:83], a[108:111], v[192:207]
    ds_read_b64_tr_b16 v[68:69], v4 offset:57344
    ds_read_b64_tr_b16 v[70:71], v4 offset:59392
    v_mfma_f32_32x32x16_bf16 v[144:159], v[84:87], a[104:107], v[144:159]
    ds_read_b64_tr_b16 v[72:73], v5 offset:57344
    ds_read_b64_tr_b16 v[74:75], v5 offset:59392
    v_mfma_f32_32x32x16_bf16 v[208:223], v[84:87], a[108:111], v[208:223]
    ds_read_b64_tr_b16 v[76:77], v6 offset:57344
    ds_read_b64_tr_b16 v[78:79], v6 offset:59392
    v_mfma_f32_32x32x16_bf16 v[160:175], v[88:91], a[104:107], v[160:175]
    v_mfma_f32_32x32x16_bf16 v[224:239], v[88:91], a[108:111], v[224:239]
    buffer_load_dwordx4 a[72:75], v11, s[48:51], s52 offen offset:1024 sc1
    v_mfma_f32_32x32x16_bf16 v[176:191], v[92:95], a[104:107], v[176:191]
    buffer_load_dwordx4 a[76:79], v12, s[48:51], s52 offen offset:1024 sc1
    v_mfma_f32_32x32x16_bf16 v[240:255], v[92:95], a[108:111], v[240:255]
    buffer_load_dwordx4 v8, s[12:15], s53 offen offset:1024 lds
    s_waitcnt lgkmcnt(0)
    v_mfma_f32_32x32x16_bf16 v[128:143], v[64:67], a[112:115], v[128:143]
    ds_read_b64_tr_b16 v[80:81], v3 offset:61440
    ds_read_b64_tr_b16 v[82:83], v3 offset:63488
    v_mfma_f32_32x32x16_bf16 v[192:207], v[64:67], a[116:119], v[192:207]
    ds_read_b64_tr_b16 v[84:85], v4 offset:61440
    ds_read_b64_tr_b16 v[86:87], v4 offset:63488
    v_mfma_f32_32x32x16_bf16 v[144:159], v[68:71], a[112:115], v[144:159]
    ds_read_b64_tr_b16 v[88:89], v5 offset:61440
    ds_read_b64_tr_b16 v[90:91], v5 offset:63488
    v_mfma_f32_32x32x16_bf16 v[208:223], v[68:71], a[116:119], v[208:223]
    ds_read_b64_tr_b16 v[92:93], v6 offset:61440
    ds_read_b64_tr_b16 v[94:95], v6 offset:63488
    v_mfma_f32_32x32x16_bf16 v[160:175], v[72:75], a[112:115], v[160:175]
    v_mfma_f32_32x32x16_bf16 v[224:239], v[72:75], a[116:119], v[224:239]
    buffer_load_dwordx4 a[80:83], v11, s[48:51], s52 offen offset:2048 sc1
    v_mfma_f32_32x32x16_bf16 v[176:191], v[76:79], a[112:115], v[176:191]
    buffer_load_dwordx4 a[84:87], v12, s[48:51], s52 offen offset:2048 sc1
    v_mfma_f32_32x32x16_bf16 v[240:255], v[76:79], a[116:119], v[240:255]
    buffer_load_dwordx4 v9, s[12:15], s53 offen offset:2048 lds
    s_waitcnt lgkmcnt(0)
    v_mfma_f32_32x32x16_bf16 v[128:143], v[80:83], a[120:123], v[128:143]
    s_waitcnt vmcnt(21)
    s_barrier
    v_mfma_f32_32x32x16_bf16 v[192:207], v[80:83], a[124:127], v[192:207]
    ds_read_b64_tr_b16 v[64:65], v3 offset:0
    ds_read_b64_tr_b16 v[66:67], v3 offset:2048
    v_mfma_f32_32x32x16_bf16 v[144:159], v[84:87], a[120:123], v[144:159]
    ds_read_b64_tr_b16 v[68:69], v4 offset:0
    ds_read_b64_tr_b16 v[70:71], v4 offset:2048
    v_mfma_f32_32x32x16_bf16 v[208:223], v[84:87], a[124:127], v[208:223]
    ds_read_b64_tr_b16 v[72:73], v5 offset:0
    ds_read_b64_tr_b16 v[74:75], v5 offset:2048
    v_mfma_f32_32x32x16_bf16 v[160:175], v[88:91], a[120:123], v[160:175]
    ds_read_b64_tr_b16 v[76:77], v6 offset:0
    ds_read_b64_tr_b16 v[78:79], v6 offset:2048
    v_mfma_f32_32x32x16_bf16 v[224:239], v[88:91], a[124:127], v[224:239]
    buffer_load_dwordx4 a[88:91], v11, s[48:51], s52 offen offset:3072 sc1
    v_mfma_f32_32x32x16_bf16 v[176:191], v[92:95], a[120:123], v[176:191]
    buffer_load_dwordx4 a[92:95], v12, s[48:51], s52 offen offset:3072 sc1
    s_sub_u32 s55, s55, 1
    v_mfma_f32_32x32x16_bf16 v[240:255], v[92:95], a[124:127], v[240:255]
    buffer_load_dwordx4 v10, s[12:15], s53 offen offset:3072 lds
    s_add_u32 s52, s52, 4096
    s_add_u32 s53, s53, s54
    s_cmp_lg_u32 s55, 0
    s_cbranch_scc1 W_LOOP_T2
    s_waitcnt lgkmcnt(0)
    s_cmp_eq_u32 s60, 4
    s_cbranch_scc1 W_EP_Q
    s_cmp_eq_u32 s60, 2
    s_cbranch_scc1 W_EP_H
W_EP_ST:
    v_cvt_pk_bf16_f32 v128, v128, v129
    v_cvt_pk_bf16_f32 v129, v130, v131
    v_cvt_pk_bf16_f32 v130, v132, v133
    v_cvt_pk_bf16_f32 v131, v134, v135
    buffer_store_dwordx4 v[128:131], v2, s[4:7], s66 offen offset:0 sc1
    v_cvt_pk_bf16_f32 v136, v136, v137
    v_cvt_pk_bf16_f32 v137, v138, v139
    v_cvt_pk_bf16_f32 v138, v140, v141
    v_cvt_pk_bf16_f32 v139, v142, v143
    buffer_store_dwordx4 v[136:139], v2, s[4:7], s66 offen offset:1024 sc1
    v_cvt_pk_bf16_f32 v144, v144, v145
    v_cvt_pk_bf16_f32 v145, v146, v147
    v_cvt_pk_bf16_f32 v146, v148, v149
    v_cvt_pk_bf16_f32 v147, v150, v151
    buffer_store_dwordx4 v[144:147], v2, s[4:7], s66 offen offset:2048 sc1
    v_cvt_pk_bf16_f32 v152, v152, v153
    v_cvt_pk_bf16_f32 v153, v154, v155
    v_cvt_pk_bf16_f32 v154, v156, v157
    v_cvt_pk_bf16_f32 v155, v158, v159
    buffer_store_dwordx4 v[152:155], v2, s[4:7], s66 offen offset:3072 sc1
    s_add_u32 s56, s66, 4096
    v_cvt_pk_bf16_f32 v160, v160, v161
    v_cvt_pk_bf16_f32 v161, v162, v163
    v_cvt_pk_bf16_f32 v162, v164, v165
    v_cvt_pk_bf16_f32 v163, v166, v167
    buffer_store_dwordx4 v[160:163], v2, s[4:7], s56 offen offset:0 sc1
    v_cvt_pk_bf16_f32 v168, v168, v169
    v_cvt_pk_bf16_f32 v169, v170, v171
    v_cvt_pk_bf16_f32 v170, v172, v173
    v_cvt_pk_bf16_f32 v171, v174, v175
    buffer_store_dwordx4 v[168:171], v2, s[4:7], s56 offen offset:1024 sc1
    v_cvt_pk_bf16_f32 v176, v176, v177
    v_cvt_pk_bf16_f32 v177, v178, v179
    v_cvt_pk_bf16_f32 v178, v180, v181
    v_cvt_pk_bf16_f32 v179, v182, v183
    buffer_store_dwordx4 v[176:179], v2, s[4:7], s56 offen offset:2048 sc1
    v_cvt_pk_bf16_f32 v184, v184, v185
    v_cvt_pk_bf16_f32 v185, v186, v187
    v_cvt_pk_bf16_f32 v186, v188, v189
    v_cvt_pk_bf16_f32 v187, v190, v191
    buffer_store_dwordx4 v[184:187], v2, s[4:7], s56 offen offset:3072 sc1
    s_add_u32 s56, s66, 0
    s_add_u32 s56, s56, s67
    v_cvt_pk_bf16_f32 v192, v192, v193
    v_cvt_pk_bf16_f32 v193, v194, v195
    v_cvt_pk_bf16_f32 v194, v196, v197
    v_cvt_pk_bf16_f32 v195, v198, v199
    buffer_store_dwordx4 v[192:195], v2, s[4:7], s56 offen offset:0 sc1
    v_cvt_pk_bf16_f32 v200, v200, v201
    v_cvt_pk_bf16_f32 v201, v202, v203
    v_cvt_pk_bf16_f32 v202, v204, v205
    v_cvt_pk_bf16_f32 v203, v206, v207
    buffer_store_dwordx4 v[200:203], v2, s[4:7], s56 offen offset:1024 sc1
    v_cvt_pk_bf16_f32 v208, v208, v209
    v_cvt_pk_bf16_f32 v209, v210, v211
    v_cvt_pk_bf16_f32 v210, v212, v213
    v_cvt_pk_bf16_f32 v211, v214, v215
    buffer_store_dwordx4 v[208:211], v2, s[4:7], s56 offen offset:2048 sc1
    v_cvt_pk_bf16_f32 v216, v216, v217
    v_cvt_pk_bf16_f32 v217, v218, v219
    v_cvt_pk_bf16_f32 v218, v220, v221
    v_cvt_pk_bf16_f32 v219, v222, v223
    buffer_store_dwordx4 v[216:219], v2, s[4:7], s56 offen offset:3072 sc1
    s_add_u32 s56, s66, 4096
    s_add_u32 s56, s56, s67
    v_cvt_pk_bf16_f32 v224, v224, v225
    v_cvt_pk_bf16_f32 v225, v226, v227
    v_cvt_pk_bf16_f32 v226, v228, v229
    v_cvt_pk_bf16_f32 v227, v230, v231
    buffer_store_dwordx4 v[224:227], v2, s[4:7], s56 offen offset:0 sc1
    v_cvt_pk_bf16_f32 v232, v232, v233
    v_cvt_pk_bf16_f32 v233, v234, v235
    v_cvt_pk_bf16_f32 v234, v236, v237
    v_cvt_pk_bf16_f32 v235, v238, v239
    buffer_store_dwordx4 v[232:235], v2, s[4:7], s56 offen offset:1024 sc1
    v_cvt_pk_bf16_f32 v240, v240, v241
    v_cvt_pk_bf16_f32 v241, v242, v243
    v_cvt_pk_bf16_f32 v242, v244, v245
    v_cvt_pk_bf16_f32 v243, v246, v247
    buffer_store_dwordx4 v[240:243], v2, s[4:7], s56 offen offset:2048 sc1
    v_cvt_pk_bf16_f32 v248, v248, v249
    v_cvt_pk_bf16_f32 v249, v250, v251
    v_cvt_pk_bf16_f32 v250, v252, v253
    v_cvt_pk_bf16_f32 v251, v254, v255
    buffer_store_dwordx4 v[248:251], v2, s[4:7], s56 offen offset:3072 sc1
    s_cmp_eq_u32 s60, 3
    s_cbranch_scc1 W_SIG_Y
    s_lshl_b32 s57, s60, 2
    s_add_u32 s57, s57, 0x5200028
    s_lshl_b32 s56, s61, 5
    s_add_u32 s56, s56, s62
    s_lshl_b32 s56, s56, 6
    s_add_u32 s56, s56, s57
    s_waitcnt vmcnt(0)
    s_barrier
    s_cmp_lg_u32 s44, 0
    s_cbranch_scc1 kvsig_39
    v_mov_b32 v13, 1
    s_mov_b64 exec, 1
    buffer_store_dword v13, off, s[4:7], s56 sc1
    buffer_store_dword v13, off, s[4:7], s56 offset:12 sc1
    s_mov_b64 exec, -1
kvsig_39:
    s_branch W_NEXT
W_SIG_Y:
    s_lshl_b32 s56, s69, 8
    s_xor_b32 s56, s56, s45
    s_lshr_b32 s57, s62, 1
    s_lshl_b32 s57, s57, 6
    s_add_u32 s56, s56, s57
    s_and_b32 s57, s62, 1
    s_lshl_b32 s57, s57, 2
    s_add_u32 s56, s56, s57
    s_add_u32 s56, s56, 0x5200020
    v_mov_b32 v13, 1
    s_waitcnt vmcnt(0)
    s_mov_b64 exec, 1
    buffer_store_dword v13, off, s[4:7], s56 sc1
    buffer_store_dword v13, off, s[4:7], s56 offset:256 sc1
    s_mov_b64 exec, -1
    s_branch W_NEXT
W_SET_YH:
    s_mov_b32 s60, 3
    s_mov_b32 s12, s34
    s_and_b32 s13, s35, 0xffff
    s_mov_b32 s14, 0x700000
    s_mov_b32 s15, 0x20000
    s_mov_b32 s50, 0x10000000
    s_mov_b32 s54, 131072
    s_mov_b32 s55, 14
    s_lshl_b32 s69, s61, 2
    s_add_u32 s69, s69, s44
    s_mul_i32 s56, s69, 229376
    s_add_u32 s56, s56, 0x3c00000
    v_add_u32 v11, s56, v2
    v_add_u32 v12, 229376, v11
    s_mul_i32 s66, s69, 65536
    s_mul_i32 s56, s62, 8192
    s_add_u32 s66, s66, s56
    s_add_u32 s66, s66, 0x4a00000
    s_mov_b32 s67, 65536
    s_lshl_b32 s56, s62, 8
    v_mul_u32_u24 v13, 2048, v16
    v_add3_u32 v7, v13, v15, s56
    v_add_u32 v8, 7168, v7
    v_add_u32 v9, 14336, v7
    v_add_u32 v10, 21504, v7
    s_mov_b32 s52, 0
    s_mov_b32 s53, 0
    s_lshr_b32 s56, s61, 1
    s_lshl_b32 s56, s56, 11
    s_and_b32 s57, s61, 1
    s_lshl_b32 s57, s57, 1
    s_add_u32 s56, s56, s57
    s_add_u32 s56, s56, 0x5200030
    v_min_u32 v14, 27, v1
    v_lshlrev_b32 v14, 6, v14
    s_cmp_lg_u32 s44, 0
    s_cbranch_scc1 hwait_40
    s_mov_b32 s68, 0x80000
hwait_41:
    buffer_load_ushort v13, v14, s[4:7], s56 offen sc1
    s_waitcnt vmcnt(0)
    v_cmp_gt_u32 vcc, 257, v13
    s_cbranch_vccz hwait_41_ok
    s_sub_u32 s68, s68, 1
    s_cmp_lg_u32 s68, 0
    s_cbranch_scc1 hwait_41
hwait_41_ok:
hwait_40:
    s_barrier
    s_add_u32 m0, s64, 0
    buffer_load_dwordx4 a[0:3], v11, s[48:51], s52 offen offset:0 sc1
    buffer_load_dwordx4 v7, s[12:15], s53 offen offset:0 lds
    buffer_load_dwordx4 a[8:11], v11, s[48:51], s52 offen offset:1024 sc1
    buffer_load_dwordx4 v8, s[12:15], s53 offen offset:1024 lds
    buffer_load_dwordx4 a[16:19], v11, s[48:51], s52 offen offset:2048 sc1
    buffer_load_dwordx4 v9, s[12:15], s53 offen offset:2048 lds
    buffer_load_dwordx4 a[24:27], v11, s[48:51], s52 offen offset:3072 sc1
    buffer_load_dwordx4 v10, s[12:15], s53 offen offset:3072 lds
    s_add_u32 s52, s52, 4096
    s_add_u32 s53, s53, s54
    s_add_u32 m0, s64, 16384
    buffer_load_dwordx4 a[32:35], v11, s[48:51], s52 offen offset:0 sc1
    buffer_load_dwordx4 v7, s[12:15], s53 offen offset:0 lds
    buffer_load_dwordx4 a[40:43], v11, s[48:51], s52 offen offset:1024 sc1
    buffer_load_dwordx4 v8, s[12:15], s53 offen offset:1024 lds
    buffer_load_dwordx4 a[48:51], v11, s[48:51], s52 offen offset:2048 sc1
    buffer_load_dwordx4 v9, s[12:15], s53 offen offset:2048 lds
    buffer_load_dwordx4 a[56:59], v11, s[48:51], s52 offen offset:3072 sc1
    buffer_load_dwordx4 v10, s[12:15], s53 offen offset:3072 lds
    s_add_u32 s52, s52, 4096
    s_add_u32 s53, s53, s54
    s_add_u32 m0, s64, 32768
    buffer_load_dwordx4 a[64:67], v11, s[48:51], s52 offen offset:0 sc1
    buffer_load_dwordx4 v7, s[12:15], s53 offen offset:0 lds
    buffer_load_dwordx4 a[72:75], v11, s[48:51], s52 offen offset:1024 sc1
    buffer_load_dwordx4 v8, s[12:15], s53 offen offset:1024 lds
    buffer_load_dwordx4 a[80:83], v11, s[48:51], s52 offen offset:2048 sc1
    buffer_load_dwordx4 v9, s[12:15], s53 offen offset:2048 lds
    buffer_load_dwordx4 a[88:91], v11, s[48:51], s52 offen offset:3072 sc1
    buffer_load_dwordx4 v10, s[12:15], s53 offen offset:3072 lds
    s_add_u32 s52, s52, 4096
    s_add_u32 s53, s53, s54
    v_mov_b32 v128, 0
    v_mov_b32 v129, 0
    v_mov_b32 v130, 0
    v_mov_b32 v131, 0
    v_mov_b32 v132, 0
    v_mov_b32 v133, 0
    v_mov_b32 v134, 0
    v_mov_b32 v135, 0
    v_mov_b32 v136, 0
    v_mov_b32 v137, 0
    v_mov_b32 v138, 0
    v_mov_b32 v139, 0
    v_mov_b32 v140, 0
    v_mov_b32 v141, 0
    v_mov_b32 v142, 0
    v_mov_b32 v143, 0
    v_mov_b32 v144, 0
    v_mov_b32 v145, 0
    v_mov_b32 v146, 0
    v_mov_b32 v147, 0
    v_mov_b32 v148, 0
    v_mov_b32 v149, 0
    v_mov_b32 v150, 0
    v_mov_b32 v151, 0
    v_mov_b32 v152, 0
    v_mov_b32 v153, 0
    v_mov_b32 v154, 0
    v_mov_b32 v155, 0
    v_mov_b32 v156, 0
    v_mov_b32 v157, 0
    v_mov_b32 v158, 0
    v_mov_b32 v159, 0
    v_mov_b32 v160, 0
    v_mov_b32 v161, 0
    v_mov_b32 v162, 0
    v_mov_b32 v163, 0
    v_mov_b32 v164, 0
    v_mov_b32 v165, 0
    v_mov_b32 v166, 0
    v_mov_b32 v167, 0
    v_mov_b32 v168, 0
    v_mov_b32 v169, 0
    v_mov_b32 v170, 0
    v_mov_b32 v171, 0
    v_mov_b32 v172, 0
    v_mov_b32 v173, 0
    v_mov_b32 v174, 0
    v_mov_b32 v175, 0
    v_mov_b32 v176, 0
    v_mov_b32 v177, 0
    v_mov_b32 v178, 0
    v_mov_b32 v179, 0
    v_mov_b32 v180, 0
    v_mov_b32 v181, 0
    v_mov_b32 v182, 0
    v_mov_b32 v183, 0
    v_mov_b32 v184, 0
    v_mov_b32 v185, 0
    v_mov_b32 v186, 0
    v_mov_b32 v187, 0
    v_mov_b32 v188, 0
    v_mov_b32 v189, 0
    v_mov_b32 v190, 0
    v_mov_b32 v191, 0
    s_waitcnt vmcnt(16)
    s_barrier
    ds_read_b64_tr_b16 v[64:65], v3 offset:0
    ds_read_b64_tr_b16 v[66:67], v3 offset:2048
    ds_read_b64_tr_b16 v[68:69], v4 offset:0
    ds_read_b64_tr_b16 v[70:71], v4 offset:2048
    ds_read_b64_tr_b16 v[72:73], v5 offset:0
    ds_read_b64_tr_b16 v[74:75], v5 offset:2048
    ds_read_b64_tr_b16 v[76:77], v6 offset:0
    ds_read_b64_tr_b16 v[78:79], v6 offset:2048
W_LOOP_Y1:
    s_waitcnt lgkmcnt(0)
    v_mfma_f32_32x32x16_bf16 v[128:143], v[64:67], a[0:3], v[128:143]
    ds_read_b64_tr_b16 v[80:81], v3 offset:4096
    ds_read_b64_tr_b16 v[82:83], v3 offset:6144
    v_mfma_f32_32x32x16_bf16 v[144:159], v[68:71], a[0:3], v[144:159]
    ds_read_b64_tr_b16 v[84:85], v4 offset:4096
    ds_read_b64_tr_b16 v[86:87], v4 offset:6144
    s_add_u32 m0, s64, 49152
    v_mfma_f32_32x32x16_bf16 v[160:175], v[72:75], a[0:3], v[160:175]
    ds_read_b64_tr_b16 v[88:89], v5 offset:4096
    ds_read_b64_tr_b16 v[90:91], v5 offset:6144
    buffer_load_dwordx4 a[96:99], v11, s[48:51], s52 offen offset:0 sc1
    v_mfma_f32_32x32x16_bf16 v[176:191], v[76:79], a[0:3], v[176:191]
    ds_read_b64_tr_b16 v[92:93], v6 offset:4096
    ds_read_b64_tr_b16 v[94:95], v6 offset:6144
    buffer_load_dwordx4 v7, s[12:15], s53 offen offset:0 lds
    s_waitcnt lgkmcnt(0)
    v_mfma_f32_32x32x16_bf16 v[128:143], v[80:83], a[8:11], v[128:143]
    ds_read_b64_tr_b16 v[64:65], v3 offset:8192
    ds_read_b64_tr_b16 v[66:67], v3 offset:10240
    v_mfma_f32_32x32x16_bf16 v[144:159], v[84:87], a[8:11], v[144:159]
    ds_read_b64_tr_b16 v[68:69], v4 offset:8192
    ds_read_b64_tr_b16 v[70:71], v4 offset:10240
    v_mfma_f32_32x32x16_bf16 v[160:175], v[88:91], a[8:11], v[160:175]
    ds_read_b64_tr_b16 v[72:73], v5 offset:8192
    ds_read_b64_tr_b16 v[74:75], v5 offset:10240
    buffer_load_dwordx4 a[104:107], v11, s[48:51], s52 offen offset:1024 sc1
    v_mfma_f32_32x32x16_bf16 v[176:191], v[92:95], a[8:11], v[176:191]
    ds_read_b64_tr_b16 v[76:77], v6 offset:8192
    ds_read_b64_tr_b16 v[78:79], v6 offset:10240
    buffer_load_dwordx4 v8, s[12:15], s53 offen offset:1024 lds
    s_waitcnt lgkmcnt(0)
    v_mfma_f32_32x32x16_bf16 v[128:143], v[64:67], a[16:19], v[128:143]
    ds_read_b64_tr_b16 v[80:81], v3 offset:12288
    ds_read_b64_tr_b16 v[82:83], v3 offset:14336
    v_mfma_f32_32x32x16_bf16 v[144:159], v[68:71], a[16:19], v[144:159]
    ds_read_b64_tr_b16 v[84:85], v4 offset:12288
    ds_read_b64_tr_b16 v[86:87], v4 offset:14336
    v_mfma_f32_32x32x16_bf16 v[160:175], v[72:75], a[16:19], v[160:175]
    ds_read_b64_tr_b16 v[88:89], v5 offset:12288
    ds_read_b64_tr_b16 v[90:91], v5 offset:14336
    buffer_load_dwordx4 a[112:115], v11, s[48:51], s52 offen offset:2048 sc1
    v_mfma_f32_32x32x16_bf16 v[176:191], v[76:79], a[16:19], v[176:191]
    ds_read_b64_tr_b16 v[92:93], v6 offset:12288
    ds_read_b64_tr_b16 v[94:95], v6 offset:14336
    buffer_load_dwordx4 v9, s[12:15], s53 offen offset:2048 lds
    s_waitcnt lgkmcnt(0)
    v_mfma_f32_32x32x16_bf16 v[128:143], v[80:83], a[24:27], v[128:143]
    s_waitcnt vmcnt(14)
    s_barrier
    v_mfma_f32_32x32x16_bf16 v[144:159], v[84:87], a[24:27], v[144:159]
    ds_read_b64_tr_b16 v[64:65], v3 offset:16384
    ds_read_b64_tr_b16 v[66:67], v3 offset:18432
    ds_read_b64_tr_b16 v[68:69], v4 offset:16384
    v_mfma_f32_32x32x16_bf16 v[160:175], v[88:91], a[24:27], v[160:175]
    ds_read_b64_tr_b16 v[70:71], v4 offset:18432
    ds_read_b64_tr_b16 v[72:73], v5 offset:16384
    ds_read_b64_tr_b16 v[74:75], v5 offset:18432
    buffer_load_dwordx4 a[120:123], v11, s[48:51], s52 offen offset:3072 sc1
    v_mfma_f32_32x32x16_bf16 v[176:191], v[92:95], a[24:27], v[176:191]
    ds_read_b64_tr_b16 v[76:77], v6 offset:16384
    ds_read_b64_tr_b16 v[78:79], v6 offset:18432
    buffer_load_dwordx4 v10, s[12:15], s53 offen offset:3072 lds
    s_add_u32 s52, s52, 4096
    s_add_u32 s53, s53, s54
    s_waitcnt lgkmcnt(0)
    v_mfma_f32_32x32x16_bf16 v[128:143], v[64:67], a[32:35], v[128:143]
    ds_read_b64_tr_b16 v[80:81], v3 offset:20480
    ds_read_b64_tr_b16 v[82:83], v3 offset:22528
    s_cmp_eq_u32 s55, 1
    s_cselect_b32 s50, 0, s50
    s_cselect_b32 s14, 0, s14
    v_mfma_f32_32x32x16_bf16 v[144:159], v[68:71], a[32:35], v[144:159]
    ds_read_b64_tr_b16 v[84:85], v4 offset:20480
    ds_read_b64_tr_b16 v[86:87], v4 offset:22528
    s_add_u32 m0, s64, 0
    v_mfma_f32_32x32x16_bf16 v[160:175], v[72:75], a[32:35], v[160:175]
    ds_read_b64_tr_b16 v[88:89], v5 offset:20480
    ds_read_b64_tr_b16 v[90:91], v5 offset:22528
    buffer_load_dwordx4 a[0:3], v11, s[48:51], s52 offen offset:0 sc1
    v_mfma_f32_32x32x16_bf16 v[176:191], v[76:79], a[32:35], v[176:191]
    ds_read_b64_tr_b16 v[92:93], v6 offset:20480
    ds_read_b64_tr_b16 v[94:95], v6 offset:22528
    buffer_load_dwordx4 v7, s[12:15], s53 offen offset:0 lds
    s_waitcnt lgkmcnt(0)
    v_mfma_f32_32x32x16_bf16 v[128:143], v[80:83], a[40:43], v[128:143]
    ds_read_b64_tr_b16 v[64:65], v3 offset:24576
    ds_read_b64_tr_b16 v[66:67], v3 offset:26624
    v_mfma_f32_32x32x16_bf16 v[144:159], v[84:87], a[40:43], v[144:159]
    ds_read_b64_tr_b16 v[68:69], v4 offset:24576
    ds_read_b64_tr_b16 v[70:71], v4 offset:26624
    v_mfma_f32_32x32x16_bf16 v[160:175], v[88:91], a[40:43], v[160:175]
    ds_read_b64_tr_b16 v[72:73], v5 offset:24576
    ds_read_b64_tr_b16 v[74:75], v5 offset:26624
    buffer_load_dwordx4 a[8:11], v11, s[48:51], s52 offen offset:1024 sc1
    v_mfma_f32_32x32x16_bf16 v[176:191], v[92:95], a[40:43], v[176:191]
    ds_read_b64_tr_b16 v[76:77], v6 offset:24576
    ds_read_b64_tr_b16 v[78:79], v6 offset:26624
    buffer_load_dwordx4 v8, s[12:15], s53 offen offset:1024 lds
    s_waitcnt lgkmcnt(0)
    v_mfma_f32_32x32x16_bf16 v[128:143], v[64:67], a[48:51], v[128:143]
    ds_read_b64_tr_b16 v[80:81], v3 offset:28672
    ds_read_b64_tr_b16 v[82:83], v3 offset:30720
    v_mfma_f32_32x32x16_bf16 v[144:159], v[68:71], a[48:51], v[144:159]
    ds_read_b64_tr_b16 v[84:85], v4 offset:28672
    ds_read_b64_tr_b16 v[86:87], v4 offset:30720
    v_mfma_f32_32x32x16_bf16 v[160:175], v[72:75], a[48:51], v[160:175]
    ds_read_b64_tr_b16 v[88:89], v5 offset:28672
    ds_read_b64_tr_b16 v[90:91], v5 offset:30720
    buffer_load_dwordx4 a[16:19], v11, s[48:51], s52 offen offset:2048 sc1
    v_mfma_f32_32x32x16_bf16 v[176:191], v[76:79], a[48:51], v[176:191]
    ds_read_b64_tr_b16 v[92:93], v6 offset:28672
    ds_read_b64_tr_b16 v[94:95], v6 offset:30720
    buffer_load_dwordx4 v9, s[12:15], s53 offen offset:2048 lds
    s_waitcnt lgkmcnt(0)
    v_mfma_f32_32x32x16_bf16 v[128:143], v[80:83], a[56:59], v[128:143]
    s_waitcnt vmcnt(14)
    s_barrier
    v_mfma_f32_32x32x16_bf16 v[144:159], v[84:87], a[56:59], v[144:159]
    ds_read_b64_tr_b16 v[64:65], v3 offset:32768
    ds_read_b64_tr_b16 v[66:67], v3 offset:34816
    ds_read_b64_tr_b16 v[68:69], v4 offset:32768
    v_mfma_f32_32x32x16_bf16 v[160:175], v[88:91], a[56:59], v[160:175]
    ds_read_b64_tr_b16 v[70:71], v4 offset:34816
    ds_read_b64_tr_b16 v[72:73], v5 offset:32768
    ds_read_b64_tr_b16 v[74:75], v5 offset:34816
    buffer_load_dwordx4 a[24:27], v11, s[48:51], s52 offen offset:3072 sc1
    v_mfma_f32_32x32x16_bf16 v[176:191], v[92:95], a[56:59], v[176:191]
    ds_read_b64_tr_b16 v[76:77], v6 offset:32768
    ds_read_b64_tr_b16 v[78:79], v6 offset:34816
    buffer_load_dwordx4 v10, s[12:15], s53 offen offset:3072 lds
    s_add_u32 s52, s52, 4096
    s_add_u32 s53, s53, s54
    s_waitcnt lgkmcnt(0)
    v_mfma_f32_32x32x16_bf16 v[128:143], v[64:67], a[64:67], v[128:143]
    ds_read_b64_tr_b16 v[80:81], v3 offset:36864
    ds_read_b64_tr_b16 v[82:83], v3 offset:38912
    v_mfma_f32_32x32x16_bf16 v[144:159], v[68:71], a[64:67], v[144:159]
    ds_read_b64_tr_b16 v[84:85], v4 offset:36864
    ds_read_b64_tr_b16 v[86:87], v4 offset:38912
    s_add_u32 m0, s64, 16384
    v_mfma_f32_32x32x16_bf16 v[160:175], v[72:75], a[64:67], v[160:175]
    ds_read_b64_tr_b16 v[88:89], v5 offset:36864
    ds_read_b64_tr_b16 v[90:91], v5 offset:38912
    buffer_load_dwordx4 a[32:35], v11, s[48:51], s52 offen offset:0 sc1
    v_mfma_f32_32x32x16_bf16 v[176:191], v[76:79], a[64:67], v[176:191]
    ds_read_b64_tr_b16 v[92:93], v6 offset:36864
    ds_read_b64_tr_b16 v[94:95], v6 offset:38912
    buffer_load_dwordx4 v7, s[12:15], s53 offen offset:0 lds
    s_waitcnt lgkmcnt(0)
    v_mfma_f32_32x32x16_bf16 v[128:143], v[80:83], a[72:75], v[128:143]
    ds_read_b64_tr_b16 v[64:65], v3 offset:40960
    ds_read_b64_tr_b16 v[66:67], v3 offset:43008
    v_mfma_f32_32x32x16_bf16 v[144:159], v[84:87], a[72:75], v[144:159]
    ds_read_b64_tr_b16 v[68:69], v4 offset:40960
    ds_read_b64_tr_b16 v[70:71], v4 offset:43008
    v_mfma_f32_32x32x16_bf16 v[160:175], v[88:91], a[72:75], v[160:175]
    ds_read_b64_tr_b16 v[72:73], v5 offset:40960
    ds_read_b64_tr_b16 v[74:75], v5 offset:43008
    buffer_load_dwordx4 a[40:43], v11, s[48:51], s52 offen offset:1024 sc1
    v_mfma_f32_32x32x16_bf16 v[176:191], v[92:95], a[72:75], v[176:191]
    ds_read_b64_tr_b16 v[76:77], v6 offset:40960
    ds_read_b64_tr_b16 v[78:79], v6 offset:43008
    buffer_load_dwordx4 v8, s[12:15], s53 offen offset:1024 lds
    s_waitcnt lgkmcnt(0)
    v_mfma_f32_32x32x16_bf16 v[128:143], v[64:67], a[80:83], v[128:143]
    ds_read_b64_tr_b16 v[80:81], v3 offset:45056
    ds_read_b64_tr_b16 v[82:83], v3 offset:47104
    v_mfma_f32_32x32x16_bf16 v[144:159], v[68:71], a[80:83], v[144:159]
    ds_read_b64_tr_b16 v[84:85], v4 offset:45056
    ds_read_b64_tr_b16 v[86:87], v4 offset:47104
    v_mfma_f32_32x32x16_bf16 v[160:175], v[72:75], a[80:83], v[160:175]
    ds_read_b64_tr_b16 v[88:89], v5 offset:45056
    ds_read_b64_tr_b16 v[90:91], v5 offset:47104
    buffer_load_dwordx4 a[48:51], v11, s[48:51], s52 offen offset:2048 sc1
    v_mfma_f32_32x32x16_bf16 v[176:191], v[76:79], a[80:83], v[176:191]
    ds_read_b64_tr_b16 v[92:93], v6 offset:45056
    ds_read_b64_tr_b16 v[94:95], v6 offset:47104
    buffer_load_dwordx4 v9, s[12:15], s53 offen offset:2048 lds
    s_waitcnt lgkmcnt(0)
    v_mfma_f32_32x32x16_bf16 v[128:143], v[80:83], a[88:91], v[128:143]
    s_waitcnt vmcnt(14)
    s_barrier
    v_mfma_f32_32x32x16_bf16 v[144:159], v[84:87], a[88:91], v[144:159]
    ds_read_b64_tr_b16 v[64:65], v3 offset:49152
    ds_read_b64_tr_b16 v[66:67], v3 offset:51200
    ds_read_b64_tr_b16 v[68:69], v4 offset:49152
    v_mfma_f32_32x32x16_bf16 v[160:175], v[88:91], a[88:91], v[160:175]
    ds_read_b64_tr_b16 v[70:71], v4 offset:51200
    ds_read_b64_tr_b16 v[72:73], v5 offset:49152
    ds_read_b64_tr_b16 v[74:75], v5 offset:51200
    buffer_load_dwordx4 a[56:59], v11, s[48:51], s52 offen offset:3072 sc1
    v_mfma_f32_32x32x16_bf16 v[176:191], v[92:95], a[88:91], v[176:191]
    ds_read_b64_tr_b16 v[76:77], v6 offset:49152
    ds_read_b64_tr_b16 v[78:79], v6 offset:51200
    buffer_load_dwordx4 v10, s[12:15], s53 offen offset:3072 lds
    s_add_u32 s52, s52, 4096
    s_add_u32 s53, s53, s54
    s_waitcnt lgkmcnt(0)
    v_mfma_f32_32x32x16_bf16 v[128:143], v[64:67], a[96:99], v[128:143]
    ds_read_b64_tr_b16 v[80:81], v3 offset:53248
    ds_read_b64_tr_b16 v[82:83], v3 offset:55296
    v_mfma_f32_32x32x16_bf16 v[144:159], v[68:71], a[96:99], v[144:159]
    ds_read_b64_tr_b16 v[84:85], v4 offset:53248
    ds_read_b64_tr_b16 v[86:87], v4 offset:55296
    s_add_u32 m0, s64, 32768
    v_mfma_f32_32x32x16_bf16 v[160:175], v[72:75], a[96:99], v[160:175]
    ds_read_b64_tr_b16 v[88:89], v5 offset:53248
    ds_read_b64_tr_b16 v[90:91], v5 offset:55296
    buffer_load_dwordx4 a[64:67], v11, s[48:51], s52 offen offset:0 sc1
    v_mfma_f32_32x32x16_bf16 v[176:191], v[76:79], a[96:99], v[176:191]
    ds_read_b64_tr_b16 v[92:93], v6 offset:53248
    ds_read_b64_tr_b16 v[94:95], v6 offset:55296
    buffer_load_dwordx4 v7, s[12:15], s53 offen offset:0 lds
    s_waitcnt lgkmcnt(0)
    v_mfma_f32_32x32x16_bf16 v[128:143], v[80:83], a[104:107], v[128:143]
    ds_read_b64_tr_b16 v[64:65], v3 offset:57344
    ds_read_b64_tr_b16 v[66:67], v3 offset:59392
    v_mfma_f32_32x32x16_bf16 v[144:159], v[84:87], a[104:107], v[144:159]
    ds_read_b64_tr_b16 v[68:69], v4 offset:57344
    ds_read_b64_tr_b16 v[70:71], v4 offset:59392
    v_mfma_f32_32x32x16_bf16 v[160:175], v[88:91], a[104:107], v[160:175]
    ds_read_b64_tr_b16 v[72:73], v5 offset:57344
    ds_read_b64_tr_b16 v[74:75], v5 offset:59392
    buffer_load_dwordx4 a[72:75], v11, s[48:51], s52 offen offset:1024 sc1
    v_mfma_f32_32x32x16_bf16 v[176:191], v[92:95], a[104:107], v[176:191]
    ds_read_b64_tr_b16 v[76:77], v6 offset:57344
    ds_read_b64_tr_b16 v[78:79], v6 offset:59392
    buffer_load_dwordx4 v8, s[12:15], s53 offen offset:1024 lds
    s_waitcnt lgkmcnt(0)
    v_mfma_f32_32x32x16_bf16 v[128:143], v[64:67], a[112:115], v[128:143]
    ds_read_b64_tr_b16 v[80:81], v3 offset:61440
    ds_read_b64_tr_b16 v[82:83], v3 offset:63488
    v_mfma_f32_32x32x16_bf16 v[144:159], v[68:71], a[112:115], v[144:159]
    ds_read_b64_tr_b16 v[84:85], v4 offset:61440
    ds_read_b64_tr_b16 v[86:87], v4 offset:63488
    v_mfma_f32_32x32x16_bf16 v[160:175], v[72:75], a[112:115], v[160:175]
    ds_read_b64_tr_b16 v[88:89], v5 offset:61440
    ds_read_b64_tr_b16 v[90:91], v5 offset:63488
    buffer_load_dwordx4 a[80:83], v11, s[48:51], s52 offen offset:2048 sc1
    v_mfma_f32_32x32x16_bf16 v[176:191], v[76:79], a[112:115], v[176:191]
    ds_read_b64_tr_b16 v[92:93], v6 offset:61440
    ds_read_b64_tr_b16 v[94:95], v6 offset:63488
    buffer_load_dwordx4 v9, s[12:15], s53 offen offset:2048 lds
    s_waitcnt lgkmcnt(0)
    v_mfma_f32_32x32x16_bf16 v[128:143], v[80:83], a[120:123], v[128:143]
    s_waitcnt vmcnt(14)
    s_barrier
    v_mfma_f32_32x32x16_bf16 v[144:159], v[84:87], a[120:123], v[144:159]
    ds_read_b64_tr_b16 v[64:65], v3 offset:0
    ds_read_b64_tr_b16 v[66:67], v3 offset:2048
    ds_read_b64_tr_b16 v[68:69], v4 offset:0
    v_mfma_f32_32x32x16_bf16 v[160:175], v[88:91], a[120:123], v[160:175]
    ds_read_b64_tr_b16 v[70:71], v4 offset:2048
    ds_read_b64_tr_b16 v[72:73], v5 offset:0
    ds_read_b64_tr_b16 v[74:75], v5 offset:2048
    buffer_load_dwordx4 a[88:91], v11, s[48:51], s52 offen offset:3072 sc1
    s_sub_u32 s55, s55, 1
    v_mfma_f32_32x32x16_bf16 v[176:191], v[92:95], a[120:123], v[176:191]
    ds_read_b64_tr_b16 v[76:77], v6 offset:0
    ds_read_b64_tr_b16 v[78:79], v6 offset:2048
    buffer_load_dwordx4 v10, s[12:15], s53 offen offset:3072 lds
    s_add_u32 s52, s52, 4096
    s_add_u32 s53, s53, s54
    s_cmp_lg_u32 s55, 0
    s_cbranch_scc1 W_LOOP_Y1
    s_waitcnt lgkmcnt(0)
    v_cvt_pk_bf16_f32 v128, v128, v129
    v_cvt_pk_bf16_f32 v129, v130, v131
    v_cvt_pk_bf16_f32 v130, v132, v133
    v_cvt_pk_bf16_f32 v131, v134, v135
    buffer_store_dwordx4 v[128:131], v2, s[4:7], s66 offen offset:0 sc1
    v_cvt_pk_bf16_f32 v136, v136, v137
    v_cvt_pk_bf16_f32 v137, v138, v139
    v_cvt_pk_bf16_f32 v138, v140, v141
    v_cvt_pk_bf16_f32 v139, v142, v143
    buffer_store_dwordx4 v[136:139], v2, s[4:7], s66 offen offset:1024 sc1
    v_cvt_pk_bf16_f32 v144, v144, v145
    v_cvt_pk_bf16_f32 v145, v146, v147
    v_cvt_pk_bf16_f32 v146, v148, v149
    v_cvt_pk_bf16_f32 v147, v150, v151
    buffer_store_dwordx4 v[144:147], v2, s[4:7], s66 offen offset:2048 sc1
    v_cvt_pk_bf16_f32 v152, v152, v153
    v_cvt_pk_bf16_f32 v153, v154, v155
    v_cvt_pk_bf16_f32 v154, v156, v157
    v_cvt_pk_bf16_f32 v155, v158, v159
    buffer_store_dwordx4 v[152:155], v2, s[4:7], s66 offen offset:3072 sc1
    s_add_u32 s56, s66, 4096
    v_cvt_pk_bf16_f32 v160, v160, v161
    v_cvt_pk_bf16_f32 v161, v162, v163
    v_cvt_pk_bf16_f32 v162, v164, v165
    v_cvt_pk_bf16_f32 v163, v166, v167
    buffer_store_dwordx4 v[160:163], v2, s[4:7], s56 offen offset:0 sc1
    v_cvt_pk_bf16_f32 v168, v168, v169
    v_cvt_pk_bf16_f32 v169, v170, v171
    v_cvt_pk_bf16_f32 v170, v172, v173
    v_cvt_pk_bf16_f32 v171, v174, v175
    buffer_store_dwordx4 v[168:171], v2, s[4:7], s56 offen offset:1024 sc1
    v_cvt_pk_bf16_f32 v176, v176, v177
    v_cvt_pk_bf16_f32 v177, v178, v179
    v_cvt_pk_bf16_f32 v178, v180, v181
    v_cvt_pk_bf16_f32 v179, v182, v183
    buffer_store_dwordx4 v[176:179], v2, s[4:7], s56 offen offset:2048 sc1
    v_cvt_pk_bf16_f32 v184, v184, v185
    v_cvt_pk_bf16_f32 v185, v186, v187
    v_cvt_pk_bf16_f32 v186, v188, v189
    v_cvt_pk_bf16_f32 v187, v190, v191
    buffer_store_dwordx4 v[184:187], v2, s[4:7], s56 offen offset:3072 sc1
    s_lshl_b32 s56, s69, 8
    s_xor_b32 s56, s56, s45
    s_lshr_b32 s57, s62, 1
    s_lshl_b32 s57, s57, 6
    s_add_u32 s56, s56, s57
    s_and_b32 s57, s62, 1
    s_lshl_b32 s57, s57, 2
    s_add_u32 s56, s56, s57
    s_add_u32 s56, s56, 0x5200020
    v_mov_b32 v13, 1
    s_waitcnt vmcnt(0)
    s_mov_b64 exec, 1
    buffer_store_dword v13, off, s[4:7], s56 sc1
    s_mov_b64 exec, -1
    s_branch W_NEXT
W_EP_H:
    v_mul_f32 v64, 0xbfb8aa3b, v128
    v_mul_f32 v65, 0xbfb8aa3b, v129
    v_mul_f32 v66, 0xbfb8aa3b, v130
    v_mul_f32 v67, 0xbfb8aa3b, v131
    v_mul_f32 v68, 0xbfb8aa3b, v132
    v_mul_f32 v69, 0xbfb8aa3b, v133
    v_mul_f32 v70, 0xbfb8aa3b, v134
    v_mul_f32 v71, 0xbfb8aa3b, v135
    v_exp_f32 v64, v64
    v_exp_f32 v65, v65
    v_exp_f32 v66, v66
    v_exp_f32 v67, v67
    v_exp_f32 v68, v68
    v_exp_f32 v69, v69
    v_exp_f32 v70, v70
    v_exp_f32 v71, v71
    v_add_f32 v64, 1.0, v64
    v_add_f32 v65, 1.0, v65
    v_add_f32 v66, 1.0, v66
    v_add_f32 v67, 1.0, v67
    v_add_f32 v68, 1.0, v68
    v_add_f32 v69, 1.0, v69
    v_add_f32 v70, 1.0, v70
    v_add_f32 v71, 1.0, v71
    v_rcp_f32 v64, v64
    v_rcp_f32 v65, v65
    v_rcp_f32 v66, v66
    v_rcp_f32 v67, v67
    v_rcp_f32 v68, v68
    v_rcp_f32 v69, v69
    v_rcp_f32 v70, v70
    v_rcp_f32 v71, v71
    v_mul_f32 v128, v128, v64
    v_mul_f32 v129, v129, v65
    v_mul_f32 v130, v130, v66
    v_mul_f32 v131, v131, v67
    v_mul_f32 v132, v132, v68
    v_mul_f32 v133, v133, v69
    v_mul_f32 v134, v134, v70
    v_mul_f32 v135, v135, v71
    v_cvt_pk_bf16_f32 v128, v128, v129
    v_cvt_pk_bf16_f32 v129, v130, v131
    v_cvt_pk_bf16_f32 v130, v132, v133
    v_cvt_pk_bf16_f32 v131, v134, v135
    buffer_store_dwordx4 v[128:131], v2, s[4:7], s66 offen offset:0 sc1
    v_mul_f32 v72, 0xbfb8aa3b, v136
    v_mul_f32 v73, 0xbfb8aa3b, v137
    v_mul_f32 v74, 0xbfb8aa3b, v138
    v_mul_f32 v75, 0xbfb8aa3b, v139
    v_mul_f32 v76, 0xbfb8aa3b, v140
    v_mul_f32 v77, 0xbfb8aa3b, v141
    v_mul_f32 v78, 0xbfb8aa3b, v142
    v_mul_f32 v79, 0xbfb8aa3b, v143
    v_exp_f32 v72, v72
    v_exp_f32 v73, v73
    v_exp_f32 v74, v74
    v_exp_f32 v75, v75
    v_exp_f32 v76, v76
    v_exp_f32 v77, v77
    v_exp_f32 v78, v78
    v_exp_f32 v79, v79
    v_add_f32 v72, 1.0, v72
    v_add_f32 v73, 1.0, v73
    v_add_f32 v74, 1.0, v74
    v_add_f32 v75, 1.0, v75
    v_add_f32 v76, 1.0, v76
    v_add_f32 v77, 1.0, v77
    v_add_f32 v78, 1.0, v78
    v_add_f32 v79, 1.0, v79
    v_rcp_f32 v72, v72
    v_rcp_f32 v73, v73
    v_rcp_f32 v74, v74
    v_rcp_f32 v75, v75
    v_rcp_f32 v76, v76
    v_rcp_f32 v77, v77
    v_rcp_f32 v78, v78
    v_rcp_f32 v79, v79
    v_mul_f32 v136, v136, v72
    v_mul_f32 v137, v137, v73
    v_mul_f32 v138, v138, v74
    v_mul_f32 v139, v139, v75
    v_mul_f32 v140, v140, v76
    v_mul_f32 v141, v141, v77
    v_mul_f32 v142, v142, v78
    v_mul_f32 v143, v143, v79
    v_cvt_pk_bf16_f32 v136, v136, v137
    v_cvt_pk_bf16_f32 v137, v138, v139
    v_cvt_pk_bf16_f32 v138, v140, v141
    v_cvt_pk_bf16_f32 v139, v142, v143
    buffer_store_dwordx4 v[136:139], v2, s[4:7], s66 offen offset:1024 sc1
    v_mul_f32 v64, 0xbfb8aa3b, v144
    v_mul_f32 v65, 0xbfb8aa3b, v145
    v_mul_f32 v66, 0xbfb8aa3b, v146
    v_mul_f32 v67, 0xbfb8aa3b, v147
    v_mul_f32 v68, 0xbfb8aa3b, v148
    v_mul_f32 v69, 0xbfb8aa3b, v149
    v_mul_f32 v70, 0xbfb8aa3b, v150
    v_mul_f32 v71, 0xbfb8aa3b, v151
    v_exp_f32 v64, v64
    v_exp_f32 v65, v65
    v_exp_f32 v66, v66
    v_exp_f32 v67, v67
    v_exp_f32 v68, v68
    v_exp_f32 v69, v69
    v_exp_f32 v70, v70
    v_exp_f32 v71, v71
    v_add_f32 v64, 1.0, v64
    v_add_f32 v65, 1.0, v65
    v_add_f32 v66, 1.0, v66
    v_add_f32 v67, 1.0, v67
    v_add_f32 v68, 1.0, v68
    v_add_f32 v69, 1.0, v69
    v_add_f32 v70, 1.0, v70
    v_add_f32 v71, 1.0, v71
    v_rcp_f32 v64, v64
    v_rcp_f32 v65, v65
    v_rcp_f32 v66, v66
    v_rcp_f32 v67, v67
    v_rcp_f32 v68, v68
    v_rcp_f32 v69, v69
    v_rcp_f32 v70, v70
    v_rcp_f32 v71, v71
    v_mul_f32 v144, v144, v64
    v_mul_f32 v145, v145, v65
    v_mul_f32 v146, v146, v66
    v_mul_f32 v147, v147, v67
    v_mul_f32 v148, v148, v68
    v_mul_f32 v149, v149, v69
    v_mul_f32 v150, v150, v70
    v_mul_f32 v151, v151, v71
    v_cvt_pk_bf16_f32 v144, v144, v145
    v_cvt_pk_bf16_f32 v145, v146, v147
    v_cvt_pk_bf16_f32 v146, v148, v149
    v_cvt_pk_bf16_f32 v147, v150, v151
    buffer_store_dwordx4 v[144:147], v2, s[4:7], s66 offen offset:2048 sc1
    v_mul_f32 v72, 0xbfb8aa3b, v152
    v_mul_f32 v73, 0xbfb8aa3b, v153
    v_mul_f32 v74, 0xbfb8aa3b, v154
    v_mul_f32 v75, 0xbfb8aa3b, v155
    v_mul_f32 v76, 0xbfb8aa3b, v156
    v_mul_f32 v77, 0xbfb8aa3b, v157
    v_mul_f32 v78, 0xbfb8aa3b, v158
    v_mul_f32 v79, 0xbfb8aa3b, v159
    v_exp_f32 v72, v72
    v_exp_f32 v73, v73
    v_exp_f32 v74, v74
    v_exp_f32 v75, v75
    v_exp_f32 v76, v76
    v_exp_f32 v77, v77
    v_exp_f32 v78, v78
    v_exp_f32 v79, v79
    v_add_f32 v72, 1.0, v72
    v_add_f32 v73, 1.0, v73
    v_add_f32 v74, 1.0, v74
    v_add_f32 v75, 1.0, v75
    v_add_f32 v76, 1.0, v76
    v_add_f32 v77, 1.0, v77
    v_add_f32 v78, 1.0, v78
    v_add_f32 v79, 1.0, v79
    v_rcp_f32 v72, v72
    v_rcp_f32 v73, v73
    v_rcp_f32 v74, v74
    v_rcp_f32 v75, v75
    v_rcp_f32 v76, v76
    v_rcp_f32 v77, v77
    v_rcp_f32 v78, v78
    v_rcp_f32 v79, v79
    v_mul_f32 v152, v152, v72
    v_mul_f32 v153, v153, v73
    v_mul_f32 v154, v154, v74
    v_mul_f32 v155, v155, v75
    v_mul_f32 v156, v156, v76
    v_mul_f32 v157, v157, v77
    v_mul_f32 v158, v158, v78
    v_mul_f32 v159, v159, v79
    v_cvt_pk_bf16_f32 v152, v152, v153
    v_cvt_pk_bf16_f32 v153, v154, v155
    v_cvt_pk_bf16_f32 v154, v156, v157
    v_cvt_pk_bf16_f32 v155, v158, v159
    buffer_store_dwordx4 v[152:155], v2, s[4:7], s66 offen offset:3072 sc1
    s_add_u32 s56, s66, 4096
    v_mul_f32 v64, 0xbfb8aa3b, v160
    v_mul_f32 v65, 0xbfb8aa3b, v161
    v_mul_f32 v66, 0xbfb8aa3b, v162
    v_mul_f32 v67, 0xbfb8aa3b, v163
    v_mul_f32 v68, 0xbfb8aa3b, v164
    v_mul_f32 v69, 0xbfb8aa3b, v165
    v_mul_f32 v70, 0xbfb8aa3b, v166
    v_mul_f32 v71, 0xbfb8aa3b, v167
    v_exp_f32 v64, v64
    v_exp_f32 v65, v65
    v_exp_f32 v66, v66
    v_exp_f32 v67, v67
    v_exp_f32 v68, v68
    v_exp_f32 v69, v69
    v_exp_f32 v70, v70
    v_exp_f32 v71, v71
    v_add_f32 v64, 1.0, v64
    v_add_f32 v65, 1.0, v65
    v_add_f32 v66, 1.0, v66
    v_add_f32 v67, 1.0, v67
    v_add_f32 v68, 1.0, v68
    v_add_f32 v69, 1.0, v69
    v_add_f32 v70, 1.0, v70
    v_add_f32 v71, 1.0, v71
    v_rcp_f32 v64, v64
    v_rcp_f32 v65, v65
    v_rcp_f32 v66, v66
    v_rcp_f32 v67, v67
    v_rcp_f32 v68, v68
    v_rcp_f32 v69, v69
    v_rcp_f32 v70, v70
    v_rcp_f32 v71, v71
    v_mul_f32 v160, v160, v64
    v_mul_f32 v161, v161, v65
    v_mul_f32 v162, v162, v66
    v_mul_f32 v163, v163, v67
    v_mul_f32 v164, v164, v68
    v_mul_f32 v165, v165, v69
    v_mul_f32 v166, v166, v70
    v_mul_f32 v167, v167, v71
    v_cvt_pk_bf16_f32 v160, v160, v161
    v_cvt_pk_bf16_f32 v161, v162, v163
    v_cvt_pk_bf16_f32 v162, v164, v165
    v_cvt_pk_bf16_f32 v163, v166, v167
    buffer_store_dwordx4 v[160:163], v2, s[4:7], s56 offen offset:0 sc1
    v_mul_f32 v72, 0xbfb8aa3b, v168
    v_mul_f32 v73, 0xbfb8aa3b, v169
    v_mul_f32 v74, 0xbfb8aa3b, v170
    v_mul_f32 v75, 0xbfb8aa3b, v171
    v_mul_f32 v76, 0xbfb8aa3b, v172
    v_mul_f32 v77, 0xbfb8aa3b, v173
    v_mul_f32 v78, 0xbfb8aa3b, v174
    v_mul_f32 v79, 0xbfb8aa3b, v175
    v_exp_f32 v72, v72
    v_exp_f32 v73, v73
    v_exp_f32 v74, v74
    v_exp_f32 v75, v75
    v_exp_f32 v76, v76
    v_exp_f32 v77, v77
    v_exp_f32 v78, v78
    v_exp_f32 v79, v79
    v_add_f32 v72, 1.0, v72
    v_add_f32 v73, 1.0, v73
    v_add_f32 v74, 1.0, v74
    v_add_f32 v75, 1.0, v75
    v_add_f32 v76, 1.0, v76
    v_add_f32 v77, 1.0, v77
    v_add_f32 v78, 1.0, v78
    v_add_f32 v79, 1.0, v79
    v_rcp_f32 v72, v72
    v_rcp_f32 v73, v73
    v_rcp_f32 v74, v74
    v_rcp_f32 v75, v75
    v_rcp_f32 v76, v76
    v_rcp_f32 v77, v77
    v_rcp_f32 v78, v78
    v_rcp_f32 v79, v79
    v_mul_f32 v168, v168, v72
    v_mul_f32 v169, v169, v73
    v_mul_f32 v170, v170, v74
    v_mul_f32 v171, v171, v75
    v_mul_f32 v172, v172, v76
    v_mul_f32 v173, v173, v77
    v_mul_f32 v174, v174, v78
    v_mul_f32 v175, v175, v79
    v_cvt_pk_bf16_f32 v168, v168, v169
    v_cvt_pk_bf16_f32 v169, v170, v171
    v_cvt_pk_bf16_f32 v170, v172, v173
    v_cvt_pk_bf16_f32 v171, v174, v175
    buffer_store_dwordx4 v[168:171], v2, s[4:7], s56 offen offset:1024 sc1
    v_mul_f32 v64, 0xbfb8aa3b, v176
    v_mul_f32 v65, 0xbfb8aa3b, v177
    v_mul_f32 v66, 0xbfb8aa3b, v178
    v_mul_f32 v67, 0xbfb8aa3b, v179
    v_mul_f32 v68, 0xbfb8aa3b, v180
    v_mul_f32 v69, 0xbfb8aa3b, v181
    v_mul_f32 v70, 0xbfb8aa3b, v182
    v_mul_f32 v71, 0xbfb8aa3b, v183
    v_exp_f32 v64, v64
    v_exp_f32 v65, v65
    v_exp_f32 v66, v66
    v_exp_f32 v67, v67
    v_exp_f32 v68, v68
    v_exp_f32 v69, v69
    v_exp_f32 v70, v70
    v_exp_f32 v71, v71
    v_add_f32 v64, 1.0, v64
    v_add_f32 v65, 1.0, v65
    v_add_f32 v66, 1.0, v66
    v_add_f32 v67, 1.0, v67
    v_add_f32 v68, 1.0, v68
    v_add_f32 v69, 1.0, v69
    v_add_f32 v70, 1.0, v70
    v_add_f32 v71, 1.0, v71
    v_rcp_f32 v64, v64
    v_rcp_f32 v65, v65
    v_rcp_f32 v66, v66
    v_rcp_f32 v67, v67
    v_rcp_f32 v68, v68
    v_rcp_f32 v69, v69
    v_rcp_f32 v70, v70
    v_rcp_f32 v71, v71
    v_mul_f32 v176, v176, v64
    v_mul_f32 v177, v177, v65
    v_mul_f32 v178, v178, v66
    v_mul_f32 v179, v179, v67
    v_mul_f32 v180, v180, v68
    v_mul_f32 v181, v181, v69
    v_mul_f32 v182, v182, v70
    v_mul_f32 v183, v183, v71
    v_cvt_pk_bf16_f32 v176, v176, v177
    v_cvt_pk_bf16_f32 v177, v178, v179
    v_cvt_pk_bf16_f32 v178, v180, v181
    v_cvt_pk_bf16_f32 v179, v182, v183
    buffer_store_dwordx4 v[176:179], v2, s[4:7], s56 offen offset:2048 sc1
    v_mul_f32 v72, 0xbfb8aa3b, v184
    v_mul_f32 v73, 0xbfb8aa3b, v185
    v_mul_f32 v74, 0xbfb8aa3b, v186
    v_mul_f32 v75, 0xbfb8aa3b, v187
    v_mul_f32 v76, 0xbfb8aa3b, v188
    v_mul_f32 v77, 0xbfb8aa3b, v189
    v_mul_f32 v78, 0xbfb8aa3b, v190
    v_mul_f32 v79, 0xbfb8aa3b, v191
    v_exp_f32 v72, v72
    v_exp_f32 v73, v73
    v_exp_f32 v74, v74
    v_exp_f32 v75, v75
    v_exp_f32 v76, v76
    v_exp_f32 v77, v77
    v_exp_f32 v78, v78
    v_exp_f32 v79, v79
    v_add_f32 v72, 1.0, v72
    v_add_f32 v73, 1.0, v73
    v_add_f32 v74, 1.0, v74
    v_add_f32 v75, 1.0, v75
    v_add_f32 v76, 1.0, v76
    v_add_f32 v77, 1.0, v77
    v_add_f32 v78, 1.0, v78
    v_add_f32 v79, 1.0, v79
    v_rcp_f32 v72, v72
    v_rcp_f32 v73, v73
    v_rcp_f32 v74, v74
    v_rcp_f32 v75, v75
    v_rcp_f32 v76, v76
    v_rcp_f32 v77, v77
    v_rcp_f32 v78, v78
    v_rcp_f32 v79, v79
    v_mul_f32 v184, v184, v72
    v_mul_f32 v185, v185, v73
    v_mul_f32 v186, v186, v74
    v_mul_f32 v187, v187, v75
    v_mul_f32 v188, v188, v76
    v_mul_f32 v189, v189, v77
    v_mul_f32 v190, v190, v78
    v_mul_f32 v191, v191, v79
    v_cvt_pk_bf16_f32 v184, v184, v185
    v_cvt_pk_bf16_f32 v185, v186, v187
    v_cvt_pk_bf16_f32 v186, v188, v189
    v_cvt_pk_bf16_f32 v187, v190, v191
    buffer_store_dwordx4 v[184:187], v2, s[4:7], s56 offen offset:3072 sc1
    s_add_u32 s56, s66, 0
    s_add_u32 s56, s56, s67
    v_mul_f32 v64, 0xbfb8aa3b, v192
    v_mul_f32 v65, 0xbfb8aa3b, v193
    v_mul_f32 v66, 0xbfb8aa3b, v194
    v_mul_f32 v67, 0xbfb8aa3b, v195
    v_mul_f32 v68, 0xbfb8aa3b, v196
    v_mul_f32 v69, 0xbfb8aa3b, v197
    v_mul_f32 v70, 0xbfb8aa3b, v198
    v_mul_f32 v71, 0xbfb8aa3b, v199
    v_exp_f32 v64, v64
    v_exp_f32 v65, v65
    v_exp_f32 v66, v66
    v_exp_f32 v67, v67
    v_exp_f32 v68, v68
    v_exp_f32 v69, v69
    v_exp_f32 v70, v70
    v_exp_f32 v71, v71
    v_add_f32 v64, 1.0, v64
    v_add_f32 v65, 1.0, v65
    v_add_f32 v66, 1.0, v66
    v_add_f32 v67, 1.0, v67
    v_add_f32 v68, 1.0, v68
    v_add_f32 v69, 1.0, v69
    v_add_f32 v70, 1.0, v70
    v_add_f32 v71, 1.0, v71
    v_rcp_f32 v64, v64
    v_rcp_f32 v65, v65
    v_rcp_f32 v66, v66
    v_rcp_f32 v67, v67
    v_rcp_f32 v68, v68
    v_rcp_f32 v69, v69
    v_rcp_f32 v70, v70
    v_rcp_f32 v71, v71
    v_mul_f32 v192, v192, v64
    v_mul_f32 v193, v193, v65
    v_mul_f32 v194, v194, v66
    v_mul_f32 v195, v195, v67
    v_mul_f32 v196, v196, v68
    v_mul_f32 v197, v197, v69
    v_mul_f32 v198, v198, v70
    v_mul_f32 v199, v199, v71
    v_cvt_pk_bf16_f32 v192, v192, v193
    v_cvt_pk_bf16_f32 v193, v194, v195
    v_cvt_pk_bf16_f32 v194, v196, v197
    v_cvt_pk_bf16_f32 v195, v198, v199
    buffer_store_dwordx4 v[192:195], v2, s[4:7], s56 offen offset:0 sc1
    v_mul_f32 v72, 0xbfb8aa3b, v200
    v_mul_f32 v73, 0xbfb8aa3b, v201
    v_mul_f32 v74, 0xbfb8aa3b, v202
    v_mul_f32 v75, 0xbfb8aa3b, v203
    v_mul_f32 v76, 0xbfb8aa3b, v204
    v_mul_f32 v77, 0xbfb8aa3b, v205
    v_mul_f32 v78, 0xbfb8aa3b, v206
    v_mul_f32 v79, 0xbfb8aa3b, v207
    v_exp_f32 v72, v72
    v_exp_f32 v73, v73
    v_exp_f32 v74, v74
    v_exp_f32 v75, v75
    v_exp_f32 v76, v76
    v_exp_f32 v77, v77
    v_exp_f32 v78, v78
    v_exp_f32 v79, v79
    v_add_f32 v72, 1.0, v72
    v_add_f32 v73, 1.0, v73
    v_add_f32 v74, 1.0, v74
    v_add_f32 v75, 1.0, v75
    v_add_f32 v76, 1.0, v76
    v_add_f32 v77, 1.0, v77
    v_add_f32 v78, 1.0, v78
    v_add_f32 v79, 1.0, v79
    v_rcp_f32 v72, v72
    v_rcp_f32 v73, v73
    v_rcp_f32 v74, v74
    v_rcp_f32 v75, v75
    v_rcp_f32 v76, v76
    v_rcp_f32 v77, v77
    v_rcp_f32 v78, v78
    v_rcp_f32 v79, v79
    v_mul_f32 v200, v200, v72
    v_mul_f32 v201, v201, v73
    v_mul_f32 v202, v202, v74
    v_mul_f32 v203, v203, v75
    v_mul_f32 v204, v204, v76
    v_mul_f32 v205, v205, v77
    v_mul_f32 v206, v206, v78
    v_mul_f32 v207, v207, v79
    v_cvt_pk_bf16_f32 v200, v200, v201
    v_cvt_pk_bf16_f32 v201, v202, v203
    v_cvt_pk_bf16_f32 v202, v204, v205
    v_cvt_pk_bf16_f32 v203, v206, v207
    buffer_store_dwordx4 v[200:203], v2, s[4:7], s56 offen offset:1024 sc1
    v_mul_f32 v64, 0xbfb8aa3b, v208
    v_mul_f32 v65, 0xbfb8aa3b, v209
    v_mul_f32 v66, 0xbfb8aa3b, v210
    v_mul_f32 v67, 0xbfb8aa3b, v211
    v_mul_f32 v68, 0xbfb8aa3b, v212
    v_mul_f32 v69, 0xbfb8aa3b, v213
    v_mul_f32 v70, 0xbfb8aa3b, v214
    v_mul_f32 v71, 0xbfb8aa3b, v215
    v_exp_f32 v64, v64
    v_exp_f32 v65, v65
    v_exp_f32 v66, v66
    v_exp_f32 v67, v67
    v_exp_f32 v68, v68
    v_exp_f32 v69, v69
    v_exp_f32 v70, v70
    v_exp_f32 v71, v71
    v_add_f32 v64, 1.0, v64
    v_add_f32 v65, 1.0, v65
    v_add_f32 v66, 1.0, v66
    v_add_f32 v67, 1.0, v67
    v_add_f32 v68, 1.0, v68
    v_add_f32 v69, 1.0, v69
    v_add_f32 v70, 1.0, v70
    v_add_f32 v71, 1.0, v71
    v_rcp_f32 v64, v64
    v_rcp_f32 v65, v65
    v_rcp_f32 v66, v66
    v_rcp_f32 v67, v67
    v_rcp_f32 v68, v68
    v_rcp_f32 v69, v69
    v_rcp_f32 v70, v70
    v_rcp_f32 v71, v71
    v_mul_f32 v208, v208, v64
    v_mul_f32 v209, v209, v65
    v_mul_f32 v210, v210, v66
    v_mul_f32 v211, v211, v67
    v_mul_f32 v212, v212, v68
    v_mul_f32 v213, v213, v69
    v_mul_f32 v214, v214, v70
    v_mul_f32 v215, v215, v71
    v_cvt_pk_bf16_f32 v208, v208, v209
    v_cvt_pk_bf16_f32 v209, v210, v211
    v_cvt_pk_bf16_f32 v210, v212, v213
    v_cvt_pk_bf16_f32 v211, v214, v215
    buffer_store_dwordx4 v[208:211], v2, s[4:7], s56 offen offset:2048 sc1
    v_mul_f32 v72, 0xbfb8aa3b, v216
    v_mul_f32 v73, 0xbfb8aa3b, v217
    v_mul_f32 v74, 0xbfb8aa3b, v218
    v_mul_f32 v75, 0xbfb8aa3b, v219
    v_mul_f32 v76, 0xbfb8aa3b, v220
    v_mul_f32 v77, 0xbfb8aa3b, v221
    v_mul_f32 v78, 0xbfb8aa3b, v222
    v_mul_f32 v79, 0xbfb8aa3b, v223
    v_exp_f32 v72, v72
    v_exp_f32 v73, v73
    v_exp_f32 v74, v74
    v_exp_f32 v75, v75
    v_exp_f32 v76, v76
    v_exp_f32 v77, v77
    v_exp_f32 v78, v78
    v_exp_f32 v79, v79
    v_add_f32 v72, 1.0, v72
    v_add_f32 v73, 1.0, v73
    v_add_f32 v74, 1.0, v74
    v_add_f32 v75, 1.0, v75
    v_add_f32 v76, 1.0, v76
    v_add_f32 v77, 1.0, v77
    v_add_f32 v78, 1.0, v78
    v_add_f32 v79, 1.0, v79
    v_rcp_f32 v72, v72
    v_rcp_f32 v73, v73
    v_rcp_f32 v74, v74
    v_rcp_f32 v75, v75
    v_rcp_f32 v76, v76
    v_rcp_f32 v77, v77
    v_rcp_f32 v78, v78
    v_rcp_f32 v79, v79
    v_mul_f32 v216, v216, v72
    v_mul_f32 v217, v217, v73
    v_mul_f32 v218, v218, v74
    v_mul_f32 v219, v219, v75
    v_mul_f32 v220, v220, v76
    v_mul_f32 v221, v221, v77
    v_mul_f32 v222, v222, v78
    v_mul_f32 v223, v223, v79
    v_cvt_pk_bf16_f32 v216, v216, v217
    v_cvt_pk_bf16_f32 v217, v218, v219
    v_cvt_pk_bf16_f32 v218, v220, v221
    v_cvt_pk_bf16_f32 v219, v222, v223
    buffer_store_dwordx4 v[216:219], v2, s[4:7], s56 offen offset:3072 sc1
    s_add_u32 s56, s66, 4096
    s_add_u32 s56, s56, s67
    v_mul_f32 v64, 0xbfb8aa3b, v224
    v_mul_f32 v65, 0xbfb8aa3b, v225
    v_mul_f32 v66, 0xbfb8aa3b, v226
    v_mul_f32 v67, 0xbfb8aa3b, v227
    v_mul_f32 v68, 0xbfb8aa3b, v228
    v_mul_f32 v69, 0xbfb8aa3b, v229
    v_mul_f32 v70, 0xbfb8aa3b, v230
    v_mul_f32 v71, 0xbfb8aa3b, v231
    v_exp_f32 v64, v64
    v_exp_f32 v65, v65
    v_exp_f32 v66, v66
    v_exp_f32 v67, v67
    v_exp_f32 v68, v68
    v_exp_f32 v69, v69
    v_exp_f32 v70, v70
    v_exp_f32 v71, v71
    v_add_f32 v64, 1.0, v64
    v_add_f32 v65, 1.0, v65
    v_add_f32 v66, 1.0, v66
    v_add_f32 v67, 1.0, v67
    v_add_f32 v68, 1.0, v68
    v_add_f32 v69, 1.0, v69
    v_add_f32 v70, 1.0, v70
    v_add_f32 v71, 1.0, v71
    v_rcp_f32 v64, v64
    v_rcp_f32 v65, v65
    v_rcp_f32 v66, v66
    v_rcp_f32 v67, v67
    v_rcp_f32 v68, v68
    v_rcp_f32 v69, v69
    v_rcp_f32 v70, v70
    v_rcp_f32 v71, v71
    v_mul_f32 v224, v224, v64
    v_mul_f32 v225, v225, v65
    v_mul_f32 v226, v226, v66
    v_mul_f32 v227, v227, v67
    v_mul_f32 v228, v228, v68
    v_mul_f32 v229, v229, v69
    v_mul_f32 v230, v230, v70
    v_mul_f32 v231, v231, v71
    v_cvt_pk_bf16_f32 v224, v224, v225
    v_cvt_pk_bf16_f32 v225, v226, v227
    v_cvt_pk_bf16_f32 v226, v228, v229
    v_cvt_pk_bf16_f32 v227, v230, v231
    buffer_store_dwordx4 v[224:227], v2, s[4:7], s56 offen offset:0 sc1
    v_mul_f32 v72, 0xbfb8aa3b, v232
    v_mul_f32 v73, 0xbfb8aa3b, v233
    v_mul_f32 v74, 0xbfb8aa3b, v234
    v_mul_f32 v75, 0xbfb8aa3b, v235
    v_mul_f32 v76, 0xbfb8aa3b, v236
    v_mul_f32 v77, 0xbfb8aa3b, v237
    v_mul_f32 v78, 0xbfb8aa3b, v238
    v_mul_f32 v79, 0xbfb8aa3b, v239
    v_exp_f32 v72, v72
    v_exp_f32 v73, v73
    v_exp_f32 v74, v74
    v_exp_f32 v75, v75
    v_exp_f32 v76, v76
    v_exp_f32 v77, v77
    v_exp_f32 v78, v78
    v_exp_f32 v79, v79
    v_add_f32 v72, 1.0, v72
    v_add_f32 v73, 1.0, v73
    v_add_f32 v74, 1.0, v74
    v_add_f32 v75, 1.0, v75
    v_add_f32 v76, 1.0, v76
    v_add_f32 v77, 1.0, v77
    v_add_f32 v78, 1.0, v78
    v_add_f32 v79, 1.0, v79
    v_rcp_f32 v72, v72
    v_rcp_f32 v73, v73
    v_rcp_f32 v74, v74
    v_rcp_f32 v75, v75
    v_rcp_f32 v76, v76
    v_rcp_f32 v77, v77
    v_rcp_f32 v78, v78
    v_rcp_f32 v79, v79
    v_mul_f32 v232, v232, v72
    v_mul_f32 v233, v233, v73
    v_mul_f32 v234, v234, v74
    v_mul_f32 v235, v235, v75
    v_mul_f32 v236, v236, v76
    v_mul_f32 v237, v237, v77
    v_mul_f32 v238, v238, v78
    v_mul_f32 v239, v239, v79
    v_cvt_pk_bf16_f32 v232, v232, v233
    v_cvt_pk_bf16_f32 v233, v234, v235
    v_cvt_pk_bf16_f32 v234, v236, v237
    v_cvt_pk_bf16_f32 v235, v238, v239
    buffer_store_dwordx4 v[232:235], v2, s[4:7], s56 offen offset:1024 sc1
    v_mul_f32 v64, 0xbfb8aa3b, v240
    v_mul_f32 v65, 0xbfb8aa3b, v241
    v_mul_f32 v66, 0xbfb8aa3b, v242
    v_mul_f32 v67, 0xbfb8aa3b, v243
    v_mul_f32 v68, 0xbfb8aa3b, v244
    v_mul_f32 v69, 0xbfb8aa3b, v245
    v_mul_f32 v70, 0xbfb8aa3b, v246
    v_mul_f32 v71, 0xbfb8aa3b, v247
    v_exp_f32 v64, v64
    v_exp_f32 v65, v65
    v_exp_f32 v66, v66
    v_exp_f32 v67, v67
    v_exp_f32 v68, v68
    v_exp_f32 v69, v69
    v_exp_f32 v70, v70
    v_exp_f32 v71, v71
    v_add_f32 v64, 1.0, v64
    v_add_f32 v65, 1.0, v65
    v_add_f32 v66, 1.0, v66
    v_add_f32 v67, 1.0, v67
    v_add_f32 v68, 1.0, v68
    v_add_f32 v69, 1.0, v69
    v_add_f32 v70, 1.0, v70
    v_add_f32 v71, 1.0, v71
    v_rcp_f32 v64, v64
    v_rcp_f32 v65, v65
    v_rcp_f32 v66, v66
    v_rcp_f32 v67, v67
    v_rcp_f32 v68, v68
    v_rcp_f32 v69, v69
    v_rcp_f32 v70, v70
    v_rcp_f32 v71, v71
    v_mul_f32 v240, v240, v64
    v_mul_f32 v241, v241, v65
    v_mul_f32 v242, v242, v66
    v_mul_f32 v243, v243, v67
    v_mul_f32 v244, v244, v68
    v_mul_f32 v245, v245, v69
    v_mul_f32 v246, v246, v70
    v_mul_f32 v247, v247, v71
    v_cvt_pk_bf16_f32 v240, v240, v241
    v_cvt_pk_bf16_f32 v241, v242, v243
    v_cvt_pk_bf16_f32 v242, v244, v245
    v_cvt_pk_bf16_f32 v243, v246, v247
    buffer_store_dwordx4 v[240:243], v2, s[4:7], s56 offen offset:2048 sc1
    v_mul_f32 v72, 0xbfb8aa3b, v248
    v_mul_f32 v73, 0xbfb8aa3b, v249
    v_mul_f32 v74, 0xbfb8aa3b, v250
    v_mul_f32 v75, 0xbfb8aa3b, v251
    v_mul_f32 v76, 0xbfb8aa3b, v252
    v_mul_f32 v77, 0xbfb8aa3b, v253
    v_mul_f32 v78, 0xbfb8aa3b, v254
    v_mul_f32 v79, 0xbfb8aa3b, v255
    v_exp_f32 v72, v72
    v_exp_f32 v73, v73
    v_exp_f32 v74, v74
    v_exp_f32 v75, v75
    v_exp_f32 v76, v76
    v_exp_f32 v77, v77
    v_exp_f32 v78, v78
    v_exp_f32 v79, v79
    v_add_f32 v72, 1.0, v72
    v_add_f32 v73, 1.0, v73
    v_add_f32 v74, 1.0, v74
    v_add_f32 v75, 1.0, v75
    v_add_f32 v76, 1.0, v76
    v_add_f32 v77, 1.0, v77
    v_add_f32 v78, 1.0, v78
    v_add_f32 v79, 1.0, v79
    v_rcp_f32 v72, v72
    v_rcp_f32 v73, v73
    v_rcp_f32 v74, v74
    v_rcp_f32 v75, v75
    v_rcp_f32 v76, v76
    v_rcp_f32 v77, v77
    v_rcp_f32 v78, v78
    v_rcp_f32 v79, v79
    v_mul_f32 v248, v248, v72
    v_mul_f32 v249, v249, v73
    v_mul_f32 v250, v250, v74
    v_mul_f32 v251, v251, v75
    v_mul_f32 v252, v252, v76
    v_mul_f32 v253, v253, v77
    v_mul_f32 v254, v254, v78
    v_mul_f32 v255, v255, v79
    v_cvt_pk_bf16_f32 v248, v248, v249
    v_cvt_pk_bf16_f32 v249, v250, v251
    v_cvt_pk_bf16_f32 v250, v252, v253
    v_cvt_pk_bf16_f32 v251, v254, v255
    buffer_store_dwordx4 v[248:251], v2, s[4:7], s56 offen offset:3072 sc1
    s_lshl_b32 s56, s61, 5
    s_add_u32 s56, s56, s62
    s_lshl_b32 s56, s56, 6
    s_add_u32 s56, s56, 0x5200030
    s_waitcnt vmcnt(0)
    s_barrier
    s_cmp_lg_u32 s44, 0
    s_cbranch_scc1 hsig_42
    v_mov_b32 v13, 1
    s_mov_b64 exec, 1
    buffer_store_dword v13, off, s[4:7], s56 sc1
    s_mov_b64 exec, -1
hsig_42:
    s_branch W_NEXT
W_EP_Q:
    v_cvt_pk_bf16_f32 v64, v128, v129
    v_cvt_pk_bf16_f32 v65, v130, v131
    v_cvt_pk_bf16_f32 v66, v132, v133
    v_cvt_pk_bf16_f32 v67, v134, v135
    v_cvt_pk_bf16_f32 v68, v136, v137
    v_cvt_pk_bf16_f32 v69, v138, v139
    v_cvt_pk_bf16_f32 v70, v140, v141
    v_cvt_pk_bf16_f32 v71, v142, v143
    v_cvt_pk_bf16_f32 v72, v144, v145
    v_cvt_pk_bf16_f32 v73, v146, v147
    v_cvt_pk_bf16_f32 v74, v148, v149
    v_cvt_pk_bf16_f32 v75, v150, v151
    v_cvt_pk_bf16_f32 v76, v152, v153
    v_cvt_pk_bf16_f32 v77, v154, v155
    v_cvt_pk_bf16_f32 v78, v156, v157
    v_cvt_pk_bf16_f32 v79, v158, v159
    v_cvt_pk_bf16_f32 v80, v160, v161
    v_cvt_pk_bf16_f32 v81, v162, v163
    v_cvt_pk_bf16_f32 v82, v164, v165
    v_cvt_pk_bf16_f32 v83, v166, v167
    v_cvt_pk_bf16_f32 v84, v168, v169
    v_cvt_pk_bf16_f32 v85, v170, v171
    v_cvt_pk_bf16_f32 v86, v172, v173
    v_cvt_pk_bf16_f32 v87, v174, v175
    v_cvt_pk_bf16_f32 v88, v176, v177
    v_cvt_pk_bf16_f32 v89, v178, v179
    v_cvt_pk_bf16_f32 v90, v180, v181
    v_cvt_pk_bf16_f32 v91, v182, v183
    v_cvt_pk_bf16_f32 v92, v184, v185
    v_cvt_pk_bf16_f32 v93, v186, v187
    v_cvt_pk_bf16_f32 v94, v188, v189
    v_cvt_pk_bf16_f32 v95, v190, v191
    v_cvt_pk_bf16_f32 v96, v192, v193
    v_cvt_pk_bf16_f32 v97, v194, v195
    v_cvt_pk_bf16_f32 v98, v196, v197
    v_cvt_pk_bf16_f32 v99, v198, v199
    v_cvt_pk_bf16_f32 v100, v200, v201
    v_cvt_pk_bf16_f32 v101, v202, v203
    v_cvt_pk_bf16_f32 v102, v204, v205
    v_cvt_pk_bf16_f32 v103, v206, v207
    v_cvt_pk_bf16_f32 v104, v208, v209
    v_cvt_pk_bf16_f32 v105, v210, v211
    v_cvt_pk_bf16_f32 v106, v212, v213
    v_cvt_pk_bf16_f32 v107, v214, v215
    v_cvt_pk_bf16_f32 v108, v216, v217
    v_cvt_pk_bf16_f32 v109, v218, v219
    v_cvt_pk_bf16_f32 v110, v220, v221
    v_cvt_pk_bf16_f32 v111, v222, v223
    v_cvt_pk_bf16_f32 v112, v224, v225
    v_cvt_pk_bf16_f32 v113, v226, v227
    v_cvt_pk_bf16_f32 v114, v228, v229
    v_cvt_pk_bf16_f32 v115, v230, v231
    v_cvt_pk_bf16_f32 v116, v232, v233
    v_cvt_pk_bf16_f32 v117, v234, v235
    v_cvt_pk_bf16_f32 v118, v236, v237
    v_cvt_pk_bf16_f32 v119, v238, v239
    v_cvt_pk_bf16_f32 v120, v240, v241
    v_cvt_pk_bf16_f32 v121, v242, v243
    v_cvt_pk_bf16_f32 v122, v244, v245
    v_cvt_pk_bf16_f32 v123, v246, v247
    v_cvt_pk_bf16_f32 v124, v248, v249
    v_cvt_pk_bf16_f32 v125, v250, v251
    v_cvt_pk_bf16_f32 v126, v252, v253
    v_cvt_pk_bf16_f32 v127, v254, v255
    s_lshl_b32 s56, s61, 5
    s_add_u32 s56, s56, s62
    s_lshl_b32 s56, s56, 6
    s_add_u32 s56, s56, 0x5200028
    v_and_b32 v14, 4, v1
    v_bfe_u32 v17, v1, 3, 1
    v_mad_u32_u24 v14, v17, 12, v14
    s_mov_b32 s68, 0x80000
kvwait_43:
    buffer_load_dword v13, v14, s[4:7], s56 offen sc1
    s_waitcnt vmcnt(0)
    v_cmp_gt_u32 vcc, 257, v13
    s_cbranch_vccz kvwait_43_ok
    s_sub_u32 s68, s68, 1
    s_cmp_lg_u32 s68, 0
    s_cbranch_scc1 kvwait_43
kvwait_43_ok:
    s_waitcnt vmcnt(0)
    s_add_u32 s56, s66, 0xfd800000
    buffer_load_dwordx4 a[0:3], v2, s[4:7], s56 offen offset:0 sc1
    buffer_load_dwordx4 a[4:7], v2, s[4:7], s56 offen offset:1024 sc1
    buffer_load_dwordx4 a[8:11], v2, s[4:7], s56 offen offset:2048 sc1
    buffer_load_dwordx4 a[12:15], v2, s[4:7], s56 offen offset:3072 sc1
    s_add_u32 s56, s66, 0xfd801000
    buffer_load_dwordx4 a[16:19], v2, s[4:7], s56 offen offset:0 sc1
    buffer_load_dwordx4 a[20:23], v2, s[4:7], s56 offen offset:1024 sc1
    buffer_load_dwordx4 a[24:27], v2, s[4:7], s56 offen offset:2048 sc1
    buffer_load_dwordx4 a[28:31], v2, s[4:7], s56 offen offset:3072 sc1
    s_add_u32 s56, s66, 0xfe800000
    buffer_load_dwordx4 a[32:35], v2, s[4:7], s56 offen offset:0 sc1
    buffer_load_dwordx4 a[36:39], v2, s[4:7], s56 offen offset:1024 sc1
    buffer_load_dwordx4 a[40:43], v2, s[4:7], s56 offen offset:2048 sc1
    buffer_load_dwordx4 a[44:47], v2, s[4:7], s56 offen offset:3072 sc1
    s_add_u32 s56, s66, 0xfe801000
    buffer_load_dwordx4 a[48:51], v2, s[4:7], s56 offen offset:0 sc1
    buffer_load_dwordx4 a[52:55], v2, s[4:7], s56 offen offset:1024 sc1
    buffer_load_dwordx4 a[56:59], v2, s[4:7], s56 offen offset:2048 sc1
    buffer_load_dwordx4 a[60:63], v2, s[4:7], s56 offen offset:3072 sc1
    s_add_u32 s56, s66, 0xfd900000
    buffer_load_dwordx4 a[64:67], v2, s[4:7], s56 offen offset:0 sc1
    buffer_load_dwordx4 a[68:71], v2, s[4:7], s56 offen offset:1024 sc1
    buffer_load_dwordx4 a[72:75], v2, s[4:7], s56 offen offset:2048 sc1
    buffer_load_dwordx4 a[76:79], v2, s[4:7], s56 offen offset:3072 sc1
    s_add_u32 s56, s66, 0xfd901000
    buffer_load_dwordx4 a[80:83], v2, s[4:7], s56 offen offset:0 sc1
    buffer_load_dwordx4 a[84:87], v2, s[4:7], s56 offen offset:1024 sc1
    buffer_load_dwordx4 a[88:91], v2, s[4:7], s56 offen offset:2048 sc1
    buffer_load_dwordx4 a[92:95], v2, s[4:7], s56 offen offset:3072 sc1
    s_add_u32 s56, s66, 0xfe900000
    buffer_load_dwordx4 a[96:99], v2, s[4:7], s56 offen offset:0 sc1
    buffer_load_dwordx4 a[100:103], v2, s[4:7], s56 offen offset:1024 sc1
    buffer_load_dwordx4 a[104:107], v2, s[4:7], s56 offen offset:2048 sc1
    buffer_load_dwordx4 a[108:111], v2, s[4:7], s56 offen offset:3072 sc1
    s_add_u32 s56, s66, 0xfe901000
    buffer_load_dwordx4 a[112:115], v2, s[4:7], s56 offen offset:0 sc1
    buffer_load_dwordx4 a[116:119], v2, s[4:7], s56 offen offset:1024 sc1
    buffer_load_dwordx4 a[120:123], v2, s[4:7], s56 offen offset:2048 sc1
    buffer_load_dwordx4 a[124:127], v2, s[4:7], s56 offen offset:3072 sc1
    v_and_b32 v13, 31, v1
    v_lshrrev_b32 v14, 5, v1
    v_lshlrev_b32 v17, 2, v14
    v_sub_u32 v17, v13, v17
    v_mov_b32 v18, 0xf149f2ca
    v_cmp_gt_i32 vcc, 0, v17
    s_nop 1
    v_cndmask_b32 v20, 0, v18, vcc
    v_cmp_gt_i32 vcc, 1, v17
    s_nop 1
    v_cndmask_b32 v21, 0, v18, vcc
    v_cmp_gt_i32 vcc, 2, v17
    s_nop 1
    v_cndmask_b32 v22, 0, v18, vcc
    v_cmp_gt_i32 vcc, 3, v17
    s_nop 1
    v_cndmask_b32 v23, 0, v18, vcc
    v_cmp_gt_i32 vcc, 8, v17
    s_nop 1
    v_cndmask_b32 v24, 0, v18, vcc
    v_cmp_gt_i32 vcc, 9, v17
    s_nop 1
    v_cndmask_b32 v25, 0, v18, vcc
    v_cmp_gt_i32 vcc, 10, v17
    s_nop 1
    v_cndmask_b32 v26, 0, v18, vcc
    v_cmp_gt_i32 vcc, 11, v17
    s_nop 1
    v_cndmask_b32 v27, 0, v18, vcc
    v_cmp_gt_i32 vcc, 16, v17
    s_nop 1
    v_cndmask_b32 v28, 0, v18, vcc
    v_cmp_gt_i32 vcc, 17, v17
    s_nop 1
    v_cndmask_b32 v29, 0, v18, vcc
    v_cmp_gt_i32 vcc, 18, v17
    s_nop 1
    v_cndmask_b32 v30, 0, v18, vcc
    v_cmp_gt_i32 vcc, 19, v17
    s_nop 1
    v_cndmask_b32 v31, 0, v18, vcc
    v_cmp_gt_i32 vcc, 24, v17
    s_nop 1
    v_cndmask_b32 v32, 0, v18, vcc
    v_cmp_gt_i32 vcc, 25, v17
    s_nop 1
    v_cndmask_b32 v33, 0, v18, vcc
    v_cmp_gt_i32 vcc, 26, v17
    s_nop 1
    v_cndmask_b32 v34, 0, v18, vcc
    v_cmp_gt_i32 vcc, 27, v17
    s_nop 1
    v_cndmask_b32 v35, 0, v18, vcc
    v_and_b32 v17, 7, v1
    v_lshlrev_b32 v17, 4, v17
    v_lshl_add_u32 v54, v14, 7, v17
    v_lshlrev_b32 v17, 4, v13
    v_lshl_add_u32 v55, v14, 3, v17
    v_mul_u32_u24 v56, 4194304, v14
    v_lshl_add_u32 v56, v13, 6, v56
    s_mov_b32 s73, 0x3e0293ee
    s_add_u32 s70, s69, 0
    s_lshl_b32 s71, s70, 16
    s_lshl_b32 s57, s62, 11
    s_add_u32 s71, s71, s57
    s_add_u32 s71, s71, 0x2400000
    s_add_u32 s72, s71, 0x400000
    s_waitcnt vmcnt(24)
    v_mfma_f32_32x32x16_bf16 v[36:51], a[0:3], v[64:67], v[20:35]
    v_mfma_f32_32x32x16_bf16 v[36:51], a[4:7], v[68:71], v[36:51]
    v_mfma_f32_32x32x16_bf16 v[36:51], a[8:11], v[72:75], v[36:51]
    v_mfma_f32_32x32x16_bf16 v[36:51], a[12:15], v[76:79], v[36:51]
    v_mfma_f32_32x32x16_bf16 v[36:51], a[16:19], v[80:83], v[36:51]
    v_mfma_f32_32x32x16_bf16 v[36:51], a[20:23], v[84:87], v[36:51]
    v_mfma_f32_32x32x16_bf16 v[36:51], a[24:27], v[88:91], v[36:51]
    v_mfma_f32_32x32x16_bf16 v[36:51], a[28:31], v[92:95], v[36:51]
    s_nop 11
    v_max3_f32 v13, v36, v37, v38
    v_max3_f32 v14, v39, v40, v41
    v_max3_f32 v13, v13, v42, v43
    v_max3_f32 v14, v14, v44, v45
    v_max3_f32 v13, v13, v46, v47
    v_max3_f32 v14, v14, v48, v49
    v_max3_f32 v13, v13, v50, v51
    v_max_f32 v13, v13, v14
    v_mov_b32 v14, v13
    s_nop 1
    v_permlane32_swap_b32 v13, v14
    v_max_f32 v13, v13, v14
    v_mov_b32 v57, v13
    v_mul_f32 v13, 0xbe0293ee, v13
    v_fma_f32 v36, v36, s73, v13
    v_fma_f32 v37, v37, s73, v13
    v_fma_f32 v38, v38, s73, v13
    v_fma_f32 v39, v39, s73, v13
    v_fma_f32 v40, v40, s73, v13
    v_fma_f32 v41, v41, s73, v13
    v_fma_f32 v42, v42, s73, v13
    v_fma_f32 v43, v43, s73, v13
    v_fma_f32 v44, v44, s73, v13
    v_fma_f32 v45, v45, s73, v13
    v_fma_f32 v46, v46, s73, v13
    v_fma_f32 v47, v47, s73, v13
    v_fma_f32 v48, v48, s73, v13
    v_fma_f32 v49, v49, s73, v13
    v_fma_f32 v50, v50, s73, v13
    v_fma_f32 v51, v51, s73, v13
    v_exp_f32 v36, v36
    v_exp_f32 v37, v37
    v_exp_f32 v38, v38
    v_exp_f32 v39, v39
    v_exp_f32 v40, v40
    v_exp_f32 v41, v41
    v_exp_f32 v42, v42
    v_exp_f32 v43, v43
    v_exp_f32 v44, v44
    v_exp_f32 v45, v45
    v_exp_f32 v46, v46
    v_exp_f32 v47, v47
    v_exp_f32 v48, v48
    v_exp_f32 v49, v49
    v_exp_f32 v50, v50
    v_exp_f32 v51, v51
    v_add_f32 v13, v36, v37
    v_add_f32 v14, v38, v39
    v_add_f32 v13, v13, v40
    v_add_f32 v14, v14, v41
    v_add_f32 v13, v13, v42
    v_add_f32 v14, v14, v43
    v_add_f32 v13, v13, v44
    v_add_f32 v14, v14, v45
    v_add_f32 v13, v13, v46
    v_add_f32 v14, v14, v47
    v_add_f32 v13, v13, v48
    v_add_f32 v14, v14, v49
    v_add_f32 v13, v13, v50
    v_add_f32 v14, v14, v51
    v_add_f32 v13, v13, v14
    v_mov_b32 v14, v13
    s_nop 1
    v_permlane32_swap_b32 v13, v14
    v_add_f32 v13, v13, v14
    v_mov_b32 v58, v13
    v_cvt_pk_bf16_f32 v184, v36, v37
    v_cvt_pk_bf16_f32 v185, v38, v39
    v_cvt_pk_bf16_f32 v186, v40, v41
    v_cvt_pk_bf16_f32 v187, v42, v43
    v_cvt_pk_bf16_f32 v188, v44, v45
    v_cvt_pk_bf16_f32 v189, v46, v47
    v_cvt_pk_bf16_f32 v190, v48, v49
    v_cvt_pk_bf16_f32 v191, v50, v51
    s_waitcnt vmcnt(16)
    v_mfma_f32_32x32x16_bf16 v[192:207], a[32:35], v[184:187], 0
    v_mfma_f32_32x32x16_bf16 v[208:223], a[40:43], v[184:187], 0
    v_mfma_f32_32x32x16_bf16 v[224:239], a[48:51], v[184:187], 0
    v_mfma_f32_32x32x16_bf16 v[240:255], a[56:59], v[184:187], 0
    v_mfma_f32_32x32x16_bf16 v[192:207], a[36:39], v[188:191], v[192:207]
    v_mfma_f32_32x32x16_bf16 v[208:223], a[44:47], v[188:191], v[208:223]
    v_mfma_f32_32x32x16_bf16 v[224:239], a[52:55], v[188:191], v[224:239]
    v_mfma_f32_32x32x16_bf16 v[240:255], a[60:63], v[188:191], v[240:255]
    s_mov_b32 s68, 0x100000
km_44:
    s_cmp_ge_u32 s70, 62
    s_cbranch_scc1 km_44_data
    buffer_load_dword v13, v56, s[4:7], s71 offen sc1
    s_waitcnt vmcnt(0)
    v_cmp_eq_u32 vcc, -1, v13
    s_cbranch_vccnz km_44_again
km_44_data:
    buffer_load_dwordx4 v[144:147], v54, s[4:7], s71 offen offset:0 sc1
    buffer_load_dwordx4 v[148:151], v54, s[4:7], s71 offen offset:256 sc1
    buffer_load_dwordx4 v[152:155], v54, s[4:7], s71 offen offset:512 sc1
    buffer_load_dwordx4 v[156:159], v54, s[4:7], s71 offen offset:768 sc1
    buffer_load_dwordx4 v[160:163], v54, s[4:7], s71 offen offset:1024 sc1
    buffer_load_dwordx4 v[164:167], v54, s[4:7], s71 offen offset:1280 sc1
    buffer_load_dwordx4 v[168:171], v54, s[4:7], s71 offen offset:1536 sc1
    buffer_load_dwordx4 v[172:175], v54, s[4:7], s71 offen offset:1792 sc1
    buffer_load_dwordx2 v[176:177], v55, s[4:7], s72 offen offset:0 sc1
    buffer_load_dwordx2 v[178:179], v55, s[4:7], s72 offen offset:512 sc1
    buffer_load_dwordx2 v[180:181], v55, s[4:7], s72 offen offset:1024 sc1
    buffer_load_dwordx2 v[182:183], v55, s[4:7], s72 offen offset:1536 sc1
    s_waitcnt vmcnt(4)
    v_max3_u32 v13, v144, v145, v146
    v_max3_u32 v14, v147, v148, v149
    v_max3_u32 v13, v13, v150, v151
    v_max3_u32 v14, v14, v152, v153
    v_max3_u32 v13, v13, v154, v155
    v_max3_u32 v14, v14, v156, v157
    v_max3_u32 v13, v13, v158, v159
    v_max3_u32 v14, v14, v160, v161
    v_max3_u32 v13, v13, v162, v163
    v_max3_u32 v14, v14, v164, v165
    v_max3_u32 v13, v13, v166, v167
    v_max3_u32 v14, v14, v168, v169
    v_max3_u32 v13, v13, v170, v171
    v_max3_u32 v14, v14, v172, v173
    v_max3_u32 v13, v13, v174, v175
    v_max_u32 v13, v13, v14
    v_cmp_eq_u32 vcc, -1, v13
    s_cbranch_vccz km_44_ok
km_44_again:
    s_waitcnt vmcnt(0)
    s_sub_u32 s68, s68, 1
    s_cmp_lg_u32 s68, 0
    s_cbranch_scc1 km_44
km_44_ok:
    v_mfma_f32_32x32x16_bf16 v[128:143], v[144:147], v[64:67], 0
    v_mfma_f32_32x32x16_bf16 v[128:143], v[148:151], v[68:71], v[128:143]
    v_mfma_f32_32x32x16_bf16 v[128:143], v[152:155], v[72:75], v[128:143]
    v_mfma_f32_32x32x16_bf16 v[128:143], v[156:159], v[76:79], v[128:143]
    v_mfma_f32_32x32x16_bf16 v[128:143], v[160:163], v[80:83], v[128:143]
    v_mfma_f32_32x32x16_bf16 v[128:143], v[164:167], v[84:87], v[128:143]
    v_mfma_f32_32x32x16_bf16 v[128:143], v[168:171], v[88:91], v[128:143]
    v_mfma_f32_32x32x16_bf16 v[128:143], v[172:175], v[92:95], v[128:143]
    s_nop 11
    v_max3_f32 v13, v128, v129, v57
    v_max3_f32 v13, v13, v130, v131
    v_mov_b32 v14, v13
    s_nop 1
    v_permlane32_swap_b32 v13, v14
    v_max_f32 v13, v13, v14
    v_mul_f32 v13, 0xbe0293ee, v13
    v_fma_f32 v128, v128, s73, v13
    v_fma_f32 v129, v129, s73, v13
    v_fma_f32 v130, v130, s73, v13
    v_fma_f32 v131, v131, s73, v13
    v_fma_f32 v60, v57, s73, v13
    v_exp_f32 v128, v128
    v_exp_f32 v129, v129
    v_exp_f32 v130, v130
    v_exp_f32 v131, v131
    v_exp_f32 v60, v60
    v_add_f32 v13, v128, v129
    v_add_f32 v14, v130, v131
    v_add_f32 v13, v13, v14
    v_mov_b32 v14, v13
    s_nop 1
    v_permlane32_swap_b32 v13, v14
    v_add_f32 v13, v13, v14
    v_fma_f32 v13, v60, v58, v13
    v_rcp_f32 v13, v13
    s_nop 0
    v_mul_f32 v128, v128, v13
    v_mul_f32 v129, v129, v13
    v_mul_f32 v130, v130, v13
    v_mul_f32 v131, v131, v13
    v_mul_f32 v60, v60, v13
    v_mov_b32 v61, v60
    v_cvt_pk_bf16_f32 v52, v128, v129
    v_cvt_pk_bf16_f32 v53, v130, v131
    v_pk_mul_f32 v[192:193], v[192:193], v[60:61]
    v_pk_mul_f32 v[194:195], v[194:195], v[60:61]
    v_pk_mul_f32 v[196:197], v[196:197], v[60:61]
    v_pk_mul_f32 v[198:199], v[198:199], v[60:61]
    v_pk_mul_f32 v[200:201], v[200:201], v[60:61]
    v_pk_mul_f32 v[202:203], v[202:203], v[60:61]
    v_pk_mul_f32 v[204:205], v[204:205], v[60:61]
    v_pk_mul_f32 v[206:207], v[206:207], v[60:61]
    v_pk_mul_f32 v[208:209], v[208:209], v[60:61]
    v_pk_mul_f32 v[210:211], v[210:211], v[60:61]
    v_pk_mul_f32 v[212:213], v[212:213], v[60:61]
    v_pk_mul_f32 v[214:215], v[214:215], v[60:61]
    v_pk_mul_f32 v[216:217], v[216:217], v[60:61]
    v_pk_mul_f32 v[218:219], v[218:219], v[60:61]
    v_pk_mul_f32 v[220:221], v[220:221], v[60:61]
    v_pk_mul_f32 v[222:223], v[222:223], v[60:61]
    v_pk_mul_f32 v[224:225], v[224:225], v[60:61]
    v_pk_mul_f32 v[226:227], v[226:227], v[60:61]
    v_pk_mul_f32 v[228:229], v[228:229], v[60:61]
    v_pk_mul_f32 v[230:231], v[230:231], v[60:61]
    v_pk_mul_f32 v[232:233], v[232:233], v[60:61]
    v_pk_mul_f32 v[234:235], v[234:235], v[60:61]
    v_pk_mul_f32 v[236:237], v[236:237], v[60:61]
    v_pk_mul_f32 v[238:239], v[238:239], v[60:61]
    v_pk_mul_f32 v[240:241], v[240:241], v[60:61]
    v_pk_mul_f32 v[242:243], v[242:243], v[60:61]
    v_pk_mul_f32 v[244:245], v[244:245], v[60:61]
    v_pk_mul_f32 v[246:247], v[246:247], v[60:61]
    v_pk_mul_f32 v[248:249], v[248:249], v[60:61]
    v_pk_mul_f32 v[250:251], v[250:251], v[60:61]
    v_pk_mul_f32 v[252:253], v[252:253], v[60:61]
    v_pk_mul_f32 v[254:255], v[254:255], v[60:61]
    s_mov_b32 s68, 0x100000
vm_45:
    s_waitcnt vmcnt(0)
    v_max3_u32 v13, v176, v177, v178
    v_max3_u32 v14, v179, v180, v181
    v_max3_u32 v13, v13, v182, v183
    v_max_u32 v13, v13, v14
    v_cmp_eq_u32 vcc, -1, v13
    s_cbranch_vccz vm_45_ok
    buffer_load_dwordx2 v[176:177], v55, s[4:7], s72 offen offset:0 sc1
    buffer_load_dwordx2 v[178:179], v55, s[4:7], s72 offen offset:512 sc1
    buffer_load_dwordx2 v[180:181], v55, s[4:7], s72 offen offset:1024 sc1
    buffer_load_dwordx2 v[182:183], v55, s[4:7], s72 offen offset:1536 sc1
    s_sub_u32 s68, s68, 1
    s_cmp_lg_u32 s68, 0
    s_cbranch_scc1 vm_45
    s_waitcnt vmcnt(0)
vm_45_ok:
    v_mfma_f32_32x32x8_bf16 v[192:207], v[176:177], v[52:53], v[192:207]
    v_mfma_f32_32x32x8_bf16 v[208:223], v[178:179], v[52:53], v[208:223]
    v_mfma_f32_32x32x8_bf16 v[224:239], v[180:181], v[52:53], v[224:239]
    v_mfma_f32_32x32x8_bf16 v[240:255], v[182:183], v[52:53], v[240:255]
    s_cmp_lt_u32 s70, 58
    s_cbranch_scc1 osen_46
    v_mov_b32 v128, -1
    v_mov_b32 v129, -1
    v_mov_b32 v130, -1
    v_mov_b32 v131, -1
    s_add_u32 s56, s66, 1048576
    s_add_u32 s57, s56, 4096
    buffer_store_dwordx4 v[128:131], v2, s[4:7], s56 offen offset:0 sc1
    buffer_store_dwordx4 v[128:131], v2, s[4:7], s56 offen offset:1024 sc1
    buffer_store_dwordx4 v[128:131], v2, s[4:7], s56 offen offset:2048 sc1
    buffer_store_dwordx4 v[128:131], v2, s[4:7], s56 offen offset:3072 sc1
    buffer_store_dwordx4 v[128:131], v2, s[4:7], s57 offen offset:0 sc1
    buffer_store_dwordx4 v[128:131], v2, s[4:7], s57 offen offset:1024 sc1
    buffer_store_dwordx4 v[128:131], v2, s[4:7], s57 offen offset:2048 sc1
    buffer_store_dwordx4 v[128:131], v2, s[4:7], s57 offen offset:3072 sc1
osen_46:
    s_add_u32 s56, s66, 0
    s_add_u32 s57, s56, 4096
    v_cvt_pk_bf16_f32 v192, v192, v193
    v_cvt_pk_bf16_f32 v193, v194, v195
    v_cvt_pk_bf16_f32 v194, v196, v197
    v_cvt_pk_bf16_f32 v195, v198, v199
    buffer_store_dwordx4 v[192:195], v2, s[4:7], s56 offen offset:0 sc1
    v_cvt_pk_bf16_f32 v200, v200, v201
    v_cvt_pk_bf16_f32 v201, v202, v203
    v_cvt_pk_bf16_f32 v202, v204, v205
    v_cvt_pk_bf16_f32 v203, v206, v207
    buffer_store_dwordx4 v[200:203], v2, s[4:7], s56 offen offset:1024 sc1
    v_cvt_pk_bf16_f32 v208, v208, v209
    v_cvt_pk_bf16_f32 v209, v210, v211
    v_cvt_pk_bf16_f32 v210, v212, v213
    v_cvt_pk_bf16_f32 v211, v214, v215
    buffer_store_dwordx4 v[208:211], v2, s[4:7], s56 offen offset:2048 sc1
    v_cvt_pk_bf16_f32 v216, v216, v217
    v_cvt_pk_bf16_f32 v217, v218, v219
    v_cvt_pk_bf16_f32 v218, v220, v221
    v_cvt_pk_bf16_f32 v219, v222, v223
    buffer_store_dwordx4 v[216:219], v2, s[4:7], s56 offen offset:3072 sc1
    v_cvt_pk_bf16_f32 v224, v224, v225
    v_cvt_pk_bf16_f32 v225, v226, v227
    v_cvt_pk_bf16_f32 v226, v228, v229
    v_cvt_pk_bf16_f32 v227, v230, v231
    buffer_store_dwordx4 v[224:227], v2, s[4:7], s57 offen offset:0 sc1
    v_cvt_pk_bf16_f32 v232, v232, v233
    v_cvt_pk_bf16_f32 v233, v234, v235
    v_cvt_pk_bf16_f32 v234, v236, v237
    v_cvt_pk_bf16_f32 v235, v238, v239
    buffer_store_dwordx4 v[232:235], v2, s[4:7], s57 offen offset:1024 sc1
    v_cvt_pk_bf16_f32 v240, v240, v241
    v_cvt_pk_bf16_f32 v241, v242, v243
    v_cvt_pk_bf16_f32 v242, v244, v245
    v_cvt_pk_bf16_f32 v243, v246, v247
    buffer_store_dwordx4 v[240:243], v2, s[4:7], s57 offen offset:2048 sc1
    v_cvt_pk_bf16_f32 v248, v248, v249
    v_cvt_pk_bf16_f32 v249, v250, v251
    v_cvt_pk_bf16_f32 v250, v252, v253
    v_cvt_pk_bf16_f32 v251, v254, v255
    buffer_store_dwordx4 v[248:251], v2, s[4:7], s57 offen offset:3072 sc1
    s_lshl_b32 s56, s70, 8
    s_xor_b32 s56, s56, s45
    s_lshr_b32 s57, s62, 3
    s_lshl_b32 s57, s57, 6
    s_add_u32 s56, s56, s57
    s_and_b32 s57, s62, 7
    s_lshl_b32 s57, s57, 2
    s_add_u32 s56, s56, s57
    s_add_u32 s56, s56, 0x5200000
    v_mov_b32 v13, 1
    s_waitcnt vmcnt(0)
    s_mov_b64 exec, 1
    buffer_store_dword v13, off, s[4:7], s56 sc1
    s_mov_b64 exec, -1
    s_add_u32 s70, s69, 4
    s_lshl_b32 s71, s70, 16
    s_lshl_b32 s57, s62, 11
    s_add_u32 s71, s71, s57
    s_add_u32 s71, s71, 0x2400000
    s_add_u32 s72, s71, 0x400000
    v_mfma_f32_32x32x16_bf16 v[36:51], a[64:67], v[96:99], v[20:35]
    v_mfma_f32_32x32x16_bf16 v[36:51], a[68:71], v[100:103], v[36:51]
    v_mfma_f32_32x32x16_bf16 v[36:51], a[72:75], v[104:107], v[36:51]
    v_mfma_f32_32x32x16_bf16 v[36:51], a[76:79], v[108:111], v[36:51]
    v_mfma_f32_32x32x16_bf16 v[36:51], a[80:83], v[112:115], v[36:51]
    v_mfma_f32_32x32x16_bf16 v[36:51], a[84:87], v[116:119], v[36:51]
    v_mfma_f32_32x32x16_bf16 v[36:51], a[88:91], v[120:123], v[36:51]
    v_mfma_f32_32x32x16_bf16 v[36:51], a[92:95], v[124:127], v[36:51]
    s_nop 11
    v_max3_f32 v13, v36, v37, v38
    v_max3_f32 v14, v39, v40, v41
    v_max3_f32 v13, v13, v42, v43
    v_max3_f32 v14, v14, v44, v45
    v_max3_f32 v13, v13, v46, v47
    v_max3_f32 v14, v14, v48, v49
    v_max3_f32 v13, v13, v50, v51
    v_max_f32 v13, v13, v14
    v_mov_b32 v14, v13
    s_nop 1
    v_permlane32_swap_b32 v13, v14
    v_max_f32 v13, v13, v14
    v_mov_b32 v57, v13
    v_mul_f32 v13, 0xbe0293ee, v13
    v_fma_f32 v36, v36, s73, v13
    v_fma_f32 v37, v37, s73, v13
    v_fma_f32 v38, v38, s73, v13
    v_fma_f32 v39, v39, s73, v13
    v_fma_f32 v40, v40, s73, v13
    v_fma_f32 v41, v41, s73, v13
    v_fma_f32 v42, v42, s73, v13
    v_fma_f32 v43, v43, s73, v13
    v_fma_f32 v44, v44, s73, v13
    v_fma_f32 v45, v45, s73, v13
    v_fma_f32 v46, v46, s73, v13
    v_fma_f32 v47, v47, s73, v13
    v_fma_f32 v48, v48, s73, v13
    v_fma_f32 v49, v49, s73, v13
    v_fma_f32 v50, v50, s73, v13
    v_fma_f32 v51, v51, s73, v13
    v_exp_f32 v36, v36
    v_exp_f32 v37, v37
    v_exp_f32 v38, v38
    v_exp_f32 v39, v39
    v_exp_f32 v40, v40
    v_exp_f32 v41, v41
    v_exp_f32 v42, v42
    v_exp_f32 v43, v43
    v_exp_f32 v44, v44
    v_exp_f32 v45, v45
    v_exp_f32 v46, v46
    v_exp_f32 v47, v47
    v_exp_f32 v48, v48
    v_exp_f32 v49, v49
    v_exp_f32 v50, v50
    v_exp_f32 v51, v51
    v_add_f32 v13, v36, v37
    v_add_f32 v14, v38, v39
    v_add_f32 v13, v13, v40
    v_add_f32 v14, v14, v41
    v_add_f32 v13, v13, v42
    v_add_f32 v14, v14, v43
    v_add_f32 v13, v13, v44
    v_add_f32 v14, v14, v45
    v_add_f32 v13, v13, v46
    v_add_f32 v14, v14, v47
    v_add_f32 v13, v13, v48
    v_add_f32 v14, v14, v49
    v_add_f32 v13, v13, v50
    v_add_f32 v14, v14, v51
    v_add_f32 v13, v13, v14
    v_mov_b32 v14, v13
    s_nop 1
    v_permlane32_swap_b32 v13, v14
    v_add_f32 v13, v13, v14
    v_mov_b32 v58, v13
    v_cvt_pk_bf16_f32 v184, v36, v37
    v_cvt_pk_bf16_f32 v185, v38, v39
    v_cvt_pk_bf16_f32 v186, v40, v41
    v_cvt_pk_bf16_f32 v187, v42, v43
    v_cvt_pk_bf16_f32 v188, v44, v45
    v_cvt_pk_bf16_f32 v189, v46, v47
    v_cvt_pk_bf16_f32 v190, v48, v49
    v_cvt_pk_bf16_f32 v191, v50, v51
    v_mfma_f32_32x32x16_bf16 v[192:207], a[96:99], v[184:187], 0
    v_mfma_f32_32x32x16_bf16 v[208:223], a[104:107], v[184:187], 0
    v_mfma_f32_32x32x16_bf16 v[224:239], a[112:115], v[184:187], 0
    v_mfma_f32_32x32x16_bf16 v[240:255], a[120:123], v[184:187], 0
    v_mfma_f32_32x32x16_bf16 v[192:207], a[100:103], v[188:191], v[192:207]
    v_mfma_f32_32x32x16_bf16 v[208:223], a[108:111], v[188:191], v[208:223]
    v_mfma_f32_32x32x16_bf16 v[224:239], a[116:119], v[188:191], v[224:239]
    v_mfma_f32_32x32x16_bf16 v[240:255], a[124:127], v[188:191], v[240:255]
    s_mov_b32 s68, 0x100000
km_47:
    s_cmp_ge_u32 s70, 62
    s_cbranch_scc1 km_47_data
    buffer_load_dword v13, v56, s[4:7], s71 offen sc1
    s_waitcnt vmcnt(0)
    v_cmp_eq_u32 vcc, -1, v13
    s_cbranch_vccnz km_47_again
km_47_data:
    buffer_load_dwordx4 v[144:147], v54, s[4:7], s71 offen offset:0 sc1
    buffer_load_dwordx4 v[148:151], v54, s[4:7], s71 offen offset:256 sc1
    buffer_load_dwordx4 v[152:155], v54, s[4:7], s71 offen offset:512 sc1
    buffer_load_dwordx4 v[156:159], v54, s[4:7], s71 offen offset:768 sc1
    buffer_load_dwordx4 v[160:163], v54, s[4:7], s71 offen offset:1024 sc1
    buffer_load_dwordx4 v[164:167], v54, s[4:7], s71 offen offset:1280 sc1
    buffer_load_dwordx4 v[168:171], v54, s[4:7], s71 offen offset:1536 sc1
    buffer_load_dwordx4 v[172:175], v54, s[4:7], s71 offen offset:1792 sc1
    buffer_load_dwordx2 v[176:177], v55, s[4:7], s72 offen offset:0 sc1
    buffer_load_dwordx2 v[178:179], v55, s[4:7], s72 offen offset:512 sc1
    buffer_load_dwordx2 v[180:181], v55, s[4:7], s72 offen offset:1024 sc1
    buffer_load_dwordx2 v[182:183], v55, s[4:7], s72 offen offset:1536 sc1
    s_waitcnt vmcnt(4)
    v_max3_u32 v13, v144, v145, v146
    v_max3_u32 v14, v147, v148, v149
    v_max3_u32 v13, v13, v150, v151
    v_max3_u32 v14, v14, v152, v153
    v_max3_u32 v13, v13, v154, v155
    v_max3_u32 v14, v14, v156, v157
    v_max3_u32 v13, v13, v158, v159
    v_max3_u32 v14, v14, v160, v161
    v_max3_u32 v13, v13, v162, v163
    v_max3_u32 v14, v14, v164, v165
    v_max3_u32 v13, v13, v166, v167
    v_max3_u32 v14, v14, v168, v169
    v_max3_u32 v13, v13, v170, v171
    v_max3_u32 v14, v14, v172, v173
    v_max3_u32 v13, v13, v174, v175
    v_max_u32 v13, v13, v14
    v_cmp_eq_u32 vcc, -1, v13
    s_cbranch_vccz km_47_ok
km_47_again:
    s_waitcnt vmcnt(0)
    s_sub_u32 s68, s68, 1
    s_cmp_lg_u32 s68, 0
    s_cbranch_scc1 km_47
km_47_ok:
    v_mfma_f32_32x32x16_bf16 v[128:143], v[144:147], v[96:99], 0
    v_mfma_f32_32x32x16_bf16 v[128:143], v[148:151], v[100:103], v[128:143]
    v_mfma_f32_32x32x16_bf16 v[128:143], v[152:155], v[104:107], v[128:143]
    v_mfma_f32_32x32x16_bf16 v[128:143], v[156:159], v[108:111], v[128:143]
    v_mfma_f32_32x32x16_bf16 v[128:143], v[160:163], v[112:115], v[128:143]
    v_mfma_f32_32x32x16_bf16 v[128:143], v[164:167], v[116:119], v[128:143]
    v_mfma_f32_32x32x16_bf16 v[128:143], v[168:171], v[120:123], v[128:143]
    v_mfma_f32_32x32x16_bf16 v[128:143], v[172:175], v[124:127], v[128:143]
    s_nop 11
    v_max3_f32 v13, v128, v129, v57
    v_max3_f32 v13, v13, v130, v131
    v_mov_b32 v14, v13
    s_nop 1
    v_permlane32_swap_b32 v13, v14
    v_max_f32 v13, v13, v14
    v_mul_f32 v13, 0xbe0293ee, v13
    v_fma_f32 v128, v128, s73, v13
    v_fma_f32 v129, v129, s73, v13
    v_fma_f32 v130, v130, s73, v13
    v_fma_f32 v131, v131, s73, v13
    v_fma_f32 v60, v57, s73, v13
    v_exp_f32 v128, v128
    v_exp_f32 v129, v129
    v_exp_f32 v130, v130
    v_exp_f32 v131, v131
    v_exp_f32 v60, v60
    v_add_f32 v13, v128, v129
    v_add_f32 v14, v130, v131
    v_add_f32 v13, v13, v14
    v_mov_b32 v14, v13
    s_nop 1
    v_permlane32_swap_b32 v13, v14
    v_add_f32 v13, v13, v14
    v_fma_f32 v13, v60, v58, v13
    v_rcp_f32 v13, v13
    s_nop 0
    v_mul_f32 v128, v128, v13
    v_mul_f32 v129, v129, v13
    v_mul_f32 v130, v130, v13
    v_mul_f32 v131, v131, v13
    v_mul_f32 v60, v60, v13
    v_mov_b32 v61, v60
    v_cvt_pk_bf16_f32 v52, v128, v129
    v_cvt_pk_bf16_f32 v53, v130, v131
    v_pk_mul_f32 v[192:193], v[192:193], v[60:61]
    v_pk_mul_f32 v[194:195], v[194:195], v[60:61]
    v_pk_mul_f32 v[196:197], v[196:197], v[60:61]
    v_pk_mul_f32 v[198:199], v[198:199], v[60:61]
    v_pk_mul_f32 v[200:201], v[200:201], v[60:61]
    v_pk_mul_f32 v[202:203], v[202:203], v[60:61]
    v_pk_mul_f32 v[204:205], v[204:205], v[60:61]
    v_pk_mul_f32 v[206:207], v[206:207], v[60:61]
    v_pk_mul_f32 v[208:209], v[208:209], v[60:61]
    v_pk_mul_f32 v[210:211], v[210:211], v[60:61]
    v_pk_mul_f32 v[212:213], v[212:213], v[60:61]
    v_pk_mul_f32 v[214:215], v[214:215], v[60:61]
    v_pk_mul_f32 v[216:217], v[216:217], v[60:61]
    v_pk_mul_f32 v[218:219], v[218:219], v[60:61]
    v_pk_mul_f32 v[220:221], v[220:221], v[60:61]
    v_pk_mul_f32 v[222:223], v[222:223], v[60:61]
    v_pk_mul_f32 v[224:225], v[224:225], v[60:61]
    v_pk_mul_f32 v[226:227], v[226:227], v[60:61]
    v_pk_mul_f32 v[228:229], v[228:229], v[60:61]
    v_pk_mul_f32 v[230:231], v[230:231], v[60:61]
    v_pk_mul_f32 v[232:233], v[232:233], v[60:61]
    v_pk_mul_f32 v[234:235], v[234:235], v[60:61]
    v_pk_mul_f32 v[236:237], v[236:237], v[60:61]
    v_pk_mul_f32 v[238:239], v[238:239], v[60:61]
    v_pk_mul_f32 v[240:241], v[240:241], v[60:61]
    v_pk_mul_f32 v[242:243], v[242:243], v[60:61]
    v_pk_mul_f32 v[244:245], v[244:245], v[60:61]
    v_pk_mul_f32 v[246:247], v[246:247], v[60:61]
    v_pk_mul_f32 v[248:249], v[248:249], v[60:61]
    v_pk_mul_f32 v[250:251], v[250:251], v[60:61]
    v_pk_mul_f32 v[252:253], v[252:253], v[60:61]
    v_pk_mul_f32 v[254:255], v[254:255], v[60:61]
    s_mov_b32 s68, 0x100000
vm_48:
    s_waitcnt vmcnt(0)
    v_max3_u32 v13, v176, v177, v178
    v_max3_u32 v14, v179, v180, v181
    v_max3_u32 v13, v13, v182, v183
    v_max_u32 v13, v13, v14
    v_cmp_eq_u32 vcc, -1, v13
    s_cbranch_vccz vm_48_ok
    buffer_load_dwordx2 v[176:177], v55, s[4:7], s72 offen offset:0 sc1
    buffer_load_dwordx2 v[178:179], v55, s[4:7], s72 offen offset:512 sc1
    buffer_load_dwordx2 v[180:181], v55, s[4:7], s72 offen offset:1024 sc1
    buffer_load_dwordx2 v[182:183], v55, s[4:7], s72 offen offset:1536 sc1
    s_sub_u32 s68, s68, 1
    s_cmp_lg_u32 s68, 0
    s_cbranch_scc1 vm_48
    s_waitcnt vmcnt(0)
vm_48_ok:
    v_mfma_f32_32x32x8_bf16 v[192:207], v[176:177], v[52:53], v[192:207]
    v_mfma_f32_32x32x8_bf16 v[208:223], v[178:179], v[52:53], v[208:223]
    v_mfma_f32_32x32x8_bf16 v[224:239], v[180:181], v[52:53], v[224:239]
    v_mfma_f32_32x32x8_bf16 v[240:255], v[182:183], v[52:53], v[240:255]
    s_add_u32 s56, s66, 1048576
    s_add_u32 s57, s56, 4096
    v_cvt_pk_bf16_f32 v192, v192, v193
    v_cvt_pk_bf16_f32 v193, v194, v195
    v_cvt_pk_bf16_f32 v194, v196, v197
    v_cvt_pk_bf16_f32 v195, v198, v199
    buffer_store_dwordx4 v[192:195], v2, s[4:7], s56 offen offset:0 sc1
    v_cvt_pk_bf16_f32 v200, v200, v201
    v_cvt_pk_bf16_f32 v201, v202, v203
    v_cvt_pk_bf16_f32 v202, v204, v205
    v_cvt_pk_bf16_f32 v203, v206, v207
    buffer_store_dwordx4 v[200:203], v2, s[4:7], s56 offen offset:1024 sc1
    v_cvt_pk_bf16_f32 v208, v208, v209
    v_cvt_pk_bf16_f32 v209, v210, v211
    v_cvt_pk_bf16_f32 v210, v212, v213
    v_cvt_pk_bf16_f32 v211, v214, v215
    buffer_store_dwordx4 v[208:211], v2, s[4:7], s56 offen offset:2048 sc1
    v_cvt_pk_bf16_f32 v216, v216, v217
    v_cvt_pk_bf16_f32 v217, v218, v219
    v_cvt_pk_bf16_f32 v218, v220, v221
    v_cvt_pk_bf16_f32 v219, v222, v223
    buffer_store_dwordx4 v[216:219], v2, s[4:7], s56 offen offset:3072 sc1
    v_cvt_pk_bf16_f32 v224, v224, v225
    v_cvt_pk_bf16_f32 v225, v226, v227
    v_cvt_pk_bf16_f32 v226, v228, v229
    v_cvt_pk_bf16_f32 v227, v230, v231
    buffer_store_dwordx4 v[224:227], v2, s[4:7], s57 offen offset:0 sc1
    v_cvt_pk_bf16_f32 v232, v232, v233
    v_cvt_pk_bf16_f32 v233, v234, v235
    v_cvt_pk_bf16_f32 v234, v236, v237
    v_cvt_pk_bf16_f32 v235, v238, v239
    buffer_store_dwordx4 v[232:235], v2, s[4:7], s57 offen offset:1024 sc1
    v_cvt_pk_bf16_f32 v240, v240, v241
    v_cvt_pk_bf16_f32 v241, v242, v243
    v_cvt_pk_bf16_f32 v242, v244, v245
    v_cvt_pk_bf16_f32 v243, v246, v247
    buffer_store_dwordx4 v[240:243], v2, s[4:7], s57 offen offset:2048 sc1
    v_cvt_pk_bf16_f32 v248, v248, v249
    v_cvt_pk_bf16_f32 v249, v250, v251
    v_cvt_pk_bf16_f32 v250, v252, v253
    v_cvt_pk_bf16_f32 v251, v254, v255
    buffer_store_dwordx4 v[248:251], v2, s[4:7], s57 offen offset:3072 sc1
    s_lshl_b32 s56, s70, 8
    s_xor_b32 s56, s56, s45
    s_lshr_b32 s57, s62, 3
    s_lshl_b32 s57, s57, 6
    s_add_u32 s56, s56, s57
    s_and_b32 s57, s62, 7
    s_lshl_b32 s57, s57, 2
    s_add_u32 s56, s56, s57
    s_add_u32 s56, s56, 0x5200000
    v_mov_b32 v13, 1
    s_waitcnt vmcnt(0)
    s_mov_b64 exec, 1
    buffer_store_dword v13, off, s[4:7], s56 sc1
    s_mov_b64 exec, -1
    s_branch W_NEXT
W_WO:
    s_sub_u32 s61, s42, 2
    s_mov_b32 s62, s43
    s_mov_b32 s12, s26
    s_and_b32 s13, s27, 0xffff
    s_mov_b32 s14, 0x800000
    s_mov_b32 s15, 0x20000
    s_mov_b32 s76, s16
    s_and_b32 s77, s17, 0xffff
    s_mov_b32 s78, 0x400000
    s_mov_b32 s79, 0x20000
    s_mov_b32 s80, s36
    s_and_b32 s81, s37, 0xffff
    s_mov_b32 s82, 0x400000
    s_mov_b32 s83, 0x20000
    v_lshrrev_b32 v40, 4, v1
    v_and_b32 v41, 15, v1
    v_lshrrev_b32 v13, 2, v1
    v_lshlrev_b32 v13, 11, v13
    v_and_b32 v14, 3, v1
    v_lshl_add_u32 v13, v14, 4, v13
    s_lshl_b32 s56, s44, 21
    s_lshl_b32 s57, s62, 6
    s_add_u32 s56, s56, s57
    v_add_u32 v7, s56, v13
    v_lshrrev_b32 v13, 1, v40
    v_lshlrev_b32 v13, 4, v13
    v_and_b32 v14, 1, v40
    v_lshl_add_u32 v13, v14, 2, v13
    v_lshrrev_b32 v14, 2, v41
    v_add_u32 v13, v13, v14
    v_lshlrev_b32 v13, 6, v13
    v_and_b32 v14, 3, v41
    v_lshl_add_u32 v13, v14, 3, v13
    s_lshl_b32 s64, s44, 15
    v_add_u32 v3, s64, v13
    s_barrier
    s_add_u32 m0, s64, 0
    s_mov_b32 s56, 0
    buffer_load_dwordx4 v7, s[12:15], s56 offen lds
    s_add_u32 m0, s64, 1024
    s_mov_b32 s56, 32768
    buffer_load_dwordx4 v7, s[12:15], s56 offen lds
    s_add_u32 m0, s64, 2048
    s_mov_b32 s56, 65536
    buffer_load_dwordx4 v7, s[12:15], s56 offen lds
    s_add_u32 m0, s64, 3072
    s_mov_b32 s56, 98304
    buffer_load_dwordx4 v7, s[12:15], s56 offen lds
    s_add_u32 m0, s64, 4096
    s_mov_b32 s56, 131072
    buffer_load_dwordx4 v7, s[12:15], s56 offen lds
    s_add_u32 m0, s64, 5120
    s_mov_b32 s56, 163840
    buffer_load_dwordx4 v7, s[12:15], s56 offen lds
    s_add_u32 m0, s64, 6144
    s_mov_b32 s56, 196608
    buffer_load_dwordx4 v7, s[12:15], s56 offen lds
    s_add_u32 m0, s64, 7168
    s_mov_b32 s56, 229376
    buffer_load_dwordx4 v7, s[12:15], s56 offen lds
    s_add_u32 m0, s64, 8192
    s_mov_b32 s56, 262144
    buffer_load_dwordx4 v7, s[12:15], s56 offen lds
    s_add_u32 m0, s64, 9216
    s_mov_b32 s56, 294912
    buffer_load_dwordx4 v7, s[12:15], s56 offen lds
    s_add_u32 m0, s64, 10240
    s_mov_b32 s56, 327680
    buffer_load_dwordx4 v7, s[12:15], s56 offen lds
    s_add_u32 m0, s64, 11264
    s_mov_b32 s56, 360448
    buffer_load_dwordx4 v7, s[12:15], s56 offen lds
    s_add_u32 m0, s64, 12288
    s_mov_b32 s56, 393216
    buffer_load_dwordx4 v7, s[12:15], s56 offen lds
    s_add_u32 m0, s64, 13312
    s_mov_b32 s56, 425984
    buffer_load_dwordx4 v7, s[12:15], s56 offen lds
    s_add_u32 m0, s64, 14336
    s_mov_b32 s56, 458752
    buffer_load_dwordx4 v7, s[12:15], s56 offen lds
    s_add_u32 m0, s64, 15360
    s_mov_b32 s56, 491520
    buffer_load_dwordx4 v7, s[12:15], s56 offen lds
    s_add_u32 m0, s64, 16384
    s_mov_b32 s56, 524288
    buffer_load_dwordx4 v7, s[12:15], s56 offen lds
    s_add_u32 m0, s64, 17408
    s_mov_b32 s56, 557056
    buffer_load_dwordx4 v7, s[12:15], s56 offen lds
    s_add_u32 m0, s64, 18432
    s_mov_b32 s56, 589824
    buffer_load_dwordx4 v7, s[12:15], s56 offen lds
    s_add_u32 m0, s64, 19456
    s_mov_b32 s56, 622592
    buffer_load_dwordx4 v7, s[12:15], s56 offen lds
    s_add_u32 m0, s64, 20480
    s_mov_b32 s56, 655360
    buffer_load_dwordx4 v7, s[12:15], s56 offen lds
    s_add_u32 m0, s64, 21504
    s_mov_b32 s56, 688128
    buffer_load_dwordx4 v7, s[12:15], s56 offen lds
    s_add_u32 m0, s64, 22528
    s_mov_b32 s56, 720896
    buffer_load_dwordx4 v7, s[12:15], s56 offen lds
    s_add_u32 m0, s64, 23552
    s_mov_b32 s56, 753664
    buffer_load_dwordx4 v7, s[12:15], s56 offen lds
    s_add_u32 m0, s64, 24576
    s_mov_b32 s56, 786432
    buffer_load_dwordx4 v7, s[12:15], s56 offen lds
    s_add_u32 m0, s64, 25600
    s_mov_b32 s56, 819200
    buffer_load_dwordx4 v7, s[12:15], s56 offen lds
    s_add_u32 m0, s64, 26624
    s_mov_b32 s56, 851968
    buffer_load_dwordx4 v7, s[12:15], s56 offen lds
    s_add_u32 m0, s64, 27648
    s_mov_b32 s56, 884736
    buffer_load_dwordx4 v7, s[12:15], s56 offen lds
    s_add_u32 m0, s64, 28672
    s_mov_b32 s56, 917504
    buffer_load_dwordx4 v7, s[12:15], s56 offen lds
    s_add_u32 m0, s64, 29696
    s_mov_b32 s56, 950272
    buffer_load_dwordx4 v7, s[12:15], s56 offen lds
    s_add_u32 m0, s64, 30720
    s_mov_b32 s56, 983040
    buffer_load_dwordx4 v7, s[12:15], s56 offen lds
    s_add_u32 m0, s64, 31744
    s_mov_b32 s56, 1015808
    buffer_load_dwordx4 v7, s[12:15], s56 offen lds
    s_waitcnt vmcnt(0)
    ds_read_b64_tr_b16 a[0:1], v3 offset:0
    ds_read_b64_tr_b16 a[2:3], v3 offset:512
    ds_read_b64_tr_b16 a[4:5], v3 offset:32
    ds_read_b64_tr_b16 a[6:7], v3 offset:544
    ds_read_b64_tr_b16 a[8:9], v3 offset:2048
    ds_read_b64_tr_b16 a[10:11], v3 offset:2560
    ds_read_b64_tr_b16 a[12:13], v3 offset:2080
    ds_read_b64_tr_b16 a[14:15], v3 offset:2592
    s_waitcnt lgkmcnt(0)
    ds_read_b64_tr_b16 a[16:17], v3 offset:4096
    ds_read_b64_tr_b16 a[18:19], v3 offset:4608
    ds_read_b64_tr_b16 a[20:21], v3 offset:4128
    ds_read_b64_tr_b16 a[22:23], v3 offset:4640
    ds_read_b64_tr_b16 a[24:25], v3 offset:6144
    ds_read_b64_tr_b16 a[26:27], v3 offset:6656
    ds_read_b64_tr_b16 a[28:29], v3 offset:6176
    ds_read_b64_tr_b16 a[30:31], v3 offset:6688
    s_waitcnt lgkmcnt(0)
    ds_read_b64_tr_b16 a[32:33], v3 offset:8192
    ds_read_b64_tr_b16 a[34:35], v3 offset:8704
    ds_read_b64_tr_b16 a[36:37], v3 offset:8224
    ds_read_b64_tr_b16 a[38:39], v3 offset:8736
    ds_read_b64_tr_b16 a[40:41], v3 offset:10240
    ds_read_b64_tr_b16 a[42:43], v3 offset:10752
    ds_read_b64_tr_b16 a[44:45], v3 offset:10272
    ds_read_b64_tr_b16 a[46:47], v3 offset:10784
    s_waitcnt lgkmcnt(0)
    ds_read_b64_tr_b16 a[48:49], v3 offset:12288
    ds_read_b64_tr_b16 a[50:51], v3 offset:12800
    ds_read_b64_tr_b16 a[52:53], v3 offset:12320
    ds_read_b64_tr_b16 a[54:55], v3 offset:12832
    ds_read_b64_tr_b16 a[56:57], v3 offset:14336
    ds_read_b64_tr_b16 a[58:59], v3 offset:14848
    ds_read_b64_tr_b16 a[60:61], v3 offset:14368
    ds_read_b64_tr_b16 a[62:63], v3 offset:14880
    s_waitcnt lgkmcnt(0)
    ds_read_b64_tr_b16 a[64:65], v3 offset:16384
    ds_read_b64_tr_b16 a[66:67], v3 offset:16896
    ds_read_b64_tr_b16 a[68:69], v3 offset:16416
    ds_read_b64_tr_b16 a[70:71], v3 offset:16928
    ds_read_b64_tr_b16 a[72:73], v3 offset:18432
    ds_read_b64_tr_b16 a[74:75], v3 offset:18944
    ds_read_b64_tr_b16 a[76:77], v3 offset:18464
    ds_read_b64_tr_b16 a[78:79], v3 offset:18976
    s_waitcnt lgkmcnt(0)
    ds_read_b64_tr_b16 a[80:81], v3 offset:20480
    ds_read_b64_tr_b16 a[82:83], v3 offset:20992
    ds_read_b64_tr_b16 a[84:85], v3 offset:20512
    ds_read_b64_tr_b16 a[86:87], v3 offset:21024
    ds_read_b64_tr_b16 a[88:89], v3 offset:22528
    ds_read_b64_tr_b16 a[90:91], v3 offset:23040
    ds_read_b64_tr_b16 a[92:93], v3 offset:22560
    ds_read_b64_tr_b16 a[94:95], v3 offset:23072
    s_waitcnt lgkmcnt(0)
    ds_read_b64_tr_b16 a[96:97], v3 offset:24576
    ds_read_b64_tr_b16 a[98:99], v3 offset:25088
    ds_read_b64_tr_b16 a[100:101], v3 offset:24608
    ds_read_b64_tr_b16 a[102:103], v3 offset:25120
    ds_read_b64_tr_b16 a[104:105], v3 offset:26624
    ds_read_b64_tr_b16 a[106:107], v3 offset:27136
    ds_read_b64_tr_b16 a[108:109], v3 offset:26656
    ds_read_b64_tr_b16 a[110:111], v3 offset:27168
    s_waitcnt lgkmcnt(0)
    ds_read_b64_tr_b16 a[112:113], v3 offset:28672
    ds_read_b64_tr_b16 a[114:115], v3 offset:29184
    ds_read_b64_tr_b16 a[116:117], v3 offset:28704
    ds_read_b64_tr_b16 a[118:119], v3 offset:29216
    ds_read_b64_tr_b16 a[120:121], v3 offset:30720
    ds_read_b64_tr_b16 a[122:123], v3 offset:31232
    ds_read_b64_tr_b16 a[124:125], v3 offset:30752
    ds_read_b64_tr_b16 a[126:127], v3 offset:31264
    s_waitcnt lgkmcnt(0)
    s_add_u32 m0, s64, 0
    s_mov_b32 s56, 1048576
    buffer_load_dwordx4 v7, s[12:15], s56 offen lds
    s_add_u32 m0, s64, 1024
    s_mov_b32 s56, 1081344
    buffer_load_dwordx4 v7, s[12:15], s56 offen lds
    s_add_u32 m0, s64, 2048
    s_mov_b32 s56, 1114112
    buffer_load_dwordx4 v7, s[12:15], s56 offen lds
    s_add_u32 m0, s64, 3072
    s_mov_b32 s56, 1146880
    buffer_load_dwordx4 v7, s[12:15], s56 offen lds
    s_add_u32 m0, s64, 4096
    s_mov_b32 s56, 1179648
    buffer_load_dwordx4 v7, s[12:15], s56 offen lds
    s_add_u32 m0, s64, 5120
    s_mov_b32 s56, 1212416
    buffer_load_dwordx4 v7, s[12:15], s56 offen lds
    s_add_u32 m0, s64, 6144
    s_mov_b32 s56, 1245184
    buffer_load_dwordx4 v7, s[12:15], s56 offen lds
    s_add_u32 m0, s64, 7168
    s_mov_b32 s56, 1277952
    buffer_load_dwordx4 v7, s[12:15], s56 offen lds
    s_add_u32 m0, s64, 8192
    s_mov_b32 s56, 1310720
    buffer_load_dwordx4 v7, s[12:15], s56 offen lds
    s_add_u32 m0, s64, 9216
    s_mov_b32 s56, 1343488
    buffer_load_dwordx4 v7, s[12:15], s56 offen lds
    s_add_u32 m0, s64, 10240
    s_mov_b32 s56, 1376256
    buffer_load_dwordx4 v7, s[12:15], s56 offen lds
    s_add_u32 m0, s64, 11264
    s_mov_b32 s56, 1409024
    buffer_load_dwordx4 v7, s[12:15], s56 offen lds
    s_add_u32 m0, s64, 12288
    s_mov_b32 s56, 1441792
    buffer_load_dwordx4 v7, s[12:15], s56 offen lds
    s_add_u32 m0, s64, 13312
    s_mov_b32 s56, 1474560
    buffer_load_dwordx4 v7, s[12:15], s56 offen lds
    s_add_u32 m0, s64, 14336
    s_mov_b32 s56, 1507328
    buffer_load_dwordx4 v7, s[12:15], s56 offen lds
    s_add_u32 m0, s64, 15360
    s_mov_b32 s56, 1540096
    buffer_load_dwordx4 v7, s[12:15], s56 offen lds
    s_add_u32 m0, s64, 16384
    s_mov_b32 s56, 1572864
    buffer_load_dwordx4 v7, s[12:15], s56 offen lds
    s_add_u32 m0, s64, 17408
    s_mov_b32 s56, 1605632
    buffer_load_dwordx4 v7, s[12:15], s56 offen lds
    s_add_u32 m0, s64, 18432
    s_mov_b32 s56, 1638400
    buffer_load_dwordx4 v7, s[12:15], s56 offen lds
    s_add_u32 m0, s64, 19456
    s_mov_b32 s56, 1671168
    buffer_load_dwordx4 v7, s[12:15], s56 offen lds
    s_add_u32 m0, s64, 20480
    s_mov_b32 s56, 1703936
    buffer_load_dwordx4 v7, s[12:15], s56 offen lds
    s_add_u32 m0, s64, 21504
    s_mov_b32 s56, 1736704
    buffer_load_dwordx4 v7, s[12:15], s56 offen lds
    s_add_u32 m0, s64, 22528
    s_mov_b32 s56, 1769472
    buffer_load_dwordx4 v7, s[12:15], s56 offen lds
    s_add_u32 m0, s64, 23552
    s_mov_b32 s56, 1802240
    buffer_load_dwordx4 v7, s[12:15], s56 offen lds
    s_add_u32 m0, s64, 24576
    s_mov_b32 s56, 1835008
    buffer_load_dwordx4 v7, s[12:15], s56 offen lds
    s_add_u32 m0, s64, 25600
    s_mov_b32 s56, 1867776
    buffer_load_dwordx4 v7, s[12:15], s56 offen lds
    s_add_u32 m0, s64, 26624
    s_mov_b32 s56, 1900544
    buffer_load_dwordx4 v7, s[12:15], s56 offen lds
    s_add_u32 m0, s64, 27648
    s_mov_b32 s56, 1933312
    buffer_load_dwordx4 v7, s[12:15], s56 offen lds
    s_add_u32 m0, s64, 28672
    s_mov_b32 s56, 1966080
    buffer_load_dwordx4 v7, s[12:15], s56 offen lds
    s_add_u32 m0, s64, 29696
    s_mov_b32 s56, 1998848
    buffer_load_dwordx4 v7, s[12:15], s56 offen lds
    s_add_u32 m0, s64, 30720
    s_mov_b32 s56, 2031616
    buffer_load_dwordx4 v7, s[12:15], s56 offen lds
    s_add_u32 m0, s64, 31744
    s_mov_b32 s56, 2064384
    buffer_load_dwordx4 v7, s[12:15], s56 offen lds
    s_waitcnt vmcnt(0)
    ds_read_b64_tr_b16 a[128:129], v3 offset:0
    ds_read_b64_tr_b16 a[130:131], v3 offset:512
    ds_read_b64_tr_b16 a[132:133], v3 offset:32
    ds_read_b64_tr_b16 a[134:135], v3 offset:544
    ds_read_b64_tr_b16 a[136:137], v3 offset:2048
    ds_read_b64_tr_b16 a[138:139], v3 offset:2560
    ds_read_b64_tr_b16 a[140:141], v3 offset:2080
    ds_read_b64_tr_b16 a[142:143], v3 offset:2592
    s_waitcnt lgkmcnt(0)
    ds_read_b64_tr_b16 a[144:145], v3 offset:4096
    ds_read_b64_tr_b16 a[146:147], v3 offset:4608
    ds_read_b64_tr_b16 a[148:149], v3 offset:4128
    ds_read_b64_tr_b16 a[150:151], v3 offset:4640
    ds_read_b64_tr_b16 a[152:153], v3 offset:6144
    ds_read_b64_tr_b16 a[154:155], v3 offset:6656
    ds_read_b64_tr_b16 a[156:157], v3 offset:6176
    ds_read_b64_tr_b16 a[158:159], v3 offset:6688
    s_waitcnt lgkmcnt(0)
    ds_read_b64_tr_b16 a[160:161], v3 offset:8192
    ds_read_b64_tr_b16 a[162:163], v3 offset:8704
    ds_read_b64_tr_b16 a[164:165], v3 offset:8224
    ds_read_b64_tr_b16 a[166:167], v3 offset:8736
    ds_read_b64_tr_b16 a[168:169], v3 offset:10240
    ds_read_b64_tr_b16 a[170:171], v3 offset:10752
    ds_read_b64_tr_b16 a[172:173], v3 offset:10272
    ds_read_b64_tr_b16 a[174:175], v3 offset:10784
    s_waitcnt lgkmcnt(0)
    ds_read_b64_tr_b16 a[176:177], v3 offset:12288
    ds_read_b64_tr_b16 a[178:179], v3 offset:12800
    ds_read_b64_tr_b16 a[180:181], v3 offset:12320
    ds_read_b64_tr_b16 a[182:183], v3 offset:12832
    ds_read_b64_tr_b16 a[184:185], v3 offset:14336
    ds_read_b64_tr_b16 a[186:187], v3 offset:14848
    ds_read_b64_tr_b16 a[188:189], v3 offset:14368
    ds_read_b64_tr_b16 a[190:191], v3 offset:14880
    s_waitcnt lgkmcnt(0)
    ds_read_b64_tr_b16 a[192:193], v3 offset:16384
    ds_read_b64_tr_b16 a[194:195], v3 offset:16896
    ds_read_b64_tr_b16 a[196:197], v3 offset:16416
    ds_read_b64_tr_b16 a[198:199], v3 offset:16928
    ds_read_b64_tr_b16 a[200:201], v3 offset:18432
    ds_read_b64_tr_b16 a[202:203], v3 offset:18944
    ds_read_b64_tr_b16 a[204:205], v3 offset:18464
    ds_read_b64_tr_b16 a[206:207], v3 offset:18976
    s_waitcnt lgkmcnt(0)
    ds_read_b64_tr_b16 a[208:209], v3 offset:20480
    ds_read_b64_tr_b16 a[210:211], v3 offset:20992
    ds_read_b64_tr_b16 a[212:213], v3 offset:20512
    ds_read_b64_tr_b16 a[214:215], v3 offset:21024
    ds_read_b64_tr_b16 a[216:217], v3 offset:22528
    ds_read_b64_tr_b16 a[218:219], v3 offset:23040
    ds_read_b64_tr_b16 a[220:221], v3 offset:22560
    ds_read_b64_tr_b16 a[222:223], v3 offset:23072
    s_waitcnt lgkmcnt(0)
    ds_read_b64_tr_b16 a[224:225], v3 offset:24576
    ds_read_b64_tr_b16 a[226:227], v3 offset:25088
    ds_read_b64_tr_b16 a[228:229], v3 offset:24608
    ds_read_b64_tr_b16 a[230:231], v3 offset:25120
    ds_read_b64_tr_b16 a[232:233], v3 offset:26624
    ds_read_b64_tr_b16 a[234:235], v3 offset:27136
    ds_read_b64_tr_b16 a[236:237], v3 offset:26656
    ds_read_b64_tr_b16 a[238:239], v3 offset:27168
    s_waitcnt lgkmcnt(0)
    ds_read_b64_tr_b16 a[240:241], v3 offset:28672
    ds_read_b64_tr_b16 a[242:243], v3 offset:29184
    ds_read_b64_tr_b16 a[244:245], v3 offset:28704
    ds_read_b64_tr_b16 a[246:247], v3 offset:29216
    ds_read_b64_tr_b16 a[248:249], v3 offset:30720
    ds_read_b64_tr_b16 a[250:251], v3 offset:31232
    ds_read_b64_tr_b16 a[252:253], v3 offset:30752
    ds_read_b64_tr_b16 a[254:255], v3 offset:31264
    s_waitcnt lgkmcnt(0)
    v_lshlrev_b32 v13, 9, v40
    v_and_b32 v14, 7, v41
    v_lshl_add_u32 v13, v14, 4, v13
    v_lshrrev_b32 v14, 3, v41
    v_lshl_add_u32 v13, v14, 11, v13
    s_lshl_b32 s56, s44, 16
    s_lshl_b32 s57, s61, 7
    s_add_u32 s56, s56, s57
    s_add_u32 s56, s56, 0x2c00000
    v_add_u32 v26, s56, v13
    s_lshr_b32 s56, s62, 3
    s_lshl_b32 s56, s56, 6
    s_bfe_u32 s57, s62, 0x10002
    s_lshl_b32 s57, s57, 2
    s_add_u32 s56, s56, s57
    s_add_u32 s56, s56, 0x5200020
    s_lshl_b32 s57, s44, 6
    s_add_u32 s57, s57, 0x5200000
    v_lshlrev_b32 v13, 2, v41
    v_add_u32 v13, s57, v13
    v_mov_b32 v14, s56
    v_cmp_gt_u32 vcc, 8, v41
    s_nop 1
    v_cndmask_b32 v27, v14, v13, vcc
    v_mov_b32 v243, v14
    s_lshl_b32 s56, s62, 3
    v_add_u32 v13, s56, v1
    v_subrev_u32 v13, 16, v13
    v_and_b32 v13, 255, v13
    v_and_b32 v14, 7, v1
    v_lshlrev_b32 v14, 5, v14
    v_bfe_u32 v17, v1, 3, 1
    v_lshl_add_u32 v14, v17, 2, v14
    v_add_u32 v14, 27, v14
    v_cmp_gt_u32 vcc, 16, v1
    s_nop 1
    v_cndmask_b32 v13, v13, v14, vcc
    v_lshrrev_b32 v14, 3, v13
    v_lshlrev_b32 v14, 11, v14
    v_bfe_u32 v17, v13, 2, 1
    v_lshl_add_u32 v14, v17, 18, v14
    v_and_b32 v17, 3, v13
    v_lshl_add_u32 v14, v17, 9, v14
    s_lshl_b32 s56, s44, 16
    s_lshl_b32 s57, s61, 7
    s_add_u32 s56, s56, s57
    s_add_u32 s56, s56, 0x2c00000
    v_add_u32 v14, s56, v14
    v_mov_b32 v17, 0x80000000
    v_cmp_gt_u32 vcc, 16, v1
    s_nop 1
    v_cndmask_b32 v244, v17, v14, vcc
    s_lshl_b32 s56, s44, 1
    s_lshl_b32 s57, s61, 3
    s_add_u32 s57, s57, s56
    v_and_b32 v18, 1, v40
    v_add_u32 v17, s57, v18
    v_lshlrev_b32 v13, 11, v17
    v_lshl_add_u32 v13, v41, 2, v13
    s_lshl_b32 s57, s62, 6
    v_add_u32 v13, s57, v13
    v_mov_b32 v14, 0x80000000
    v_cmp_gt_u32 vcc, 32, v1
    s_nop 1
    v_cndmask_b32 v29, v14, v13, vcc
    v_lshrrev_b32 v240, 1, v40
    v_lshl_add_u32 v242, v240, 16, v13
    v_lshrrev_b32 v241, 3, v41
    v_lshrrev_b32 v13, 3, v41
    v_lshlrev_b32 v13, 10, v13
    v_bfe_u32 v14, v41, 1, 1
    v_lshl_add_u32 v13, v14, 9, v13
    v_lshl_add_u32 v13, v17, 4, v13
    v_bfe_u32 v14, v41, 2, 1
    v_lshl_add_u32 v13, v14, 3, v13
    v_and_b32 v14, 1, v41
    v_lshl_add_u32 v13, v14, 2, v13
    s_lshl_b32 s57, s62, 11
    s_add_u32 s57, s57, 0x4a00000
    v_add_u32 v28, s57, v13
    v_mul_u32_u24 v13, 144, v41
    v_lshl_add_u32 v13, v40, 4, v13
    s_mul_i32 s56, s44, 2304
    s_add_u32 s56, s56, 131072
    v_add_u32 v30, s56, v13
    v_mul_u32_u24 v13, 144, v18
    v_lshl_add_u32 v13, v41, 3, v13
    s_mul_i32 s56, s44, 288
    s_add_u32 s56, s56, 131072
    v_add_u32 v31, s56, v13
    s_mov_b32 s60, 0
    s_lshl_b32 s66, s60, 8
    s_lshl_b32 s67, s60, 16
    s_lshl_b32 s65, s60, 18
    s_min_u32 s71, s66, 16128
    s_xor_b32 s71, s71, s45
    s_mov_b32 s68, 0x100000
oflag_49:
    buffer_load_dword v13, v27, s[4:7], s71 offen sc1
    s_waitcnt vmcnt(0)
    v_cmp_gt_u32 vcc, 1, v13
    s_cbranch_vccz oflag_49_ok
    s_sub_u32 s68, s68, 1
    s_cmp_lg_u32 s68, 0
    s_cbranch_scc1 oflag_49
oflag_49_ok:
    s_add_u32 s66, s66, 256
    s_min_u32 s71, s66, 16128
    s_xor_b32 s71, s71, s45
    buffer_load_dword v20, v27, s[4:7], s71 offen sc1
    buffer_load_dwordx4 v[64:67], v26, s[4:7], s65 offen sc1
    s_add_u32 s65, s65, 4096
    buffer_load_dwordx4 v[68:71], v26, s[4:7], s65 offen sc1
    s_add_u32 s65, s65, 4096
    buffer_load_dwordx4 v[72:75], v26, s[4:7], s65 offen sc1
    s_add_u32 s65, s65, 4096
    buffer_load_dwordx4 v[76:79], v26, s[4:7], s65 offen sc1
    s_add_u32 s65, s65, 4096
    buffer_load_dwordx4 v[80:83], v26, s[4:7], s65 offen sc1
    s_add_u32 s65, s65, 4096
    buffer_load_dwordx4 v[84:87], v26, s[4:7], s65 offen sc1
    s_add_u32 s65, s65, 4096
    buffer_load_dwordx4 v[88:91], v26, s[4:7], s65 offen sc1
    s_add_u32 s65, s65, 4096
    buffer_load_dwordx4 v[92:95], v26, s[4:7], s65 offen sc1
    s_add_u32 s65, s65, 4096
    buffer_load_dwordx4 v[96:99], v26, s[4:7], s65 offen sc1
    s_add_u32 s65, s65, 4096
    buffer_load_dwordx4 v[100:103], v26, s[4:7], s65 offen sc1
    s_add_u32 s65, s65, 4096
    buffer_load_dwordx4 v[104:107], v26, s[4:7], s65 offen sc1
    s_add_u32 s65, s65, 4096
    buffer_load_dwordx4 v[108:111], v26, s[4:7], s65 offen sc1
    s_add_u32 s65, s65, 4096
    buffer_load_dwordx4 v[112:115], v26, s[4:7], s65 offen sc1
    s_add_u32 s65, s65, 4096
    buffer_load_dwordx4 v[116:119], v26, s[4:7], s65 offen sc1
    s_add_u32 s65, s65, 4096
    buffer_load_dwordx4 v[120:123], v26, s[4:7], s65 offen sc1
    s_add_u32 s65, s65, 4096
    buffer_load_dwordx4 v[124:127], v26, s[4:7], s65 offen sc1
    s_add_u32 s65, s65, 4096
    buffer_load_dword v22, v28, s[4:7], s67 offen sc1
    buffer_load_dword v24, v29, s[76:79], s67 offen
    buffer_load_dword v13, v27, s[4:7], s66 offen sc1
    s_branch wo_segf0
wo_seg0:
    s_waitcnt vmcnt(16)
    s_mov_b32 s69, s67
    s_add_u32 s60, s60, 1
    v_cmp_eq_u32 vcc, 0, v20
    s_cmp_eq_u32 s60, 62
    s_cbranch_scc1 wo_drain0
    s_cbranch_vccnz wo_drain0
    s_add_u32 s66, s66, 256
    s_lshl_b32 s67, s60, 16
    s_lshl_b32 s65, s60, 18
    s_min_u32 s71, s66, 16128
    s_xor_b32 s71, s71, s45
    buffer_load_dword v21, v27, s[4:7], s71 offen sc1
    buffer_load_dword v23, v28, s[4:7], s67 offen sc1
    buffer_load_dword v25, v29, s[76:79], s67 offen
    s_waitcnt vmcnt(19)
    v_mfma_f32_16x16x32_bf16 v[128:131], a[0:3], v[64:67], 0
    v_mfma_f32_16x16x32_bf16 v[132:135], a[4:7], v[64:67], 0
    v_mfma_f32_16x16x32_bf16 v[136:139], a[8:11], v[64:67], 0
    v_mfma_f32_16x16x32_bf16 v[140:143], a[12:15], v[64:67], 0
    buffer_load_dwordx4 v[64:67], v26, s[4:7], s65 offen sc1
    s_add_u32 s65, s65, 4096
    s_waitcnt vmcnt(19)
    v_mfma_f32_16x16x32_bf16 v[128:131], a[16:19], v[68:71], v[128:131]
    v_mfma_f32_16x16x32_bf16 v[132:135], a[20:23], v[68:71], v[132:135]
    v_mfma_f32_16x16x32_bf16 v[136:139], a[24:27], v[68:71], v[136:139]
    v_mfma_f32_16x16x32_bf16 v[140:143], a[28:31], v[68:71], v[140:143]
    buffer_load_dwordx4 v[68:71], v26, s[4:7], s65 offen sc1
    s_add_u32 s65, s65, 4096
    s_waitcnt vmcnt(19)
    v_mfma_f32_16x16x32_bf16 v[128:131], a[32:35], v[72:75], v[128:131]
    v_mfma_f32_16x16x32_bf16 v[132:135], a[36:39], v[72:75], v[132:135]
    v_mfma_f32_16x16x32_bf16 v[136:139], a[40:43], v[72:75], v[136:139]
    v_mfma_f32_16x16x32_bf16 v[140:143], a[44:47], v[72:75], v[140:143]
    buffer_load_dwordx4 v[72:75], v26, s[4:7], s65 offen sc1
    s_add_u32 s65, s65, 4096
    s_waitcnt vmcnt(19)
    v_mfma_f32_16x16x32_bf16 v[128:131], a[48:51], v[76:79], v[128:131]
    v_mfma_f32_16x16x32_bf16 v[132:135], a[52:55], v[76:79], v[132:135]
    v_mfma_f32_16x16x32_bf16 v[136:139], a[56:59], v[76:79], v[136:139]
    v_mfma_f32_16x16x32_bf16 v[140:143], a[60:63], v[76:79], v[140:143]
    buffer_load_dwordx4 v[76:79], v26, s[4:7], s65 offen sc1
    s_add_u32 s65, s65, 4096
    s_waitcnt vmcnt(19)
    v_mfma_f32_16x16x32_bf16 v[128:131], a[64:67], v[80:83], v[128:131]
    v_mfma_f32_16x16x32_bf16 v[132:135], a[68:71], v[80:83], v[132:135]
    v_mfma_f32_16x16x32_bf16 v[136:139], a[72:75], v[80:83], v[136:139]
    v_mfma_f32_16x16x32_bf16 v[140:143], a[76:79], v[80:83], v[140:143]
    buffer_load_dwordx4 v[80:83], v26, s[4:7], s65 offen sc1
    s_add_u32 s65, s65, 4096
    s_waitcnt vmcnt(19)
    v_mfma_f32_16x16x32_bf16 v[128:131], a[80:83], v[84:87], v[128:131]
    v_mfma_f32_16x16x32_bf16 v[132:135], a[84:87], v[84:87], v[132:135]
    v_mfma_f32_16x16x32_bf16 v[136:139], a[88:91], v[84:87], v[136:139]
    v_mfma_f32_16x16x32_bf16 v[140:143], a[92:95], v[84:87], v[140:143]
    buffer_load_dwordx4 v[84:87], v26, s[4:7], s65 offen sc1
    s_add_u32 s65, s65, 4096
    s_waitcnt vmcnt(19)
    v_mfma_f32_16x16x32_bf16 v[128:131], a[96:99], v[88:91], v[128:131]
    v_mfma_f32_16x16x32_bf16 v[132:135], a[100:103], v[88:91], v[132:135]
    v_mfma_f32_16x16x32_bf16 v[136:139], a[104:107], v[88:91], v[136:139]
    v_mfma_f32_16x16x32_bf16 v[140:143], a[108:111], v[88:91], v[140:143]
    buffer_load_dwordx4 v[88:91], v26, s[4:7], s65 offen sc1
    s_add_u32 s65, s65, 4096
    s_waitcnt vmcnt(19)
    v_mfma_f32_16x16x32_bf16 v[128:131], a[112:115], v[92:95], v[128:131]
    v_mfma_f32_16x16x32_bf16 v[132:135], a[116:119], v[92:95], v[132:135]
    v_mfma_f32_16x16x32_bf16 v[136:139], a[120:123], v[92:95], v[136:139]
    v_mfma_f32_16x16x32_bf16 v[140:143], a[124:127], v[92:95], v[140:143]
    buffer_load_dwordx4 v[92:95], v26, s[4:7], s65 offen sc1
    s_add_u32 s65, s65, 4096
    s_waitcnt vmcnt(19)
    v_mfma_f32_16x16x32_bf16 v[128:131], a[128:131], v[96:99], v[128:131]
    v_mfma_f32_16x16x32_bf16 v[132:135], a[132:135], v[96:99], v[132:135]
    v_mfma_f32_16x16x32_bf16 v[136:139], a[136:139], v[96:99], v[136:139]
    v_mfma_f32_16x16x32_bf16 v[140:143], a[140:143], v[96:99], v[140:143]
    buffer_load_dwordx4 v[96:99], v26, s[4:7], s65 offen sc1
    s_add_u32 s65, s65, 4096
    s_waitcnt vmcnt(19)
    v_mfma_f32_16x16x32_bf16 v[128:131], a[144:147], v[100:103], v[128:131]
    v_mfma_f32_16x16x32_bf16 v[132:135], a[148:151], v[100:103], v[132:135]
    v_mfma_f32_16x16x32_bf16 v[136:139], a[152:155], v[100:103], v[136:139]
    v_mfma_f32_16x16x32_bf16 v[140:143], a[156:159], v[100:103], v[140:143]
    buffer_load_dwordx4 v[100:103], v26, s[4:7], s65 offen sc1
    s_add_u32 s65, s65, 4096
    s_waitcnt vmcnt(19)
    v_mfma_f32_16x16x32_bf16 v[128:131], a[160:163], v[104:107], v[128:131]
    v_mfma_f32_16x16x32_bf16 v[132:135], a[164:167], v[104:107], v[132:135]
    v_mfma_f32_16x16x32_bf16 v[136:139], a[168:171], v[104:107], v[136:139]
    v_mfma_f32_16x16x32_bf16 v[140:143], a[172:175], v[104:107], v[140:143]
    buffer_load_dwordx4 v[104:107], v26, s[4:7], s65 offen sc1
    s_add_u32 s65, s65, 4096
    s_waitcnt vmcnt(19)
    v_mfma_f32_16x16x32_bf16 v[128:131], a[176:179], v[108:111], v[128:131]
    v_mfma_f32_16x16x32_bf16 v[132:135], a[180:183], v[108:111], v[132:135]
    v_mfma_f32_16x16x32_bf16 v[136:139], a[184:187], v[108:111], v[136:139]
    v_mfma_f32_16x16x32_bf16 v[140:143], a[188:191], v[108:111], v[140:143]
    buffer_load_dwordx4 v[108:111], v26, s[4:7], s65 offen sc1
    s_add_u32 s65, s65, 4096
    s_waitcnt vmcnt(19)
    v_mfma_f32_16x16x32_bf16 v[128:131], a[192:195], v[112:115], v[128:131]
    v_mfma_f32_16x16x32_bf16 v[132:135], a[196:199], v[112:115], v[132:135]
    v_mfma_f32_16x16x32_bf16 v[136:139], a[200:203], v[112:115], v[136:139]
    v_mfma_f32_16x16x32_bf16 v[140:143], a[204:207], v[112:115], v[140:143]
    buffer_load_dwordx4 v[112:115], v26, s[4:7], s65 offen sc1
    s_add_u32 s65, s65, 4096
    s_waitcnt vmcnt(19)
    v_mfma_f32_16x16x32_bf16 v[128:131], a[208:211], v[116:119], v[128:131]
    v_mfma_f32_16x16x32_bf16 v[132:135], a[212:215], v[116:119], v[132:135]
    v_mfma_f32_16x16x32_bf16 v[136:139], a[216:219], v[116:119], v[136:139]
    v_mfma_f32_16x16x32_bf16 v[140:143], a[220:223], v[116:119], v[140:143]
    buffer_load_dwordx4 v[116:119], v26, s[4:7], s65 offen sc1
    s_add_u32 s65, s65, 4096
    s_waitcnt vmcnt(19)
    v_mfma_f32_16x16x32_bf16 v[128:131], a[224:227], v[120:123], v[128:131]
    v_mfma_f32_16x16x32_bf16 v[132:135], a[228:231], v[120:123], v[132:135]
    v_mfma_f32_16x16x32_bf16 v[136:139], a[232:235], v[120:123], v[136:139]
    v_mfma_f32_16x16x32_bf16 v[140:143], a[236:239], v[120:123], v[140:143]
    buffer_load_dwordx4 v[120:123], v26, s[4:7], s65 offen sc1
    s_add_u32 s65, s65, 4096
    s_waitcnt vmcnt(19)
    v_mfma_f32_16x16x32_bf16 v[128:131], a[240:243], v[124:127], v[128:131]
    v_mfma_f32_16x16x32_bf16 v[132:135], a[244:247], v[124:127], v[132:135]
    v_mfma_f32_16x16x32_bf16 v[136:139], a[248:251], v[124:127], v[136:139]
    v_mfma_f32_16x16x32_bf16 v[140:143], a[252:255], v[124:127], v[140:143]
    buffer_load_dwordx4 v[124:127], v26, s[4:7], s65 offen sc1
    s_add_u32 s65, s65, 4096
    s_nop 1
    v_add_f32_dpp v128, v136, v128 row_ror:8 row_mask:0xf bank_mask:0xf
    v_add_f32_dpp v129, v137, v129 row_ror:8 row_mask:0xf bank_mask:0xf
    v_add_f32_dpp v130, v138, v130 row_ror:8 row_mask:0xf bank_mask:0xf
    v_add_f32_dpp v131, v139, v131 row_ror:8 row_mask:0xf bank_mask:0xf
    v_add_f32_dpp v132, v140, v132 row_ror:8 row_mask:0xf bank_mask:0xf
    v_add_f32_dpp v133, v141, v133 row_ror:8 row_mask:0xf bank_mask:0xf
    v_add_f32_dpp v134, v142, v134 row_ror:8 row_mask:0xf bank_mask:0xf
    v_add_f32_dpp v135, v143, v135 row_ror:8 row_mask:0xf bank_mask:0xf
    ds_write_b128 v30, v[128:131] offset:0
    ds_write_b128 v30, v[132:135] offset:64
    s_waitcnt lgkmcnt(0)
    s_barrier
    ds_read_b64 v[40:41], v31 offset:0
    ds_read_b64 v[42:43], v31 offset:2304
    ds_read_b64 v[44:45], v31 offset:4608
    ds_read_b64 v[46:47], v31 offset:6912
    v_lshlrev_b32 v48, 16, v24
    v_and_b32 v49, 0xffff0000, v24
    v_lshlrev_b32 v50, 16, v22
    v_and_b32 v51, 0xffff0000, v22
    s_waitcnt lgkmcnt(0)
    v_add_f32 v40, v40, v42
    v_add_f32 v44, v44, v46
    v_add_f32 v41, v41, v43
    v_add_f32 v45, v45, v47
    v_add_f32 v40, v40, v44
    v_add_f32 v41, v41, v45
    v_cvt_pk_bf16_f32 v40, v40, v41
    v_and_b32 v41, 0xffff0000, v40
    v_lshlrev_b32 v40, 16, v40
    v_add_f32 v40, v40, v48
    v_add_f32 v41, v41, v49
    v_cvt_pk_bf16_f32 v40, v40, v41
    v_and_b32 v41, 0xffff0000, v40
    v_lshlrev_b32 v40, 16, v40
    v_add_f32 v40, v40, v50
    v_add_f32 v41, v41, v51
    v_cvt_pk_bf16_f32 v40, v40, v41
    buffer_store_dword v40, v29, s[80:83], s69 offen sc0 sc1 nt
    s_branch wo_seg1
wo_drain0:
    s_waitcnt vmcnt(16)
    v_mfma_f32_16x16x32_bf16 v[128:131], a[0:3], v[64:67], 0
    v_mfma_f32_16x16x32_bf16 v[132:135], a[4:7], v[64:67], 0
    v_mfma_f32_16x16x32_bf16 v[136:139], a[8:11], v[64:67], 0
    v_mfma_f32_16x16x32_bf16 v[140:143], a[12:15], v[64:67], 0
    s_waitcnt vmcnt(15)
    v_mfma_f32_16x16x32_bf16 v[128:131], a[16:19], v[68:71], v[128:131]
    v_mfma_f32_16x16x32_bf16 v[132:135], a[20:23], v[68:71], v[132:135]
    v_mfma_f32_16x16x32_bf16 v[136:139], a[24:27], v[68:71], v[136:139]
    v_mfma_f32_16x16x32_bf16 v[140:143], a[28:31], v[68:71], v[140:143]
    s_waitcnt vmcnt(14)
    v_mfma_f32_16x16x32_bf16 v[128:131], a[32:35], v[72:75], v[128:131]
    v_mfma_f32_16x16x32_bf16 v[132:135], a[36:39], v[72:75], v[132:135]
    v_mfma_f32_16x16x32_bf16 v[136:139], a[40:43], v[72:75], v[136:139]
    v_mfma_f32_16x16x32_bf16 v[140:143], a[44:47], v[72:75], v[140:143]
    s_waitcnt vmcnt(13)
    v_mfma_f32_16x16x32_bf16 v[128:131], a[48:51], v[76:79], v[128:131]
    v_mfma_f32_16x16x32_bf16 v[132:135], a[52:55], v[76:79], v[132:135]
    v_mfma_f32_16x16x32_bf16 v[136:139], a[56:59], v[76:79], v[136:139]
    v_mfma_f32_16x16x32_bf16 v[140:143], a[60:63], v[76:79], v[140:143]
    s_waitcnt vmcnt(12)
    v_mfma_f32_16x16x32_bf16 v[128:131], a[64:67], v[80:83], v[128:131]
    v_mfma_f32_16x16x32_bf16 v[132:135], a[68:71], v[80:83], v[132:135]
    v_mfma_f32_16x16x32_bf16 v[136:139], a[72:75], v[80:83], v[136:139]
    v_mfma_f32_16x16x32_bf16 v[140:143], a[76:79], v[80:83], v[140:143]
    s_waitcnt vmcnt(11)
    v_mfma_f32_16x16x32_bf16 v[128:131], a[80:83], v[84:87], v[128:131]
    v_mfma_f32_16x16x32_bf16 v[132:135], a[84:87], v[84:87], v[132:135]
    v_mfma_f32_16x16x32_bf16 v[136:139], a[88:91], v[84:87], v[136:139]
    v_mfma_f32_16x16x32_bf16 v[140:143], a[92:95], v[84:87], v[140:143]
    s_waitcnt vmcnt(10)
    v_mfma_f32_16x16x32_bf16 v[128:131], a[96:99], v[88:91], v[128:131]
    v_mfma_f32_16x16x32_bf16 v[132:135], a[100:103], v[88:91], v[132:135]
    v_mfma_f32_16x16x32_bf16 v[136:139], a[104:107], v[88:91], v[136:139]
    v_mfma_f32_16x16x32_bf16 v[140:143], a[108:111], v[88:91], v[140:143]
    s_waitcnt vmcnt(9)
    v_mfma_f32_16x16x32_bf16 v[128:131], a[112:115], v[92:95], v[128:131]
    v_mfma_f32_16x16x32_bf16 v[132:135], a[116:119], v[92:95], v[132:135]
    v_mfma_f32_16x16x32_bf16 v[136:139], a[120:123], v[92:95], v[136:139]
    v_mfma_f32_16x16x32_bf16 v[140:143], a[124:127], v[92:95], v[140:143]
    s_waitcnt vmcnt(8)
    v_mfma_f32_16x16x32_bf16 v[128:131], a[128:131], v[96:99], v[128:131]
    v_mfma_f32_16x16x32_bf16 v[132:135], a[132:135], v[96:99], v[132:135]
    v_mfma_f32_16x16x32_bf16 v[136:139], a[136:139], v[96:99], v[136:139]
    v_mfma_f32_16x16x32_bf16 v[140:143], a[140:143], v[96:99], v[140:143]
    s_waitcnt vmcnt(7)
    v_mfma_f32_16x16x32_bf16 v[128:131], a[144:147], v[100:103], v[128:131]
    v_mfma_f32_16x16x32_bf16 v[132:135], a[148:151], v[100:103], v[132:135]
    v_mfma_f32_16x16x32_bf16 v[136:139], a[152:155], v[100:103], v[136:139]
    v_mfma_f32_16x16x32_bf16 v[140:143], a[156:159], v[100:103], v[140:143]
    s_waitcnt vmcnt(6)
    v_mfma_f32_16x16x32_bf16 v[128:131], a[160:163], v[104:107], v[128:131]
    v_mfma_f32_16x16x32_bf16 v[132:135], a[164:167], v[104:107], v[132:135]
    v_mfma_f32_16x16x32_bf16 v[136:139], a[168:171], v[104:107], v[136:139]
    v_mfma_f32_16x16x32_bf16 v[140:143], a[172:175], v[104:107], v[140:143]
    s_waitcnt vmcnt(5)
    v_mfma_f32_16x16x32_bf16 v[128:131], a[176:179], v[108:111], v[128:131]
    v_mfma_f32_16x16x32_bf16 v[132:135], a[180:183], v[108:111], v[132:135]
    v_mfma_f32_16x16x32_bf16 v[136:139], a[184:187], v[108:111], v[136:139]
    v_mfma_f32_16x16x32_bf16 v[140:143], a[188:191], v[108:111], v[140:143]
    s_waitcnt vmcnt(4)
    v_mfma_f32_16x16x32_bf16 v[128:131], a[192:195], v[112:115], v[128:131]
    v_mfma_f32_16x16x32_bf16 v[132:135], a[196:199], v[112:115], v[132:135]
    v_mfma_f32_16x16x32_bf16 v[136:139], a[200:203], v[112:115], v[136:139]
    v_mfma_f32_16x16x32_bf16 v[140:143], a[204:207], v[112:115], v[140:143]
    s_waitcnt vmcnt(3)
    v_mfma_f32_16x16x32_bf16 v[128:131], a[208:211], v[116:119], v[128:131]
    v_mfma_f32_16x16x32_bf16 v[132:135], a[212:215], v[116:119], v[132:135]
    v_mfma_f32_16x16x32_bf16 v[136:139], a[216:219], v[116:119], v[136:139]
    v_mfma_f32_16x16x32_bf16 v[140:143], a[220:223], v[116:119], v[140:143]
    s_waitcnt vmcnt(2)
    v_mfma_f32_16x16x32_bf16 v[128:131], a[224:227], v[120:123], v[128:131]
    v_mfma_f32_16x16x32_bf16 v[132:135], a[228:231], v[120:123], v[132:135]
    v_mfma_f32_16x16x32_bf16 v[136:139], a[232:235], v[120:123], v[136:139]
    v_mfma_f32_16x16x32_bf16 v[140:143], a[236:239], v[120:123], v[140:143]
    s_waitcnt vmcnt(1)
    v_mfma_f32_16x16x32_bf16 v[128:131], a[240:243], v[124:127], v[128:131]
    v_mfma_f32_16x16x32_bf16 v[132:135], a[244:247], v[124:127], v[132:135]
    v_mfma_f32_16x16x32_bf16 v[136:139], a[248:251], v[124:127], v[136:139]
    v_mfma_f32_16x16x32_bf16 v[140:143], a[252:255], v[124:127], v[140:143]
    s_nop 3
    v_add_f32_dpp v128, v136, v128 row_ror:8 row_mask:0xf bank_mask:0xf
    v_add_f32_dpp v129, v137, v129 row_ror:8 row_mask:0xf bank_mask:0xf
    v_add_f32_dpp v130, v138, v130 row_ror:8 row_mask:0xf bank_mask:0xf
    v_add_f32_dpp v131, v139, v131 row_ror:8 row_mask:0xf bank_mask:0xf
    v_add_f32_dpp v132, v140, v132 row_ror:8 row_mask:0xf bank_mask:0xf
    v_add_f32_dpp v133, v141, v133 row_ror:8 row_mask:0xf bank_mask:0xf
    v_add_f32_dpp v134, v142, v134 row_ror:8 row_mask:0xf bank_mask:0xf
    v_add_f32_dpp v135, v143, v135 row_ror:8 row_mask:0xf bank_mask:0xf
    ds_write_b128 v30, v[128:131] offset:0
    ds_write_b128 v30, v[132:135] offset:64
    s_waitcnt lgkmcnt(0)
    s_barrier
    ds_read_b64 v[40:41], v31 offset:0
    ds_read_b64 v[42:43], v31 offset:2304
    ds_read_b64 v[44:45], v31 offset:4608
    ds_read_b64 v[46:47], v31 offset:6912
    v_lshlrev_b32 v48, 16, v24
    v_and_b32 v49, 0xffff0000, v24
    v_lshlrev_b32 v50, 16, v22
    v_and_b32 v51, 0xffff0000, v22
    s_waitcnt lgkmcnt(0)
    v_add_f32 v40, v40, v42
    v_add_f32 v44, v44, v46
    v_add_f32 v41, v41, v43
    v_add_f32 v45, v45, v47
    v_add_f32 v40, v40, v44
    v_add_f32 v41, v41, v45
    v_cvt_pk_bf16_f32 v40, v40, v41
    v_and_b32 v41, 0xffff0000, v40
    v_lshlrev_b32 v40, 16, v40
    v_add_f32 v40, v40, v48
    v_add_f32 v41, v41, v49
    v_cvt_pk_bf16_f32 v40, v40, v41
    v_and_b32 v41, 0xffff0000, v40
    v_lshlrev_b32 v40, 16, v40
    v_add_f32 v40, v40, v50
    v_add_f32 v41, v41, v51
    v_cvt_pk_bf16_f32 v40, v40, v41
wo_next0:
    s_cmp_eq_u32 s60, 63
    s_cbranch_scc1 wo_last
    s_lshl_b32 s66, s60, 8
    s_lshl_b32 s67, s60, 16
    s_lshl_b32 s65, s60, 18
    s_min_u32 s71, s66, 16128
    s_xor_b32 s71, s71, s45
    s_mov_b32 s68, 0x100000
oflag_50:
    buffer_load_dword v13, v27, s[4:7], s71 offen sc1
    s_waitcnt vmcnt(0)
    v_cmp_gt_u32 vcc, 1, v13
    s_cbranch_vccz oflag_50_ok
    s_sub_u32 s68, s68, 1
    s_cmp_lg_u32 s68, 0
    s_cbranch_scc1 oflag_50
oflag_50_ok:
    s_add_u32 s66, s66, 256
    s_min_u32 s71, s66, 16128
    s_xor_b32 s71, s71, s45
    buffer_load_dword v21, v27, s[4:7], s71 offen sc1
    buffer_load_dwordx4 v[64:67], v26, s[4:7], s65 offen sc1
    s_add_u32 s65, s65, 4096
    buffer_load_dwordx4 v[68:71], v26, s[4:7], s65 offen sc1
    s_add_u32 s65, s65, 4096
    buffer_load_dwordx4 v[72:75], v26, s[4:7], s65 offen sc1
    s_add_u32 s65, s65, 4096
    buffer_load_dwordx4 v[76:79], v26, s[4:7], s65 offen sc1
    s_add_u32 s65, s65, 4096
    buffer_load_dwordx4 v[80:83], v26, s[4:7], s65 offen sc1
    s_add_u32 s65, s65, 4096
    buffer_load_dwordx4 v[84:87], v26, s[4:7], s65 offen sc1
    s_add_u32 s65, s65, 4096
    buffer_load_dwordx4 v[88:91], v26, s[4:7], s65 offen sc1
    s_add_u32 s65, s65, 4096
    buffer_load_dwordx4 v[92:95], v26, s[4:7], s65 offen sc1
    s_add_u32 s65, s65, 4096
    buffer_load_dwordx4 v[96:99], v26, s[4:7], s65 offen sc1
    s_add_u32 s65, s65, 4096
    buffer_load_dwordx4 v[100:103], v26, s[4:7], s65 offen sc1
    s_add_u32 s65, s65, 4096
    buffer_load_dwordx4 v[104:107], v26, s[4:7], s65 offen sc1
    s_add_u32 s65, s65, 4096
    buffer_load_dwordx4 v[108:111], v26, s[4:7], s65 offen sc1
    s_add_u32 s65, s65, 4096
    buffer_load_dwordx4 v[112:115], v26, s[4:7], s65 offen sc1
    s_add_u32 s65, s65, 4096
    buffer_load_dwordx4 v[116:119], v26, s[4:7], s65 offen sc1
    s_add_u32 s65, s65, 4096
    buffer_load_dwordx4 v[120:123], v26, s[4:7], s65 offen sc1
    s_add_u32 s65, s65, 4096
    buffer_load_dwordx4 v[124:127], v26, s[4:7], s65 offen sc1
    s_add_u32 s65, s65, 4096
    buffer_load_dword v23, v28, s[4:7], s67 offen sc1
    buffer_load_dword v25, v29, s[76:79], s67 offen
    buffer_store_dword v40, v29, s[80:83], s69 offen sc0 sc1 nt
wo_segf1:
    s_waitcnt vmcnt(19)
    s_mov_b32 s69, s67
    s_add_u32 s60, s60, 1
    v_cmp_eq_u32 vcc, 0, v21
    s_cmp_eq_u32 s60, 62
    s_cbranch_scc1 wo_drainf1
    s_cbranch_vccnz wo_drainf1
    s_add_u32 s66, s66, 256
    s_lshl_b32 s67, s60, 16
    s_lshl_b32 s65, s60, 18
    s_min_u32 s71, s66, 16128
    s_xor_b32 s71, s71, s45
    buffer_load_dword v20, v27, s[4:7], s71 offen sc1
    buffer_load_dword v22, v28, s[4:7], s67 offen sc1
    buffer_load_dword v24, v29, s[76:79], s67 offen
    s_waitcnt vmcnt(21)
    v_mfma_f32_16x16x32_bf16 v[128:131], a[0:3], v[64:67], 0
    v_mfma_f32_16x16x32_bf16 v[132:135], a[4:7], v[64:67], 0
    v_mfma_f32_16x16x32_bf16 v[136:139], a[8:11], v[64:67], 0
    v_mfma_f32_16x16x32_bf16 v[140:143], a[12:15], v[64:67], 0
    buffer_load_dwordx4 v[64:67], v26, s[4:7], s65 offen sc1
    s_add_u32 s65, s65, 4096
    s_waitcnt vmcnt(21)
    v_mfma_f32_16x16x32_bf16 v[128:131], a[16:19], v[68:71], v[128:131]
    v_mfma_f32_16x16x32_bf16 v[132:135], a[20:23], v[68:71], v[132:135]
    v_mfma_f32_16x16x32_bf16 v[136:139], a[24:27], v[68:71], v[136:139]
    v_mfma_f32_16x16x32_bf16 v[140:143], a[28:31], v[68:71], v[140:143]
    buffer_load_dwordx4 v[68:71], v26, s[4:7], s65 offen sc1
    s_add_u32 s65, s65, 4096
    s_waitcnt vmcnt(21)
    v_mfma_f32_16x16x32_bf16 v[128:131], a[32:35], v[72:75], v[128:131]
    v_mfma_f32_16x16x32_bf16 v[132:135], a[36:39], v[72:75], v[132:135]
    v_mfma_f32_16x16x32_bf16 v[136:139], a[40:43], v[72:75], v[136:139]
    v_mfma_f32_16x16x32_bf16 v[140:143], a[44:47], v[72:75], v[140:143]
    buffer_load_dwordx4 v[72:75], v26, s[4:7], s65 offen sc1
    s_add_u32 s65, s65, 4096
    s_waitcnt vmcnt(21)
    v_mfma_f32_16x16x32_bf16 v[128:131], a[48:51], v[76:79], v[128:131]
    v_mfma_f32_16x16x32_bf16 v[132:135], a[52:55], v[76:79], v[132:135]
    v_mfma_f32_16x16x32_bf16 v[136:139], a[56:59], v[76:79], v[136:139]
    v_mfma_f32_16x16x32_bf16 v[140:143], a[60:63], v[76:79], v[140:143]
    buffer_load_dwordx4 v[76:79], v26, s[4:7], s65 offen sc1
    s_add_u32 s65, s65, 4096
    s_waitcnt vmcnt(21)
    v_mfma_f32_16x16x32_bf16 v[128:131], a[64:67], v[80:83], v[128:131]
    v_mfma_f32_16x16x32_bf16 v[132:135], a[68:71], v[80:83], v[132:135]
    v_mfma_f32_16x16x32_bf16 v[136:139], a[72:75], v[80:83], v[136:139]
    v_mfma_f32_16x16x32_bf16 v[140:143], a[76:79], v[80:83], v[140:143]
    buffer_load_dwordx4 v[80:83], v26, s[4:7], s65 offen sc1
    s_add_u32 s65, s65, 4096
    s_waitcnt vmcnt(21)
    v_mfma_f32_16x16x32_bf16 v[128:131], a[80:83], v[84:87], v[128:131]
    v_mfma_f32_16x16x32_bf16 v[132:135], a[84:87], v[84:87], v[132:135]
    v_mfma_f32_16x16x32_bf16 v[136:139], a[88:91], v[84:87], v[136:139]
    v_mfma_f32_16x16x32_bf16 v[140:143], a[92:95], v[84:87], v[140:143]
    buffer_load_dwordx4 v[84:87], v26, s[4:7], s65 offen sc1
    s_add_u32 s65, s65, 4096
    s_waitcnt vmcnt(21)
    v_mfma_f32_16x16x32_bf16 v[128:131], a[96:99], v[88:91], v[128:131]
    v_mfma_f32_16x16x32_bf16 v[132:135], a[100:103], v[88:91], v[132:135]
    v_mfma_f32_16x16x32_bf16 v[136:139], a[104:107], v[88:91], v[136:139]
    v_mfma_f32_16x16x32_bf16 v[140:143], a[108:111], v[88:91], v[140:143]
    buffer_load_dwordx4 v[88:91], v26, s[4:7], s65 offen sc1
    s_add_u32 s65, s65, 4096
    s_waitcnt vmcnt(21)
    v_mfma_f32_16x16x32_bf16 v[128:131], a[112:115], v[92:95], v[128:131]
    v_mfma_f32_16x16x32_bf16 v[132:135], a[116:119], v[92:95], v[132:135]
    v_mfma_f32_16x16x32_bf16 v[136:139], a[120:123], v[92:95], v[136:139]
    v_mfma_f32_16x16x32_bf16 v[140:143], a[124:127], v[92:95], v[140:143]
    buffer_load_dwordx4 v[92:95], v26, s[4:7], s65 offen sc1
    s_add_u32 s65, s65, 4096
    s_waitcnt vmcnt(21)
    v_mfma_f32_16x16x32_bf16 v[128:131], a[128:131], v[96:99], v[128:131]
    v_mfma_f32_16x16x32_bf16 v[132:135], a[132:135], v[96:99], v[132:135]
    v_mfma_f32_16x16x32_bf16 v[136:139], a[136:139], v[96:99], v[136:139]
    v_mfma_f32_16x16x32_bf16 v[140:143], a[140:143], v[96:99], v[140:143]
    buffer_load_dwordx4 v[96:99], v26, s[4:7], s65 offen sc1
    s_add_u32 s65, s65, 4096
    s_waitcnt vmcnt(21)
    v_mfma_f32_16x16x32_bf16 v[128:131], a[144:147], v[100:103], v[128:131]
    v_mfma_f32_16x16x32_bf16 v[132:135], a[148:151], v[100:103], v[132:135]
    v_mfma_f32_16x16x32_bf16 v[136:139], a[152:155], v[100:103], v[136:139]
    v_mfma_f32_16x16x32_bf16 v[140:143], a[156:159], v[100:103], v[140:143]
    buffer_load_dwordx4 v[100:103], v26, s[4:7], s65 offen sc1
    s_add_u32 s65, s65, 4096
    s_waitcnt vmcnt(21)
    v_mfma_f32_16x16x32_bf16 v[128:131], a[160:163], v[104:107], v[128:131]
    v_mfma_f32_16x16x32_bf16 v[132:135], a[164:167], v[104:107], v[132:135]
    v_mfma_f32_16x16x32_bf16 v[136:139], a[168:171], v[104:107], v[136:139]
    v_mfma_f32_16x16x32_bf16 v[140:143], a[172:175], v[104:107], v[140:143]
    buffer_load_dwordx4 v[104:107], v26, s[4:7], s65 offen sc1
    s_add_u32 s65, s65, 4096
    s_waitcnt vmcnt(21)
    v_mfma_f32_16x16x32_bf16 v[128:131], a[176:179], v[108:111], v[128:131]
    v_mfma_f32_16x16x32_bf16 v[132:135], a[180:183], v[108:111], v[132:135]
    v_mfma_f32_16x16x32_bf16 v[136:139], a[184:187], v[108:111], v[136:139]
    v_mfma_f32_16x16x32_bf16 v[140:143], a[188:191], v[108:111], v[140:143]
    buffer_load_dwordx4 v[108:111], v26, s[4:7], s65 offen sc1
    s_add_u32 s65, s65, 4096
    s_waitcnt vmcnt(21)
    v_mfma_f32_16x16x32_bf16 v[128:131], a[192:195], v[112:115], v[128:131]
    v_mfma_f32_16x16x32_bf16 v[132:135], a[196:199], v[112:115], v[132:135]
    v_mfma_f32_16x16x32_bf16 v[136:139], a[200:203], v[112:115], v[136:139]
    v_mfma_f32_16x16x32_bf16 v[140:143], a[204:207], v[112:115], v[140:143]
    buffer_load_dwordx4 v[112:115], v26, s[4:7], s65 offen sc1
    s_add_u32 s65, s65, 4096
    s_waitcnt vmcnt(21)
    v_mfma_f32_16x16x32_bf16 v[128:131], a[208:211], v[116:119], v[128:131]
    v_mfma_f32_16x16x32_bf16 v[132:135], a[212:215], v[116:119], v[132:135]
    v_mfma_f32_16x16x32_bf16 v[136:139], a[216:219], v[116:119], v[136:139]
    v_mfma_f32_16x16x32_bf16 v[140:143], a[220:223], v[116:119], v[140:143]
    buffer_load_dwordx4 v[116:119], v26, s[4:7], s65 offen sc1
    s_add_u32 s65, s65, 4096
    s_waitcnt vmcnt(21)
    v_mfma_f32_16x16x32_bf16 v[128:131], a[224:227], v[120:123], v[128:131]
    v_mfma_f32_16x16x32_bf16 v[132:135], a[228:231], v[120:123], v[132:135]
    v_mfma_f32_16x16x32_bf16 v[136:139], a[232:235], v[120:123], v[136:139]
    v_mfma_f32_16x16x32_bf16 v[140:143], a[236:239], v[120:123], v[140:143]
    buffer_load_dwordx4 v[120:123], v26, s[4:7], s65 offen sc1
    s_add_u32 s65, s65, 4096
    s_waitcnt vmcnt(21)
    v_mfma_f32_16x16x32_bf16 v[128:131], a[240:243], v[124:127], v[128:131]
    v_mfma_f32_16x16x32_bf16 v[132:135], a[244:247], v[124:127], v[132:135]
    v_mfma_f32_16x16x32_bf16 v[136:139], a[248:251], v[124:127], v[136:139]
    v_mfma_f32_16x16x32_bf16 v[140:143], a[252:255], v[124:127], v[140:143]
    buffer_load_dwordx4 v[124:127], v26, s[4:7], s65 offen sc1
    s_add_u32 s65, s65, 4096
    s_nop 1
    v_add_f32_dpp v128, v136, v128 row_ror:8 row_mask:0xf bank_mask:0xf
    v_add_f32_dpp v129, v137, v129 row_ror:8 row_mask:0xf bank_mask:0xf
    v_add_f32_dpp v130, v138, v130 row_ror:8 row_mask:0xf bank_mask:0xf
    v_add_f32_dpp v131, v139, v131 row_ror:8 row_mask:0xf bank_mask:0xf
    v_add_f32_dpp v132, v140, v132 row_ror:8 row_mask:0xf bank_mask:0xf
    v_add_f32_dpp v133, v141, v133 row_ror:8 row_mask:0xf bank_mask:0xf
    v_add_f32_dpp v134, v142, v134 row_ror:8 row_mask:0xf bank_mask:0xf
    v_add_f32_dpp v135, v143, v135 row_ror:8 row_mask:0xf bank_mask:0xf
    ds_write_b128 v30, v[128:131] offset:9216
    ds_write_b128 v30, v[132:135] offset:9280
    s_waitcnt lgkmcnt(0)
    s_barrier
    ds_read_b64 v[40:41], v31 offset:9216
    ds_read_b64 v[42:43], v31 offset:11520
    ds_read_b64 v[44:45], v31 offset:13824
    ds_read_b64 v[46:47], v31 offset:16128
    s_waitcnt vmcnt(20)
    v_lshlrev_b32 v48, 16, v25
    v_and_b32 v49, 0xffff0000, v25
    v_lshlrev_b32 v50, 16, v23
    v_and_b32 v51, 0xffff0000, v23
    s_waitcnt lgkmcnt(0)
    v_add_f32 v40, v40, v42
    v_add_f32 v44, v44, v46
    v_add_f32 v41, v41, v43
    v_add_f32 v45, v45, v47
    v_add_f32 v40, v40, v44
    v_add_f32 v41, v41, v45
    v_cvt_pk_bf16_f32 v40, v40, v41
    v_and_b32 v41, 0xffff0000, v40
    v_lshlrev_b32 v40, 16, v40
    v_add_f32 v40, v40, v48
    v_add_f32 v41, v41, v49
    v_cvt_pk_bf16_f32 v40, v40, v41
    v_and_b32 v41, 0xffff0000, v40
    v_lshlrev_b32 v40, 16, v40
    v_add_f32 v40, v40, v50
    v_add_f32 v41, v41, v51
    v_cvt_pk_bf16_f32 v40, v40, v41
    buffer_store_dword v40, v29, s[80:83], s69 offen sc0 sc1 nt
    s_branch wo_seg0
wo_drainf1:
    s_waitcnt vmcnt(18)
    v_mfma_f32_16x16x32_bf16 v[128:131], a[0:3], v[64:67], 0
    v_mfma_f32_16x16x32_bf16 v[132:135], a[4:7], v[64:67], 0
    v_mfma_f32_16x16x32_bf16 v[136:139], a[8:11], v[64:67], 0
    v_mfma_f32_16x16x32_bf16 v[140:143], a[12:15], v[64:67], 0
    s_waitcnt vmcnt(17)
    v_mfma_f32_16x16x32_bf16 v[128:131], a[16:19], v[68:71], v[128:131]
    v_mfma_f32_16x16x32_bf16 v[132:135], a[20:23], v[68:71], v[132:135]
    v_mfma_f32_16x16x32_bf16 v[136:139], a[24:27], v[68:71], v[136:139]
    v_mfma_f32_16x16x32_bf16 v[140:143], a[28:31], v[68:71], v[140:143]
    s_waitcnt vmcnt(16)
    v_mfma_f32_16x16x32_bf16 v[128:131], a[32:35], v[72:75], v[128:131]
    v_mfma_f32_16x16x32_bf16 v[132:135], a[36:39], v[72:75], v[132:135]
    v_mfma_f32_16x16x32_bf16 v[136:139], a[40:43], v[72:75], v[136:139]
    v_mfma_f32_16x16x32_bf16 v[140:143], a[44:47], v[72:75], v[140:143]
    s_waitcnt vmcnt(15)
    v_mfma_f32_16x16x32_bf16 v[128:131], a[48:51], v[76:79], v[128:131]
    v_mfma_f32_16x16x32_bf16 v[132:135], a[52:55], v[76:79], v[132:135]
    v_mfma_f32_16x16x32_bf16 v[136:139], a[56:59], v[76:79], v[136:139]
    v_mfma_f32_16x16x32_bf16 v[140:143], a[60:63], v[76:79], v[140:143]
    s_waitcnt vmcnt(14)
    v_mfma_f32_16x16x32_bf16 v[128:131], a[64:67], v[80:83], v[128:131]
    v_mfma_f32_16x16x32_bf16 v[132:135], a[68:71], v[80:83], v[132:135]
    v_mfma_f32_16x16x32_bf16 v[136:139], a[72:75], v[80:83], v[136:139]
    v_mfma_f32_16x16x32_bf16 v[140:143], a[76:79], v[80:83], v[140:143]
    s_waitcnt vmcnt(13)
    v_mfma_f32_16x16x32_bf16 v[128:131], a[80:83], v[84:87], v[128:131]
    v_mfma_f32_16x16x32_bf16 v[132:135], a[84:87], v[84:87], v[132:135]
    v_mfma_f32_16x16x32_bf16 v[136:139], a[88:91], v[84:87], v[136:139]
    v_mfma_f32_16x16x32_bf16 v[140:143], a[92:95], v[84:87], v[140:143]
    s_waitcnt vmcnt(12)
    v_mfma_f32_16x16x32_bf16 v[128:131], a[96:99], v[88:91], v[128:131]
    v_mfma_f32_16x16x32_bf16 v[132:135], a[100:103], v[88:91], v[132:135]
    v_mfma_f32_16x16x32_bf16 v[136:139], a[104:107], v[88:91], v[136:139]
    v_mfma_f32_16x16x32_bf16 v[140:143], a[108:111], v[88:91], v[140:143]
    s_waitcnt vmcnt(11)
    v_mfma_f32_16x16x32_bf16 v[128:131], a[112:115], v[92:95], v[128:131]
    v_mfma_f32_16x16x32_bf16 v[132:135], a[116:119], v[92:95], v[132:135]
    v_mfma_f32_16x16x32_bf16 v[136:139], a[120:123], v[92:95], v[136:139]
    v_mfma_f32_16x16x32_bf16 v[140:143], a[124:127], v[92:95], v[140:143]
    s_waitcnt vmcnt(10)
    v_mfma_f32_16x16x32_bf16 v[128:131], a[128:131], v[96:99], v[128:131]
    v_mfma_f32_16x16x32_bf16 v[132:135], a[132:135], v[96:99], v[132:135]
    v_mfma_f32_16x16x32_bf16 v[136:139], a[136:139], v[96:99], v[136:139]
    v_mfma_f32_16x16x32_bf16 v[140:143], a[140:143], v[96:99], v[140:143]
    s_waitcnt vmcnt(9)
    v_mfma_f32_16x16x32_bf16 v[128:131], a[144:147], v[100:103], v[128:131]
    v_mfma_f32_16x16x32_bf16 v[132:135], a[148:151], v[100:103], v[132:135]
    v_mfma_f32_16x16x32_bf16 v[136:139], a[152:155], v[100:103], v[136:139]
    v_mfma_f32_16x16x32_bf16 v[140:143], a[156:159], v[100:103], v[140:143]
    s_waitcnt vmcnt(8)
    v_mfma_f32_16x16x32_bf16 v[128:131], a[160:163], v[104:107], v[128:131]
    v_mfma_f32_16x16x32_bf16 v[132:135], a[164:167], v[104:107], v[132:135]
    v_mfma_f32_16x16x32_bf16 v[136:139], a[168:171], v[104:107], v[136:139]
    v_mfma_f32_16x16x32_bf16 v[140:143], a[172:175], v[104:107], v[140:143]
    s_waitcnt vmcnt(7)
    v_mfma_f32_16x16x32_bf16 v[128:131], a[176:179], v[108:111], v[128:131]
    v_mfma_f32_16x16x32_bf16 v[132:135], a[180:183], v[108:111], v[132:135]
    v_mfma_f32_16x16x32_bf16 v[136:139], a[184:187], v[108:111], v[136:139]
    v_mfma_f32_16x16x32_bf16 v[140:143], a[188:191], v[108:111], v[140:143]
    s_waitcnt vmcnt(6)
    v_mfma_f32_16x16x32_bf16 v[128:131], a[192:195], v[112:115], v[128:131]
    v_mfma_f32_16x16x32_bf16 v[132:135], a[196:199], v[112:115], v[132:135]
    v_mfma_f32_16x16x32_bf16 v[136:139], a[200:203], v[112:115], v[136:139]
    v_mfma_f32_16x16x32_bf16 v[140:143], a[204:207], v[112:115], v[140:143]
    s_waitcnt vmcnt(5)
    v_mfma_f32_16x16x32_bf16 v[128:131], a[208:211], v[116:119], v[128:131]
    v_mfma_f32_16x16x32_bf16 v[132:135], a[212:215], v[116:119], v[132:135]
    v_mfma_f32_16x16x32_bf16 v[136:139], a[216:219], v[116:119], v[136:139]
    v_mfma_f32_16x16x32_bf16 v[140:143], a[220:223], v[116:119], v[140:143]
    s_waitcnt vmcnt(4)
    v_mfma_f32_16x16x32_bf16 v[128:131], a[224:227], v[120:123], v[128:131]
    v_mfma_f32_16x16x32_bf16 v[132:135], a[228:231], v[120:123], v[132:135]
    v_mfma_f32_16x16x32_bf16 v[136:139], a[232:235], v[120:123], v[136:139]
    v_mfma_f32_16x16x32_bf16 v[140:143], a[236:239], v[120:123], v[140:143]
    s_waitcnt vmcnt(3)
    v_mfma_f32_16x16x32_bf16 v[128:131], a[240:243], v[124:127], v[128:131]
    v_mfma_f32_16x16x32_bf16 v[132:135], a[244:247], v[124:127], v[132:135]
    v_mfma_f32_16x16x32_bf16 v[136:139], a[248:251], v[124:127], v[136:139]
    v_mfma_f32_16x16x32_bf16 v[140:143], a[252:255], v[124:127], v[140:143]
    s_nop 3
    v_add_f32_dpp v128, v136, v128 row_ror:8 row_mask:0xf bank_mask:0xf
    v_add_f32_dpp v129, v137, v129 row_ror:8 row_mask:0xf bank_mask:0xf
    v_add_f32_dpp v130, v138, v130 row_ror:8 row_mask:0xf bank_mask:0xf
    v_add_f32_dpp v131, v139, v131 row_ror:8 row_mask:0xf bank_mask:0xf
    v_add_f32_dpp v132, v140, v132 row_ror:8 row_mask:0xf bank_mask:0xf
    v_add_f32_dpp v133, v141, v133 row_ror:8 row_mask:0xf bank_mask:0xf
    v_add_f32_dpp v134, v142, v134 row_ror:8 row_mask:0xf bank_mask:0xf
    v_add_f32_dpp v135, v143, v135 row_ror:8 row_mask:0xf bank_mask:0xf
    ds_write_b128 v30, v[128:131] offset:9216
    ds_write_b128 v30, v[132:135] offset:9280
    s_waitcnt lgkmcnt(0)
    s_barrier
    ds_read_b64 v[40:41], v31 offset:9216
    ds_read_b64 v[42:43], v31 offset:11520
    ds_read_b64 v[44:45], v31 offset:13824
    ds_read_b64 v[46:47], v31 offset:16128
    s_waitcnt vmcnt(1)
    v_lshlrev_b32 v48, 16, v25
    v_and_b32 v49, 0xffff0000, v25
    v_lshlrev_b32 v50, 16, v23
    v_and_b32 v51, 0xffff0000, v23
    s_waitcnt lgkmcnt(0)
    v_add_f32 v40, v40, v42
    v_add_f32 v44, v44, v46
    v_add_f32 v41, v41, v43
    v_add_f32 v45, v45, v47
    v_add_f32 v40, v40, v44
    v_add_f32 v41, v41, v45
    v_cvt_pk_bf16_f32 v40, v40, v41
    v_and_b32 v41, 0xffff0000, v40
    v_lshlrev_b32 v40, 16, v40
    v_add_f32 v40, v40, v48
    v_add_f32 v41, v41, v49
    v_cvt_pk_bf16_f32 v40, v40, v41
    v_and_b32 v41, 0xffff0000, v40
    v_lshlrev_b32 v40, 16, v40
    v_add_f32 v40, v40, v50
    v_add_f32 v41, v41, v51
    v_cvt_pk_bf16_f32 v40, v40, v41
    s_branch wo_next1
wo_seg1:
    s_waitcnt vmcnt(16)
    s_mov_b32 s69, s67
    s_add_u32 s60, s60, 1
    v_cmp_eq_u32 vcc, 0, v21
    s_cmp_eq_u32 s60, 62
    s_cbranch_scc1 wo_drain1
    s_cbranch_vccnz wo_drain1
    s_add_u32 s66, s66, 256
    s_lshl_b32 s67, s60, 16
    s_lshl_b32 s65, s60, 18
    s_min_u32 s71, s66, 16128
    s_xor_b32 s71, s71, s45
    buffer_load_dword v20, v27, s[4:7], s71 offen sc1
    buffer_load_dword v22, v28, s[4:7], s67 offen sc1
    buffer_load_dword v24, v29, s[76:79], s67 offen
    s_waitcnt vmcnt(19)
    v_mfma_f32_16x16x32_bf16 v[128:131], a[0:3], v[64:67], 0
    v_mfma_f32_16x16x32_bf16 v[132:135], a[4:7], v[64:67], 0
    v_mfma_f32_16x16x32_bf16 v[136:139], a[8:11], v[64:67], 0
    v_mfma_f32_16x16x32_bf16 v[140:143], a[12:15], v[64:67], 0
    buffer_load_dwordx4 v[64:67], v26, s[4:7], s65 offen sc1
    s_add_u32 s65, s65, 4096
    s_waitcnt vmcnt(19)
    v_mfma_f32_16x16x32_bf16 v[128:131], a[16:19], v[68:71], v[128:131]
    v_mfma_f32_16x16x32_bf16 v[132:135], a[20:23], v[68:71], v[132:135]
    v_mfma_f32_16x16x32_bf16 v[136:139], a[24:27], v[68:71], v[136:139]
    v_mfma_f32_16x16x32_bf16 v[140:143], a[28:31], v[68:71], v[140:143]
    buffer_load_dwordx4 v[68:71], v26, s[4:7], s65 offen sc1
    s_add_u32 s65, s65, 4096
    s_waitcnt vmcnt(19)
    v_mfma_f32_16x16x32_bf16 v[128:131], a[32:35], v[72:75], v[128:131]
    v_mfma_f32_16x16x32_bf16 v[132:135], a[36:39], v[72:75], v[132:135]
    v_mfma_f32_16x16x32_bf16 v[136:139], a[40:43], v[72:75], v[136:139]
    v_mfma_f32_16x16x32_bf16 v[140:143], a[44:47], v[72:75], v[140:143]
    buffer_load_dwordx4 v[72:75], v26, s[4:7], s65 offen sc1
    s_add_u32 s65, s65, 4096
    s_waitcnt vmcnt(19)
    v_mfma_f32_16x16x32_bf16 v[128:131], a[48:51], v[76:79], v[128:131]
    v_mfma_f32_16x16x32_bf16 v[132:135], a[52:55], v[76:79], v[132:135]
    v_mfma_f32_16x16x32_bf16 v[136:139], a[56:59], v[76:79], v[136:139]
    v_mfma_f32_16x16x32_bf16 v[140:143], a[60:63], v[76:79], v[140:143]
    buffer_load_dwordx4 v[76:79], v26, s[4:7], s65 offen sc1
    s_add_u32 s65, s65, 4096
    s_waitcnt vmcnt(19)
    v_mfma_f32_16x16x32_bf16 v[128:131], a[64:67], v[80:83], v[128:131]
    v_mfma_f32_16x16x32_bf16 v[132:135], a[68:71], v[80:83], v[132:135]
    v_mfma_f32_16x16x32_bf16 v[136:139], a[72:75], v[80:83], v[136:139]
    v_mfma_f32_16x16x32_bf16 v[140:143], a[76:79], v[80:83], v[140:143]
    buffer_load_dwordx4 v[80:83], v26, s[4:7], s65 offen sc1
    s_add_u32 s65, s65, 4096
    s_waitcnt vmcnt(19)
    v_mfma_f32_16x16x32_bf16 v[128:131], a[80:83], v[84:87], v[128:131]
    v_mfma_f32_16x16x32_bf16 v[132:135], a[84:87], v[84:87], v[132:135]
    v_mfma_f32_16x16x32_bf16 v[136:139], a[88:91], v[84:87], v[136:139]
    v_mfma_f32_16x16x32_bf16 v[140:143], a[92:95], v[84:87], v[140:143]
    buffer_load_dwordx4 v[84:87], v26, s[4:7], s65 offen sc1
    s_add_u32 s65, s65, 4096
    s_waitcnt vmcnt(19)
    v_mfma_f32_16x16x32_bf16 v[128:131], a[96:99], v[88:91], v[128:131]
    v_mfma_f32_16x16x32_bf16 v[132:135], a[100:103], v[88:91], v[132:135]
    v_mfma_f32_16x16x32_bf16 v[136:139], a[104:107], v[88:91], v[136:139]
    v_mfma_f32_16x16x32_bf16 v[140:143], a[108:111], v[88:91], v[140:143]
    buffer_load_dwordx4 v[88:91], v26, s[4:7], s65 offen sc1
    s_add_u32 s65, s65, 4096
    s_waitcnt vmcnt(19)
    v_mfma_f32_16x16x32_bf16 v[128:131], a[112:115], v[92:95], v[128:131]
    v_mfma_f32_16x16x32_bf16 v[132:135], a[116:119], v[92:95], v[132:135]
    v_mfma_f32_16x16x32_bf16 v[136:139], a[120:123], v[92:95], v[136:139]
    v_mfma_f32_16x16x32_bf16 v[140:143], a[124:127], v[92:95], v[140:143]
    buffer_load_dwordx4 v[92:95], v26, s[4:7], s65 offen sc1
    s_add_u32 s65, s65, 4096
    s_waitcnt vmcnt(19)
    v_mfma_f32_16x16x32_bf16 v[128:131], a[128:131], v[96:99], v[128:131]
    v_mfma_f32_16x16x32_bf16 v[132:135], a[132:135], v[96:99], v[132:135]
    v_mfma_f32_16x16x32_bf16 v[136:139], a[136:139], v[96:99], v[136:139]
    v_mfma_f32_16x16x32_bf16 v[140:143], a[140:143], v[96:99], v[140:143]
    buffer_load_dwordx4 v[96:99], v26, s[4:7], s65 offen sc1
    s_add_u32 s65, s65, 4096
    s_waitcnt vmcnt(19)
    v_mfma_f32_16x16x32_bf16 v[128:131], a[144:147], v[100:103], v[128:131]
    v_mfma_f32_16x16x32_bf16 v[132:135], a[148:151], v[100:103], v[132:135]
    v_mfma_f32_16x16x32_bf16 v[136:139], a[152:155], v[100:103], v[136:139]
    v_mfma_f32_16x16x32_bf16 v[140:143], a[156:159], v[100:103], v[140:143]
    buffer_load_dwordx4 v[100:103], v26, s[4:7], s65 offen sc1
    s_add_u32 s65, s65, 4096
    s_waitcnt vmcnt(19)
    v_mfma_f32_16x16x32_bf16 v[128:131], a[160:163], v[104:107], v[128:131]
    v_mfma_f32_16x16x32_bf16 v[132:135], a[164:167], v[104:107], v[132:135]
    v_mfma_f32_16x16x32_bf16 v[136:139], a[168:171], v[104:107], v[136:139]
    v_mfma_f32_16x16x32_bf16 v[140:143], a[172:175], v[104:107], v[140:143]
    buffer_load_dwordx4 v[104:107], v26, s[4:7], s65 offen sc1
    s_add_u32 s65, s65, 4096
    s_waitcnt vmcnt(19)
    v_mfma_f32_16x16x32_bf16 v[128:131], a[176:179], v[108:111], v[128:131]
    v_mfma_f32_16x16x32_bf16 v[132:135], a[180:183], v[108:111], v[132:135]
    v_mfma_f32_16x16x32_bf16 v[136:139], a[184:187], v[108:111], v[136:139]
    v_mfma_f32_16x16x32_bf16 v[140:143], a[188:191], v[108:111], v[140:143]
    buffer_load_dwordx4 v[108:111], v26, s[4:7], s65 offen sc1
    s_add_u32 s65, s65, 4096
    s_waitcnt vmcnt(19)
    v_mfma_f32_16x16x32_bf16 v[128:131], a[192:195], v[112:115], v[128:131]
    v_mfma_f32_16x16x32_bf16 v[132:135], a[196:199], v[112:115], v[132:135]
    v_mfma_f32_16x16x32_bf16 v[136:139], a[200:203], v[112:115], v[136:139]
    v_mfma_f32_16x16x32_bf16 v[140:143], a[204:207], v[112:115], v[140:143]
    buffer_load_dwordx4 v[112:115], v26, s[4:7], s65 offen sc1
    s_add_u32 s65, s65, 4096
    s_waitcnt vmcnt(19)
    v_mfma_f32_16x16x32_bf16 v[128:131], a[208:211], v[116:119], v[128:131]
    v_mfma_f32_16x16x32_bf16 v[132:135], a[212:215], v[116:119], v[132:135]
    v_mfma_f32_16x16x32_bf16 v[136:139], a[216:219], v[116:119], v[136:139]
    v_mfma_f32_16x16x32_bf16 v[140:143], a[220:223], v[116:119], v[140:143]
    buffer_load_dwordx4 v[116:119], v26, s[4:7], s65 offen sc1
    s_add_u32 s65, s65, 4096
    s_waitcnt vmcnt(19)
    v_mfma_f32_16x16x32_bf16 v[128:131], a[224:227], v[120:123], v[128:131]
    v_mfma_f32_16x16x32_bf16 v[132:135], a[228:231], v[120:123], v[132:135]
    v_mfma_f32_16x16x32_bf16 v[136:139], a[232:235], v[120:123], v[136:139]
    v_mfma_f32_16x16x32_bf16 v[140:143], a[236:239], v[120:123], v[140:143]
    buffer_load_dwordx4 v[120:123], v26, s[4:7], s65 offen sc1
    s_add_u32 s65, s65, 4096
    s_waitcnt vmcnt(19)
    v_mfma_f32_16x16x32_bf16 v[128:131], a[240:243], v[124:127], v[128:131]
    v_mfma_f32_16x16x32_bf16 v[132:135], a[244:247], v[124:127], v[132:135]
    v_mfma_f32_16x16x32_bf16 v[136:139], a[248:251], v[124:127], v[136:139]
    v_mfma_f32_16x16x32_bf16 v[140:143], a[252:255], v[124:127], v[140:143]
    buffer_load_dwordx4 v[124:127], v26, s[4:7], s65 offen sc1
    s_add_u32 s65, s65, 4096
    s_nop 1
    v_add_f32_dpp v128, v136, v128 row_ror:8 row_mask:0xf bank_mask:0xf
    v_add_f32_dpp v129, v137, v129 row_ror:8 row_mask:0xf bank_mask:0xf
    v_add_f32_dpp v130, v138, v130 row_ror:8 row_mask:0xf bank_mask:0xf
    v_add_f32_dpp v131, v139, v131 row_ror:8 row_mask:0xf bank_mask:0xf
    v_add_f32_dpp v132, v140, v132 row_ror:8 row_mask:0xf bank_mask:0xf
    v_add_f32_dpp v133, v141, v133 row_ror:8 row_mask:0xf bank_mask:0xf
    v_add_f32_dpp v134, v142, v134 row_ror:8 row_mask:0xf bank_mask:0xf
    v_add_f32_dpp v135, v143, v135 row_ror:8 row_mask:0xf bank_mask:0xf
    ds_write_b128 v30, v[128:131] offset:9216
    ds_write_b128 v30, v[132:135] offset:9280
    s_waitcnt lgkmcnt(0)
    s_barrier
    ds_read_b64 v[40:41], v31 offset:9216
    ds_read_b64 v[42:43], v31 offset:11520
    ds_read_b64 v[44:45], v31 offset:13824
    ds_read_b64 v[46:47], v31 offset:16128
    v_lshlrev_b32 v48, 16, v25
    v_and_b32 v49, 0xffff0000, v25
    v_lshlrev_b32 v50, 16, v23
    v_and_b32 v51, 0xffff0000, v23
    s_waitcnt lgkmcnt(0)
    v_add_f32 v40, v40, v42
    v_add_f32 v44, v44, v46
    v_add_f32 v41, v41, v43
    v_add_f32 v45, v45, v47
    v_add_f32 v40, v40, v44
    v_add_f32 v41, v41, v45
    v_cvt_pk_bf16_f32 v40, v40, v41
    v_and_b32 v41, 0xffff0000, v40
    v_lshlrev_b32 v40, 16, v40
    v_add_f32 v40, v40, v48
    v_add_f32 v41, v41, v49
    v_cvt_pk_bf16_f32 v40, v40, v41
    v_and_b32 v41, 0xffff0000, v40
    v_lshlrev_b32 v40, 16, v40
    v_add_f32 v40, v40, v50
    v_add_f32 v41, v41, v51
    v_cvt_pk_bf16_f32 v40, v40, v41
    buffer_store_dword v40, v29, s[80:83], s69 offen sc0 sc1 nt
    s_branch wo_seg0
wo_drain1:
    s_waitcnt vmcnt(16)
    v_mfma_f32_16x16x32_bf16 v[128:131], a[0:3], v[64:67], 0
    v_mfma_f32_16x16x32_bf16 v[132:135], a[4:7], v[64:67], 0
    v_mfma_f32_16x16x32_bf16 v[136:139], a[8:11], v[64:67], 0
    v_mfma_f32_16x16x32_bf16 v[140:143], a[12:15], v[64:67], 0
    s_waitcnt vmcnt(15)
    v_mfma_f32_16x16x32_bf16 v[128:131], a[16:19], v[68:71], v[128:131]
    v_mfma_f32_16x16x32_bf16 v[132:135], a[20:23], v[68:71], v[132:135]
    v_mfma_f32_16x16x32_bf16 v[136:139], a[24:27], v[68:71], v[136:139]
    v_mfma_f32_16x16x32_bf16 v[140:143], a[28:31], v[68:71], v[140:143]
    s_waitcnt vmcnt(14)
    v_mfma_f32_16x16x32_bf16 v[128:131], a[32:35], v[72:75], v[128:131]
    v_mfma_f32_16x16x32_bf16 v[132:135], a[36:39], v[72:75], v[132:135]
    v_mfma_f32_16x16x32_bf16 v[136:139], a[40:43], v[72:75], v[136:139]
    v_mfma_f32_16x16x32_bf16 v[140:143], a[44:47], v[72:75], v[140:143]
    s_waitcnt vmcnt(13)
    v_mfma_f32_16x16x32_bf16 v[128:131], a[48:51], v[76:79], v[128:131]
    v_mfma_f32_16x16x32_bf16 v[132:135], a[52:55], v[76:79], v[132:135]
    v_mfma_f32_16x16x32_bf16 v[136:139], a[56:59], v[76:79], v[136:139]
    v_mfma_f32_16x16x32_bf16 v[140:143], a[60:63], v[76:79], v[140:143]
    s_waitcnt vmcnt(12)
    v_mfma_f32_16x16x32_bf16 v[128:131], a[64:67], v[80:83], v[128:131]
    v_mfma_f32_16x16x32_bf16 v[132:135], a[68:71], v[80:83], v[132:135]
    v_mfma_f32_16x16x32_bf16 v[136:139], a[72:75], v[80:83], v[136:139]
    v_mfma_f32_16x16x32_bf16 v[140:143], a[76:79], v[80:83], v[140:143]
    s_waitcnt vmcnt(11)
    v_mfma_f32_16x16x32_bf16 v[128:131], a[80:83], v[84:87], v[128:131]
    v_mfma_f32_16x16x32_bf16 v[132:135], a[84:87], v[84:87], v[132:135]
    v_mfma_f32_16x16x32_bf16 v[136:139], a[88:91], v[84:87], v[136:139]
    v_mfma_f32_16x16x32_bf16 v[140:143], a[92:95], v[84:87], v[140:143]
    s_waitcnt vmcnt(10)
    v_mfma_f32_16x16x32_bf16 v[128:131], a[96:99], v[88:91], v[128:131]
    v_mfma_f32_16x16x32_bf16 v[132:135], a[100:103], v[88:91], v[132:135]
    v_mfma_f32_16x16x32_bf16 v[136:139], a[104:107], v[88:91], v[136:139]
    v_mfma_f32_16x16x32_bf16 v[140:143], a[108:111], v[88:91], v[140:143]
    s_waitcnt vmcnt(9)
    v_mfma_f32_16x16x32_bf16 v[128:131], a[112:115], v[92:95], v[128:131]
    v_mfma_f32_16x16x32_bf16 v[132:135], a[116:119], v[92:95], v[132:135]
    v_mfma_f32_16x16x32_bf16 v[136:139], a[120:123], v[92:95], v[136:139]
    v_mfma_f32_16x16x32_bf16 v[140:143], a[124:127], v[92:95], v[140:143]
    s_waitcnt vmcnt(8)
    v_mfma_f32_16x16x32_bf16 v[128:131], a[128:131], v[96:99], v[128:131]
    v_mfma_f32_16x16x32_bf16 v[132:135], a[132:135], v[96:99], v[132:135]
    v_mfma_f32_16x16x32_bf16 v[136:139], a[136:139], v[96:99], v[136:139]
    v_mfma_f32_16x16x32_bf16 v[140:143], a[140:143], v[96:99], v[140:143]
    s_waitcnt vmcnt(7)
    v_mfma_f32_16x16x32_bf16 v[128:131], a[144:147], v[100:103], v[128:131]
    v_mfma_f32_16x16x32_bf16 v[132:135], a[148:151], v[100:103], v[132:135]
    v_mfma_f32_16x16x32_bf16 v[136:139], a[152:155], v[100:103], v[136:139]
    v_mfma_f32_16x16x32_bf16 v[140:143], a[156:159], v[100:103], v[140:143]
    s_waitcnt vmcnt(6)
    v_mfma_f32_16x16x32_bf16 v[128:131], a[160:163], v[104:107], v[128:131]
    v_mfma_f32_16x16x32_bf16 v[132:135], a[164:167], v[104:107], v[132:135]
    v_mfma_f32_16x16x32_bf16 v[136:139], a[168:171], v[104:107], v[136:139]
    v_mfma_f32_16x16x32_bf16 v[140:143], a[172:175], v[104:107], v[140:143]
    s_waitcnt vmcnt(5)
    v_mfma_f32_16x16x32_bf16 v[128:131], a[176:179], v[108:111], v[128:131]
    v_mfma_f32_16x16x32_bf16 v[132:135], a[180:183], v[108:111], v[132:135]
    v_mfma_f32_16x16x32_bf16 v[136:139], a[184:187], v[108:111], v[136:139]
    v_mfma_f32_16x16x32_bf16 v[140:143], a[188:191], v[108:111], v[140:143]
    s_waitcnt vmcnt(4)
    v_mfma_f32_16x16x32_bf16 v[128:131], a[192:195], v[112:115], v[128:131]
    v_mfma_f32_16x16x32_bf16 v[132:135], a[196:199], v[112:115], v[132:135]
    v_mfma_f32_16x16x32_bf16 v[136:139], a[200:203], v[112:115], v[136:139]
    v_mfma_f32_16x16x32_bf16 v[140:143], a[204:207], v[112:115], v[140:143]
    s_waitcnt vmcnt(3)
    v_mfma_f32_16x16x32_bf16 v[128:131], a[208:211], v[116:119], v[128:131]
    v_mfma_f32_16x16x32_bf16 v[132:135], a[212:215], v[116:119], v[132:135]
    v_mfma_f32_16x16x32_bf16 v[136:139], a[216:219], v[116:119], v[136:139]
    v_mfma_f32_16x16x32_bf16 v[140:143], a[220:223], v[116:119], v[140:143]
    s_waitcnt vmcnt(2)
    v_mfma_f32_16x16x32_bf16 v[128:131], a[224:227], v[120:123], v[128:131]
    v_mfma_f32_16x16x32_bf16 v[132:135], a[228:231], v[120:123], v[132:135]
    v_mfma_f32_16x16x32_bf16 v[136:139], a[232:235], v[120:123], v[136:139]
    v_mfma_f32_16x16x32_bf16 v[140:143], a[236:239], v[120:123], v[140:143]
    s_waitcnt vmcnt(1)
    v_mfma_f32_16x16x32_bf16 v[128:131], a[240:243], v[124:127], v[128:131]
    v_mfma_f32_16x16x32_bf16 v[132:135], a[244:247], v[124:127], v[132:135]
    v_mfma_f32_16x16x32_bf16 v[136:139], a[248:251], v[124:127], v[136:139]
    v_mfma_f32_16x16x32_bf16 v[140:143], a[252:255], v[124:127], v[140:143]
    s_nop 3
    v_add_f32_dpp v128, v136, v128 row_ror:8 row_mask:0xf bank_mask:0xf
    v_add_f32_dpp v129, v137, v129 row_ror:8 row_mask:0xf bank_mask:0xf
    v_add_f32_dpp v130, v138, v130 row_ror:8 row_mask:0xf bank_mask:0xf
    v_add_f32_dpp v131, v139, v131 row_ror:8 row_mask:0xf bank_mask:0xf
    v_add_f32_dpp v132, v140, v132 row_ror:8 row_mask:0xf bank_mask:0xf
    v_add_f32_dpp v133, v141, v133 row_ror:8 row_mask:0xf bank_mask:0xf
    v_add_f32_dpp v134, v142, v134 row_ror:8 row_mask:0xf bank_mask:0xf
    v_add_f32_dpp v135, v143, v135 row_ror:8 row_mask:0xf bank_mask:0xf
    ds_write_b128 v30, v[128:131] offset:9216
    ds_write_b128 v30, v[132:135] offset:9280
    s_waitcnt lgkmcnt(0)
    s_barrier
    ds_read_b64 v[40:41], v31 offset:9216
    ds_read_b64 v[42:43], v31 offset:11520
    ds_read_b64 v[44:45], v31 offset:13824
    ds_read_b64 v[46:47], v31 offset:16128
    v_lshlrev_b32 v48, 16, v25
    v_and_b32 v49, 0xffff0000, v25
    v_lshlrev_b32 v50, 16, v23
    v_and_b32 v51, 0xffff0000, v23
    s_waitcnt lgkmcnt(0)
    v_add_f32 v40, v40, v42
    v_add_f32 v44, v44, v46
    v_add_f32 v41, v41, v43
    v_add_f32 v45, v45, v47
    v_add_f32 v40, v40, v44
    v_add_f32 v41, v41, v45
    v_cvt_pk_bf16_f32 v40, v40, v41
    v_and_b32 v41, 0xffff0000, v40
    v_lshlrev_b32 v40, 16, v40
    v_add_f32 v40, v40, v48
    v_add_f32 v41, v41, v49
    v_cvt_pk_bf16_f32 v40, v40, v41
    v_and_b32 v41, 0xffff0000, v40
    v_lshlrev_b32 v40, 16, v40
    v_add_f32 v40, v40, v50
    v_add_f32 v41, v41, v51
    v_cvt_pk_bf16_f32 v40, v40, v41
wo_next1:
    s_cmp_eq_u32 s60, 64
    s_cbranch_scc1 wo_end
    s_cmp_eq_u32 s60, 62
    s_cbranch_scc1 wo_pair
    s_lshl_b32 s66, s60, 8
    s_lshl_b32 s67, s60, 16
    s_lshl_b32 s65, s60, 18
    s_min_u32 s71, s66, 16128
    s_xor_b32 s71, s71, s45
    s_mov_b32 s68, 0x100000
oflag_51:
    buffer_load_dword v13, v27, s[4:7], s71 offen sc1
    s_waitcnt vmcnt(0)
    v_cmp_gt_u32 vcc, 1, v13
    s_cbranch_vccz oflag_51_ok
    s_sub_u32 s68, s68, 1
    s_cmp_lg_u32 s68, 0
    s_cbranch_scc1 oflag_51
oflag_51_ok:
    s_add_u32 s66, s66, 256
    s_min_u32 s71, s66, 16128
    s_xor_b32 s71, s71, s45
    buffer_load_dword v20, v27, s[4:7], s71 offen sc1
    buffer_load_dwordx4 v[64:67], v26, s[4:7], s65 offen sc1
    s_add_u32 s65, s65, 4096
    buffer_load_dwordx4 v[68:71], v26, s[4:7], s65 offen sc1
    s_add_u32 s65, s65, 4096
    buffer_load_dwordx4 v[72:75], v26, s[4:7], s65 offen sc1
    s_add_u32 s65, s65, 4096
    buffer_load_dwordx4 v[76:79], v26, s[4:7], s65 offen sc1
    s_add_u32 s65, s65, 4096
    buffer_load_dwordx4 v[80:83], v26, s[4:7], s65 offen sc1
    s_add_u32 s65, s65, 4096
    buffer_load_dwordx4 v[84:87], v26, s[4:7], s65 offen sc1
    s_add_u32 s65, s65, 4096
    buffer_load_dwordx4 v[88:91], v26, s[4:7], s65 offen sc1
    s_add_u32 s65, s65, 4096
    buffer_load_dwordx4 v[92:95], v26, s[4:7], s65 offen sc1
    s_add_u32 s65, s65, 4096
    buffer_load_dwordx4 v[96:99], v26, s[4:7], s65 offen sc1
    s_add_u32 s65, s65, 4096
    buffer_load_dwordx4 v[100:103], v26, s[4:7], s65 offen sc1
    s_add_u32 s65, s65, 4096
    buffer_load_dwordx4 v[104:107], v26, s[4:7], s65 offen sc1
    s_add_u32 s65, s65, 4096
    buffer_load_dwordx4 v[108:111], v26, s[4:7], s65 offen sc1
    s_add_u32 s65, s65, 4096
    buffer_load_dwordx4 v[112:115], v26, s[4:7], s65 offen sc1
    s_add_u32 s65, s65, 4096
    buffer_load_dwordx4 v[116:119], v26, s[4:7], s65 offen sc1
    s_add_u32 s65, s65, 4096
    buffer_load_dwordx4 v[120:123], v26, s[4:7], s65 offen sc1
    s_add_u32 s65, s65, 4096
    buffer_load_dwordx4 v[124:127], v26, s[4:7], s65 offen sc1
    s_add_u32 s65, s65, 4096
    buffer_load_dword v22, v28, s[4:7], s67 offen sc1
    buffer_load_dword v24, v29, s[76:79], s67 offen
    buffer_store_dword v40, v29, s[80:83], s69 offen sc0 sc1 nt
wo_segf0:
    s_waitcnt vmcnt(19)
    s_mov_b32 s69, s67
    s_add_u32 s60, s60, 1
    v_cmp_eq_u32 vcc, 0, v20
    s_cbranch_vccnz wo_drainf0
    s_add_u32 s66, s66, 256
    s_lshl_b32 s67, s60, 16
    s_lshl_b32 s65, s60, 18
    s_min_u32 s71, s66, 16128
    s_xor_b32 s71, s71, s45
    buffer_load_dword v21, v27, s[4:7], s71 offen sc1
    buffer_load_dword v23, v28, s[4:7], s67 offen sc1
    buffer_load_dword v25, v29, s[76:79], s67 offen
    s_waitcnt vmcnt(21)
    v_mfma_f32_16x16x32_bf16 v[128:131], a[0:3], v[64:67], 0
    v_mfma_f32_16x16x32_bf16 v[132:135], a[4:7], v[64:67], 0
    v_mfma_f32_16x16x32_bf16 v[136:139], a[8:11], v[64:67], 0
    v_mfma_f32_16x16x32_bf16 v[140:143], a[12:15], v[64:67], 0
    buffer_load_dwordx4 v[64:67], v26, s[4:7], s65 offen sc1
    s_add_u32 s65, s65, 4096
    s_waitcnt vmcnt(21)
    v_mfma_f32_16x16x32_bf16 v[128:131], a[16:19], v[68:71], v[128:131]
    v_mfma_f32_16x16x32_bf16 v[132:135], a[20:23], v[68:71], v[132:135]
    v_mfma_f32_16x16x32_bf16 v[136:139], a[24:27], v[68:71], v[136:139]
    v_mfma_f32_16x16x32_bf16 v[140:143], a[28:31], v[68:71], v[140:143]
    buffer_load_dwordx4 v[68:71], v26, s[4:7], s65 offen sc1
    s_add_u32 s65, s65, 4096
    s_waitcnt vmcnt(21)
    v_mfma_f32_16x16x32_bf16 v[128:131], a[32:35], v[72:75], v[128:131]
    v_mfma_f32_16x16x32_bf16 v[132:135], a[36:39], v[72:75], v[132:135]
    v_mfma_f32_16x16x32_bf16 v[136:139], a[40:43], v[72:75], v[136:139]
    v_mfma_f32_16x16x32_bf16 v[140:143], a[44:47], v[72:75], v[140:143]
    buffer_load_dwordx4 v[72:75], v26, s[4:7], s65 offen sc1
    s_add_u32 s65, s65, 4096
    s_waitcnt vmcnt(21)
    v_mfma_f32_16x16x32_bf16 v[128:131], a[48:51], v[76:79], v[128:131]
    v_mfma_f32_16x16x32_bf16 v[132:135], a[52:55], v[76:79], v[132:135]
    v_mfma_f32_16x16x32_bf16 v[136:139], a[56:59], v[76:79], v[136:139]
    v_mfma_f32_16x16x32_bf16 v[140:143], a[60:63], v[76:79], v[140:143]
    buffer_load_dwordx4 v[76:79], v26, s[4:7], s65 offen sc1
    s_add_u32 s65, s65, 4096
    s_waitcnt vmcnt(21)
    v_mfma_f32_16x16x32_bf16 v[128:131], a[64:67], v[80:83], v[128:131]
    v_mfma_f32_16x16x32_bf16 v[132:135], a[68:71], v[80:83], v[132:135]
    v_mfma_f32_16x16x32_bf16 v[136:139], a[72:75], v[80:83], v[136:139]
    v_mfma_f32_16x16x32_bf16 v[140:143], a[76:79], v[80:83], v[140:143]
    buffer_load_dwordx4 v[80:83], v26, s[4:7], s65 offen sc1
    s_add_u32 s65, s65, 4096
    s_waitcnt vmcnt(21)
    v_mfma_f32_16x16x32_bf16 v[128:131], a[80:83], v[84:87], v[128:131]
    v_mfma_f32_16x16x32_bf16 v[132:135], a[84:87], v[84:87], v[132:135]
    v_mfma_f32_16x16x32_bf16 v[136:139], a[88:91], v[84:87], v[136:139]
    v_mfma_f32_16x16x32_bf16 v[140:143], a[92:95], v[84:87], v[140:143]
    buffer_load_dwordx4 v[84:87], v26, s[4:7], s65 offen sc1
    s_add_u32 s65, s65, 4096
    s_waitcnt vmcnt(21)
    v_mfma_f32_16x16x32_bf16 v[128:131], a[96:99], v[88:91], v[128:131]
    v_mfma_f32_16x16x32_bf16 v[132:135], a[100:103], v[88:91], v[132:135]
    v_mfma_f32_16x16x32_bf16 v[136:139], a[104:107], v[88:91], v[136:139]
    v_mfma_f32_16x16x32_bf16 v[140:143], a[108:111], v[88:91], v[140:143]
    buffer_load_dwordx4 v[88:91], v26, s[4:7], s65 offen sc1
    s_add_u32 s65, s65, 4096
    s_waitcnt vmcnt(21)
    v_mfma_f32_16x16x32_bf16 v[128:131], a[112:115], v[92:95], v[128:131]
    v_mfma_f32_16x16x32_bf16 v[132:135], a[116:119], v[92:95], v[132:135]
    v_mfma_f32_16x16x32_bf16 v[136:139], a[120:123], v[92:95], v[136:139]
    v_mfma_f32_16x16x32_bf16 v[140:143], a[124:127], v[92:95], v[140:143]
    buffer_load_dwordx4 v[92:95], v26, s[4:7], s65 offen sc1
    s_add_u32 s65, s65, 4096
    s_waitcnt vmcnt(21)
    v_mfma_f32_16x16x32_bf16 v[128:131], a[128:131], v[96:99], v[128:131]
    v_mfma_f32_16x16x32_bf16 v[132:135], a[132:135], v[96:99], v[132:135]
    v_mfma_f32_16x16x32_bf16 v[136:139], a[136:139], v[96:99], v[136:139]
    v_mfma_f32_16x16x32_bf16 v[140:143], a[140:143], v[96:99], v[140:143]
    buffer_load_dwordx4 v[96:99], v26, s[4:7], s65 offen sc1
    s_add_u32 s65, s65, 4096
    s_waitcnt vmcnt(21)
    v_mfma_f32_16x16x32_bf16 v[128:131], a[144:147], v[100:103], v[128:131]
    v_mfma_f32_16x16x32_bf16 v[132:135], a[148:151], v[100:103], v[132:135]
    v_mfma_f32_16x16x32_bf16 v[136:139], a[152:155], v[100:103], v[136:139]
    v_mfma_f32_16x16x32_bf16 v[140:143], a[156:159], v[100:103], v[140:143]
    buffer_load_dwordx4 v[100:103], v26, s[4:7], s65 offen sc1
    s_add_u32 s65, s65, 4096
    s_waitcnt vmcnt(21)
    v_mfma_f32_16x16x32_bf16 v[128:131], a[160:163], v[104:107], v[128:131]
    v_mfma_f32_16x16x32_bf16 v[132:135], a[164:167], v[104:107], v[132:135]
    v_mfma_f32_16x16x32_bf16 v[136:139], a[168:171], v[104:107], v[136:139]
    v_mfma_f32_16x16x32_bf16 v[140:143], a[172:175], v[104:107], v[140:143]
    buffer_load_dwordx4 v[104:107], v26, s[4:7], s65 offen sc1
    s_add_u32 s65, s65, 4096
    s_waitcnt vmcnt(21)
    v_mfma_f32_16x16x32_bf16 v[128:131], a[176:179], v[108:111], v[128:131]
    v_mfma_f32_16x16x32_bf16 v[132:135], a[180:183], v[108:111], v[132:135]
    v_mfma_f32_16x16x32_bf16 v[136:139], a[184:187], v[108:111], v[136:139]
    v_mfma_f32_16x16x32_bf16 v[140:143], a[188:191], v[108:111], v[140:143]
    buffer_load_dwordx4 v[108:111], v26, s[4:7], s65 offen sc1
    s_add_u32 s65, s65, 4096
    s_waitcnt vmcnt(21)
    v_mfma_f32_16x16x32_bf16 v[128:131], a[192:195], v[112:115], v[128:131]
    v_mfma_f32_16x16x32_bf16 v[132:135], a[196:199], v[112:115], v[132:135]
    v_mfma_f32_16x16x32_bf16 v[136:139], a[200:203], v[112:115], v[136:139]
    v_mfma_f32_16x16x32_bf16 v[140:143], a[204:207], v[112:115], v[140:143]
    buffer_load_dwordx4 v[112:115], v26, s[4:7], s65 offen sc1
    s_add_u32 s65, s65, 4096
    s_waitcnt vmcnt(21)
    v_mfma_f32_16x16x32_bf16 v[128:131], a[208:211], v[116:119], v[128:131]
    v_mfma_f32_16x16x32_bf16 v[132:135], a[212:215], v[116:119], v[132:135]
    v_mfma_f32_16x16x32_bf16 v[136:139], a[216:219], v[116:119], v[136:139]
    v_mfma_f32_16x16x32_bf16 v[140:143], a[220:223], v[116:119], v[140:143]
    buffer_load_dwordx4 v[116:119], v26, s[4:7], s65 offen sc1
    s_add_u32 s65, s65, 4096
    s_waitcnt vmcnt(21)
    v_mfma_f32_16x16x32_bf16 v[128:131], a[224:227], v[120:123], v[128:131]
    v_mfma_f32_16x16x32_bf16 v[132:135], a[228:231], v[120:123], v[132:135]
    v_mfma_f32_16x16x32_bf16 v[136:139], a[232:235], v[120:123], v[136:139]
    v_mfma_f32_16x16x32_bf16 v[140:143], a[236:239], v[120:123], v[140:143]
    buffer_load_dwordx4 v[120:123], v26, s[4:7], s65 offen sc1
    s_add_u32 s65, s65, 4096
    s_waitcnt vmcnt(21)
    v_mfma_f32_16x16x32_bf16 v[128:131], a[240:243], v[124:127], v[128:131]
    v_mfma_f32_16x16x32_bf16 v[132:135], a[244:247], v[124:127], v[132:135]
    v_mfma_f32_16x16x32_bf16 v[136:139], a[248:251], v[124:127], v[136:139]
    v_mfma_f32_16x16x32_bf16 v[140:143], a[252:255], v[124:127], v[140:143]
    buffer_load_dwordx4 v[124:127], v26, s[4:7], s65 offen sc1
    s_add_u32 s65, s65, 4096
    s_nop 1
    v_add_f32_dpp v128, v136, v128 row_ror:8 row_mask:0xf bank_mask:0xf
    v_add_f32_dpp v129, v137, v129 row_ror:8 row_mask:0xf bank_mask:0xf
    v_add_f32_dpp v130, v138, v130 row_ror:8 row_mask:0xf bank_mask:0xf
    v_add_f32_dpp v131, v139, v131 row_ror:8 row_mask:0xf bank_mask:0xf
    v_add_f32_dpp v132, v140, v132 row_ror:8 row_mask:0xf bank_mask:0xf
    v_add_f32_dpp v133, v141, v133 row_ror:8 row_mask:0xf bank_mask:0xf
    v_add_f32_dpp v134, v142, v134 row_ror:8 row_mask:0xf bank_mask:0xf
    v_add_f32_dpp v135, v143, v135 row_ror:8 row_mask:0xf bank_mask:0xf
    ds_write_b128 v30, v[128:131] offset:0
    ds_write_b128 v30, v[132:135] offset:64
    s_waitcnt lgkmcnt(0)
    s_barrier
    ds_read_b64 v[40:41], v31 offset:0
    ds_read_b64 v[42:43], v31 offset:2304
    ds_read_b64 v[44:45], v31 offset:4608
    ds_read_b64 v[46:47], v31 offset:6912
    s_waitcnt vmcnt(20)
    v_lshlrev_b32 v48, 16, v24
    v_and_b32 v49, 0xffff0000, v24
    v_lshlrev_b32 v50, 16, v22
    v_and_b32 v51, 0xffff0000, v22
    s_waitcnt lgkmcnt(0)
    v_add_f32 v40, v40, v42
    v_add_f32 v44, v44, v46
    v_add_f32 v41, v41, v43
    v_add_f32 v45, v45, v47
    v_add_f32 v40, v40, v44
    v_add_f32 v41, v41, v45
    v_cvt_pk_bf16_f32 v40, v40, v41
    v_and_b32 v41, 0xffff0000, v40
    v_lshlrev_b32 v40, 16, v40
    v_add_f32 v40, v40, v48
    v_add_f32 v41, v41, v49
    v_cvt_pk_bf16_f32 v40, v40, v41
    v_and_b32 v41, 0xffff0000, v40
    v_lshlrev_b32 v40, 16, v40
    v_add_f32 v40, v40, v50
    v_add_f32 v41, v41, v51
    v_cvt_pk_bf16_f32 v40, v40, v41
    buffer_store_dword v40, v29, s[80:83], s69 offen sc0 sc1 nt
    s_branch wo_seg1
wo_drainf0:
    s_waitcnt vmcnt(18)
    v_mfma_f32_16x16x32_bf16 v[128:131], a[0:3], v[64:67], 0
    v_mfma_f32_16x16x32_bf16 v[132:135], a[4:7], v[64:67], 0
    v_mfma_f32_16x16x32_bf16 v[136:139], a[8:11], v[64:67], 0
    v_mfma_f32_16x16x32_bf16 v[140:143], a[12:15], v[64:67], 0
    s_waitcnt vmcnt(17)
    v_mfma_f32_16x16x32_bf16 v[128:131], a[16:19], v[68:71], v[128:131]
    v_mfma_f32_16x16x32_bf16 v[132:135], a[20:23], v[68:71], v[132:135]
    v_mfma_f32_16x16x32_bf16 v[136:139], a[24:27], v[68:71], v[136:139]
    v_mfma_f32_16x16x32_bf16 v[140:143], a[28:31], v[68:71], v[140:143]
    s_waitcnt vmcnt(16)
    v_mfma_f32_16x16x32_bf16 v[128:131], a[32:35], v[72:75], v[128:131]
    v_mfma_f32_16x16x32_bf16 v[132:135], a[36:39], v[72:75], v[132:135]
    v_mfma_f32_16x16x32_bf16 v[136:139], a[40:43], v[72:75], v[136:139]
    v_mfma_f32_16x16x32_bf16 v[140:143], a[44:47], v[72:75], v[140:143]
    s_waitcnt vmcnt(15)
    v_mfma_f32_16x16x32_bf16 v[128:131], a[48:51], v[76:79], v[128:131]
    v_mfma_f32_16x16x32_bf16 v[132:135], a[52:55], v[76:79], v[132:135]
    v_mfma_f32_16x16x32_bf16 v[136:139], a[56:59], v[76:79], v[136:139]
    v_mfma_f32_16x16x32_bf16 v[140:143], a[60:63], v[76:79], v[140:143]
    s_waitcnt vmcnt(14)
    v_mfma_f32_16x16x32_bf16 v[128:131], a[64:67], v[80:83], v[128:131]
    v_mfma_f32_16x16x32_bf16 v[132:135], a[68:71], v[80:83], v[132:135]
    v_mfma_f32_16x16x32_bf16 v[136:139], a[72:75], v[80:83], v[136:139]
    v_mfma_f32_16x16x32_bf16 v[140:143], a[76:79], v[80:83], v[140:143]
    s_waitcnt vmcnt(13)
    v_mfma_f32_16x16x32_bf16 v[128:131], a[80:83], v[84:87], v[128:131]
    v_mfma_f32_16x16x32_bf16 v[132:135], a[84:87], v[84:87], v[132:135]
    v_mfma_f32_16x16x32_bf16 v[136:139], a[88:91], v[84:87], v[136:139]
    v_mfma_f32_16x16x32_bf16 v[140:143], a[92:95], v[84:87], v[140:143]
    s_waitcnt vmcnt(12)
    v_mfma_f32_16x16x32_bf16 v[128:131], a[96:99], v[88:91], v[128:131]
    v_mfma_f32_16x16x32_bf16 v[132:135], a[100:103], v[88:91], v[132:135]
    v_mfma_f32_16x16x32_bf16 v[136:139], a[104:107], v[88:91], v[136:139]
    v_mfma_f32_16x16x32_bf16 v[140:143], a[108:111], v[88:91], v[140:143]
    s_waitcnt vmcnt(11)
    v_mfma_f32_16x16x32_bf16 v[128:131], a[112:115], v[92:95], v[128:131]
    v_mfma_f32_16x16x32_bf16 v[132:135], a[116:119], v[92:95], v[132:135]
    v_mfma_f32_16x16x32_bf16 v[136:139], a[120:123], v[92:95], v[136:139]
    v_mfma_f32_16x16x32_bf16 v[140:143], a[124:127], v[92:95], v[140:143]
    s_waitcnt vmcnt(10)
    v_mfma_f32_16x16x32_bf16 v[128:131], a[128:131], v[96:99], v[128:131]
    v_mfma_f32_16x16x32_bf16 v[132:135], a[132:135], v[96:99], v[132:135]
    v_mfma_f32_16x16x32_bf16 v[136:139], a[136:139], v[96:99], v[136:139]
    v_mfma_f32_16x16x32_bf16 v[140:143], a[140:143], v[96:99], v[140:143]
    s_waitcnt vmcnt(9)
    v_mfma_f32_16x16x32_bf16 v[128:131], a[144:147], v[100:103], v[128:131]
    v_mfma_f32_16x16x32_bf16 v[132:135], a[148:151], v[100:103], v[132:135]
    v_mfma_f32_16x16x32_bf16 v[136:139], a[152:155], v[100:103], v[136:139]
    v_mfma_f32_16x16x32_bf16 v[140:143], a[156:159], v[100:103], v[140:143]
    s_waitcnt vmcnt(8)
    v_mfma_f32_16x16x32_bf16 v[128:131], a[160:163], v[104:107], v[128:131]
    v_mfma_f32_16x16x32_bf16 v[132:135], a[164:167], v[104:107], v[132:135]
    v_mfma_f32_16x16x32_bf16 v[136:139], a[168:171], v[104:107], v[136:139]
    v_mfma_f32_16x16x32_bf16 v[140:143], a[172:175], v[104:107], v[140:143]
    s_waitcnt vmcnt(7)
    v_mfma_f32_16x16x32_bf16 v[128:131], a[176:179], v[108:111], v[128:131]
    v_mfma_f32_16x16x32_bf16 v[132:135], a[180:183], v[108:111], v[132:135]
    v_mfma_f32_16x16x32_bf16 v[136:139], a[184:187], v[108:111], v[136:139]
    v_mfma_f32_16x16x32_bf16 v[140:143], a[188:191], v[108:111], v[140:143]
    s_waitcnt vmcnt(6)
    v_mfma_f32_16x16x32_bf16 v[128:131], a[192:195], v[112:115], v[128:131]
    v_mfma_f32_16x16x32_bf16 v[132:135], a[196:199], v[112:115], v[132:135]
    v_mfma_f32_16x16x32_bf16 v[136:139], a[200:203], v[112:115], v[136:139]
    v_mfma_f32_16x16x32_bf16 v[140:143], a[204:207], v[112:115], v[140:143]
    s_waitcnt vmcnt(5)
    v_mfma_f32_16x16x32_bf16 v[128:131], a[208:211], v[116:119], v[128:131]
    v_mfma_f32_16x16x32_bf16 v[132:135], a[212:215], v[116:119], v[132:135]
    v_mfma_f32_16x16x32_bf16 v[136:139], a[216:219], v[116:119], v[136:139]
    v_mfma_f32_16x16x32_bf16 v[140:143], a[220:223], v[116:119], v[140:143]
    s_waitcnt vmcnt(4)
    v_mfma_f32_16x16x32_bf16 v[128:131], a[224:227], v[120:123], v[128:131]
    v_mfma_f32_16x16x32_bf16 v[132:135], a[228:231], v[120:123], v[132:135]
    v_mfma_f32_16x16x32_bf16 v[136:139], a[232:235], v[120:123], v[136:139]
    v_mfma_f32_16x16x32_bf16 v[140:143], a[236:239], v[120:123], v[140:143]
    s_waitcnt vmcnt(3)
    v_mfma_f32_16x16x32_bf16 v[128:131], a[240:243], v[124:127], v[128:131]
    v_mfma_f32_16x16x32_bf16 v[132:135], a[244:247], v[124:127], v[132:135]
    v_mfma_f32_16x16x32_bf16 v[136:139], a[248:251], v[124:127], v[136:139]
    v_mfma_f32_16x16x32_bf16 v[140:143], a[252:255], v[124:127], v[140:143]
    s_nop 3
    v_add_f32_dpp v128, v136, v128 row_ror:8 row_mask:0xf bank_mask:0xf
    v_add_f32_dpp v129, v137, v129 row_ror:8 row_mask:0xf bank_mask:0xf
    v_add_f32_dpp v130, v138, v130 row_ror:8 row_mask:0xf bank_mask:0xf
    v_add_f32_dpp v131, v139, v131 row_ror:8 row_mask:0xf bank_mask:0xf
    v_add_f32_dpp v132, v140, v132 row_ror:8 row_mask:0xf bank_mask:0xf
    v_add_f32_dpp v133, v141, v133 row_ror:8 row_mask:0xf bank_mask:0xf
    v_add_f32_dpp v134, v142, v134 row_ror:8 row_mask:0xf bank_mask:0xf
    v_add_f32_dpp v135, v143, v135 row_ror:8 row_mask:0xf bank_mask:0xf
    ds_write_b128 v30, v[128:131] offset:0
    ds_write_b128 v30, v[132:135] offset:64
    s_waitcnt lgkmcnt(0)
    s_barrier
    ds_read_b64 v[40:41], v31 offset:0
    ds_read_b64 v[42:43], v31 offset:2304
    ds_read_b64 v[44:45], v31 offset:4608
    ds_read_b64 v[46:47], v31 offset:6912
    s_waitcnt vmcnt(1)
    v_lshlrev_b32 v48, 16, v24
    v_and_b32 v49, 0xffff0000, v24
    v_lshlrev_b32 v50, 16, v22
    v_and_b32 v51, 0xffff0000, v22
    s_waitcnt lgkmcnt(0)
    v_add_f32 v40, v40, v42
    v_add_f32 v44, v44, v46
    v_add_f32 v41, v41, v43
    v_add_f32 v45, v45, v47
    v_add_f32 v40, v40, v44
    v_add_f32 v41, v41, v45
    v_cvt_pk_bf16_f32 v40, v40, v41
    v_and_b32 v41, 0xffff0000, v40
    v_lshlrev_b32 v40, 16, v40
    v_add_f32 v40, v40, v48
    v_add_f32 v41, v41, v49
    v_cvt_pk_bf16_f32 v40, v40, v41
    v_and_b32 v41, 0xffff0000, v40
    v_lshlrev_b32 v40, 16, v40
    v_add_f32 v40, v40, v50
    v_add_f32 v41, v41, v51
    v_cvt_pk_bf16_f32 v40, v40, v41
    s_branch wo_next0
wo_last:
    s_lshl_b32 s66, s60, 8
    s_lshl_b32 s67, s60, 16
    s_lshl_b32 s65, s60, 18
    s_min_u32 s71, s66, 16128
    s_xor_b32 s71, s71, s45
    s_mov_b32 s68, 0x100000
oflag_52:
    buffer_load_dword v13, v27, s[4:7], s71 offen sc1
    s_waitcnt vmcnt(0)
    v_cmp_gt_u32 vcc, 1, v13
    s_cbranch_vccz oflag_52_ok
    s_sub_u32 s68, s68, 1
    s_cmp_lg_u32 s68, 0
    s_cbranch_scc1 oflag_52
oflag_52_ok:
    buffer_load_dwordx4 v[64:67], v26, s[4:7], s65 offen sc1
    s_add_u32 s65, s65, 4096
    buffer_load_dwordx4 v[68:71], v26, s[4:7], s65 offen sc1
    s_add_u32 s65, s65, 4096
    buffer_load_dwordx4 v[72:75], v26, s[4:7], s65 offen sc1
    s_add_u32 s65, s65, 4096
    buffer_load_dwordx4 v[76:79], v26, s[4:7], s65 offen sc1
    s_add_u32 s65, s65, 4096
    buffer_load_dwordx4 v[80:83], v26, s[4:7], s65 offen sc1
    s_add_u32 s65, s65, 4096
    buffer_load_dwordx4 v[84:87], v26, s[4:7], s65 offen sc1
    s_add_u32 s65, s65, 4096
    buffer_load_dwordx4 v[88:91], v26, s[4:7], s65 offen sc1
    s_add_u32 s65, s65, 4096
    buffer_load_dwordx4 v[92:95], v26, s[4:7], s65 offen sc1
    s_add_u32 s65, s65, 4096
    buffer_load_dwordx4 v[96:99], v26, s[4:7], s65 offen sc1
    s_add_u32 s65, s65, 4096
    buffer_load_dwordx4 v[100:103], v26, s[4:7], s65 offen sc1
    s_add_u32 s65, s65, 4096
    buffer_load_dwordx4 v[104:107], v26, s[4:7], s65 offen sc1
    s_add_u32 s65, s65, 4096
    buffer_load_dwordx4 v[108:111], v26, s[4:7], s65 offen sc1
    s_add_u32 s65, s65, 4096
    buffer_load_dwordx4 v[112:115], v26, s[4:7], s65 offen sc1
    s_add_u32 s65, s65, 4096
    buffer_load_dwordx4 v[116:119], v26, s[4:7], s65 offen sc1
    s_add_u32 s65, s65, 4096
    buffer_load_dwordx4 v[120:123], v26, s[4:7], s65 offen sc1
    s_add_u32 s65, s65, 4096
    buffer_load_dwordx4 v[124:127], v26, s[4:7], s65 offen sc1
    s_add_u32 s65, s65, 4096
    buffer_load_dword v23, v28, s[4:7], s67 offen sc1
    buffer_load_dword v25, v29, s[76:79], s67 offen
    buffer_store_dword v40, v29, s[80:83], s69 offen sc0 sc1 nt
    s_mov_b32 s69, s67
    s_mov_b32 s60, 64
    s_branch wo_drainf1
wo_end:
    buffer_store_dword v40, v29, s[80:83], s69 offen sc0 sc1 nt
    s_branch WDONE
wo_pair:
    s_mov_b32 s66, 15872
    s_mov_b32 s67, 4063232
    s_mov_b32 s65, 16252928
    v_lshl_add_u32 v27, v240, 8, v27
    v_lshl_add_u32 v28, v240, 16, v28
    v_mul_u32_u24 v13, 1152, v240
    v_add_u32 v31, v13, v31
    v_mul_u32_u24 v13, 260096, v241
    v_add_u32 v26, v13, v26
    v_lshl_add_u32 v243, v240, 8, v243
    s_min_u32 s71, s66, 16128
    s_xor_b32 s71, s71, s45
    s_mov_b32 s68, 0x100000
yflag_53:
    buffer_load_dword v13, v243, s[4:7], s71 offen sc1
    s_waitcnt vmcnt(0)
    v_cmp_gt_u32 vcc, 1, v13
    s_cbranch_vccz yflag_53_ok
    s_sub_u32 s68, s68, 1
    s_cmp_lg_u32 s68, 0
    s_cbranch_scc1 yflag_53
yflag_53_ok:
    buffer_load_dword v22, v28, s[4:7], s67 offen sc1
    buffer_load_dword v24, v242, s[76:79], s67 offen
    buffer_store_dword v40, v29, s[80:83], s69 offen sc0 sc1 nt
    s_mov_b32 s68, 0x100000
wo_again:
wo_probe:
    buffer_load_dword v246, v244, s[4:7], s65 offen sc1
    s_waitcnt vmcnt(0)
    v_cmp_eq_u32 vcc, -1, v246
    s_cbranch_vccz wo_pdata
    s_sub_u32 s68, s68, 1
    s_cmp_gt_i32 s68, 0
    s_cbranch_scc1 wo_probe
wo_pdata:
    buffer_load_dwordx4 v[64:67], v26, s[4:7], s65 offen offset:0 sc1
    buffer_load_dwordx4 v[68:71], v26, s[4:7], s65 offen offset:2048 sc1
    s_add_u32 s65, s65, 4096
    buffer_load_dwordx4 v[72:75], v26, s[4:7], s65 offen offset:0 sc1
    buffer_load_dwordx4 v[76:79], v26, s[4:7], s65 offen offset:2048 sc1
    s_add_u32 s65, s65, 4096
    buffer_load_dwordx4 v[80:83], v26, s[4:7], s65 offen offset:0 sc1
    buffer_load_dwordx4 v[84:87], v26, s[4:7], s65 offen offset:2048 sc1
    s_add_u32 s65, s65, 4096
    buffer_load_dwordx4 v[88:91], v26, s[4:7], s65 offen offset:0 sc1
    buffer_load_dwordx4 v[92:95], v26, s[4:7], s65 offen offset:2048 sc1
    s_add_u32 s65, s65, 4096
    buffer_load_dwordx4 v[96:99], v26, s[4:7], s65 offen offset:0 sc1
    buffer_load_dwordx4 v[100:103], v26, s[4:7], s65 offen offset:2048 sc1
    s_add_u32 s65, s65, 4096
    buffer_load_dwordx4 v[104:107], v26, s[4:7], s65 offen offset:0 sc1
    buffer_load_dwordx4 v[108:111], v26, s[4:7], s65 offen offset:2048 sc1
    s_add_u32 s65, s65, 4096
    buffer_load_dwordx4 v[112:115], v26, s[4:7], s65 offen offset:0 sc1
    buffer_load_dwordx4 v[116:119], v26, s[4:7], s65 offen offset:2048 sc1
    s_add_u32 s65, s65, 4096
    buffer_load_dwordx4 v[120:123], v26, s[4:7], s65 offen offset:0 sc1
    buffer_load_dwordx4 v[124:127], v26, s[4:7], s65 offen offset:2048 sc1
    s_add_u32 s65, s65, 4096
    s_waitcnt vmcnt(15)
    v_mfma_f32_16x16x32_bf16 v[128:131], a[0:3], v[64:67], 0
    v_max_u32 v245, v64, v65
    buffer_load_dwordx4 v[144:147], v26, s[4:7], s65 offen offset:0 sc1
    v_mfma_f32_16x16x32_bf16 v[132:135], a[4:7], v[64:67], 0
    v_max3_u32 v245, v245, v66, v67
    s_waitcnt vmcnt(15)
    v_mfma_f32_16x16x32_bf16 v[128:131], a[8:11], v[68:71], v[128:131]
    v_max3_u32 v245, v245, v68, v69
    buffer_load_dwordx4 v[148:151], v26, s[4:7], s65 offen offset:2048 sc1
    s_add_u32 s65, s65, 4096
    v_mfma_f32_16x16x32_bf16 v[132:135], a[12:15], v[68:71], v[132:135]
    v_max3_u32 v245, v245, v70, v71
    s_waitcnt vmcnt(15)
    v_mfma_f32_16x16x32_bf16 v[128:131], a[16:19], v[72:75], v[128:131]
    v_max3_u32 v245, v245, v72, v73
    buffer_load_dwordx4 v[152:155], v26, s[4:7], s65 offen offset:0 sc1
    v_mfma_f32_16x16x32_bf16 v[132:135], a[20:23], v[72:75], v[132:135]
    v_max3_u32 v245, v245, v74, v75
    s_waitcnt vmcnt(15)
    v_mfma_f32_16x16x32_bf16 v[128:131], a[24:27], v[76:79], v[128:131]
    v_max3_u32 v245, v245, v76, v77
    buffer_load_dwordx4 v[156:159], v26, s[4:7], s65 offen offset:2048 sc1
    s_add_u32 s65, s65, 4096
    v_mfma_f32_16x16x32_bf16 v[132:135], a[28:31], v[76:79], v[132:135]
    v_max3_u32 v245, v245, v78, v79
    s_waitcnt vmcnt(15)
    v_mfma_f32_16x16x32_bf16 v[128:131], a[32:35], v[80:83], v[128:131]
    v_max3_u32 v245, v245, v80, v81
    buffer_load_dwordx4 v[160:163], v26, s[4:7], s65 offen offset:0 sc1
    v_mfma_f32_16x16x32_bf16 v[132:135], a[36:39], v[80:83], v[132:135]
    v_max3_u32 v245, v245, v82, v83
    s_waitcnt vmcnt(15)
    v_mfma_f32_16x16x32_bf16 v[128:131], a[40:43], v[84:87], v[128:131]
    v_max3_u32 v245, v245, v84, v85
    buffer_load_dwordx4 v[164:167], v26, s[4:7], s65 offen offset:2048 sc1
    s_add_u32 s65, s65, 4096
    v_mfma_f32_16x16x32_bf16 v[132:135], a[44:47], v[84:87], v[132:135]
    v_max3_u32 v245, v245, v86, v87
    s_waitcnt vmcnt(15)
    v_mfma_f32_16x16x32_bf16 v[128:131], a[48:51], v[88:91], v[128:131]
    v_max3_u32 v245, v245, v88, v89
    buffer_load_dwordx4 v[168:171], v26, s[4:7], s65 offen offset:0 sc1
    v_mfma_f32_16x16x32_bf16 v[132:135], a[52:55], v[88:91], v[132:135]
    v_max3_u32 v245, v245, v90, v91
    s_waitcnt vmcnt(15)
    v_mfma_f32_16x16x32_bf16 v[128:131], a[56:59], v[92:95], v[128:131]
    v_max3_u32 v245, v245, v92, v93
    buffer_load_dwordx4 v[172:175], v26, s[4:7], s65 offen offset:2048 sc1
    s_add_u32 s65, s65, 4096
    v_mfma_f32_16x16x32_bf16 v[132:135], a[60:63], v[92:95], v[132:135]
    v_max3_u32 v245, v245, v94, v95
    s_waitcnt vmcnt(15)
    v_mfma_f32_16x16x32_bf16 v[128:131], a[64:67], v[96:99], v[128:131]
    v_max3_u32 v245, v245, v96, v97
    buffer_load_dwordx4 v[176:179], v26, s[4:7], s65 offen offset:0 sc1
    v_mfma_f32_16x16x32_bf16 v[132:135], a[68:71], v[96:99], v[132:135]
    v_max3_u32 v245, v245, v98, v99
    s_waitcnt vmcnt(15)
    v_mfma_f32_16x16x32_bf16 v[128:131], a[72:75], v[100:103], v[128:131]
    v_max3_u32 v245, v245, v100, v101
    buffer_load_dwordx4 v[180:183], v26, s[4:7], s65 offen offset:2048 sc1
    s_add_u32 s65, s65, 4096
    v_mfma_f32_16x16x32_bf16 v[132:135], a[76:79], v[100:103], v[132:135]
    v_max3_u32 v245, v245, v102, v103
    s_waitcnt vmcnt(15)
    v_mfma_f32_16x16x32_bf16 v[128:131], a[80:83], v[104:107], v[128:131]
    v_max3_u32 v245, v245, v104, v105
    buffer_load_dwordx4 v[184:187], v26, s[4:7], s65 offen offset:0 sc1
    v_mfma_f32_16x16x32_bf16 v[132:135], a[84:87], v[104:107], v[132:135]
    v_max3_u32 v245, v245, v106, v107
    s_waitcnt vmcnt(15)
    v_mfma_f32_16x16x32_bf16 v[128:131], a[88:91], v[108:111], v[128:131]
    v_max3_u32 v245, v245, v108, v109
    buffer_load_dwordx4 v[188:191], v26, s[4:7], s65 offen offset:2048 sc1
    s_add_u32 s65, s65, 4096
    v_mfma_f32_16x16x32_bf16 v[132:135], a[92:95], v[108:111], v[132:135]
    v_max3_u32 v245, v245, v110, v111
    s_waitcnt vmcnt(15)
    v_mfma_f32_16x16x32_bf16 v[128:131], a[96:99], v[112:115], v[128:131]
    v_max3_u32 v245, v245, v112, v113
    buffer_load_dwordx4 v[192:195], v26, s[4:7], s65 offen offset:0 sc1
    v_mfma_f32_16x16x32_bf16 v[132:135], a[100:103], v[112:115], v[132:135]
    v_max3_u32 v245, v245, v114, v115
    s_waitcnt vmcnt(15)
    v_mfma_f32_16x16x32_bf16 v[128:131], a[104:107], v[116:119], v[128:131]
    v_max3_u32 v245, v245, v116, v117
    buffer_load_dwordx4 v[196:199], v26, s[4:7], s65 offen offset:2048 sc1
    s_add_u32 s65, s65, 4096
    v_mfma_f32_16x16x32_bf16 v[132:135], a[108:111], v[116:119], v[132:135]
    v_max3_u32 v245, v245, v118, v119
    s_waitcnt vmcnt(15)
    v_mfma_f32_16x16x32_bf16 v[128:131], a[112:115], v[120:123], v[128:131]
    v_max3_u32 v245, v245, v120, v121
    buffer_load_dwordx4 v[200:203], v26, s[4:7], s65 offen offset:0 sc1
    v_mfma_f32_16x16x32_bf16 v[132:135], a[116:119], v[120:123], v[132:135]
    v_max3_u32 v245, v245, v122, v123
    s_waitcnt vmcnt(15)
    v_mfma_f32_16x16x32_bf16 v[128:131], a[120:123], v[124:127], v[128:131]
    v_max3_u32 v245, v245, v124, v125
    buffer_load_dwordx4 v[204:207], v26, s[4:7], s65 offen offset:2048 sc1
    s_mov_b32 s65, 16252928
    v_mfma_f32_16x16x32_bf16 v[132:135], a[124:127], v[124:127], v[132:135]
    v_max3_u32 v245, v245, v126, v127
    s_waitcnt vmcnt(15)
    v_mfma_f32_16x16x32_bf16 v[128:131], a[128:131], v[144:147], v[128:131]
    v_max3_u32 v245, v245, v144, v145
    v_mfma_f32_16x16x32_bf16 v[132:135], a[132:135], v[144:147], v[132:135]
    v_max3_u32 v245, v245, v146, v147
    s_waitcnt vmcnt(14)
    v_mfma_f32_16x16x32_bf16 v[128:131], a[136:139], v[148:151], v[128:131]
    v_max3_u32 v245, v245, v148, v149
    v_mfma_f32_16x16x32_bf16 v[132:135], a[140:143], v[148:151], v[132:135]
    v_max3_u32 v245, v245, v150, v151
    s_waitcnt vmcnt(13)
    v_mfma_f32_16x16x32_bf16 v[128:131], a[144:147], v[152:155], v[128:131]
    v_max3_u32 v245, v245, v152, v153
    v_mfma_f32_16x16x32_bf16 v[132:135], a[148:151], v[152:155], v[132:135]
    v_max3_u32 v245, v245, v154, v155
    s_waitcnt vmcnt(12)
    v_mfma_f32_16x16x32_bf16 v[128:131], a[152:155], v[156:159], v[128:131]
    v_max3_u32 v245, v245, v156, v157
    v_mfma_f32_16x16x32_bf16 v[132:135], a[156:159], v[156:159], v[132:135]
    v_max3_u32 v245, v245, v158, v159
    s_waitcnt vmcnt(11)
    v_mfma_f32_16x16x32_bf16 v[128:131], a[160:163], v[160:163], v[128:131]
    v_max3_u32 v245, v245, v160, v161
    v_mfma_f32_16x16x32_bf16 v[132:135], a[164:167], v[160:163], v[132:135]
    v_max3_u32 v245, v245, v162, v163
    s_waitcnt vmcnt(10)
    v_mfma_f32_16x16x32_bf16 v[128:131], a[168:171], v[164:167], v[128:131]
    v_max3_u32 v245, v245, v164, v165
    v_mfma_f32_16x16x32_bf16 v[132:135], a[172:175], v[164:167], v[132:135]
    v_max3_u32 v245, v245, v166, v167
    s_waitcnt vmcnt(9)
    v_mfma_f32_16x16x32_bf16 v[128:131], a[176:179], v[168:171], v[128:131]
    v_max3_u32 v245, v245, v168, v169
    v_mfma_f32_16x16x32_bf16 v[132:135], a[180:183], v[168:171], v[132:135]
    v_max3_u32 v245, v245, v170, v171
    s_waitcnt vmcnt(8)
    v_mfma_f32_16x16x32_bf16 v[128:131], a[184:187], v[172:175], v[128:131]
    v_max3_u32 v245, v245, v172, v173
    v_mfma_f32_16x16x32_bf16 v[132:135], a[188:191], v[172:175], v[132:135]
    v_max3_u32 v245, v245, v174, v175
    s_waitcnt vmcnt(7)
    v_mfma_f32_16x16x32_bf16 v[128:131], a[192:195], v[176:179], v[128:131]
    v_max3_u32 v245, v245, v176, v177
    v_mfma_f32_16x16x32_bf16 v[132:135], a[196:199], v[176:179], v[132:135]
    v_max3_u32 v245, v245, v178, v179
    s_waitcnt vmcnt(6)
    v_mfma_f32_16x16x32_bf16 v[128:131], a[200:203], v[180:183], v[128:131]
    v_max3_u32 v245, v245, v180, v181
    v_mfma_f32_16x16x32_bf16 v[132:135], a[204:207], v[180:183], v[132:135]
    v_max3_u32 v245, v245, v182, v183
    s_waitcnt vmcnt(5)
    v_mfma_f32_16x16x32_bf16 v[128:131], a[208:211], v[184:187], v[128:131]
    v_max3_u32 v245, v245, v184, v185
    v_mfma_f32_16x16x32_bf16 v[132:135], a[212:215], v[184:187], v[132:135]
    v_max3_u32 v245, v245, v186, v187
    s_waitcnt vmcnt(4)
    v_mfma_f32_16x16x32_bf16 v[128:131], a[216:219], v[188:191], v[128:131]
    v_max3_u32 v245, v245, v188, v189
    v_mfma_f32_16x16x32_bf16 v[132:135], a[220:223], v[188:191], v[132:135]
    v_max3_u32 v245, v245, v190, v191
    s_waitcnt vmcnt(3)
    v_mfma_f32_16x16x32_bf16 v[128:131], a[224:227], v[192:195], v[128:131]
    v_max3_u32 v245, v245, v192, v193
    v_mfma_f32_16x16x32_bf16 v[132:135], a[228:231], v[192:195], v[132:135]
    v_max3_u32 v245, v245, v194, v195
    s_waitcnt vmcnt(2)
    v_mfma_f32_16x16x32_bf16 v[128:131], a[232:235], v[196:199], v[128:131]
    v_max3_u32 v245, v245, v196, v197
    v_mfma_f32_16x16x32_bf16 v[132:135], a[236:239], v[196:199], v[132:135]
    v_max3_u32 v245, v245, v198, v199
    s_waitcnt vmcnt(1)
    v_mfma_f32_16x16x32_bf16 v[128:131], a[240:243], v[200:203], v[128:131]
    v_max3_u32 v245, v245, v200, v201
    v_mfma_f32_16x16x32_bf16 v[132:135], a[244:247], v[200:203], v[132:135]
    v_max3_u32 v245, v245, v202, v203
    s_waitcnt vmcnt(0)
    v_mfma_f32_16x16x32_bf16 v[128:131], a[248:251], v[204:207], v[128:131]
    v_max3_u32 v245, v245, v204, v205
    v_mfma_f32_16x16x32_bf16 v[132:135], a[252:255], v[204:207], v[132:135]
    v_max3_u32 v245, v245, v206, v207
    v_cmp_eq_u32 vcc, -1, v245
    s_cbranch_vccz wo_pfin
    s_sub_u32 s68, s68, 1
    s_cmp_gt_i32 s68, 0
    s_cbranch_scc1 wo_again
wo_pfin:
    s_nop 0
    ds_write_b128 v30, v[128:131] offset:0
    s_nop 2
    ds_write_b128 v30, v[132:135] offset:64
    s_waitcnt lgkmcnt(0)
    s_barrier
    ds_read_b64 v[40:41], v31 offset:0
    ds_read_b64 v[42:43], v31 offset:2304
    ds_read_b64 v[44:45], v31 offset:4608
    ds_read_b64 v[46:47], v31 offset:6912
    v_lshlrev_b32 v48, 16, v24
    v_and_b32 v49, 0xffff0000, v24
    v_lshlrev_b32 v50, 16, v22
    v_and_b32 v51, 0xffff0000, v22
    s_waitcnt lgkmcnt(0)
    v_add_f32 v40, v40, v42
    v_add_f32 v44, v44, v46
    v_add_f32 v41, v41, v43
    v_add_f32 v45, v45, v47
    v_add_f32 v40, v40, v44
    v_add_f32 v41, v41, v45
    v_cvt_pk_bf16_f32 v40, v40, v41
    v_and_b32 v41, 0xffff0000, v40
    v_lshlrev_b32 v40, 16, v40
    v_add_f32 v40, v40, v48
    v_add_f32 v41, v41, v49
    v_cvt_pk_bf16_f32 v40, v40, v41
    v_and_b32 v41, 0xffff0000, v40
    v_lshlrev_b32 v40, 16, v40
    v_add_f32 v40, v40, v50
    v_add_f32 v41, v41, v51
    v_cvt_pk_bf16_f32 v40, v40, v41
    buffer_store_dword v40, v242, s[80:83], s67 offen sc0 sc1 nt
    s_branch WDONE
WDONE:
EXIT:
    s_endpgm
.section .rodata,"a"
.p2align 6
.amdhsa_kernel parallel_sum__memory_aug_recurrent_mem_tr__dense_activation_silu__prompt_kernel
  .amdhsa_next_free_vgpr 512
  .amdhsa_next_free_sgpr 102
  .amdhsa_accum_offset 256
  .amdhsa_group_segment_fixed_size 0
  .amdhsa_kernarg_size 104
  .amdhsa_user_sgpr_count 2
  .amdhsa_user_sgpr_kernarg_segment_ptr 1
  .amdhsa_system_sgpr_workgroup_id_x 1
.end_amdhsa_kernel
```
